```python
import torch

def _softmax(x, axis=-1):
    return torch.softmax(x, dim=axis)

def _gelu(x):
    return torch.nn.functional.gelu(x, approximate='tanh')

def _silu(x):
    return torch.nn.functional.silu(x)

def _sigmoid(x):
    return torch.sigmoid(x)

def _layernorm(x, axis=-1, eps=1e-05):
    m = x.mean(dim=axis, keepdim=True)
    v = x.var(dim=axis, keepdim=True, unbiased=False)
    return (x - m) / torch.sqrt(v + eps)

def _scatter_add(tgt, idx, src, axis=0):
    return tgt.clone().index_add_(axis, idx, src)

def _segment_sum(src, seg, n):
    out = torch.zeros((n,) + src.shape[1:], dtype=src.dtype)
    return out.index_add_(0, seg, src)

def _pad(x, pw):
    flat = tuple((v for pair in reversed(pw) for v in pair))
    return torch.nn.functional.pad(x, flat)
kernel_name = 'adaLN_cond__memory_aug_recurrent_mem_tr__mixer_s_mlp__prompt'

def setup_inputs():

    _w = lambda a: (lambda t: t.to(torch.bfloat16) if t.is_floating_point() else t)(torch.as_tensor(a))

    def _A_setup():
        B, S, Dm = (1, 2048, 640)
        H, Dh = (32, 128)
        M, seg = (8, 32)
        seg = min(seg, S)
        S = S // seg * seg
        return {'x': _w((lambda *s: torch.randn(*s, dtype=torch.bfloat16) * 0.05)(B, S, Dm)), 'mem0': _w((lambda *s: torch.randn(*s, dtype=torch.bfloat16) * 0.4)(B, M, Dm)), 'Wq': _w((lambda *s: torch.randn(*s, dtype=torch.bfloat16) * 3.2)(Dm, H, Dh) * Dm ** (-0.5)), 'Wk': _w((lambda *s: torch.randn(*s, dtype=torch.bfloat16) * 3.2)(Dm, H, Dh) * Dm ** (-0.5)), 'Wv': _w((lambda *s: torch.randn(*s, dtype=torch.bfloat16) * 0.4)(Dm, H, Dh) * Dm ** (-0.5)), 'Wo': _w((lambda *s: torch.randn(*s, dtype=torch.bfloat16) * 0.4)(H, Dh, Dm) * (H * Dh) ** (-0.5)), 'seg_len': seg}
    _A_in = _A_setup()

    def _B_setup():
        B, S, D, F = (1, 2048, 640, 1728)
        return {'x': _w((lambda *s: torch.randn(*s, dtype=torch.bfloat16) * 0.05)(B, S, D)), 'w1': _w((lambda *s: torch.randn(*s, dtype=torch.bfloat16) * 3.2)(D, D) * D ** (-0.5)), 'w2': _w((lambda *s: torch.randn(*s, dtype=torch.bfloat16) * 3.2)(D, D) * D ** (-0.5)), 'w3': _w((lambda *s: torch.randn(*s, dtype=torch.bfloat16) * 3.2)(D, F) * D ** (-0.5)), 'w4': _w((lambda *s: torch.randn(*s, dtype=torch.bfloat16) * 3.2)(F, D) * F ** (-0.5))}
    _B_in = _B_setup()
    return {'A_x': _A_in['x'], 'A_mem0': _A_in['mem0'], 'A_Wq': _A_in['Wq'], 'A_Wk': _A_in['Wk'], 'A_Wv': _A_in['Wv'], 'A_Wo': _A_in['Wo'], 'A_seg_len': _A_in['seg_len'], 'B_x': _B_in['x'], 'B_w1': _B_in['w1'], 'B_w2': _B_in['w2'], 'B_w3': _B_in['w3'], 'B_w4': _B_in['w4'], 'c': _w((lambda *s: torch.randn(*s, dtype=torch.bfloat16) * 0.1)(1, 640) * 8.0), 'w_mod': _w((lambda *s: torch.randn(*s, dtype=torch.bfloat16) * 0.1)(640, 6 * 640) * 640 ** (-0.5) * 8.0)}

def reference(A_x, A_mem0, A_Wq, A_Wk, A_Wv, A_Wo, A_seg_len, B_x, B_w1, B_w2, B_w3, B_w4, c, w_mod):

    def _A_ref(x, mem0, Wq, Wk, Wv, Wo, seg_len):
        B, S, Dm = x.shape
        H, Dh = (Wq.shape[1], Wq.shape[2])
        M = mem0.shape[1]
        scale = Dh ** (-0.5)
        n_seg = S // seg_len
        L = M + seg_len
        idx = torch.arange(L)
        mask = (idx[:, None] < M) | (idx[:, None] >= idx[None, :])
        mem = mem0
        outs = []
        for s in range(n_seg):
            xs = x[:, s * seg_len:(s + 1) * seg_len, :].clone()
            h = torch.concatenate([mem, xs], axis=1)
            q = torch.einsum('btd,dhe->bhte', h, Wq)
            k = torch.einsum('btd,dhe->bhte', h, Wk)
            v = torch.einsum('btd,dhe->bhte', h, Wv)
            scores = torch.einsum('bhqe,bhke->bhqk', q, k) * scale
            scores = torch.where(mask[None, None], scores, -1000000000.0)
            p = _softmax(scores, axis=-1)
            o = torch.einsum('bhqk,bhke->bhqe', p, v)
            o = torch.einsum('bhte,hed->btd', o, Wo)
            mem = o[:, :M, :].clone()
            outs.append(o[:, M:, :])
        return torch.concatenate(outs, axis=1)

    def _B_ref(x, w1, w2, w3, w4):
        B, S, D = x.shape
        h = _gelu(_layernorm(x, axis=-1) @ w1)
        c = D // 4
        g0 = _pad(h[:, :, 0 * c:1 * c], ((0, 0), (1, 0), (0, 0)))[:, :S, :]
        g1 = _pad(h[:, :, 1 * c:2 * c], ((0, 0), (0, 1), (0, 0)))[:, 1:, :]
        g2 = _pad(h[:, :, 2 * c:3 * c], ((0, 0), (2, 0), (0, 0)))[:, :S, :]
        g3 = _pad(h[:, :, 3 * c:], ((0, 0), (0, 2), (0, 0)))[:, 2:, :]
        hs = torch.concatenate([g0, g1, g2, g3], axis=-1) @ w2
        x1 = x + hs
        h2 = _gelu(_layernorm(x1, axis=-1) @ w3) @ w4
        return x1 + h2
    x = A_x
    mod = (_silu(c) @ w_mod).reshape(c.shape[0], 6, 1, -1)
    sa, ca, ga, sb, cb, gb = (mod[:, 0].clone(), mod[:, 1].clone(), mod[:, 2].clone(), mod[:, 3].clone(), mod[:, 4].clone(), mod[:, 5].clone())
    h = _layernorm(x, axis=-1) * (1 + ca) + sa
    x = x + ga * _A_ref(h, A_mem0, A_Wq, A_Wk, A_Wv, A_Wo, A_seg_len)
    h = _layernorm(x, axis=-1) * (1 + cb) + sb
    x = x + gb * _B_ref(h, B_w1, B_w2, B_w3, B_w4)
    return x
```

```asm
; @launch grid=(256,1,1) block=(256,1,1) lds=163840
.amdgcn_target "amdgcn-amd-amdhsa--gfx950"
.text
.globl adaLN_cond__memory_aug_recurrent_mem_tr__mixer_s_mlp__prompt_kernel
.type adaLN_cond__memory_aug_recurrent_mem_tr__mixer_s_mlp__prompt_kernel,@function
.p2align 8
adaLN_cond__memory_aug_recurrent_mem_tr__mixer_s_mlp__prompt_kernel:
 s_cmp_ge_u32 s2, 256
 s_cbranch_scc1 adaLN_cond__memory_aug_recurrent_mem_tr__mixer_s_mlp__prompt_kernel_exit
 s_load_dwordx16 s[32:47], s[0:1], 0
 s_load_dwordx16 s[48:63], s[0:1], 64
 s_load_dwordx2 s[64:65], s[0:1], 128
 v_lshrrev_b32 v1, 6, v0
 s_nop 0
 v_readfirstlane_b32 s66, v1
 s_waitcnt lgkmcnt(0)
 s_mov_b32 s8, s64
 s_and_b32 s9, s65, 0xffff
 s_mov_b32 s10, 0x10000000
 s_mov_b32 s11, 0x20000
 s_mov_b32 s28, s62
 s_and_b32 s29, s63, 0xffff
 s_mov_b32 s30, 0x100
 s_mov_b32 s31, 0x20000
 s_mov_b32 s12, s64
 s_and_b32 s13, s65, 0xffff
 s_mov_b32 s14, 0x10000000
 s_mov_b32 s15, 0x20000
 s_mov_b32 s16, s64
 s_and_b32 s17, s65, 0xffff
 s_mov_b32 s18, 0x10000000
 s_mov_b32 s19, 0x20000
 s_mov_b32 s20, s64
 s_and_b32 s21, s65, 0xffff
 s_mov_b32 s22, 0x10000000
 s_mov_b32 s23, 0x20000
 s_mov_b32 s24, s64
 s_and_b32 s25, s65, 0xffff
 s_mov_b32 s26, 0x10000000
 s_mov_b32 s27, 0x20000
 s_getreg_b32 s72, hwreg(HW_REG_XCC_ID, 0, 3)
 v_mov_b32 v2, 0
 s_cmp_lg_u32 s66, 0
 s_cbranch_scc1 arrived_1
 s_and_b32 s74, s72, 1
 s_lshl_b32 s74, s74, 7
 s_lshr_b32 s75, s72, 1
 s_lshl_b32 s75, s75, 5
 s_add_u32 s74, s74, s75
 v_mov_b32 v1, 1
 s_mov_b64 exec, 1
 s_cmp_lt_u32 s72, 2
 s_cbranch_scc1 early_2
 buffer_load_dword v3, v2, s[28:31], 0 offen sc1
 s_waitcnt vmcnt(0)
early_2:
 buffer_atomic_add v1, v2, s[28:31], s74 offen sc0
 s_waitcnt vmcnt(0)
 ds_write_b32 v2, v1
 s_waitcnt lgkmcnt(0)
 s_mov_b64 exec, -1
arrived_1:
 s_barrier
 ds_read_b32 v1, v2
 s_waitcnt lgkmcnt(0)
 v_readfirstlane_b32 s73, v1
 s_barrier
 s_lshl_b32 s71, s72, 8
 s_or_b32 s71, s71, s73
 s_mov_b32 s67, s72
 s_mov_b32 s68, s73
 s_mov_b32 s69, 2
 s_and_b32 s74, s71, 0xfee0
 s_cbranch_scc0 rec_jump
assign:
 s_lshr_b32 s72, s71, 8
 s_and_b32 s73, s71, 0xff
 s_mov_b32 s79, 0
 v_mbcnt_lo_u32_b32 v2, -1, 0
 v_and_b32 v2, 7, v2
 v_lshlrev_b32 v2, 5, v2
 s_cmp_lg_u32 s66, 0
 s_cbranch_scc1 census_wait_5
census_3:
 s_sleep 8
 buffer_load_dword v1, v2, s[28:31], 0 offen sc1
 s_waitcnt vmcnt(0)
 v_readlane_b32 s74, v1, 0
 v_readlane_b32 s75, v1, 1
 s_add_u32 s74, s74, s75
 v_readlane_b32 s75, v1, 2
 s_add_u32 s74, s74, s75
 v_readlane_b32 s75, v1, 3
 s_add_u32 s74, s74, s75
 v_readlane_b32 s75, v1, 4
 s_add_u32 s74, s74, s75
 v_readlane_b32 s75, v1, 5
 s_add_u32 s74, s74, s75
 v_readlane_b32 s75, v1, 6
 s_add_u32 s74, s74, s75
 v_readlane_b32 s75, v1, 7
 s_add_u32 s74, s74, s75
 s_cmp_lt_u32 s74, 256
 s_cbranch_scc0 census_ok_4
 s_add_u32 s79, s79, 1
 s_cmp_lt_u32 s79, 0x40000
 s_cbranch_scc1 census_3
 s_branch adaLN_cond__memory_aug_recurrent_mem_tr__mixer_s_mlp__prompt_kernel_exit
census_ok_4:
 ds_write_b32 v2, v1
 s_waitcnt lgkmcnt(0)
census_wait_5:
 s_barrier
 ds_read_b32 v1, v2
 s_waitcnt lgkmcnt(0)
 v_readlane_b32 s80, v1, 0
 v_readlane_b32 s82, v1, 1
 v_readlane_b32 s84, v1, 2
 v_readlane_b32 s86, v1, 3
 v_readlane_b32 s81, v1, 4
 v_readlane_b32 s83, v1, 5
 v_readlane_b32 s85, v1, 6
 v_readlane_b32 s87, v1, 7
 s_barrier
 s_mov_b32 s77, 8
 s_mov_b32 s78, 8
 s_cmp_ge_u32 s87, 32
 s_cselect_b32 s78, s77, s78
 s_cselect_b32 s77, 7, s77
 s_cmp_ge_u32 s86, 32
 s_cselect_b32 s78, s77, s78
 s_cselect_b32 s77, 6, s77
 s_cmp_ge_u32 s85, 32
 s_cselect_b32 s78, s77, s78
 s_cselect_b32 s77, 5, s77
 s_cmp_ge_u32 s84, 32
 s_cselect_b32 s78, s77, s78
 s_cselect_b32 s77, 4, s77
 s_cmp_ge_u32 s83, 32
 s_cselect_b32 s78, s77, s78
 s_cselect_b32 s77, 3, s77
 s_cmp_ge_u32 s82, 32
 s_cselect_b32 s78, s77, s78
 s_cselect_b32 s77, 2, s77
 s_cmp_ge_u32 s81, 32
 s_cselect_b32 s78, s77, s78
 s_cselect_b32 s77, 1, s77
 s_cmp_ge_u32 s80, 32
 s_cselect_b32 s78, s77, s78
 s_cselect_b32 s77, 0, s77
 s_mov_b32 s74, s73
 s_cmp_gt_u32 s72, 0
 s_cselect_b32 s75, s80, 0
 s_add_u32 s74, s74, s75
 s_cmp_gt_u32 s72, 1
 s_cselect_b32 s75, s81, 0
 s_add_u32 s74, s74, s75
 s_cmp_gt_u32 s72, 2
 s_cselect_b32 s75, s82, 0
 s_add_u32 s74, s74, s75
 s_cmp_gt_u32 s72, 3
 s_cselect_b32 s75, s83, 0
 s_add_u32 s74, s74, s75
 s_cmp_gt_u32 s72, 4
 s_cselect_b32 s75, s84, 0
 s_add_u32 s74, s74, s75
 s_cmp_gt_u32 s72, 5
 s_cselect_b32 s75, s85, 0
 s_add_u32 s74, s74, s75
 s_cmp_gt_u32 s72, 6
 s_cselect_b32 s75, s86, 0
 s_add_u32 s74, s74, s75
 s_cmp_ge_u32 s78, 8
 s_cbranch_scc1 slowmap_6
 s_mov_b32 s69, 1
 s_mov_b32 s68, s73
 s_cmp_ge_u32 s73, 32
 s_cbranch_scc1 notteam_7
 s_mov_b32 s67, 0
 s_cmp_eq_u32 s72, s77
 s_cbranch_scc1 rec_jump
 s_mov_b32 s67, 1
 s_cmp_eq_u32 s72, s78
 s_cbranch_scc1 rec_jump
notteam_7:
 s_cmp_ge_u32 s72, s77
 s_cselect_b32 s75, 32, 0
 s_sub_u32 s74, s74, s75
 s_cmp_ge_u32 s72, s78
 s_cselect_b32 s75, 32, 0
 s_sub_u32 s70, s74, s75
 s_branch worker
slowmap_6:
 s_mov_b32 s69, 0
 s_and_b32 s68, s74, 31
 s_lshr_b32 s67, s74, 5
 s_cmp_lt_u32 s74, 64
 s_cbranch_scc1 rec_jump
 s_sub_u32 s70, s74, 64
 s_branch worker
rec_jump:
 s_branch rec_role
reassign:
 s_barrier
 v_mbcnt_lo_u32_b32 v0, -1, 0
 v_mbcnt_hi_u32_b32 v0, -1, v0
 s_lshl_b32 s72, s66, 6
 v_add_u32 v0, s72, v0
 s_branch assign
adaLN_cond__memory_aug_recurrent_mem_tr__mixer_s_mlp__prompt_kernel_exit:
 s_endpgm
worker:
 v_and_b32 v0, 63, v0
 v_lshlrev_b32 v1, 4, v0
 s_mov_b32 s72, 0
 s_mul_i32 s73, s70, 12288
 s_lshl_b32 s74, s66, 10
 s_add_u32 s73, s73, s74
 s_add_u32 s73, s73, 0x40000
 v_mov_b32 v12, -1
 v_mov_b32 v8, 0
 v_mov_b32 v13, -1
 v_mov_b32 v9, 0
 v_mov_b32 v14, -1
 v_mov_b32 v10, 0
 v_mov_b32 v15, -1
 v_mov_b32 v11, 0
 s_cmp_lt_u32 s73, 0x240000
 s_cselect_b32 s75, s73, 0x40000000
 buffer_store_dwordx4 v[12:15], v1, s[8:11], s75 offen sc1
 s_add_u32 s73, s73, 4096
 s_cmp_lt_u32 s73, 0x240000
 s_cselect_b32 s75, s73, 0x40000000
 buffer_store_dwordx4 v[12:15], v1, s[8:11], s75 offen sc1
 s_add_u32 s73, s73, 4096
 s_cmp_lt_u32 s73, 0x240000
 s_cselect_b32 s75, s73, 0x40000000
 buffer_store_dwordx4 v[12:15], v1, s[8:11], s75 offen sc1
 s_add_u32 s73, s73, 4096
 s_lshl_b32 s73, s70, 12
 s_add_u32 s73, s73, s74
 s_cmp_lt_u32 s73, 0x16c00
 s_cselect_b32 s75, s73, 0x40000000
 buffer_store_dwordx4 v[8:11], v1, s[8:11], s75 offen sc1
 s_sub_u32 s75, s73, 0x20000
 s_cmp_lt_u32 s75, 0x3c00
 s_cselect_b32 s75, s73, 0x40000000
 buffer_store_dwordx4 v[12:15], v1, s[8:11], s75 offen sc1
 s_mul_i32 s6, s70, 171
 s_lshr_b32 s6, s6, 9
 s_mul_i32 s73, s6, 3
 s_sub_u32 s73, s70, s73
 s_cmp_lt_u32 s73, 2
 s_cbranch_scc1 h_worker
 s_mul_i32 s6, s6, 21
 s_and_b32 s6, s6, 63
 s_mov_b32 s12, s58
 s_and_b32 s13, s59, 0xffff
 s_mov_b32 s14, 0x4b0000
 s_mov_b32 s15, 0x20000
 s_mov_b32 s16, s56
 s_and_b32 s17, s57, 0xffff
 s_mov_b32 s18, 0x500
 s_mov_b32 s19, 0x20000
 v_lshrrev_b32 v4, 3, v0
 v_mul_u32_u24 v4, 7680, v4
 v_and_b32 v5, 7, v0
 v_lshl_add_u32 v4, v5, 4, v4
 s_lshl_b32 s77, s6, 7
 s_mul_i32 s73, s66, 1228800
 s_add_u32 s77, s77, s73
 s_cmp_lt_u32 s6, 60
 s_cselect_b32 s77, s77, 0x40000000
 s_lshl_b32 s73, s66, 7
 v_lshl_add_u32 v19, v0, 1, s73
 buffer_load_ushort v16, v19, s[16:19], 0 offen offset:0
 buffer_load_ushort v17, v19, s[16:19], 0 offen offset:512
 buffer_load_ushort v18, v19, s[16:19], 0 offen offset:1024
 s_add_u32 s73, s77, 0
 buffer_load_dwordx4 v[96:99], v4, s[12:15], s73 offen nt
 s_add_u32 s73, s77, 61440
 buffer_load_dwordx4 v[100:103], v4, s[12:15], s73 offen nt
 s_add_u32 s73, s77, 122880
 buffer_load_dwordx4 v[104:107], v4, s[12:15], s73 offen nt
 s_add_u32 s73, s77, 184320
 buffer_load_dwordx4 v[108:111], v4, s[12:15], s73 offen nt
 s_add_u32 s73, s77, 245760
 buffer_load_dwordx4 v[112:115], v4, s[12:15], s73 offen nt
 s_add_u32 s73, s77, 307200
 buffer_load_dwordx4 v[116:119], v4, s[12:15], s73 offen nt
 s_add_u32 s73, s77, 368640
 buffer_load_dwordx4 v[120:123], v4, s[12:15], s73 offen nt
 s_add_u32 s73, s77, 430080
 buffer_load_dwordx4 v[124:127], v4, s[12:15], s73 offen nt
 s_add_u32 s73, s77, 491520
 buffer_load_dwordx4 v[128:131], v4, s[12:15], s73 offen nt
 s_add_u32 s73, s77, 552960
 buffer_load_dwordx4 v[132:135], v4, s[12:15], s73 offen nt
 s_add_u32 s73, s77, 614400
 buffer_load_dwordx4 v[136:139], v4, s[12:15], s73 offen nt
 s_add_u32 s73, s77, 675840
 buffer_load_dwordx4 v[140:143], v4, s[12:15], s73 offen nt
 s_add_u32 s73, s77, 737280
 buffer_load_dwordx4 v[144:147], v4, s[12:15], s73 offen nt
 s_add_u32 s73, s77, 798720
 buffer_load_dwordx4 v[148:151], v4, s[12:15], s73 offen nt
 s_add_u32 s73, s77, 860160
 buffer_load_dwordx4 v[152:155], v4, s[12:15], s73 offen nt
 s_add_u32 s73, s77, 921600
 buffer_load_dwordx4 v[156:159], v4, s[12:15], s73 offen nt
 s_add_u32 s73, s77, 983040
 buffer_load_dwordx4 v[160:163], v4, s[12:15], s73 offen nt
 s_add_u32 s73, s77, 1044480
 buffer_load_dwordx4 v[164:167], v4, s[12:15], s73 offen nt
 s_add_u32 s73, s77, 1105920
 buffer_load_dwordx4 v[168:171], v4, s[12:15], s73 offen nt
 s_add_u32 s73, s77, 1167360
 buffer_load_dwordx4 v[172:175], v4, s[12:15], s73 offen nt
 s_waitcnt vmcnt(23)
 s_barrier
 s_cmp_lg_u32 s66, 0
 s_cbranch_scc1 notw0_8
 s_and_b32 s73, s70, 7
 s_lshl_b32 s73, s73, 5
 s_add_u32 s73, s73, 4
 v_mov_b32 v2, 1
 v_mov_b32 v3, 0
 s_mov_b64 exec, 1
 buffer_atomic_add v2, v3, s[28:31], s73 offen
 s_mov_b64 exec, -1
notw0_8:
 s_waitcnt vmcnt(0)
 v_and_b32 v2, 15, v0
 v_lshrrev_b32 v3, 4, v0
 s_lshl_b32 s73, s66, 12
 s_add_u32 s73, s73, 2048
 v_add_u32 v90, s73, v1
 v_lshl_add_u32 v91, v2, 2, s73
 v_lshl_add_u32 v91, v3, 9, v91
 v_add_u32 v92, 2048, v91
 v_lshlrev_b32 v16, 16, v16
 v_mul_f32 v20, 0xbfb8aa3b, v16
 v_exp_f32 v20, v20
 s_nop 0
 v_add_f32 v20, 1.0, v20
 v_rcp_f32 v20, v20
 s_nop 0
 v_mul_f32 v16, v16, v20
 v_cvt_pk_bf16_f32 v16, v16, v16
 ds_write_b16 v19, v16 offset:0
 v_lshlrev_b32 v17, 16, v17
 v_mul_f32 v21, 0xbfb8aa3b, v17
 v_exp_f32 v21, v21
 s_nop 0
 v_add_f32 v21, 1.0, v21
 v_rcp_f32 v21, v21
 s_nop 0
 v_mul_f32 v17, v17, v21
 v_cvt_pk_bf16_f32 v17, v17, v17
 ds_write_b16 v19, v17 offset:512
 v_lshlrev_b32 v18, 16, v18
 v_mul_f32 v22, 0xbfb8aa3b, v18
 v_exp_f32 v22, v22
 s_nop 0
 v_add_f32 v22, 1.0, v22
 v_rcp_f32 v22, v22
 s_nop 0
 v_mul_f32 v18, v18, v22
 v_cvt_pk_bf16_f32 v18, v18, v18
 ds_write_b16 v19, v18 offset:1024
 v_bfe_u32 v6, v0, 3, 1
 v_mul_u32_u24 v6, 0x5555, v6
 v_add_u32 v6, 0x8888, v6
 s_mul_i32 s73, s66, 320
 v_lshl_add_u32 v7, v3, 4, s73
 v_lshrrev_b32 v3, 1, v3
 v_lshl_add_u32 v2, v2, 1, v3
 v_lshlrev_b32 v93, 2, v2
 s_lshl_b32 s73, s66, 2
 v_add_u32 v94, s73, v1
 v_mov_b64 v[24:25], 0
 v_mov_b64 v[26:27], 0
 v_mov_b64 v[28:29], 0
 v_mov_b64 v[30:31], 0
 s_waitcnt lgkmcnt(0)
 s_barrier
 ds_write_b128 v90, v[96:99] offset:0
 ds_write_b128 v90, v[100:103] offset:1024
 ds_write_b128 v90, v[104:107] offset:2048
 ds_write_b128 v90, v[108:111] offset:3072
 ds_read2_b32 v[96:97], v91 offset0:0 offset1:32
 ds_read2_b32 v[98:99], v91 offset0:64 offset1:96
 ds_read2_b32 v[100:101], v92 offset0:0 offset1:32
 ds_read2_b32 v[102:103], v92 offset0:64 offset1:96
 ds_read2_b32 v[104:105], v91 offset0:16 offset1:48
 ds_read2_b32 v[106:107], v91 offset0:80 offset1:112
 ds_read2_b32 v[108:109], v92 offset0:16 offset1:48
 ds_read2_b32 v[110:111], v92 offset0:80 offset1:112
 ds_read_b128 v[12:15], v7 offset:0
 s_waitcnt lgkmcnt(0)
 v_smfmac_f32_16x16x64_bf16 v[24:27], v[12:15], v[96:103], v6
 v_smfmac_f32_16x16x64_bf16 v[28:31], v[12:15], v[104:111], v6
 ds_write_b128 v90, v[112:115] offset:0
 ds_write_b128 v90, v[116:119] offset:1024
 ds_write_b128 v90, v[120:123] offset:2048
 ds_write_b128 v90, v[124:127] offset:3072
 ds_read2_b32 v[112:113], v91 offset0:0 offset1:32
 ds_read2_b32 v[114:115], v91 offset0:64 offset1:96
 ds_read2_b32 v[116:117], v92 offset0:0 offset1:32
 ds_read2_b32 v[118:119], v92 offset0:64 offset1:96
 ds_read2_b32 v[120:121], v91 offset0:16 offset1:48
 ds_read2_b32 v[122:123], v91 offset0:80 offset1:112
 ds_read2_b32 v[124:125], v92 offset0:16 offset1:48
 ds_read2_b32 v[126:127], v92 offset0:80 offset1:112
 ds_read_b128 v[12:15], v7 offset:64
 s_waitcnt lgkmcnt(0)
 v_smfmac_f32_16x16x64_bf16 v[24:27], v[12:15], v[112:119], v6
 v_smfmac_f32_16x16x64_bf16 v[28:31], v[12:15], v[120:127], v6
 ds_write_b128 v90, v[128:131] offset:0
 ds_write_b128 v90, v[132:135] offset:1024
 ds_write_b128 v90, v[136:139] offset:2048
 ds_write_b128 v90, v[140:143] offset:3072
 ds_read2_b32 v[128:129], v91 offset0:0 offset1:32
 ds_read2_b32 v[130:131], v91 offset0:64 offset1:96
 ds_read2_b32 v[132:133], v92 offset0:0 offset1:32
 ds_read2_b32 v[134:135], v92 offset0:64 offset1:96
 ds_read2_b32 v[136:137], v91 offset0:16 offset1:48
 ds_read2_b32 v[138:139], v91 offset0:80 offset1:112
 ds_read2_b32 v[140:141], v92 offset0:16 offset1:48
 ds_read2_b32 v[142:143], v92 offset0:80 offset1:112
 ds_read_b128 v[12:15], v7 offset:128
 s_waitcnt lgkmcnt(0)
 v_smfmac_f32_16x16x64_bf16 v[24:27], v[12:15], v[128:135], v6
 v_smfmac_f32_16x16x64_bf16 v[28:31], v[12:15], v[136:143], v6
 ds_write_b128 v90, v[144:147] offset:0
 ds_write_b128 v90, v[148:151] offset:1024
 ds_write_b128 v90, v[152:155] offset:2048
 ds_write_b128 v90, v[156:159] offset:3072
 ds_read2_b32 v[144:145], v91 offset0:0 offset1:32
 ds_read2_b32 v[146:147], v91 offset0:64 offset1:96
 ds_read2_b32 v[148:149], v92 offset0:0 offset1:32
 ds_read2_b32 v[150:151], v92 offset0:64 offset1:96
 ds_read2_b32 v[152:153], v91 offset0:16 offset1:48
 ds_read2_b32 v[154:155], v91 offset0:80 offset1:112
 ds_read2_b32 v[156:157], v92 offset0:16 offset1:48
 ds_read2_b32 v[158:159], v92 offset0:80 offset1:112
 ds_read_b128 v[12:15], v7 offset:192
 s_waitcnt lgkmcnt(0)
 v_smfmac_f32_16x16x64_bf16 v[24:27], v[12:15], v[144:151], v6
 v_smfmac_f32_16x16x64_bf16 v[28:31], v[12:15], v[152:159], v6
 ds_write_b128 v90, v[160:163] offset:0
 ds_write_b128 v90, v[164:167] offset:1024
 ds_write_b128 v90, v[168:171] offset:2048
 ds_write_b128 v90, v[172:175] offset:3072
 ds_read2_b32 v[160:161], v91 offset0:0 offset1:32
 ds_read2_b32 v[162:163], v91 offset0:64 offset1:96
 ds_read2_b32 v[164:165], v92 offset0:0 offset1:32
 ds_read2_b32 v[166:167], v92 offset0:64 offset1:96
 ds_read2_b32 v[168:169], v91 offset0:16 offset1:48
 ds_read2_b32 v[170:171], v91 offset0:80 offset1:112
 ds_read2_b32 v[172:173], v92 offset0:16 offset1:48
 ds_read2_b32 v[174:175], v92 offset0:80 offset1:112
 ds_read_b128 v[12:15], v7 offset:256
 s_waitcnt lgkmcnt(0)
 v_smfmac_f32_16x16x64_bf16 v[24:27], v[12:15], v[160:167], v6
 v_smfmac_f32_16x16x64_bf16 v[28:31], v[12:15], v[168:175], v6
 s_nop 3
 ds_write_b32 v94, v24 offset:20480
 s_nop 2
 ds_write_b32 v94, v28 offset:21504
 s_waitcnt lgkmcnt(0)
 s_barrier
 s_cmp_ge_u32 s66, 2
 s_cbranch_scc1 modskip_9
 s_cmp_ge_u32 s6, 60
 s_cbranch_scc1 modskip_9
 s_lshl_b32 s73, s66, 10
 v_add_u32 v94, s73, v1
 ds_read_b128 v[24:27], v94 offset:20480
 v_and_b32 v5, 7, v0
 v_lshlrev_b32 v5, 5, v5
wait_10:
 buffer_load_dword v4, v5, s[28:31], 4 offen sc1
 s_waitcnt vmcnt(0)
test_12:
 v_cmp_gt_u32 vcc, 24, v4
 s_and_b32 vcc_lo, vcc_lo, 0xff
 s_and_b32 vcc_hi, vcc_hi, 0x0
 s_cmp_eq_u64 vcc, 0
 s_cbranch_scc1 ready_11
 s_sleep 6
 s_add_u32 s72, s72, 1
 s_cmp_lt_u32 s72, 0x40000
 s_cbranch_scc1 wait_10
 s_branch adaLN_cond__memory_aug_recurrent_mem_tr__mixer_s_mlp__prompt_kernel_exit
ready_11:
 s_waitcnt lgkmcnt(0)
 v_pk_add_f32 v[24:25], v[24:25], v[26:27]
 v_add_f32 v24, v24, v25
 v_cvt_pk_bf16_f32 v24, 0, v24
 v_add_f32 v25, 1.0, v24
 v_cvt_pk_bf16_f32 v25, 0, v25
 s_mul_i32 s74, s6, 205
 s_lshr_b32 s74, s74, 11
 s_bitcmp1_b32 0x12, s74
 s_cselect_b64 vcc, -1, 0
 v_cndmask_b32 v24, v24, v25, vcc
 s_lshl_b32 s73, s6, 1
 s_add_u32 s73, s73, s66
 s_lshl_b32 s73, s73, 7
 s_add_u32 s73, s73, 0x20000
 s_mov_b32 exec_lo, 0xffff
 s_mov_b32 exec_hi, 0xffff
 buffer_store_dword v24, v93, s[8:11], s73 offen sc1
 s_mov_b64 exec, -1
modskip_9:
 s_barrier
 s_mov_b32 s6, 128
 s_branch do_qkv
h_worker:
 s_lshl_b32 s6, s6, 1
 s_add_u32 s6, s6, s73
 s_mov_b32 s20, s32
 s_and_b32 s21, s33, 0xffff
 s_mov_b32 s22, 0x280000
 s_mov_b32 s23, 0x20000
 v_and_b32 v2, 15, v0
 v_mul_u32_u24 v2, 1280, v2
 v_lshrrev_b32 v3, 4, v0
 v_lshl_add_u32 v2, v3, 4, v2
 s_mul_i32 s74, s6, 20480
 s_mul_i32 s73, s66, 320
 s_add_u32 s73, s73, s74
 buffer_load_dwordx4 v[56:59], v2, s[20:23], s73 offen offset:0
 buffer_load_dwordx4 v[60:63], v2, s[20:23], s73 offen offset:64
 buffer_load_dwordx4 v[64:67], v2, s[20:23], s73 offen offset:128
 buffer_load_dwordx4 v[68:71], v2, s[20:23], s73 offen offset:192
 buffer_load_dwordx4 v[72:75], v2, s[20:23], s73 offen offset:256
 s_waitcnt vmcnt(5)
 s_barrier
 s_cmp_lg_u32 s66, 0
 s_cbranch_scc1 notw0_13
 s_and_b32 s73, s70, 7
 s_lshl_b32 s73, s73, 5
 s_add_u32 s73, s73, 4
 v_mov_b32 v2, 1
 v_mov_b32 v3, 0
 s_mov_b64 exec, 1
 buffer_atomic_add v2, v3, s[28:31], s73 offen
 s_mov_b64 exec, -1
notw0_13:
 s_waitcnt vmcnt(0)
do_qkv:
 s_and_b32 s82, s70, 1
 s_lshr_b32 s73, s70, 1
 s_and_b32 s81, s73, 31
 s_lshr_b32 s80, s73, 5
 s_mov_b32 s12, s38
 s_and_b32 s13, s39, 0xffff
 s_mov_b32 s14, 0x500000
 s_mov_b32 s15, 0x20000
 s_cmp_eq_u32 s80, 1
 s_cselect_b32 s12, s40, s12
 s_cselect_b32 s13, s41, s13
 s_cmp_eq_u32 s80, 2
 s_cselect_b32 s12, s36, s12
 s_cselect_b32 s13, s37, s13
 s_and_b32 s13, s13, 0xffff
 s_lshl_b32 s75, s81, 8
 s_cmp_eq_u32 s80, 1
 s_cbranch_scc1 qkv_v
qkv_qk:
 s_lshl_b32 s73, s66, 2
 v_lshrrev_b32 v7, 4, v0
 v_add_u32 v4, s73, v7
 v_and_b32 v5, 15, v0
 s_mov_b32 s73, 8192
 v_mul_lo_u32 v6, v4, s73
 v_lshl_add_u32 v6, v5, 4, v6
 v_lshlrev_b32 v7, 2, v7
 v_xor_b32 v7, v7, v5
 v_lshlrev_b32 v7, 4, v7
 v_lshl_add_u32 v7, v4, 8, v7
 s_add_u32 s73, s75, 0
 buffer_load_dwordx4 v[96:99], v6, s[12:15], s73 offen
 s_add_u32 s73, s75, 131072
 buffer_load_dwordx4 v[100:103], v6, s[12:15], s73 offen
 s_add_u32 s73, s75, 262144
 buffer_load_dwordx4 v[104:107], v6, s[12:15], s73 offen
 s_add_u32 s73, s75, 393216
 buffer_load_dwordx4 v[108:111], v6, s[12:15], s73 offen
 s_add_u32 s73, s75, 524288
 buffer_load_dwordx4 v[112:115], v6, s[12:15], s73 offen
 s_add_u32 s73, s75, 655360
 buffer_load_dwordx4 v[116:119], v6, s[12:15], s73 offen
 s_add_u32 s73, s75, 786432
 buffer_load_dwordx4 v[120:123], v6, s[12:15], s73 offen
 s_add_u32 s73, s75, 917504
 buffer_load_dwordx4 v[124:127], v6, s[12:15], s73 offen
 s_add_u32 s73, s75, 1048576
 buffer_load_dwordx4 v[128:131], v6, s[12:15], s73 offen
 s_add_u32 s73, s75, 1179648
 buffer_load_dwordx4 v[132:135], v6, s[12:15], s73 offen
 s_add_u32 s73, s75, 1310720
 buffer_load_dwordx4 v[136:139], v6, s[12:15], s73 offen
 s_add_u32 s73, s75, 1441792
 buffer_load_dwordx4 v[140:143], v6, s[12:15], s73 offen
 s_add_u32 s73, s75, 1572864
 buffer_load_dwordx4 v[144:147], v6, s[12:15], s73 offen
 s_add_u32 s73, s75, 1703936
 buffer_load_dwordx4 v[148:151], v6, s[12:15], s73 offen
 s_add_u32 s73, s75, 1835008
 buffer_load_dwordx4 v[152:155], v6, s[12:15], s73 offen
 s_add_u32 s73, s75, 1966080
 buffer_load_dwordx4 v[156:159], v6, s[12:15], s73 offen
 s_add_u32 s73, s75, 2097152
 buffer_load_dwordx4 v[160:163], v6, s[12:15], s73 offen
 s_add_u32 s73, s75, 2228224
 buffer_load_dwordx4 v[164:167], v6, s[12:15], s73 offen
 s_add_u32 s73, s75, 2359296
 buffer_load_dwordx4 v[168:171], v6, s[12:15], s73 offen
 s_add_u32 s73, s75, 2490368
 buffer_load_dwordx4 v[172:175], v6, s[12:15], s73 offen
 s_add_u32 s73, s75, 2621440
 buffer_load_dwordx4 v[176:179], v6, s[12:15], s73 offen
 s_add_u32 s73, s75, 2752512
 buffer_load_dwordx4 v[180:183], v6, s[12:15], s73 offen
 s_add_u32 s73, s75, 2883584
 buffer_load_dwordx4 v[184:187], v6, s[12:15], s73 offen
 s_add_u32 s73, s75, 3014656
 buffer_load_dwordx4 v[188:191], v6, s[12:15], s73 offen
 s_add_u32 s73, s75, 3145728
 buffer_load_dwordx4 v[192:195], v6, s[12:15], s73 offen
 s_add_u32 s73, s75, 3276800
 buffer_load_dwordx4 v[196:199], v6, s[12:15], s73 offen
 s_add_u32 s73, s75, 3407872
 buffer_load_dwordx4 v[200:203], v6, s[12:15], s73 offen
 s_add_u32 s73, s75, 3538944
 buffer_load_dwordx4 v[204:207], v6, s[12:15], s73 offen
 s_add_u32 s73, s75, 3670016
 buffer_load_dwordx4 v[208:211], v6, s[12:15], s73 offen
 s_add_u32 s73, s75, 3801088
 buffer_load_dwordx4 v[212:215], v6, s[12:15], s73 offen
 s_add_u32 s73, s75, 3932160
 buffer_load_dwordx4 v[216:219], v6, s[12:15], s73 offen
 s_add_u32 s73, s75, 4063232
 buffer_load_dwordx4 v[220:223], v6, s[12:15], s73 offen
 s_add_u32 s73, s75, 4194304
 buffer_load_dwordx4 v[224:227], v6, s[12:15], s73 offen
 s_add_u32 s73, s75, 4325376
 buffer_load_dwordx4 v[228:231], v6, s[12:15], s73 offen
 s_add_u32 s73, s75, 4456448
 buffer_load_dwordx4 v[232:235], v6, s[12:15], s73 offen
 s_add_u32 s73, s75, 4587520
 buffer_load_dwordx4 v[236:239], v6, s[12:15], s73 offen
 s_add_u32 s73, s75, 4718592
 buffer_load_dwordx4 v[240:243], v6, s[12:15], s73 offen
 s_add_u32 s73, s75, 4849664
 buffer_load_dwordx4 v[244:247], v6, s[12:15], s73 offen
 s_add_u32 s73, s75, 4980736
 buffer_load_dwordx4 v[248:251], v6, s[12:15], s73 offen
 s_add_u32 s73, s75, 5111808
 buffer_load_dwordx4 v[252:255], v6, s[12:15], s73 offen
 s_cmp_ge_u32 s6, 128
 s_cbranch_scc1 nonorm_14
 v_and_b32 v77, 15, v0
 v_lshlrev_b32 v77, 4, v77
 s_lshl_b32 s73, s66, 2
 v_add_u32 v76, s73, v77
 v_and_b32 v55, 0xffff0000, v75
 v_lshlrev_b32 v54, 16, v75
 v_and_b32 v53, 0xffff0000, v74
 v_lshlrev_b32 v52, 16, v74
 v_and_b32 v51, 0xffff0000, v73
 v_lshlrev_b32 v50, 16, v73
 v_and_b32 v49, 0xffff0000, v72
 v_lshlrev_b32 v48, 16, v72
 v_and_b32 v47, 0xffff0000, v71
 v_lshlrev_b32 v46, 16, v71
 v_and_b32 v45, 0xffff0000, v70
 v_lshlrev_b32 v44, 16, v70
 v_and_b32 v43, 0xffff0000, v69
 v_lshlrev_b32 v42, 16, v69
 v_and_b32 v41, 0xffff0000, v68
 v_lshlrev_b32 v40, 16, v68
 v_and_b32 v39, 0xffff0000, v67
 v_lshlrev_b32 v38, 16, v67
 v_and_b32 v37, 0xffff0000, v66
 v_lshlrev_b32 v36, 16, v66
 v_and_b32 v35, 0xffff0000, v65
 v_lshlrev_b32 v34, 16, v65
 v_and_b32 v33, 0xffff0000, v64
 v_lshlrev_b32 v32, 16, v64
 v_and_b32 v31, 0xffff0000, v63
 v_lshlrev_b32 v30, 16, v63
 v_and_b32 v29, 0xffff0000, v62
 v_lshlrev_b32 v28, 16, v62
 v_and_b32 v27, 0xffff0000, v61
 v_lshlrev_b32 v26, 16, v61
 v_and_b32 v25, 0xffff0000, v60
 v_lshlrev_b32 v24, 16, v60
 v_and_b32 v23, 0xffff0000, v59
 v_lshlrev_b32 v22, 16, v59
 v_and_b32 v21, 0xffff0000, v58
 v_lshlrev_b32 v20, 16, v58
 v_and_b32 v19, 0xffff0000, v57
 v_lshlrev_b32 v18, 16, v57
 v_and_b32 v17, 0xffff0000, v56
 v_lshlrev_b32 v16, 16, v56
 v_pk_add_f32 v[82:83], v[16:17], v[18:19]
 v_pk_add_f32 v[82:83], v[82:83], v[20:21]
 v_pk_add_f32 v[82:83], v[82:83], v[22:23]
 v_pk_add_f32 v[82:83], v[82:83], v[24:25]
 v_pk_add_f32 v[82:83], v[82:83], v[26:27]
 v_pk_add_f32 v[82:83], v[82:83], v[28:29]
 v_pk_add_f32 v[82:83], v[82:83], v[30:31]
 v_pk_add_f32 v[82:83], v[82:83], v[32:33]
 v_pk_add_f32 v[82:83], v[82:83], v[34:35]
 v_pk_add_f32 v[82:83], v[82:83], v[36:37]
 v_pk_add_f32 v[82:83], v[82:83], v[38:39]
 v_pk_add_f32 v[82:83], v[82:83], v[40:41]
 v_pk_add_f32 v[82:83], v[82:83], v[42:43]
 v_pk_add_f32 v[82:83], v[82:83], v[44:45]
 v_pk_add_f32 v[82:83], v[82:83], v[46:47]
 v_pk_add_f32 v[82:83], v[82:83], v[48:49]
 v_pk_add_f32 v[82:83], v[82:83], v[50:51]
 v_pk_add_f32 v[82:83], v[82:83], v[52:53]
 v_pk_add_f32 v[82:83], v[82:83], v[54:55]
 v_add_f32 v82, v82, v83
 v_mov_b32 v83, v82
 s_nop 1
 v_permlane16_swap_b32 v82, v83
 v_add_f32 v82, v82, v83
 v_mov_b32 v83, v82
 s_nop 1
 v_permlane32_swap_b32 v82, v83
 v_add_f32 v82, v82, v83
 ds_write_b32 v76, v82 offset:0
 s_waitcnt lgkmcnt(0)
 s_barrier
 ds_read_b128 v[82:85], v77 offset:0
 s_waitcnt lgkmcnt(0)
 v_pk_add_f32 v[82:83], v[82:83], v[84:85]
 v_add_f32 v82, v82, v83
 v_mul_f32 v82, 0x3acccccd, v82
 v_mov_b32 v80, v82
 v_pk_add_f32 v[84:85], v[16:17], v[80:81] op_sel_hi:[1,0] neg_lo:[0,1] neg_hi:[0,1]
 v_pk_mul_f32 v[82:83], v[84:85], v[84:85]
 v_pk_add_f32 v[84:85], v[18:19], v[80:81] op_sel_hi:[1,0] neg_lo:[0,1] neg_hi:[0,1]
 v_pk_fma_f32 v[82:83], v[84:85], v[84:85], v[82:83]
 v_pk_add_f32 v[84:85], v[20:21], v[80:81] op_sel_hi:[1,0] neg_lo:[0,1] neg_hi:[0,1]
 v_pk_fma_f32 v[82:83], v[84:85], v[84:85], v[82:83]
 v_pk_add_f32 v[84:85], v[22:23], v[80:81] op_sel_hi:[1,0] neg_lo:[0,1] neg_hi:[0,1]
 v_pk_fma_f32 v[82:83], v[84:85], v[84:85], v[82:83]
 v_pk_add_f32 v[84:85], v[24:25], v[80:81] op_sel_hi:[1,0] neg_lo:[0,1] neg_hi:[0,1]
 v_pk_fma_f32 v[82:83], v[84:85], v[84:85], v[82:83]
 v_pk_add_f32 v[84:85], v[26:27], v[80:81] op_sel_hi:[1,0] neg_lo:[0,1] neg_hi:[0,1]
 v_pk_fma_f32 v[82:83], v[84:85], v[84:85], v[82:83]
 v_pk_add_f32 v[84:85], v[28:29], v[80:81] op_sel_hi:[1,0] neg_lo:[0,1] neg_hi:[0,1]
 v_pk_fma_f32 v[82:83], v[84:85], v[84:85], v[82:83]
 v_pk_add_f32 v[84:85], v[30:31], v[80:81] op_sel_hi:[1,0] neg_lo:[0,1] neg_hi:[0,1]
 v_pk_fma_f32 v[82:83], v[84:85], v[84:85], v[82:83]
 v_pk_add_f32 v[84:85], v[32:33], v[80:81] op_sel_hi:[1,0] neg_lo:[0,1] neg_hi:[0,1]
 v_pk_fma_f32 v[82:83], v[84:85], v[84:85], v[82:83]
 v_pk_add_f32 v[84:85], v[34:35], v[80:81] op_sel_hi:[1,0] neg_lo:[0,1] neg_hi:[0,1]
 v_pk_fma_f32 v[82:83], v[84:85], v[84:85], v[82:83]
 v_pk_add_f32 v[84:85], v[36:37], v[80:81] op_sel_hi:[1,0] neg_lo:[0,1] neg_hi:[0,1]
 v_pk_fma_f32 v[82:83], v[84:85], v[84:85], v[82:83]
 v_pk_add_f32 v[84:85], v[38:39], v[80:81] op_sel_hi:[1,0] neg_lo:[0,1] neg_hi:[0,1]
 v_pk_fma_f32 v[82:83], v[84:85], v[84:85], v[82:83]
 v_pk_add_f32 v[84:85], v[40:41], v[80:81] op_sel_hi:[1,0] neg_lo:[0,1] neg_hi:[0,1]
 v_pk_fma_f32 v[82:83], v[84:85], v[84:85], v[82:83]
 v_pk_add_f32 v[84:85], v[42:43], v[80:81] op_sel_hi:[1,0] neg_lo:[0,1] neg_hi:[0,1]
 v_pk_fma_f32 v[82:83], v[84:85], v[84:85], v[82:83]
 v_pk_add_f32 v[84:85], v[44:45], v[80:81] op_sel_hi:[1,0] neg_lo:[0,1] neg_hi:[0,1]
 v_pk_fma_f32 v[82:83], v[84:85], v[84:85], v[82:83]
 v_pk_add_f32 v[84:85], v[46:47], v[80:81] op_sel_hi:[1,0] neg_lo:[0,1] neg_hi:[0,1]
 v_pk_fma_f32 v[82:83], v[84:85], v[84:85], v[82:83]
 v_pk_add_f32 v[84:85], v[48:49], v[80:81] op_sel_hi:[1,0] neg_lo:[0,1] neg_hi:[0,1]
 v_pk_fma_f32 v[82:83], v[84:85], v[84:85], v[82:83]
 v_pk_add_f32 v[84:85], v[50:51], v[80:81] op_sel_hi:[1,0] neg_lo:[0,1] neg_hi:[0,1]
 v_pk_fma_f32 v[82:83], v[84:85], v[84:85], v[82:83]
 v_pk_add_f32 v[84:85], v[52:53], v[80:81] op_sel_hi:[1,0] neg_lo:[0,1] neg_hi:[0,1]
 v_pk_fma_f32 v[82:83], v[84:85], v[84:85], v[82:83]
 v_pk_add_f32 v[84:85], v[54:55], v[80:81] op_sel_hi:[1,0] neg_lo:[0,1] neg_hi:[0,1]
 v_pk_fma_f32 v[82:83], v[84:85], v[84:85], v[82:83]
 v_add_f32 v82, v82, v83
 v_mov_b32 v83, v82
 s_nop 1
 v_permlane16_swap_b32 v82, v83
 v_add_f32 v82, v82, v83
 v_mov_b32 v83, v82
 s_nop 1
 v_permlane32_swap_b32 v82, v83
 v_add_f32 v82, v82, v83
 ds_write_b32 v76, v82 offset:256
 s_waitcnt lgkmcnt(0)
 s_barrier
 ds_read_b128 v[82:85], v77 offset:256
 s_waitcnt lgkmcnt(0)
 v_pk_add_f32 v[82:83], v[82:83], v[84:85]
 v_add_f32 v82, v82, v83
 v_mul_f32 v82, 0x3acccccd, v82
 v_cvt_pk_bf16_f32 v82, 0, v82
 v_add_f32 v82, 0x3727c5ac, v82
 v_cvt_pk_bf16_f32 v82, 0, v82
 v_sqrt_f32 v82, v82
 v_cvt_pk_bf16_f32 v80, 0, v80
 v_cvt_pk_bf16_f32 v82, 0, v82
 v_rcp_f32 v82, v82
 v_pk_add_f32 v[16:17], v[16:17], v[80:81] op_sel_hi:[1,0] neg_lo:[0,1] neg_hi:[0,1]
 v_pk_add_f32 v[18:19], v[18:19], v[80:81] op_sel_hi:[1,0] neg_lo:[0,1] neg_hi:[0,1]
 v_pk_add_f32 v[20:21], v[20:21], v[80:81] op_sel_hi:[1,0] neg_lo:[0,1] neg_hi:[0,1]
 v_pk_add_f32 v[22:23], v[22:23], v[80:81] op_sel_hi:[1,0] neg_lo:[0,1] neg_hi:[0,1]
 v_pk_add_f32 v[24:25], v[24:25], v[80:81] op_sel_hi:[1,0] neg_lo:[0,1] neg_hi:[0,1]
 v_pk_add_f32 v[26:27], v[26:27], v[80:81] op_sel_hi:[1,0] neg_lo:[0,1] neg_hi:[0,1]
 v_pk_add_f32 v[28:29], v[28:29], v[80:81] op_sel_hi:[1,0] neg_lo:[0,1] neg_hi:[0,1]
 v_pk_add_f32 v[30:31], v[30:31], v[80:81] op_sel_hi:[1,0] neg_lo:[0,1] neg_hi:[0,1]
 v_pk_add_f32 v[32:33], v[32:33], v[80:81] op_sel_hi:[1,0] neg_lo:[0,1] neg_hi:[0,1]
 v_pk_add_f32 v[34:35], v[34:35], v[80:81] op_sel_hi:[1,0] neg_lo:[0,1] neg_hi:[0,1]
 v_pk_add_f32 v[36:37], v[36:37], v[80:81] op_sel_hi:[1,0] neg_lo:[0,1] neg_hi:[0,1]
 v_pk_add_f32 v[38:39], v[38:39], v[80:81] op_sel_hi:[1,0] neg_lo:[0,1] neg_hi:[0,1]
 v_pk_add_f32 v[40:41], v[40:41], v[80:81] op_sel_hi:[1,0] neg_lo:[0,1] neg_hi:[0,1]
 v_pk_add_f32 v[42:43], v[42:43], v[80:81] op_sel_hi:[1,0] neg_lo:[0,1] neg_hi:[0,1]
 v_pk_add_f32 v[44:45], v[44:45], v[80:81] op_sel_hi:[1,0] neg_lo:[0,1] neg_hi:[0,1]
 v_pk_add_f32 v[46:47], v[46:47], v[80:81] op_sel_hi:[1,0] neg_lo:[0,1] neg_hi:[0,1]
 v_pk_add_f32 v[48:49], v[48:49], v[80:81] op_sel_hi:[1,0] neg_lo:[0,1] neg_hi:[0,1]
 v_pk_add_f32 v[50:51], v[50:51], v[80:81] op_sel_hi:[1,0] neg_lo:[0,1] neg_hi:[0,1]
 v_pk_add_f32 v[52:53], v[52:53], v[80:81] op_sel_hi:[1,0] neg_lo:[0,1] neg_hi:[0,1]
 v_pk_add_f32 v[54:55], v[54:55], v[80:81] op_sel_hi:[1,0] neg_lo:[0,1] neg_hi:[0,1]
 v_cvt_pk_bf16_f32 v16, 0, v16
 v_cvt_pk_bf16_f32 v17, 0, v17
 v_cvt_pk_bf16_f32 v18, 0, v18
 v_cvt_pk_bf16_f32 v19, 0, v19
 v_cvt_pk_bf16_f32 v20, 0, v20
 v_cvt_pk_bf16_f32 v21, 0, v21
 v_cvt_pk_bf16_f32 v22, 0, v22
 v_cvt_pk_bf16_f32 v23, 0, v23
 v_cvt_pk_bf16_f32 v24, 0, v24
 v_cvt_pk_bf16_f32 v25, 0, v25
 v_cvt_pk_bf16_f32 v26, 0, v26
 v_cvt_pk_bf16_f32 v27, 0, v27
 v_cvt_pk_bf16_f32 v28, 0, v28
 v_cvt_pk_bf16_f32 v29, 0, v29
 v_cvt_pk_bf16_f32 v30, 0, v30
 v_cvt_pk_bf16_f32 v31, 0, v31
 v_cvt_pk_bf16_f32 v32, 0, v32
 v_cvt_pk_bf16_f32 v33, 0, v33
 v_cvt_pk_bf16_f32 v34, 0, v34
 v_cvt_pk_bf16_f32 v35, 0, v35
 v_cvt_pk_bf16_f32 v36, 0, v36
 v_cvt_pk_bf16_f32 v37, 0, v37
 v_cvt_pk_bf16_f32 v38, 0, v38
 v_cvt_pk_bf16_f32 v39, 0, v39
 v_cvt_pk_bf16_f32 v40, 0, v40
 v_cvt_pk_bf16_f32 v41, 0, v41
 v_cvt_pk_bf16_f32 v42, 0, v42
 v_cvt_pk_bf16_f32 v43, 0, v43
 v_cvt_pk_bf16_f32 v44, 0, v44
 v_cvt_pk_bf16_f32 v45, 0, v45
 v_cvt_pk_bf16_f32 v46, 0, v46
 v_cvt_pk_bf16_f32 v47, 0, v47
 v_cvt_pk_bf16_f32 v48, 0, v48
 v_cvt_pk_bf16_f32 v49, 0, v49
 v_cvt_pk_bf16_f32 v50, 0, v50
 v_cvt_pk_bf16_f32 v51, 0, v51
 v_cvt_pk_bf16_f32 v52, 0, v52
 v_cvt_pk_bf16_f32 v53, 0, v53
 v_cvt_pk_bf16_f32 v54, 0, v54
 v_cvt_pk_bf16_f32 v55, 0, v55
 v_pk_mul_f32 v[16:17], v[16:17], v[82:83] op_sel_hi:[1,0]
 v_pk_mul_f32 v[18:19], v[18:19], v[82:83] op_sel_hi:[1,0]
 v_pk_mul_f32 v[20:21], v[20:21], v[82:83] op_sel_hi:[1,0]
 v_pk_mul_f32 v[22:23], v[22:23], v[82:83] op_sel_hi:[1,0]
 v_pk_mul_f32 v[24:25], v[24:25], v[82:83] op_sel_hi:[1,0]
 v_pk_mul_f32 v[26:27], v[26:27], v[82:83] op_sel_hi:[1,0]
 v_pk_mul_f32 v[28:29], v[28:29], v[82:83] op_sel_hi:[1,0]
 v_pk_mul_f32 v[30:31], v[30:31], v[82:83] op_sel_hi:[1,0]
 v_pk_mul_f32 v[32:33], v[32:33], v[82:83] op_sel_hi:[1,0]
 v_pk_mul_f32 v[34:35], v[34:35], v[82:83] op_sel_hi:[1,0]
 v_pk_mul_f32 v[36:37], v[36:37], v[82:83] op_sel_hi:[1,0]
 v_pk_mul_f32 v[38:39], v[38:39], v[82:83] op_sel_hi:[1,0]
 v_pk_mul_f32 v[40:41], v[40:41], v[82:83] op_sel_hi:[1,0]
 v_pk_mul_f32 v[42:43], v[42:43], v[82:83] op_sel_hi:[1,0]
 v_pk_mul_f32 v[44:45], v[44:45], v[82:83] op_sel_hi:[1,0]
 v_pk_mul_f32 v[46:47], v[46:47], v[82:83] op_sel_hi:[1,0]
 v_pk_mul_f32 v[48:49], v[48:49], v[82:83] op_sel_hi:[1,0]
 v_pk_mul_f32 v[50:51], v[50:51], v[82:83] op_sel_hi:[1,0]
 v_pk_mul_f32 v[52:53], v[52:53], v[82:83] op_sel_hi:[1,0]
 v_pk_mul_f32 v[54:55], v[54:55], v[82:83] op_sel_hi:[1,0]
 v_cvt_pk_bf16_f32 v16, 0, v16
 v_cvt_pk_bf16_f32 v17, 0, v17
 v_cvt_pk_bf16_f32 v18, 0, v18
 v_cvt_pk_bf16_f32 v19, 0, v19
 v_cvt_pk_bf16_f32 v20, 0, v20
 v_cvt_pk_bf16_f32 v21, 0, v21
 v_cvt_pk_bf16_f32 v22, 0, v22
 v_cvt_pk_bf16_f32 v23, 0, v23
 v_cvt_pk_bf16_f32 v24, 0, v24
 v_cvt_pk_bf16_f32 v25, 0, v25
 v_cvt_pk_bf16_f32 v26, 0, v26
 v_cvt_pk_bf16_f32 v27, 0, v27
 v_cvt_pk_bf16_f32 v28, 0, v28
 v_cvt_pk_bf16_f32 v29, 0, v29
 v_cvt_pk_bf16_f32 v30, 0, v30
 v_cvt_pk_bf16_f32 v31, 0, v31
 v_cvt_pk_bf16_f32 v32, 0, v32
 v_cvt_pk_bf16_f32 v33, 0, v33
 v_cvt_pk_bf16_f32 v34, 0, v34
 v_cvt_pk_bf16_f32 v35, 0, v35
 v_cvt_pk_bf16_f32 v36, 0, v36
 v_cvt_pk_bf16_f32 v37, 0, v37
 v_cvt_pk_bf16_f32 v38, 0, v38
 v_cvt_pk_bf16_f32 v39, 0, v39
 v_cvt_pk_bf16_f32 v40, 0, v40
 v_cvt_pk_bf16_f32 v41, 0, v41
 v_cvt_pk_bf16_f32 v42, 0, v42
 v_cvt_pk_bf16_f32 v43, 0, v43
 v_cvt_pk_bf16_f32 v44, 0, v44
 v_cvt_pk_bf16_f32 v45, 0, v45
 v_cvt_pk_bf16_f32 v46, 0, v46
 v_cvt_pk_bf16_f32 v47, 0, v47
 v_cvt_pk_bf16_f32 v48, 0, v48
 v_cvt_pk_bf16_f32 v49, 0, v49
 v_cvt_pk_bf16_f32 v50, 0, v50
 v_cvt_pk_bf16_f32 v51, 0, v51
 v_cvt_pk_bf16_f32 v52, 0, v52
 v_cvt_pk_bf16_f32 v53, 0, v53
 v_cvt_pk_bf16_f32 v54, 0, v54
 v_cvt_pk_bf16_f32 v55, 0, v55
 s_barrier
nonorm_14:
 s_waitcnt vmcnt(39)
 ds_write_b128 v7, v[96:99] offset:0
 s_waitcnt vmcnt(38)
 ds_write_b128 v7, v[100:103] offset:4096
 s_waitcnt vmcnt(37)
 ds_write_b128 v7, v[104:107] offset:8192
 s_waitcnt vmcnt(36)
 ds_write_b128 v7, v[108:111] offset:12288
 s_waitcnt vmcnt(35)
 ds_write_b128 v7, v[112:115] offset:16384
 s_waitcnt vmcnt(34)
 ds_write_b128 v7, v[116:119] offset:20480
 s_waitcnt vmcnt(33)
 ds_write_b128 v7, v[120:123] offset:24576
 s_waitcnt vmcnt(32)
 ds_write_b128 v7, v[124:127] offset:28672
 s_waitcnt vmcnt(31)
 ds_write_b128 v7, v[128:131] offset:32768
 s_waitcnt vmcnt(30)
 ds_write_b128 v7, v[132:135] offset:36864
 s_waitcnt vmcnt(29)
 ds_write_b128 v7, v[136:139] offset:40960
 s_waitcnt vmcnt(28)
 ds_write_b128 v7, v[140:143] offset:45056
 s_waitcnt vmcnt(27)
 ds_write_b128 v7, v[144:147] offset:49152
 s_waitcnt vmcnt(26)
 ds_write_b128 v7, v[148:151] offset:53248
 s_waitcnt vmcnt(25)
 ds_write_b128 v7, v[152:155] offset:57344
 s_waitcnt vmcnt(24)
 ds_write_b128 v7, v[156:159] offset:61440
 v_add_u32 v7, 0x10000, v7
 s_waitcnt vmcnt(23)
 ds_write_b128 v7, v[160:163] offset:0
 s_waitcnt vmcnt(22)
 ds_write_b128 v7, v[164:167] offset:4096
 s_waitcnt vmcnt(21)
 ds_write_b128 v7, v[168:171] offset:8192
 s_waitcnt vmcnt(20)
 ds_write_b128 v7, v[172:175] offset:12288
 s_waitcnt vmcnt(19)
 ds_write_b128 v7, v[176:179] offset:16384
 s_waitcnt vmcnt(18)
 ds_write_b128 v7, v[180:183] offset:20480
 s_waitcnt vmcnt(17)
 ds_write_b128 v7, v[184:187] offset:24576
 s_waitcnt vmcnt(16)
 ds_write_b128 v7, v[188:191] offset:28672
 s_waitcnt vmcnt(15)
 ds_write_b128 v7, v[192:195] offset:32768
 s_waitcnt vmcnt(14)
 ds_write_b128 v7, v[196:199] offset:36864
 s_waitcnt vmcnt(13)
 ds_write_b128 v7, v[200:203] offset:40960
 s_waitcnt vmcnt(12)
 ds_write_b128 v7, v[204:207] offset:45056
 s_waitcnt vmcnt(11)
 ds_write_b128 v7, v[208:211] offset:49152
 s_waitcnt vmcnt(10)
 ds_write_b128 v7, v[212:215] offset:53248
 s_waitcnt vmcnt(9)
 ds_write_b128 v7, v[216:219] offset:57344
 s_waitcnt vmcnt(8)
 ds_write_b128 v7, v[220:223] offset:61440
 v_add_u32 v7, 0x10000, v7
 s_waitcnt vmcnt(7)
 ds_write_b128 v7, v[224:227] offset:0
 s_waitcnt vmcnt(6)
 ds_write_b128 v7, v[228:231] offset:4096
 s_waitcnt vmcnt(5)
 ds_write_b128 v7, v[232:235] offset:8192
 s_waitcnt vmcnt(4)
 ds_write_b128 v7, v[236:239] offset:12288
 s_waitcnt vmcnt(3)
 ds_write_b128 v7, v[240:243] offset:16384
 s_waitcnt vmcnt(2)
 ds_write_b128 v7, v[244:247] offset:20480
 s_waitcnt vmcnt(1)
 ds_write_b128 v7, v[248:251] offset:24576
 s_waitcnt vmcnt(0)
 ds_write_b128 v7, v[252:255] offset:28672
 s_waitcnt lgkmcnt(0)
 s_barrier
 s_and_b32 s74, s66, 1
 s_lshl_b32 s74, s74, 1
 s_add_u32 s74, s74, 0
 v_bfe_u32 v3, v0, 2, 2
 v_lshrrev_b32 v2, 4, v0
 v_lshl_add_u32 v2, v2, 3, v3
 v_lshlrev_b32 v2, 8, v2
 v_xor_b32 v3, s74, v3
 v_lshl_add_u32 v2, v3, 6, v2
 v_and_b32 v3, 3, v0
 v_lshl_add_u32 v2, v3, 4, v2
 ds_read_b64_tr_b16 v[192:193], v2 offset:0
 ds_read_b64_tr_b16 v[194:195], v2 offset:1024
 ds_read_b64_tr_b16 v[196:197], v2 offset:8
 ds_read_b64_tr_b16 v[198:199], v2 offset:1032
 ds_read_b64_tr_b16 v[208:209], v2 offset:8192
 ds_read_b64_tr_b16 v[210:211], v2 offset:9216
 ds_read_b64_tr_b16 v[212:213], v2 offset:8200
 ds_read_b64_tr_b16 v[214:215], v2 offset:9224
 ds_read_b64_tr_b16 v[224:225], v2 offset:16384
 ds_read_b64_tr_b16 v[226:227], v2 offset:17408
 ds_read_b64_tr_b16 v[228:229], v2 offset:16392
 ds_read_b64_tr_b16 v[230:231], v2 offset:17416
 s_waitcnt lgkmcnt(0)
 ds_read_b64_tr_b16 v[240:241], v2 offset:24576
 ds_read_b64_tr_b16 v[242:243], v2 offset:25600
 ds_read_b64_tr_b16 v[244:245], v2 offset:24584
 ds_read_b64_tr_b16 v[246:247], v2 offset:25608
 ds_read_b64_tr_b16 a[0:1], v2 offset:32768
 ds_read_b64_tr_b16 a[2:3], v2 offset:33792
 ds_read_b64_tr_b16 a[4:5], v2 offset:32776
 ds_read_b64_tr_b16 a[6:7], v2 offset:33800
 ds_read_b64_tr_b16 a[16:17], v2 offset:40960
 ds_read_b64_tr_b16 a[18:19], v2 offset:41984
 ds_read_b64_tr_b16 a[20:21], v2 offset:40968
 ds_read_b64_tr_b16 a[22:23], v2 offset:41992
 s_waitcnt lgkmcnt(0)
 ds_read_b64_tr_b16 a[32:33], v2 offset:49152
 ds_read_b64_tr_b16 a[34:35], v2 offset:50176
 ds_read_b64_tr_b16 a[36:37], v2 offset:49160
 ds_read_b64_tr_b16 a[38:39], v2 offset:50184
 ds_read_b64_tr_b16 a[48:49], v2 offset:57344
 ds_read_b64_tr_b16 a[50:51], v2 offset:58368
 ds_read_b64_tr_b16 a[52:53], v2 offset:57352
 ds_read_b64_tr_b16 a[54:55], v2 offset:58376
 v_add_u32 v2, 0x10000, v2
 ds_read_b64_tr_b16 a[64:65], v2 offset:0
 ds_read_b64_tr_b16 a[66:67], v2 offset:1024
 ds_read_b64_tr_b16 a[68:69], v2 offset:8
 ds_read_b64_tr_b16 a[70:71], v2 offset:1032
 s_waitcnt lgkmcnt(0)
 ds_read_b64_tr_b16 a[80:81], v2 offset:8192
 ds_read_b64_tr_b16 a[82:83], v2 offset:9216
 ds_read_b64_tr_b16 a[84:85], v2 offset:8200
 ds_read_b64_tr_b16 a[86:87], v2 offset:9224
 ds_read_b64_tr_b16 a[96:97], v2 offset:16384
 ds_read_b64_tr_b16 a[98:99], v2 offset:17408
 ds_read_b64_tr_b16 a[100:101], v2 offset:16392
 ds_read_b64_tr_b16 a[102:103], v2 offset:17416
 ds_read_b64_tr_b16 a[112:113], v2 offset:24576
 ds_read_b64_tr_b16 a[114:115], v2 offset:25600
 ds_read_b64_tr_b16 a[116:117], v2 offset:24584
 ds_read_b64_tr_b16 a[118:119], v2 offset:25608
 s_waitcnt lgkmcnt(0)
 ds_read_b64_tr_b16 a[128:129], v2 offset:32768
 ds_read_b64_tr_b16 a[130:131], v2 offset:33792
 ds_read_b64_tr_b16 a[132:133], v2 offset:32776
 ds_read_b64_tr_b16 a[134:135], v2 offset:33800
 ds_read_b64_tr_b16 a[144:145], v2 offset:40960
 ds_read_b64_tr_b16 a[146:147], v2 offset:41984
 ds_read_b64_tr_b16 a[148:149], v2 offset:40968
 ds_read_b64_tr_b16 a[150:151], v2 offset:41992
 ds_read_b64_tr_b16 a[160:161], v2 offset:49152
 ds_read_b64_tr_b16 a[162:163], v2 offset:50176
 ds_read_b64_tr_b16 a[164:165], v2 offset:49160
 ds_read_b64_tr_b16 a[166:167], v2 offset:50184
 s_waitcnt lgkmcnt(0)
 ds_read_b64_tr_b16 a[176:177], v2 offset:57344
 ds_read_b64_tr_b16 a[178:179], v2 offset:58368
 ds_read_b64_tr_b16 a[180:181], v2 offset:57352
 ds_read_b64_tr_b16 a[182:183], v2 offset:58376
 v_add_u32 v2, 0x10000, v2
 ds_read_b64_tr_b16 a[192:193], v2 offset:0
 ds_read_b64_tr_b16 a[194:195], v2 offset:1024
 ds_read_b64_tr_b16 a[196:197], v2 offset:8
 ds_read_b64_tr_b16 a[198:199], v2 offset:1032
 ds_read_b64_tr_b16 a[208:209], v2 offset:8192
 ds_read_b64_tr_b16 a[210:211], v2 offset:9216
 ds_read_b64_tr_b16 a[212:213], v2 offset:8200
 ds_read_b64_tr_b16 a[214:215], v2 offset:9224
 s_waitcnt lgkmcnt(0)
 ds_read_b64_tr_b16 a[224:225], v2 offset:16384
 ds_read_b64_tr_b16 a[226:227], v2 offset:17408
 ds_read_b64_tr_b16 a[228:229], v2 offset:16392
 ds_read_b64_tr_b16 a[230:231], v2 offset:17416
 ds_read_b64_tr_b16 a[240:241], v2 offset:24576
 ds_read_b64_tr_b16 a[242:243], v2 offset:25600
 ds_read_b64_tr_b16 a[244:245], v2 offset:24584
 ds_read_b64_tr_b16 a[246:247], v2 offset:25608
 s_waitcnt lgkmcnt(0)
 s_and_b32 s74, s66, 1
 s_lshl_b32 s74, s74, 1
 s_add_u32 s74, s74, 1
 v_bfe_u32 v3, v0, 2, 2
 v_lshrrev_b32 v2, 4, v0
 v_lshl_add_u32 v2, v2, 3, v3
 v_lshlrev_b32 v2, 8, v2
 v_xor_b32 v3, s74, v3
 v_lshl_add_u32 v2, v3, 6, v2
 v_and_b32 v3, 3, v0
 v_lshl_add_u32 v2, v3, 4, v2
 ds_read_b64_tr_b16 v[200:201], v2 offset:0
 ds_read_b64_tr_b16 v[202:203], v2 offset:1024
 ds_read_b64_tr_b16 v[204:205], v2 offset:8
 ds_read_b64_tr_b16 v[206:207], v2 offset:1032
 ds_read_b64_tr_b16 v[216:217], v2 offset:8192
 ds_read_b64_tr_b16 v[218:219], v2 offset:9216
 ds_read_b64_tr_b16 v[220:221], v2 offset:8200
 ds_read_b64_tr_b16 v[222:223], v2 offset:9224
 ds_read_b64_tr_b16 v[232:233], v2 offset:16384
 ds_read_b64_tr_b16 v[234:235], v2 offset:17408
 ds_read_b64_tr_b16 v[236:237], v2 offset:16392
 ds_read_b64_tr_b16 v[238:239], v2 offset:17416
 s_waitcnt lgkmcnt(0)
 ds_read_b64_tr_b16 v[248:249], v2 offset:24576
 ds_read_b64_tr_b16 v[250:251], v2 offset:25600
 ds_read_b64_tr_b16 v[252:253], v2 offset:24584
 ds_read_b64_tr_b16 v[254:255], v2 offset:25608
 ds_read_b64_tr_b16 a[8:9], v2 offset:32768
 ds_read_b64_tr_b16 a[10:11], v2 offset:33792
 ds_read_b64_tr_b16 a[12:13], v2 offset:32776
 ds_read_b64_tr_b16 a[14:15], v2 offset:33800
 ds_read_b64_tr_b16 a[24:25], v2 offset:40960
 ds_read_b64_tr_b16 a[26:27], v2 offset:41984
 ds_read_b64_tr_b16 a[28:29], v2 offset:40968
 ds_read_b64_tr_b16 a[30:31], v2 offset:41992
 s_waitcnt lgkmcnt(0)
 ds_read_b64_tr_b16 a[40:41], v2 offset:49152
 ds_read_b64_tr_b16 a[42:43], v2 offset:50176
 ds_read_b64_tr_b16 a[44:45], v2 offset:49160
 ds_read_b64_tr_b16 a[46:47], v2 offset:50184
 ds_read_b64_tr_b16 a[56:57], v2 offset:57344
 ds_read_b64_tr_b16 a[58:59], v2 offset:58368
 ds_read_b64_tr_b16 a[60:61], v2 offset:57352
 ds_read_b64_tr_b16 a[62:63], v2 offset:58376
 v_add_u32 v2, 0x10000, v2
 ds_read_b64_tr_b16 a[72:73], v2 offset:0
 ds_read_b64_tr_b16 a[74:75], v2 offset:1024
 ds_read_b64_tr_b16 a[76:77], v2 offset:8
 ds_read_b64_tr_b16 a[78:79], v2 offset:1032
 s_waitcnt lgkmcnt(0)
 ds_read_b64_tr_b16 a[88:89], v2 offset:8192
 ds_read_b64_tr_b16 a[90:91], v2 offset:9216
 ds_read_b64_tr_b16 a[92:93], v2 offset:8200
 ds_read_b64_tr_b16 a[94:95], v2 offset:9224
 ds_read_b64_tr_b16 a[104:105], v2 offset:16384
 ds_read_b64_tr_b16 a[106:107], v2 offset:17408
 ds_read_b64_tr_b16 a[108:109], v2 offset:16392
 ds_read_b64_tr_b16 a[110:111], v2 offset:17416
 ds_read_b64_tr_b16 a[120:121], v2 offset:24576
 ds_read_b64_tr_b16 a[122:123], v2 offset:25600
 ds_read_b64_tr_b16 a[124:125], v2 offset:24584
 ds_read_b64_tr_b16 a[126:127], v2 offset:25608
 s_waitcnt lgkmcnt(0)
 ds_read_b64_tr_b16 a[136:137], v2 offset:32768
 ds_read_b64_tr_b16 a[138:139], v2 offset:33792
 ds_read_b64_tr_b16 a[140:141], v2 offset:32776
 ds_read_b64_tr_b16 a[142:143], v2 offset:33800
 ds_read_b64_tr_b16 a[152:153], v2 offset:40960
 ds_read_b64_tr_b16 a[154:155], v2 offset:41984
 ds_read_b64_tr_b16 a[156:157], v2 offset:40968
 ds_read_b64_tr_b16 a[158:159], v2 offset:41992
 ds_read_b64_tr_b16 a[168:169], v2 offset:49152
 ds_read_b64_tr_b16 a[170:171], v2 offset:50176
 ds_read_b64_tr_b16 a[172:173], v2 offset:49160
 ds_read_b64_tr_b16 a[174:175], v2 offset:50184
 s_waitcnt lgkmcnt(0)
 ds_read_b64_tr_b16 a[184:185], v2 offset:57344
 ds_read_b64_tr_b16 a[186:187], v2 offset:58368
 ds_read_b64_tr_b16 a[188:189], v2 offset:57352
 ds_read_b64_tr_b16 a[190:191], v2 offset:58376
 v_add_u32 v2, 0x10000, v2
 ds_read_b64_tr_b16 a[200:201], v2 offset:0
 ds_read_b64_tr_b16 a[202:203], v2 offset:1024
 ds_read_b64_tr_b16 a[204:205], v2 offset:8
 ds_read_b64_tr_b16 a[206:207], v2 offset:1032
 ds_read_b64_tr_b16 a[216:217], v2 offset:8192
 ds_read_b64_tr_b16 a[218:219], v2 offset:9216
 ds_read_b64_tr_b16 a[220:221], v2 offset:8200
 ds_read_b64_tr_b16 a[222:223], v2 offset:9224
 s_waitcnt lgkmcnt(0)
 ds_read_b64_tr_b16 a[232:233], v2 offset:16384
 ds_read_b64_tr_b16 a[234:235], v2 offset:17408
 ds_read_b64_tr_b16 a[236:237], v2 offset:16392
 ds_read_b64_tr_b16 a[238:239], v2 offset:17416
 ds_read_b64_tr_b16 a[248:249], v2 offset:24576
 ds_read_b64_tr_b16 a[250:251], v2 offset:25600
 ds_read_b64_tr_b16 a[252:253], v2 offset:24584
 ds_read_b64_tr_b16 a[254:255], v2 offset:25608
 s_waitcnt lgkmcnt(0)
 v_and_b32 v5, 7, v0
 v_lshlrev_b32 v5, 5, v5
wait_15:
 buffer_load_dword v4, v5, s[28:31], 4 offen sc1
 s_waitcnt vmcnt(0)
test_17:
 v_cmp_gt_u32 vcc, 24, v4
 s_and_b32 vcc_lo, vcc_lo, 0xff
 s_and_b32 vcc_hi, vcc_hi, 0x0
 s_cmp_eq_u64 vcc, 0
 s_cbranch_scc1 ready_16
 s_sleep 6
 s_add_u32 s72, s72, 1
 s_cmp_lt_u32 s72, 0x40000
 s_cbranch_scc1 wait_15
 s_branch adaLN_cond__memory_aug_recurrent_mem_tr__mixer_s_mlp__prompt_kernel_exit
ready_16:
 s_cmp_ge_u32 s6, 128
 s_cbranch_scc1 noh_18
poll_19:
 v_lshrrev_b32 v3, 4, v0
 v_lshlrev_b32 v3, 5, v3
 s_mul_i32 s73, s66, 640
 s_add_u32 s73, s73, 0x20000
 buffer_load_dwordx4 v[96:99], v3, s[8:11], s73 offen offset:0 sc1
 buffer_load_dwordx4 v[100:103], v3, s[8:11], s73 offen offset:16 sc1
 buffer_load_dwordx4 v[104:107], v3, s[8:11], s73 offen offset:128 sc1
 buffer_load_dwordx4 v[108:111], v3, s[8:11], s73 offen offset:144 sc1
 buffer_load_dwordx4 v[112:115], v3, s[8:11], s73 offen offset:256 sc1
 buffer_load_dwordx4 v[116:119], v3, s[8:11], s73 offen offset:272 sc1
 buffer_load_dwordx4 v[120:123], v3, s[8:11], s73 offen offset:384 sc1
 buffer_load_dwordx4 v[124:127], v3, s[8:11], s73 offen offset:400 sc1
 buffer_load_dwordx4 v[128:131], v3, s[8:11], s73 offen offset:512 sc1
 buffer_load_dwordx4 v[132:135], v3, s[8:11], s73 offen offset:528 sc1
 v_lshrrev_b32 v3, 4, v0
 v_lshlrev_b32 v3, 5, v3
 s_mul_i32 s73, s66, 640
 s_add_u32 s73, s73, 0x20a00
 buffer_load_dwordx4 v[136:139], v3, s[8:11], s73 offen offset:0 sc1
 buffer_load_dwordx4 v[140:143], v3, s[8:11], s73 offen offset:16 sc1
 buffer_load_dwordx4 v[144:147], v3, s[8:11], s73 offen offset:128 sc1
 buffer_load_dwordx4 v[148:151], v3, s[8:11], s73 offen offset:144 sc1
 buffer_load_dwordx4 v[152:155], v3, s[8:11], s73 offen offset:256 sc1
 buffer_load_dwordx4 v[156:159], v3, s[8:11], s73 offen offset:272 sc1
 buffer_load_dwordx4 v[160:163], v3, s[8:11], s73 offen offset:384 sc1
 buffer_load_dwordx4 v[164:167], v3, s[8:11], s73 offen offset:400 sc1
 buffer_load_dwordx4 v[168:171], v3, s[8:11], s73 offen offset:512 sc1
 buffer_load_dwordx4 v[172:175], v3, s[8:11], s73 offen offset:528 sc1
 s_waitcnt vmcnt(0)
 v_max_u32 v2, v96, v97
 v_max3_u32 v2, v2, v98, v99
 v_max3_u32 v2, v2, v100, v101
 v_max3_u32 v2, v2, v102, v103
 v_max3_u32 v2, v2, v104, v105
 v_max3_u32 v2, v2, v106, v107
 v_max3_u32 v2, v2, v108, v109
 v_max3_u32 v2, v2, v110, v111
 v_max3_u32 v2, v2, v112, v113
 v_max3_u32 v2, v2, v114, v115
 v_max3_u32 v2, v2, v116, v117
 v_max3_u32 v2, v2, v118, v119
 v_max3_u32 v2, v2, v120, v121
 v_max3_u32 v2, v2, v122, v123
 v_max3_u32 v2, v2, v124, v125
 v_max3_u32 v2, v2, v126, v127
 v_max3_u32 v2, v2, v128, v129
 v_max3_u32 v2, v2, v130, v131
 v_max3_u32 v2, v2, v132, v133
 v_max3_u32 v2, v2, v134, v135
 v_max3_u32 v2, v2, v136, v137
 v_max3_u32 v2, v2, v138, v139
 v_max3_u32 v2, v2, v140, v141
 v_max3_u32 v2, v2, v142, v143
 v_max3_u32 v2, v2, v144, v145
 v_max3_u32 v2, v2, v146, v147
 v_max3_u32 v2, v2, v148, v149
 v_max3_u32 v2, v2, v150, v151
 v_max3_u32 v2, v2, v152, v153
 v_max3_u32 v2, v2, v154, v155
 v_max3_u32 v2, v2, v156, v157
 v_max3_u32 v2, v2, v158, v159
 v_max3_u32 v2, v2, v160, v161
 v_max3_u32 v2, v2, v162, v163
 v_max3_u32 v2, v2, v164, v165
 v_max3_u32 v2, v2, v166, v167
 v_max3_u32 v2, v2, v168, v169
 v_max3_u32 v2, v2, v170, v171
 v_max3_u32 v2, v2, v172, v173
 v_max3_u32 v2, v2, v174, v175
 v_cmp_eq_u32 vcc, -1, v2
 s_cbranch_vccz written_20
 s_sleep 6
 s_add_u32 s72, s72, 1
 s_cmp_lt_u32 s72, 0x40000
 s_cbranch_scc1 poll_19
 s_branch adaLN_cond__memory_aug_recurrent_mem_tr__mixer_s_mlp__prompt_kernel_exit
written_20:
 v_pk_mul_f32 v[16:17], v[16:17], v[136:137]
 v_pk_mul_f32 v[18:19], v[18:19], v[138:139]
 v_pk_mul_f32 v[20:21], v[20:21], v[140:141]
 v_pk_mul_f32 v[22:23], v[22:23], v[142:143]
 v_pk_mul_f32 v[24:25], v[24:25], v[144:145]
 v_pk_mul_f32 v[26:27], v[26:27], v[146:147]
 v_pk_mul_f32 v[28:29], v[28:29], v[148:149]
 v_pk_mul_f32 v[30:31], v[30:31], v[150:151]
 v_pk_mul_f32 v[32:33], v[32:33], v[152:153]
 v_pk_mul_f32 v[34:35], v[34:35], v[154:155]
 v_pk_mul_f32 v[36:37], v[36:37], v[156:157]
 v_pk_mul_f32 v[38:39], v[38:39], v[158:159]
 v_pk_mul_f32 v[40:41], v[40:41], v[160:161]
 v_pk_mul_f32 v[42:43], v[42:43], v[162:163]
 v_pk_mul_f32 v[44:45], v[44:45], v[164:165]
 v_pk_mul_f32 v[46:47], v[46:47], v[166:167]
 v_pk_mul_f32 v[48:49], v[48:49], v[168:169]
 v_pk_mul_f32 v[50:51], v[50:51], v[170:171]
 v_pk_mul_f32 v[52:53], v[52:53], v[172:173]
 v_pk_mul_f32 v[54:55], v[54:55], v[174:175]
 v_cvt_pk_bf16_f32 v16, 0, v16
 v_cvt_pk_bf16_f32 v17, 0, v17
 v_cvt_pk_bf16_f32 v18, 0, v18
 v_cvt_pk_bf16_f32 v19, 0, v19
 v_cvt_pk_bf16_f32 v20, 0, v20
 v_cvt_pk_bf16_f32 v21, 0, v21
 v_cvt_pk_bf16_f32 v22, 0, v22
 v_cvt_pk_bf16_f32 v23, 0, v23
 v_cvt_pk_bf16_f32 v24, 0, v24
 v_cvt_pk_bf16_f32 v25, 0, v25
 v_cvt_pk_bf16_f32 v26, 0, v26
 v_cvt_pk_bf16_f32 v27, 0, v27
 v_cvt_pk_bf16_f32 v28, 0, v28
 v_cvt_pk_bf16_f32 v29, 0, v29
 v_cvt_pk_bf16_f32 v30, 0, v30
 v_cvt_pk_bf16_f32 v31, 0, v31
 v_cvt_pk_bf16_f32 v32, 0, v32
 v_cvt_pk_bf16_f32 v33, 0, v33
 v_cvt_pk_bf16_f32 v34, 0, v34
 v_cvt_pk_bf16_f32 v35, 0, v35
 v_cvt_pk_bf16_f32 v36, 0, v36
 v_cvt_pk_bf16_f32 v37, 0, v37
 v_cvt_pk_bf16_f32 v38, 0, v38
 v_cvt_pk_bf16_f32 v39, 0, v39
 v_cvt_pk_bf16_f32 v40, 0, v40
 v_cvt_pk_bf16_f32 v41, 0, v41
 v_cvt_pk_bf16_f32 v42, 0, v42
 v_cvt_pk_bf16_f32 v43, 0, v43
 v_cvt_pk_bf16_f32 v44, 0, v44
 v_cvt_pk_bf16_f32 v45, 0, v45
 v_cvt_pk_bf16_f32 v46, 0, v46
 v_cvt_pk_bf16_f32 v47, 0, v47
 v_cvt_pk_bf16_f32 v48, 0, v48
 v_cvt_pk_bf16_f32 v49, 0, v49
 v_cvt_pk_bf16_f32 v50, 0, v50
 v_cvt_pk_bf16_f32 v51, 0, v51
 v_cvt_pk_bf16_f32 v52, 0, v52
 v_cvt_pk_bf16_f32 v53, 0, v53
 v_cvt_pk_bf16_f32 v54, 0, v54
 v_cvt_pk_bf16_f32 v55, 0, v55
 v_pk_add_f32 v[16:17], v[16:17], v[96:97]
 v_pk_add_f32 v[18:19], v[18:19], v[98:99]
 v_pk_add_f32 v[20:21], v[20:21], v[100:101]
 v_pk_add_f32 v[22:23], v[22:23], v[102:103]
 v_pk_add_f32 v[24:25], v[24:25], v[104:105]
 v_pk_add_f32 v[26:27], v[26:27], v[106:107]
 v_pk_add_f32 v[28:29], v[28:29], v[108:109]
 v_pk_add_f32 v[30:31], v[30:31], v[110:111]
 v_pk_add_f32 v[32:33], v[32:33], v[112:113]
 v_pk_add_f32 v[34:35], v[34:35], v[114:115]
 v_pk_add_f32 v[36:37], v[36:37], v[116:117]
 v_pk_add_f32 v[38:39], v[38:39], v[118:119]
 v_pk_add_f32 v[40:41], v[40:41], v[120:121]
 v_pk_add_f32 v[42:43], v[42:43], v[122:123]
 v_pk_add_f32 v[44:45], v[44:45], v[124:125]
 v_pk_add_f32 v[46:47], v[46:47], v[126:127]
 v_pk_add_f32 v[48:49], v[48:49], v[128:129]
 v_pk_add_f32 v[50:51], v[50:51], v[130:131]
 v_pk_add_f32 v[52:53], v[52:53], v[132:133]
 v_pk_add_f32 v[54:55], v[54:55], v[134:135]
 v_cvt_pk_bf16_f32 v56, v16, v17
 v_cvt_pk_bf16_f32 v57, v18, v19
 v_cvt_pk_bf16_f32 v58, v20, v21
 v_cvt_pk_bf16_f32 v59, v22, v23
 v_cvt_pk_bf16_f32 v60, v24, v25
 v_cvt_pk_bf16_f32 v61, v26, v27
 v_cvt_pk_bf16_f32 v62, v28, v29
 v_cvt_pk_bf16_f32 v63, v30, v31
 v_cvt_pk_bf16_f32 v64, v32, v33
 v_cvt_pk_bf16_f32 v65, v34, v35
 v_cvt_pk_bf16_f32 v66, v36, v37
 v_cvt_pk_bf16_f32 v67, v38, v39
 v_cvt_pk_bf16_f32 v68, v40, v41
 v_cvt_pk_bf16_f32 v69, v42, v43
 v_cvt_pk_bf16_f32 v70, v44, v45
 v_cvt_pk_bf16_f32 v71, v46, v47
 v_cvt_pk_bf16_f32 v72, v48, v49
 v_cvt_pk_bf16_f32 v73, v50, v51
 v_cvt_pk_bf16_f32 v74, v52, v53
 v_cvt_pk_bf16_f32 v75, v54, v55
 s_mul_i32 s74, s6, 20480
 s_mul_i32 s73, s66, 5120
 s_add_u32 s73, s73, s74
 s_add_u32 s73, s73, 0xa40000
 s_add_u32 s74, s73, 4096
 buffer_store_dwordx4 v[56:59], v1, s[8:11], s73 offen offset:0 sc1
 buffer_store_dwordx4 v[60:63], v1, s[8:11], s73 offen offset:1024 sc1
 buffer_store_dwordx4 v[64:67], v1, s[8:11], s73 offen offset:2048 sc1
 buffer_store_dwordx4 v[68:71], v1, s[8:11], s73 offen offset:3072 sc1
 buffer_store_dwordx4 v[72:75], v1, s[8:11], s74 offen offset:0 sc1
 s_waitcnt vmcnt(0)
 s_barrier
 s_cmp_lg_u32 s66, 0
 s_cbranch_scc1 notw0_21
 s_lshl_b32 s73, s6, 7
 s_add_u32 s73, s73, 0
 v_mov_b32 v2, 1
 v_mov_b32 v3, 0
 s_mov_b64 exec, 1
 buffer_store_dword v2, v3, s[8:11], s73 offen sc1
 s_mov_b64 exec, -1
notw0_21:
noh_18:
 v_and_b32 v3, 31, v0
 v_lshlrev_b32 v3, 7, v3
 s_lshl_b32 s73, s66, 12
 s_add_u32 s73, s73, 0
wait_22:
 buffer_load_dword v2, v3, s[8:11], s73 offen sc1
 s_waitcnt vmcnt(0)
test_24:
 v_cmp_gt_u32 vcc, 1, v2
 s_and_b32 vcc_lo, vcc_lo, 0xffffffff
 s_and_b32 vcc_hi, vcc_hi, 0x0
 s_cmp_eq_u64 vcc, 0
 s_cbranch_scc1 ready_23
 s_sleep 3
 s_add_u32 s72, s72, 1
 s_cmp_lt_u32 s72, 0x40000
 s_cbranch_scc1 wait_22
 s_branch adaLN_cond__memory_aug_recurrent_mem_tr__mixer_s_mlp__prompt_kernel_exit
ready_23:
 s_barrier
 s_mul_i32 s73, s66, 20480
 s_mov_b32 s79, s73
 s_mul_i32 s77, s82, 81920
 s_add_u32 s77, s77, s73
 s_add_u32 s77, s77, 0xa40000
 s_lshr_b32 s73, s66, 1
 s_mul_i32 s74, s73, 40960
 v_add_u32 v8, s74, v1
 v_mov_b32 v9, 81920
 s_lshl_b32 s74, s82, 1
 s_add_u32 s73, s73, s74
 s_lshl_b32 s73, s73, 5
 s_add_u32 s73, s73, s81
 s_lshl_b32 s78, s73, 13
 s_and_b32 s73, s66, 1
 s_lshl_b32 s73, s73, 11
 s_add_u32 s78, s78, s73
 s_cmp_eq_u32 s80, 0
 s_mov_b32 s73, 0x2200000
 s_cselect_b32 s73, 0x3200000, s73
 s_add_u32 s78, s78, s73
 s_add_u32 s73, s80, 1
 s_cmp_eq_u32 s73, 3
 s_cselect_b32 s73, 0, s73
 s_lshl_b32 s73, s73, 1
 s_add_u32 s73, s73, s82
 s_lshl_b32 s83, s81, 3
 s_add_u32 s83, s83, s73
 s_lshl_b32 s83, s83, 7
 s_add_u32 s83, s83, 16384
 s_mov_b32 s76, 0
 s_mov_b32 s85, 81920
 s_add_u32 m0, s79, 0
 s_add_u32 s73, s77, 0
 buffer_load_dwordx4 v1, s[8:11], s73 offen offset:0 sc1 lds
 buffer_load_dwordx4 v1, s[8:11], s73 offen offset:1024 sc1 lds
 buffer_load_dwordx4 v1, s[8:11], s73 offen offset:2048 sc1 lds
 buffer_load_dwordx4 v1, s[8:11], s73 offen offset:3072 sc1 lds
 s_add_u32 m0, s79, 4096
 s_add_u32 s73, s77, 4096
 buffer_load_dwordx4 v1, s[8:11], s73 offen offset:0 sc1 lds
 buffer_load_dwordx4 v1, s[8:11], s73 offen offset:1024 sc1 lds
 buffer_load_dwordx4 v1, s[8:11], s73 offen offset:2048 sc1 lds
 buffer_load_dwordx4 v1, s[8:11], s73 offen offset:3072 sc1 lds
 s_add_u32 m0, s79, 8192
 s_add_u32 s73, s77, 8192
 buffer_load_dwordx4 v1, s[8:11], s73 offen offset:0 sc1 lds
 buffer_load_dwordx4 v1, s[8:11], s73 offen offset:1024 sc1 lds
 buffer_load_dwordx4 v1, s[8:11], s73 offen offset:2048 sc1 lds
 buffer_load_dwordx4 v1, s[8:11], s73 offen offset:3072 sc1 lds
 s_add_u32 m0, s79, 12288
 s_add_u32 s73, s77, 12288
 buffer_load_dwordx4 v1, s[8:11], s73 offen offset:0 sc1 lds
 buffer_load_dwordx4 v1, s[8:11], s73 offen offset:1024 sc1 lds
 buffer_load_dwordx4 v1, s[8:11], s73 offen offset:2048 sc1 lds
 buffer_load_dwordx4 v1, s[8:11], s73 offen offset:3072 sc1 lds
 s_add_u32 m0, s79, 16384
 s_add_u32 s73, s77, 16384
 buffer_load_dwordx4 v1, s[8:11], s73 offen offset:0 sc1 lds
 buffer_load_dwordx4 v1, s[8:11], s73 offen offset:1024 sc1 lds
 buffer_load_dwordx4 v1, s[8:11], s73 offen offset:2048 sc1 lds
 buffer_load_dwordx4 v1, s[8:11], s73 offen offset:3072 sc1 lds
 s_add_u32 s79, s79, s85
 s_sub_u32 s85, 0, s85
 s_add_u32 s77, s77, 163840
 s_waitcnt vmcnt(0)
qkv_qk_loop:
 s_cmp_lg_u32 s76, 1
 s_cbranch_scc1 qkv_qk_lag
 s_waitcnt vmcnt(0)
qkv_qk_lag:
 s_waitcnt vmcnt(4)
 s_barrier
 s_max_u32 s74, s76, 2
 s_sub_u32 s74, s74, 1
 s_min_u32 s74, s74, s76
 s_cmp_lg_u32 s66, 0
 s_cbranch_scc1 notw0_25
 v_mov_b32 v2, s74
 v_mov_b32 v3, 0
 s_mov_b64 exec, 1
 buffer_store_dword v2, v3, s[8:11], s83 offen sc1
 s_mov_b64 exec, -1
notw0_25:
 s_cmp_lt_u32 s76, 15
 s_cselect_b32 s77, s77, 0x40000000
 ds_read_b128 v[48:51], v8 offset:0
 ds_read_b128 v[52:55], v8 offset:20480
 ds_read_b128 v[56:59], v8 offset:1024
 ds_read_b128 v[60:63], v8 offset:21504
 s_waitcnt lgkmcnt(2)
 v_mfma_f32_16x16x32_bf16 v[16:19], v[192:195], v[48:51], 0
 v_mfma_f32_16x16x32_bf16 v[24:27], v[196:199], v[48:51], 0
 ds_read_b128 v[64:67], v8 offset:2048
 v_mfma_f32_16x16x32_bf16 v[32:35], v[200:203], v[48:51], 0
 ds_read_b128 v[68:71], v8 offset:22528
 v_mfma_f32_16x16x32_bf16 v[40:43], v[204:207], v[48:51], 0
 s_add_u32 m0, s79, 0
 v_mfma_f32_16x16x32_bf16 v[20:23], v[192:195], v[52:55], 0
 v_mfma_f32_16x16x32_bf16 v[28:31], v[196:199], v[52:55], 0
 s_add_u32 s73, s77, 0
 v_mfma_f32_16x16x32_bf16 v[36:39], v[200:203], v[52:55], 0
 v_mfma_f32_16x16x32_bf16 v[44:47], v[204:207], v[52:55], 0
 s_waitcnt lgkmcnt(2)
 v_mfma_f32_16x16x32_bf16 v[16:19], v[208:211], v[56:59], v[16:19]
 v_mfma_f32_16x16x32_bf16 v[24:27], v[212:215], v[56:59], v[24:27]
 ds_read_b128 v[48:51], v8 offset:3072
 v_mfma_f32_16x16x32_bf16 v[32:35], v[216:219], v[56:59], v[32:35]
 ds_read_b128 v[52:55], v8 offset:23552
 v_mfma_f32_16x16x32_bf16 v[40:43], v[220:223], v[56:59], v[40:43]
 buffer_load_dwordx4 v1, s[8:11], s73 offen offset:0 sc1 lds
 v_mfma_f32_16x16x32_bf16 v[20:23], v[208:211], v[60:63], v[20:23]
 v_mfma_f32_16x16x32_bf16 v[28:31], v[212:215], v[60:63], v[28:31]
 buffer_load_dwordx4 v1, s[8:11], s73 offen offset:1024 sc1 lds
 v_mfma_f32_16x16x32_bf16 v[36:39], v[216:219], v[60:63], v[36:39]
 v_mfma_f32_16x16x32_bf16 v[44:47], v[220:223], v[60:63], v[44:47]
 s_waitcnt lgkmcnt(2)
 v_mfma_f32_16x16x32_bf16 v[16:19], v[224:227], v[64:67], v[16:19]
 v_mfma_f32_16x16x32_bf16 v[24:27], v[228:231], v[64:67], v[24:27]
 ds_read_b128 v[56:59], v8 offset:4096
 v_mfma_f32_16x16x32_bf16 v[32:35], v[232:235], v[64:67], v[32:35]
 ds_read_b128 v[60:63], v8 offset:24576
 v_mfma_f32_16x16x32_bf16 v[40:43], v[236:239], v[64:67], v[40:43]
 buffer_load_dwordx4 v1, s[8:11], s73 offen offset:2048 sc1 lds
 v_mfma_f32_16x16x32_bf16 v[20:23], v[224:227], v[68:71], v[20:23]
 v_mfma_f32_16x16x32_bf16 v[28:31], v[228:231], v[68:71], v[28:31]
 buffer_load_dwordx4 v1, s[8:11], s73 offen offset:3072 sc1 lds
 v_mfma_f32_16x16x32_bf16 v[36:39], v[232:235], v[68:71], v[36:39]
 v_mfma_f32_16x16x32_bf16 v[44:47], v[236:239], v[68:71], v[44:47]
 s_waitcnt lgkmcnt(2)
 v_mfma_f32_16x16x32_bf16 v[16:19], v[240:243], v[48:51], v[16:19]
 v_mfma_f32_16x16x32_bf16 v[24:27], v[244:247], v[48:51], v[24:27]
 ds_read_b128 v[64:67], v8 offset:5120
 v_mfma_f32_16x16x32_bf16 v[32:35], v[248:251], v[48:51], v[32:35]
 ds_read_b128 v[68:71], v8 offset:25600
 v_mfma_f32_16x16x32_bf16 v[40:43], v[252:255], v[48:51], v[40:43]
 s_add_u32 m0, s79, 4096
 v_mfma_f32_16x16x32_bf16 v[20:23], v[240:243], v[52:55], v[20:23]
 v_mfma_f32_16x16x32_bf16 v[28:31], v[244:247], v[52:55], v[28:31]
 s_add_u32 s73, s77, 4096
 v_mfma_f32_16x16x32_bf16 v[36:39], v[248:251], v[52:55], v[36:39]
 v_mfma_f32_16x16x32_bf16 v[44:47], v[252:255], v[52:55], v[44:47]
 s_waitcnt lgkmcnt(2)
 v_mfma_f32_16x16x32_bf16 v[16:19], a[0:3], v[56:59], v[16:19]
 v_mfma_f32_16x16x32_bf16 v[24:27], a[4:7], v[56:59], v[24:27]
 ds_read_b128 v[48:51], v8 offset:6144
 v_mfma_f32_16x16x32_bf16 v[32:35], a[8:11], v[56:59], v[32:35]
 ds_read_b128 v[52:55], v8 offset:26624
 v_mfma_f32_16x16x32_bf16 v[40:43], a[12:15], v[56:59], v[40:43]
 buffer_load_dwordx4 v1, s[8:11], s73 offen offset:0 sc1 lds
 v_mfma_f32_16x16x32_bf16 v[20:23], a[0:3], v[60:63], v[20:23]
 v_mfma_f32_16x16x32_bf16 v[28:31], a[4:7], v[60:63], v[28:31]
 buffer_load_dwordx4 v1, s[8:11], s73 offen offset:1024 sc1 lds
 v_mfma_f32_16x16x32_bf16 v[36:39], a[8:11], v[60:63], v[36:39]
 v_mfma_f32_16x16x32_bf16 v[44:47], a[12:15], v[60:63], v[44:47]
 s_waitcnt lgkmcnt(2)
 v_mfma_f32_16x16x32_bf16 v[16:19], a[16:19], v[64:67], v[16:19]
 v_mfma_f32_16x16x32_bf16 v[24:27], a[20:23], v[64:67], v[24:27]
 ds_read_b128 v[56:59], v8 offset:7168
 v_mfma_f32_16x16x32_bf16 v[32:35], a[24:27], v[64:67], v[32:35]
 ds_read_b128 v[60:63], v8 offset:27648
 v_mfma_f32_16x16x32_bf16 v[40:43], a[28:31], v[64:67], v[40:43]
 buffer_load_dwordx4 v1, s[8:11], s73 offen offset:2048 sc1 lds
 v_mfma_f32_16x16x32_bf16 v[20:23], a[16:19], v[68:71], v[20:23]
 v_mfma_f32_16x16x32_bf16 v[28:31], a[20:23], v[68:71], v[28:31]
 buffer_load_dwordx4 v1, s[8:11], s73 offen offset:3072 sc1 lds
 v_mfma_f32_16x16x32_bf16 v[36:39], a[24:27], v[68:71], v[36:39]
 v_mfma_f32_16x16x32_bf16 v[44:47], a[28:31], v[68:71], v[44:47]
 s_waitcnt lgkmcnt(2)
 v_mfma_f32_16x16x32_bf16 v[16:19], a[32:35], v[48:51], v[16:19]
 v_mfma_f32_16x16x32_bf16 v[24:27], a[36:39], v[48:51], v[24:27]
 ds_read_b128 v[64:67], v8 offset:8192
 v_mfma_f32_16x16x32_bf16 v[32:35], a[40:43], v[48:51], v[32:35]
 ds_read_b128 v[68:71], v8 offset:28672
 v_mfma_f32_16x16x32_bf16 v[40:43], a[44:47], v[48:51], v[40:43]
 s_add_u32 m0, s79, 8192
 v_mfma_f32_16x16x32_bf16 v[20:23], a[32:35], v[52:55], v[20:23]
 v_mfma_f32_16x16x32_bf16 v[28:31], a[36:39], v[52:55], v[28:31]
 s_add_u32 s73, s77, 8192
 v_mfma_f32_16x16x32_bf16 v[36:39], a[40:43], v[52:55], v[36:39]
 v_mfma_f32_16x16x32_bf16 v[44:47], a[44:47], v[52:55], v[44:47]
 s_waitcnt lgkmcnt(2)
 v_mfma_f32_16x16x32_bf16 v[16:19], a[48:51], v[56:59], v[16:19]
 v_mfma_f32_16x16x32_bf16 v[24:27], a[52:55], v[56:59], v[24:27]
 ds_read_b128 v[48:51], v8 offset:9216
 v_mfma_f32_16x16x32_bf16 v[32:35], a[56:59], v[56:59], v[32:35]
 ds_read_b128 v[52:55], v8 offset:29696
 v_mfma_f32_16x16x32_bf16 v[40:43], a[60:63], v[56:59], v[40:43]
 buffer_load_dwordx4 v1, s[8:11], s73 offen offset:0 sc1 lds
 v_mfma_f32_16x16x32_bf16 v[20:23], a[48:51], v[60:63], v[20:23]
 v_mfma_f32_16x16x32_bf16 v[28:31], a[52:55], v[60:63], v[28:31]
 buffer_load_dwordx4 v1, s[8:11], s73 offen offset:1024 sc1 lds
 v_mfma_f32_16x16x32_bf16 v[36:39], a[56:59], v[60:63], v[36:39]
 v_mfma_f32_16x16x32_bf16 v[44:47], a[60:63], v[60:63], v[44:47]
 s_waitcnt lgkmcnt(2)
 v_mfma_f32_16x16x32_bf16 v[16:19], a[64:67], v[64:67], v[16:19]
 v_mfma_f32_16x16x32_bf16 v[24:27], a[68:71], v[64:67], v[24:27]
 ds_read_b128 v[56:59], v8 offset:10240
 v_mfma_f32_16x16x32_bf16 v[32:35], a[72:75], v[64:67], v[32:35]
 ds_read_b128 v[60:63], v8 offset:30720
 v_mfma_f32_16x16x32_bf16 v[40:43], a[76:79], v[64:67], v[40:43]
 buffer_load_dwordx4 v1, s[8:11], s73 offen offset:2048 sc1 lds
 v_mfma_f32_16x16x32_bf16 v[20:23], a[64:67], v[68:71], v[20:23]
 v_mfma_f32_16x16x32_bf16 v[28:31], a[68:71], v[68:71], v[28:31]
 buffer_load_dwordx4 v1, s[8:11], s73 offen offset:3072 sc1 lds
 v_mfma_f32_16x16x32_bf16 v[36:39], a[72:75], v[68:71], v[36:39]
 v_mfma_f32_16x16x32_bf16 v[44:47], a[76:79], v[68:71], v[44:47]
 s_waitcnt lgkmcnt(2)
 v_mfma_f32_16x16x32_bf16 v[16:19], a[80:83], v[48:51], v[16:19]
 v_mfma_f32_16x16x32_bf16 v[24:27], a[84:87], v[48:51], v[24:27]
 ds_read_b128 v[64:67], v8 offset:11264
 v_mfma_f32_16x16x32_bf16 v[32:35], a[88:91], v[48:51], v[32:35]
 ds_read_b128 v[68:71], v8 offset:31744
 v_mfma_f32_16x16x32_bf16 v[40:43], a[92:95], v[48:51], v[40:43]
 s_add_u32 m0, s79, 12288
 v_mfma_f32_16x16x32_bf16 v[20:23], a[80:83], v[52:55], v[20:23]
 v_mfma_f32_16x16x32_bf16 v[28:31], a[84:87], v[52:55], v[28:31]
 s_add_u32 s73, s77, 12288
 v_mfma_f32_16x16x32_bf16 v[36:39], a[88:91], v[52:55], v[36:39]
 v_mfma_f32_16x16x32_bf16 v[44:47], a[92:95], v[52:55], v[44:47]
 s_waitcnt lgkmcnt(2)
 v_mfma_f32_16x16x32_bf16 v[16:19], a[96:99], v[56:59], v[16:19]
 v_mfma_f32_16x16x32_bf16 v[24:27], a[100:103], v[56:59], v[24:27]
 ds_read_b128 v[48:51], v8 offset:12288
 v_mfma_f32_16x16x32_bf16 v[32:35], a[104:107], v[56:59], v[32:35]
 ds_read_b128 v[52:55], v8 offset:32768
 v_mfma_f32_16x16x32_bf16 v[40:43], a[108:111], v[56:59], v[40:43]
 buffer_load_dwordx4 v1, s[8:11], s73 offen offset:0 sc1 lds
 v_mfma_f32_16x16x32_bf16 v[20:23], a[96:99], v[60:63], v[20:23]
 v_mfma_f32_16x16x32_bf16 v[28:31], a[100:103], v[60:63], v[28:31]
 buffer_load_dwordx4 v1, s[8:11], s73 offen offset:1024 sc1 lds
 v_mfma_f32_16x16x32_bf16 v[36:39], a[104:107], v[60:63], v[36:39]
 v_mfma_f32_16x16x32_bf16 v[44:47], a[108:111], v[60:63], v[44:47]
 s_waitcnt lgkmcnt(2)
 v_mfma_f32_16x16x32_bf16 v[16:19], a[112:115], v[64:67], v[16:19]
 v_mfma_f32_16x16x32_bf16 v[24:27], a[116:119], v[64:67], v[24:27]
 ds_read_b128 v[56:59], v8 offset:13312
 v_mfma_f32_16x16x32_bf16 v[32:35], a[120:123], v[64:67], v[32:35]
 ds_read_b128 v[60:63], v8 offset:33792
 v_mfma_f32_16x16x32_bf16 v[40:43], a[124:127], v[64:67], v[40:43]
 buffer_load_dwordx4 v1, s[8:11], s73 offen offset:2048 sc1 lds
 v_mfma_f32_16x16x32_bf16 v[20:23], a[112:115], v[68:71], v[20:23]
 v_mfma_f32_16x16x32_bf16 v[28:31], a[116:119], v[68:71], v[28:31]
 buffer_load_dwordx4 v1, s[8:11], s73 offen offset:3072 sc1 lds
 v_mfma_f32_16x16x32_bf16 v[36:39], a[120:123], v[68:71], v[36:39]
 v_mfma_f32_16x16x32_bf16 v[44:47], a[124:127], v[68:71], v[44:47]
 s_waitcnt lgkmcnt(2)
 v_mfma_f32_16x16x32_bf16 v[16:19], a[128:131], v[48:51], v[16:19]
 v_mfma_f32_16x16x32_bf16 v[24:27], a[132:135], v[48:51], v[24:27]
 ds_read_b128 v[64:67], v8 offset:14336
 v_mfma_f32_16x16x32_bf16 v[32:35], a[136:139], v[48:51], v[32:35]
 ds_read_b128 v[68:71], v8 offset:34816
 v_mfma_f32_16x16x32_bf16 v[40:43], a[140:143], v[48:51], v[40:43]
 s_add_u32 m0, s79, 16384
 v_mfma_f32_16x16x32_bf16 v[20:23], a[128:131], v[52:55], v[20:23]
 v_mfma_f32_16x16x32_bf16 v[28:31], a[132:135], v[52:55], v[28:31]
 s_add_u32 s73, s77, 16384
 v_mfma_f32_16x16x32_bf16 v[36:39], a[136:139], v[52:55], v[36:39]
 v_mfma_f32_16x16x32_bf16 v[44:47], a[140:143], v[52:55], v[44:47]
 s_waitcnt lgkmcnt(2)
 v_mfma_f32_16x16x32_bf16 v[16:19], a[144:147], v[56:59], v[16:19]
 v_mfma_f32_16x16x32_bf16 v[24:27], a[148:151], v[56:59], v[24:27]
 ds_read_b128 v[48:51], v8 offset:15360
 v_mfma_f32_16x16x32_bf16 v[32:35], a[152:155], v[56:59], v[32:35]
 ds_read_b128 v[52:55], v8 offset:35840
 v_mfma_f32_16x16x32_bf16 v[40:43], a[156:159], v[56:59], v[40:43]
 buffer_load_dwordx4 v1, s[8:11], s73 offen offset:0 sc1 lds
 v_mfma_f32_16x16x32_bf16 v[20:23], a[144:147], v[60:63], v[20:23]
 v_mfma_f32_16x16x32_bf16 v[28:31], a[148:151], v[60:63], v[28:31]
 buffer_load_dwordx4 v1, s[8:11], s73 offen offset:1024 sc1 lds
 v_mfma_f32_16x16x32_bf16 v[36:39], a[152:155], v[60:63], v[36:39]
 v_mfma_f32_16x16x32_bf16 v[44:47], a[156:159], v[60:63], v[44:47]
 s_waitcnt lgkmcnt(2)
 v_mfma_f32_16x16x32_bf16 v[16:19], a[160:163], v[64:67], v[16:19]
 v_mfma_f32_16x16x32_bf16 v[24:27], a[164:167], v[64:67], v[24:27]
 ds_read_b128 v[56:59], v8 offset:16384
 v_mfma_f32_16x16x32_bf16 v[32:35], a[168:171], v[64:67], v[32:35]
 ds_read_b128 v[60:63], v8 offset:36864
 v_mfma_f32_16x16x32_bf16 v[40:43], a[172:175], v[64:67], v[40:43]
 buffer_load_dwordx4 v1, s[8:11], s73 offen offset:2048 sc1 lds
 v_mfma_f32_16x16x32_bf16 v[20:23], a[160:163], v[68:71], v[20:23]
 v_mfma_f32_16x16x32_bf16 v[28:31], a[164:167], v[68:71], v[28:31]
 buffer_load_dwordx4 v1, s[8:11], s73 offen offset:3072 sc1 lds
 v_mfma_f32_16x16x32_bf16 v[36:39], a[168:171], v[68:71], v[36:39]
 v_mfma_f32_16x16x32_bf16 v[44:47], a[172:175], v[68:71], v[44:47]
 s_waitcnt lgkmcnt(2)
 v_mfma_f32_16x16x32_bf16 v[16:19], a[176:179], v[48:51], v[16:19]
 v_mfma_f32_16x16x32_bf16 v[24:27], a[180:183], v[48:51], v[24:27]
 ds_read_b128 v[64:67], v8 offset:17408
 v_mfma_f32_16x16x32_bf16 v[32:35], a[184:187], v[48:51], v[32:35]
 ds_read_b128 v[68:71], v8 offset:37888
 v_mfma_f32_16x16x32_bf16 v[40:43], a[188:191], v[48:51], v[40:43]
 v_mfma_f32_16x16x32_bf16 v[20:23], a[176:179], v[52:55], v[20:23]
 v_mfma_f32_16x16x32_bf16 v[28:31], a[180:183], v[52:55], v[28:31]
 v_mfma_f32_16x16x32_bf16 v[36:39], a[184:187], v[52:55], v[36:39]
 v_mfma_f32_16x16x32_bf16 v[44:47], a[188:191], v[52:55], v[44:47]
 s_waitcnt lgkmcnt(2)
 v_mfma_f32_16x16x32_bf16 v[16:19], a[192:195], v[56:59], v[16:19]
 v_mfma_f32_16x16x32_bf16 v[24:27], a[196:199], v[56:59], v[24:27]
 ds_read_b128 v[48:51], v8 offset:18432
 v_mfma_f32_16x16x32_bf16 v[32:35], a[200:203], v[56:59], v[32:35]
 ds_read_b128 v[52:55], v8 offset:38912
 v_mfma_f32_16x16x32_bf16 v[40:43], a[204:207], v[56:59], v[40:43]
 v_mfma_f32_16x16x32_bf16 v[20:23], a[192:195], v[60:63], v[20:23]
 v_mfma_f32_16x16x32_bf16 v[28:31], a[196:199], v[60:63], v[28:31]
 v_mfma_f32_16x16x32_bf16 v[36:39], a[200:203], v[60:63], v[36:39]
 v_mfma_f32_16x16x32_bf16 v[44:47], a[204:207], v[60:63], v[44:47]
 s_waitcnt lgkmcnt(2)
 v_mfma_f32_16x16x32_bf16 v[16:19], a[208:211], v[64:67], v[16:19]
 v_mfma_f32_16x16x32_bf16 v[24:27], a[212:215], v[64:67], v[24:27]
 ds_read_b128 v[56:59], v8 offset:19456
 v_mfma_f32_16x16x32_bf16 v[32:35], a[216:219], v[64:67], v[32:35]
 ds_read_b128 v[60:63], v8 offset:39936
 v_mfma_f32_16x16x32_bf16 v[40:43], a[220:223], v[64:67], v[40:43]
 v_mfma_f32_16x16x32_bf16 v[20:23], a[208:211], v[68:71], v[20:23]
 v_mfma_f32_16x16x32_bf16 v[28:31], a[212:215], v[68:71], v[28:31]
 v_mfma_f32_16x16x32_bf16 v[36:39], a[216:219], v[68:71], v[36:39]
 v_mfma_f32_16x16x32_bf16 v[44:47], a[220:223], v[68:71], v[44:47]
 s_waitcnt lgkmcnt(2)
 v_mfma_f32_16x16x32_bf16 v[16:19], a[224:227], v[48:51], v[16:19]
 v_mfma_f32_16x16x32_bf16 v[24:27], a[228:231], v[48:51], v[24:27]
 v_mfma_f32_16x16x32_bf16 v[32:35], a[232:235], v[48:51], v[32:35]
 v_mfma_f32_16x16x32_bf16 v[40:43], a[236:239], v[48:51], v[40:43]
 v_mfma_f32_16x16x32_bf16 v[20:23], a[224:227], v[52:55], v[20:23]
 v_mfma_f32_16x16x32_bf16 v[28:31], a[228:231], v[52:55], v[28:31]
 v_mfma_f32_16x16x32_bf16 v[36:39], a[232:235], v[52:55], v[36:39]
 v_mfma_f32_16x16x32_bf16 v[44:47], a[236:239], v[52:55], v[44:47]
 s_waitcnt lgkmcnt(0)
 v_mfma_f32_16x16x32_bf16 v[16:19], a[240:243], v[56:59], v[16:19]
 v_mfma_f32_16x16x32_bf16 v[24:27], a[244:247], v[56:59], v[24:27]
 v_mfma_f32_16x16x32_bf16 v[32:35], a[248:251], v[56:59], v[32:35]
 v_mfma_f32_16x16x32_bf16 v[40:43], a[252:255], v[56:59], v[40:43]
 v_mfma_f32_16x16x32_bf16 v[20:23], a[240:243], v[60:63], v[20:23]
 v_mfma_f32_16x16x32_bf16 v[28:31], a[244:247], v[60:63], v[28:31]
 v_mfma_f32_16x16x32_bf16 v[36:39], a[248:251], v[60:63], v[36:39]
 v_mfma_f32_16x16x32_bf16 v[44:47], a[252:255], v[60:63], v[44:47]
 v_add_u32 v8, v8, v9
 v_sub_u32 v9, 0, v9
 s_add_u32 s79, s79, s85
 s_sub_u32 s85, 0, s85
 s_add_u32 s77, s77, 163840
 v_cvt_pk_bf16_f32 v48, v16, v17
 v_cvt_pk_bf16_f32 v49, v18, v19
 v_cvt_pk_bf16_f32 v50, v24, v25
 v_cvt_pk_bf16_f32 v51, v26, v27
 buffer_store_dwordx4 v[48:51], v1, s[8:11], s78 offen offset:0 sc1
 v_cvt_pk_bf16_f32 v52, v20, v21
 v_cvt_pk_bf16_f32 v53, v22, v23
 v_cvt_pk_bf16_f32 v54, v28, v29
 v_cvt_pk_bf16_f32 v55, v30, v31
 s_add_u32 s73, s78, 4096
 buffer_store_dwordx4 v[52:55], v1, s[8:11], s73 offen offset:0 sc1
 v_cvt_pk_bf16_f32 v56, v32, v33
 v_cvt_pk_bf16_f32 v57, v34, v35
 v_cvt_pk_bf16_f32 v58, v40, v41
 v_cvt_pk_bf16_f32 v59, v42, v43
 buffer_store_dwordx4 v[56:59], v1, s[8:11], s78 offen offset:1024 sc1
 v_cvt_pk_bf16_f32 v60, v36, v37
 v_cvt_pk_bf16_f32 v61, v38, v39
 v_cvt_pk_bf16_f32 v62, v44, v45
 v_cvt_pk_bf16_f32 v63, v46, v47
 s_add_u32 s73, s78, 4096
 buffer_store_dwordx4 v[60:63], v1, s[8:11], s73 offen offset:1024 sc1
 s_add_u32 s78, s78, 0x100000
 s_add_u32 s76, s76, 1
 s_cmp_lt_u32 s76, 16
 s_cbranch_scc1 qkv_qk_loop
 s_waitcnt vmcnt(0)
 s_barrier
 s_cmp_lg_u32 s66, 0
 s_cbranch_scc1 notw0_26
 v_mov_b32 v2, 16
 v_mov_b32 v3, 0
 s_mov_b64 exec, 1
 buffer_store_dword v2, v3, s[8:11], s83 offen sc1
 s_mov_b64 exec, -1
notw0_26:
 s_branch qkv_done
qkv_v:
 s_lshl_b32 s73, s66, 2
 v_lshrrev_b32 v7, 4, v0
 v_add_u32 v4, s73, v7
 v_and_b32 v5, 15, v0
 s_mov_b32 s73, 8192
 v_mul_lo_u32 v6, v4, s73
 v_lshl_add_u32 v6, v5, 4, v6
 v_lshlrev_b32 v7, 2, v7
 v_xor_b32 v7, v7, v5
 v_lshlrev_b32 v7, 4, v7
 v_lshl_add_u32 v7, v4, 8, v7
 s_add_u32 s73, s75, 0
 buffer_load_dwordx4 v[96:99], v6, s[12:15], s73 offen
 s_add_u32 s73, s75, 131072
 buffer_load_dwordx4 v[100:103], v6, s[12:15], s73 offen
 s_add_u32 s73, s75, 262144
 buffer_load_dwordx4 v[104:107], v6, s[12:15], s73 offen
 s_add_u32 s73, s75, 393216
 buffer_load_dwordx4 v[108:111], v6, s[12:15], s73 offen
 s_add_u32 s73, s75, 524288
 buffer_load_dwordx4 v[112:115], v6, s[12:15], s73 offen
 s_add_u32 s73, s75, 655360
 buffer_load_dwordx4 v[116:119], v6, s[12:15], s73 offen
 s_add_u32 s73, s75, 786432
 buffer_load_dwordx4 v[120:123], v6, s[12:15], s73 offen
 s_add_u32 s73, s75, 917504
 buffer_load_dwordx4 v[124:127], v6, s[12:15], s73 offen
 s_add_u32 s73, s75, 1048576
 buffer_load_dwordx4 v[128:131], v6, s[12:15], s73 offen
 s_add_u32 s73, s75, 1179648
 buffer_load_dwordx4 v[132:135], v6, s[12:15], s73 offen
 s_add_u32 s73, s75, 1310720
 buffer_load_dwordx4 v[136:139], v6, s[12:15], s73 offen
 s_add_u32 s73, s75, 1441792
 buffer_load_dwordx4 v[140:143], v6, s[12:15], s73 offen
 s_add_u32 s73, s75, 1572864
 buffer_load_dwordx4 v[144:147], v6, s[12:15], s73 offen
 s_add_u32 s73, s75, 1703936
 buffer_load_dwordx4 v[148:151], v6, s[12:15], s73 offen
 s_add_u32 s73, s75, 1835008
 buffer_load_dwordx4 v[152:155], v6, s[12:15], s73 offen
 s_add_u32 s73, s75, 1966080
 buffer_load_dwordx4 v[156:159], v6, s[12:15], s73 offen
 s_add_u32 s73, s75, 2097152
 buffer_load_dwordx4 v[160:163], v6, s[12:15], s73 offen
 s_add_u32 s73, s75, 2228224
 buffer_load_dwordx4 v[164:167], v6, s[12:15], s73 offen
 s_add_u32 s73, s75, 2359296
 buffer_load_dwordx4 v[168:171], v6, s[12:15], s73 offen
 s_add_u32 s73, s75, 2490368
 buffer_load_dwordx4 v[172:175], v6, s[12:15], s73 offen
 s_add_u32 s73, s75, 2621440
 buffer_load_dwordx4 v[176:179], v6, s[12:15], s73 offen
 s_add_u32 s73, s75, 2752512
 buffer_load_dwordx4 v[180:183], v6, s[12:15], s73 offen
 s_add_u32 s73, s75, 2883584
 buffer_load_dwordx4 v[184:187], v6, s[12:15], s73 offen
 s_add_u32 s73, s75, 3014656
 buffer_load_dwordx4 v[188:191], v6, s[12:15], s73 offen
 s_add_u32 s73, s75, 3145728
 buffer_load_dwordx4 v[192:195], v6, s[12:15], s73 offen
 s_add_u32 s73, s75, 3276800
 buffer_load_dwordx4 v[196:199], v6, s[12:15], s73 offen
 s_add_u32 s73, s75, 3407872
 buffer_load_dwordx4 v[200:203], v6, s[12:15], s73 offen
 s_add_u32 s73, s75, 3538944
 buffer_load_dwordx4 v[204:207], v6, s[12:15], s73 offen
 s_add_u32 s73, s75, 3670016
 buffer_load_dwordx4 v[208:211], v6, s[12:15], s73 offen
 s_add_u32 s73, s75, 3801088
 buffer_load_dwordx4 v[212:215], v6, s[12:15], s73 offen
 s_add_u32 s73, s75, 3932160
 buffer_load_dwordx4 v[216:219], v6, s[12:15], s73 offen
 s_add_u32 s73, s75, 4063232
 buffer_load_dwordx4 v[220:223], v6, s[12:15], s73 offen
 s_add_u32 s73, s75, 4194304
 buffer_load_dwordx4 v[224:227], v6, s[12:15], s73 offen
 s_add_u32 s73, s75, 4325376
 buffer_load_dwordx4 v[228:231], v6, s[12:15], s73 offen
 s_add_u32 s73, s75, 4456448
 buffer_load_dwordx4 v[232:235], v6, s[12:15], s73 offen
 s_add_u32 s73, s75, 4587520
 buffer_load_dwordx4 v[236:239], v6, s[12:15], s73 offen
 s_add_u32 s73, s75, 4718592
 buffer_load_dwordx4 v[240:243], v6, s[12:15], s73 offen
 s_add_u32 s73, s75, 4849664
 buffer_load_dwordx4 v[244:247], v6, s[12:15], s73 offen
 s_add_u32 s73, s75, 4980736
 buffer_load_dwordx4 v[248:251], v6, s[12:15], s73 offen
 s_add_u32 s73, s75, 5111808
 buffer_load_dwordx4 v[252:255], v6, s[12:15], s73 offen
 s_cmp_ge_u32 s6, 128
 s_cbranch_scc1 nonorm_27
 v_and_b32 v77, 15, v0
 v_lshlrev_b32 v77, 4, v77
 s_lshl_b32 s73, s66, 2
 v_add_u32 v76, s73, v77
 v_and_b32 v55, 0xffff0000, v75
 v_lshlrev_b32 v54, 16, v75
 v_and_b32 v53, 0xffff0000, v74
 v_lshlrev_b32 v52, 16, v74
 v_and_b32 v51, 0xffff0000, v73
 v_lshlrev_b32 v50, 16, v73
 v_and_b32 v49, 0xffff0000, v72
 v_lshlrev_b32 v48, 16, v72
 v_and_b32 v47, 0xffff0000, v71
 v_lshlrev_b32 v46, 16, v71
 v_and_b32 v45, 0xffff0000, v70
 v_lshlrev_b32 v44, 16, v70
 v_and_b32 v43, 0xffff0000, v69
 v_lshlrev_b32 v42, 16, v69
 v_and_b32 v41, 0xffff0000, v68
 v_lshlrev_b32 v40, 16, v68
 v_and_b32 v39, 0xffff0000, v67
 v_lshlrev_b32 v38, 16, v67
 v_and_b32 v37, 0xffff0000, v66
 v_lshlrev_b32 v36, 16, v66
 v_and_b32 v35, 0xffff0000, v65
 v_lshlrev_b32 v34, 16, v65
 v_and_b32 v33, 0xffff0000, v64
 v_lshlrev_b32 v32, 16, v64
 v_and_b32 v31, 0xffff0000, v63
 v_lshlrev_b32 v30, 16, v63
 v_and_b32 v29, 0xffff0000, v62
 v_lshlrev_b32 v28, 16, v62
 v_and_b32 v27, 0xffff0000, v61
 v_lshlrev_b32 v26, 16, v61
 v_and_b32 v25, 0xffff0000, v60
 v_lshlrev_b32 v24, 16, v60
 v_and_b32 v23, 0xffff0000, v59
 v_lshlrev_b32 v22, 16, v59
 v_and_b32 v21, 0xffff0000, v58
 v_lshlrev_b32 v20, 16, v58
 v_and_b32 v19, 0xffff0000, v57
 v_lshlrev_b32 v18, 16, v57
 v_and_b32 v17, 0xffff0000, v56
 v_lshlrev_b32 v16, 16, v56
 v_pk_add_f32 v[82:83], v[16:17], v[18:19]
 v_pk_add_f32 v[82:83], v[82:83], v[20:21]
 v_pk_add_f32 v[82:83], v[82:83], v[22:23]
 v_pk_add_f32 v[82:83], v[82:83], v[24:25]
 v_pk_add_f32 v[82:83], v[82:83], v[26:27]
 v_pk_add_f32 v[82:83], v[82:83], v[28:29]
 v_pk_add_f32 v[82:83], v[82:83], v[30:31]
 v_pk_add_f32 v[82:83], v[82:83], v[32:33]
 v_pk_add_f32 v[82:83], v[82:83], v[34:35]
 v_pk_add_f32 v[82:83], v[82:83], v[36:37]
 v_pk_add_f32 v[82:83], v[82:83], v[38:39]
 v_pk_add_f32 v[82:83], v[82:83], v[40:41]
 v_pk_add_f32 v[82:83], v[82:83], v[42:43]
 v_pk_add_f32 v[82:83], v[82:83], v[44:45]
 v_pk_add_f32 v[82:83], v[82:83], v[46:47]
 v_pk_add_f32 v[82:83], v[82:83], v[48:49]
 v_pk_add_f32 v[82:83], v[82:83], v[50:51]
 v_pk_add_f32 v[82:83], v[82:83], v[52:53]
 v_pk_add_f32 v[82:83], v[82:83], v[54:55]
 v_add_f32 v82, v82, v83
 v_mov_b32 v83, v82
 s_nop 1
 v_permlane16_swap_b32 v82, v83
 v_add_f32 v82, v82, v83
 v_mov_b32 v83, v82
 s_nop 1
 v_permlane32_swap_b32 v82, v83
 v_add_f32 v82, v82, v83
 ds_write_b32 v76, v82 offset:0
 s_waitcnt lgkmcnt(0)
 s_barrier
 ds_read_b128 v[82:85], v77 offset:0
 s_waitcnt lgkmcnt(0)
 v_pk_add_f32 v[82:83], v[82:83], v[84:85]
 v_add_f32 v82, v82, v83
 v_mul_f32 v82, 0x3acccccd, v82
 v_mov_b32 v80, v82
 v_pk_add_f32 v[84:85], v[16:17], v[80:81] op_sel_hi:[1,0] neg_lo:[0,1] neg_hi:[0,1]
 v_pk_mul_f32 v[82:83], v[84:85], v[84:85]
 v_pk_add_f32 v[84:85], v[18:19], v[80:81] op_sel_hi:[1,0] neg_lo:[0,1] neg_hi:[0,1]
 v_pk_fma_f32 v[82:83], v[84:85], v[84:85], v[82:83]
 v_pk_add_f32 v[84:85], v[20:21], v[80:81] op_sel_hi:[1,0] neg_lo:[0,1] neg_hi:[0,1]
 v_pk_fma_f32 v[82:83], v[84:85], v[84:85], v[82:83]
 v_pk_add_f32 v[84:85], v[22:23], v[80:81] op_sel_hi:[1,0] neg_lo:[0,1] neg_hi:[0,1]
 v_pk_fma_f32 v[82:83], v[84:85], v[84:85], v[82:83]
 v_pk_add_f32 v[84:85], v[24:25], v[80:81] op_sel_hi:[1,0] neg_lo:[0,1] neg_hi:[0,1]
 v_pk_fma_f32 v[82:83], v[84:85], v[84:85], v[82:83]
 v_pk_add_f32 v[84:85], v[26:27], v[80:81] op_sel_hi:[1,0] neg_lo:[0,1] neg_hi:[0,1]
 v_pk_fma_f32 v[82:83], v[84:85], v[84:85], v[82:83]
 v_pk_add_f32 v[84:85], v[28:29], v[80:81] op_sel_hi:[1,0] neg_lo:[0,1] neg_hi:[0,1]
 v_pk_fma_f32 v[82:83], v[84:85], v[84:85], v[82:83]
 v_pk_add_f32 v[84:85], v[30:31], v[80:81] op_sel_hi:[1,0] neg_lo:[0,1] neg_hi:[0,1]
 v_pk_fma_f32 v[82:83], v[84:85], v[84:85], v[82:83]
 v_pk_add_f32 v[84:85], v[32:33], v[80:81] op_sel_hi:[1,0] neg_lo:[0,1] neg_hi:[0,1]
 v_pk_fma_f32 v[82:83], v[84:85], v[84:85], v[82:83]
 v_pk_add_f32 v[84:85], v[34:35], v[80:81] op_sel_hi:[1,0] neg_lo:[0,1] neg_hi:[0,1]
 v_pk_fma_f32 v[82:83], v[84:85], v[84:85], v[82:83]
 v_pk_add_f32 v[84:85], v[36:37], v[80:81] op_sel_hi:[1,0] neg_lo:[0,1] neg_hi:[0,1]
 v_pk_fma_f32 v[82:83], v[84:85], v[84:85], v[82:83]
 v_pk_add_f32 v[84:85], v[38:39], v[80:81] op_sel_hi:[1,0] neg_lo:[0,1] neg_hi:[0,1]
 v_pk_fma_f32 v[82:83], v[84:85], v[84:85], v[82:83]
 v_pk_add_f32 v[84:85], v[40:41], v[80:81] op_sel_hi:[1,0] neg_lo:[0,1] neg_hi:[0,1]
 v_pk_fma_f32 v[82:83], v[84:85], v[84:85], v[82:83]
 v_pk_add_f32 v[84:85], v[42:43], v[80:81] op_sel_hi:[1,0] neg_lo:[0,1] neg_hi:[0,1]
 v_pk_fma_f32 v[82:83], v[84:85], v[84:85], v[82:83]
 v_pk_add_f32 v[84:85], v[44:45], v[80:81] op_sel_hi:[1,0] neg_lo:[0,1] neg_hi:[0,1]
 v_pk_fma_f32 v[82:83], v[84:85], v[84:85], v[82:83]
 v_pk_add_f32 v[84:85], v[46:47], v[80:81] op_sel_hi:[1,0] neg_lo:[0,1] neg_hi:[0,1]
 v_pk_fma_f32 v[82:83], v[84:85], v[84:85], v[82:83]
 v_pk_add_f32 v[84:85], v[48:49], v[80:81] op_sel_hi:[1,0] neg_lo:[0,1] neg_hi:[0,1]
 v_pk_fma_f32 v[82:83], v[84:85], v[84:85], v[82:83]
 v_pk_add_f32 v[84:85], v[50:51], v[80:81] op_sel_hi:[1,0] neg_lo:[0,1] neg_hi:[0,1]
 v_pk_fma_f32 v[82:83], v[84:85], v[84:85], v[82:83]
 v_pk_add_f32 v[84:85], v[52:53], v[80:81] op_sel_hi:[1,0] neg_lo:[0,1] neg_hi:[0,1]
 v_pk_fma_f32 v[82:83], v[84:85], v[84:85], v[82:83]
 v_pk_add_f32 v[84:85], v[54:55], v[80:81] op_sel_hi:[1,0] neg_lo:[0,1] neg_hi:[0,1]
 v_pk_fma_f32 v[82:83], v[84:85], v[84:85], v[82:83]
 v_add_f32 v82, v82, v83
 v_mov_b32 v83, v82
 s_nop 1
 v_permlane16_swap_b32 v82, v83
 v_add_f32 v82, v82, v83
 v_mov_b32 v83, v82
 s_nop 1
 v_permlane32_swap_b32 v82, v83
 v_add_f32 v82, v82, v83
 ds_write_b32 v76, v82 offset:256
 s_waitcnt lgkmcnt(0)
 s_barrier
 ds_read_b128 v[82:85], v77 offset:256
 s_waitcnt lgkmcnt(0)
 v_pk_add_f32 v[82:83], v[82:83], v[84:85]
 v_add_f32 v82, v82, v83
 v_mul_f32 v82, 0x3acccccd, v82
 v_cvt_pk_bf16_f32 v82, 0, v82
 v_add_f32 v82, 0x3727c5ac, v82
 v_cvt_pk_bf16_f32 v82, 0, v82
 v_sqrt_f32 v82, v82
 v_cvt_pk_bf16_f32 v80, 0, v80
 v_cvt_pk_bf16_f32 v82, 0, v82
 v_rcp_f32 v82, v82
 v_pk_add_f32 v[16:17], v[16:17], v[80:81] op_sel_hi:[1,0] neg_lo:[0,1] neg_hi:[0,1]
 v_pk_add_f32 v[18:19], v[18:19], v[80:81] op_sel_hi:[1,0] neg_lo:[0,1] neg_hi:[0,1]
 v_pk_add_f32 v[20:21], v[20:21], v[80:81] op_sel_hi:[1,0] neg_lo:[0,1] neg_hi:[0,1]
 v_pk_add_f32 v[22:23], v[22:23], v[80:81] op_sel_hi:[1,0] neg_lo:[0,1] neg_hi:[0,1]
 v_pk_add_f32 v[24:25], v[24:25], v[80:81] op_sel_hi:[1,0] neg_lo:[0,1] neg_hi:[0,1]
 v_pk_add_f32 v[26:27], v[26:27], v[80:81] op_sel_hi:[1,0] neg_lo:[0,1] neg_hi:[0,1]
 v_pk_add_f32 v[28:29], v[28:29], v[80:81] op_sel_hi:[1,0] neg_lo:[0,1] neg_hi:[0,1]
 v_pk_add_f32 v[30:31], v[30:31], v[80:81] op_sel_hi:[1,0] neg_lo:[0,1] neg_hi:[0,1]
 v_pk_add_f32 v[32:33], v[32:33], v[80:81] op_sel_hi:[1,0] neg_lo:[0,1] neg_hi:[0,1]
 v_pk_add_f32 v[34:35], v[34:35], v[80:81] op_sel_hi:[1,0] neg_lo:[0,1] neg_hi:[0,1]
 v_pk_add_f32 v[36:37], v[36:37], v[80:81] op_sel_hi:[1,0] neg_lo:[0,1] neg_hi:[0,1]
 v_pk_add_f32 v[38:39], v[38:39], v[80:81] op_sel_hi:[1,0] neg_lo:[0,1] neg_hi:[0,1]
 v_pk_add_f32 v[40:41], v[40:41], v[80:81] op_sel_hi:[1,0] neg_lo:[0,1] neg_hi:[0,1]
 v_pk_add_f32 v[42:43], v[42:43], v[80:81] op_sel_hi:[1,0] neg_lo:[0,1] neg_hi:[0,1]
 v_pk_add_f32 v[44:45], v[44:45], v[80:81] op_sel_hi:[1,0] neg_lo:[0,1] neg_hi:[0,1]
 v_pk_add_f32 v[46:47], v[46:47], v[80:81] op_sel_hi:[1,0] neg_lo:[0,1] neg_hi:[0,1]
 v_pk_add_f32 v[48:49], v[48:49], v[80:81] op_sel_hi:[1,0] neg_lo:[0,1] neg_hi:[0,1]
 v_pk_add_f32 v[50:51], v[50:51], v[80:81] op_sel_hi:[1,0] neg_lo:[0,1] neg_hi:[0,1]
 v_pk_add_f32 v[52:53], v[52:53], v[80:81] op_sel_hi:[1,0] neg_lo:[0,1] neg_hi:[0,1]
 v_pk_add_f32 v[54:55], v[54:55], v[80:81] op_sel_hi:[1,0] neg_lo:[0,1] neg_hi:[0,1]
 v_cvt_pk_bf16_f32 v16, 0, v16
 v_cvt_pk_bf16_f32 v17, 0, v17
 v_cvt_pk_bf16_f32 v18, 0, v18
 v_cvt_pk_bf16_f32 v19, 0, v19
 v_cvt_pk_bf16_f32 v20, 0, v20
 v_cvt_pk_bf16_f32 v21, 0, v21
 v_cvt_pk_bf16_f32 v22, 0, v22
 v_cvt_pk_bf16_f32 v23, 0, v23
 v_cvt_pk_bf16_f32 v24, 0, v24
 v_cvt_pk_bf16_f32 v25, 0, v25
 v_cvt_pk_bf16_f32 v26, 0, v26
 v_cvt_pk_bf16_f32 v27, 0, v27
 v_cvt_pk_bf16_f32 v28, 0, v28
 v_cvt_pk_bf16_f32 v29, 0, v29
 v_cvt_pk_bf16_f32 v30, 0, v30
 v_cvt_pk_bf16_f32 v31, 0, v31
 v_cvt_pk_bf16_f32 v32, 0, v32
 v_cvt_pk_bf16_f32 v33, 0, v33
 v_cvt_pk_bf16_f32 v34, 0, v34
 v_cvt_pk_bf16_f32 v35, 0, v35
 v_cvt_pk_bf16_f32 v36, 0, v36
 v_cvt_pk_bf16_f32 v37, 0, v37
 v_cvt_pk_bf16_f32 v38, 0, v38
 v_cvt_pk_bf16_f32 v39, 0, v39
 v_cvt_pk_bf16_f32 v40, 0, v40
 v_cvt_pk_bf16_f32 v41, 0, v41
 v_cvt_pk_bf16_f32 v42, 0, v42
 v_cvt_pk_bf16_f32 v43, 0, v43
 v_cvt_pk_bf16_f32 v44, 0, v44
 v_cvt_pk_bf16_f32 v45, 0, v45
 v_cvt_pk_bf16_f32 v46, 0, v46
 v_cvt_pk_bf16_f32 v47, 0, v47
 v_cvt_pk_bf16_f32 v48, 0, v48
 v_cvt_pk_bf16_f32 v49, 0, v49
 v_cvt_pk_bf16_f32 v50, 0, v50
 v_cvt_pk_bf16_f32 v51, 0, v51
 v_cvt_pk_bf16_f32 v52, 0, v52
 v_cvt_pk_bf16_f32 v53, 0, v53
 v_cvt_pk_bf16_f32 v54, 0, v54
 v_cvt_pk_bf16_f32 v55, 0, v55
 v_pk_mul_f32 v[16:17], v[16:17], v[82:83] op_sel_hi:[1,0]
 v_pk_mul_f32 v[18:19], v[18:19], v[82:83] op_sel_hi:[1,0]
 v_pk_mul_f32 v[20:21], v[20:21], v[82:83] op_sel_hi:[1,0]
 v_pk_mul_f32 v[22:23], v[22:23], v[82:83] op_sel_hi:[1,0]
 v_pk_mul_f32 v[24:25], v[24:25], v[82:83] op_sel_hi:[1,0]
 v_pk_mul_f32 v[26:27], v[26:27], v[82:83] op_sel_hi:[1,0]
 v_pk_mul_f32 v[28:29], v[28:29], v[82:83] op_sel_hi:[1,0]
 v_pk_mul_f32 v[30:31], v[30:31], v[82:83] op_sel_hi:[1,0]
 v_pk_mul_f32 v[32:33], v[32:33], v[82:83] op_sel_hi:[1,0]
 v_pk_mul_f32 v[34:35], v[34:35], v[82:83] op_sel_hi:[1,0]
 v_pk_mul_f32 v[36:37], v[36:37], v[82:83] op_sel_hi:[1,0]
 v_pk_mul_f32 v[38:39], v[38:39], v[82:83] op_sel_hi:[1,0]
 v_pk_mul_f32 v[40:41], v[40:41], v[82:83] op_sel_hi:[1,0]
 v_pk_mul_f32 v[42:43], v[42:43], v[82:83] op_sel_hi:[1,0]
 v_pk_mul_f32 v[44:45], v[44:45], v[82:83] op_sel_hi:[1,0]
 v_pk_mul_f32 v[46:47], v[46:47], v[82:83] op_sel_hi:[1,0]
 v_pk_mul_f32 v[48:49], v[48:49], v[82:83] op_sel_hi:[1,0]
 v_pk_mul_f32 v[50:51], v[50:51], v[82:83] op_sel_hi:[1,0]
 v_pk_mul_f32 v[52:53], v[52:53], v[82:83] op_sel_hi:[1,0]
 v_pk_mul_f32 v[54:55], v[54:55], v[82:83] op_sel_hi:[1,0]
 v_cvt_pk_bf16_f32 v16, 0, v16
 v_cvt_pk_bf16_f32 v17, 0, v17
 v_cvt_pk_bf16_f32 v18, 0, v18
 v_cvt_pk_bf16_f32 v19, 0, v19
 v_cvt_pk_bf16_f32 v20, 0, v20
 v_cvt_pk_bf16_f32 v21, 0, v21
 v_cvt_pk_bf16_f32 v22, 0, v22
 v_cvt_pk_bf16_f32 v23, 0, v23
 v_cvt_pk_bf16_f32 v24, 0, v24
 v_cvt_pk_bf16_f32 v25, 0, v25
 v_cvt_pk_bf16_f32 v26, 0, v26
 v_cvt_pk_bf16_f32 v27, 0, v27
 v_cvt_pk_bf16_f32 v28, 0, v28
 v_cvt_pk_bf16_f32 v29, 0, v29
 v_cvt_pk_bf16_f32 v30, 0, v30
 v_cvt_pk_bf16_f32 v31, 0, v31
 v_cvt_pk_bf16_f32 v32, 0, v32
 v_cvt_pk_bf16_f32 v33, 0, v33
 v_cvt_pk_bf16_f32 v34, 0, v34
 v_cvt_pk_bf16_f32 v35, 0, v35
 v_cvt_pk_bf16_f32 v36, 0, v36
 v_cvt_pk_bf16_f32 v37, 0, v37
 v_cvt_pk_bf16_f32 v38, 0, v38
 v_cvt_pk_bf16_f32 v39, 0, v39
 v_cvt_pk_bf16_f32 v40, 0, v40
 v_cvt_pk_bf16_f32 v41, 0, v41
 v_cvt_pk_bf16_f32 v42, 0, v42
 v_cvt_pk_bf16_f32 v43, 0, v43
 v_cvt_pk_bf16_f32 v44, 0, v44
 v_cvt_pk_bf16_f32 v45, 0, v45
 v_cvt_pk_bf16_f32 v46, 0, v46
 v_cvt_pk_bf16_f32 v47, 0, v47
 v_cvt_pk_bf16_f32 v48, 0, v48
 v_cvt_pk_bf16_f32 v49, 0, v49
 v_cvt_pk_bf16_f32 v50, 0, v50
 v_cvt_pk_bf16_f32 v51, 0, v51
 v_cvt_pk_bf16_f32 v52, 0, v52
 v_cvt_pk_bf16_f32 v53, 0, v53
 v_cvt_pk_bf16_f32 v54, 0, v54
 v_cvt_pk_bf16_f32 v55, 0, v55
 s_barrier
nonorm_27:
 s_mov_b32 s73, 0x05040100
 s_mov_b32 s74, 0x07060302
 s_waitcnt vmcnt(39)
 v_perm_b32 v8, v97, v96, s73
 v_perm_b32 v9, v99, v98, s73
 v_perm_b32 v10, v97, v96, s74
 v_perm_b32 v11, v99, v98, s74
 ds_write_b128 v7, v[8:11] offset:0
 s_waitcnt vmcnt(38)
 v_perm_b32 v12, v101, v100, s73
 v_perm_b32 v13, v103, v102, s73
 v_perm_b32 v14, v101, v100, s74
 v_perm_b32 v15, v103, v102, s74
 ds_write_b128 v7, v[12:15] offset:4096
 s_waitcnt vmcnt(37)
 v_perm_b32 v8, v105, v104, s73
 v_perm_b32 v9, v107, v106, s73
 v_perm_b32 v10, v105, v104, s74
 v_perm_b32 v11, v107, v106, s74
 ds_write_b128 v7, v[8:11] offset:8192
 s_waitcnt vmcnt(36)
 v_perm_b32 v12, v109, v108, s73
 v_perm_b32 v13, v111, v110, s73
 v_perm_b32 v14, v109, v108, s74
 v_perm_b32 v15, v111, v110, s74
 ds_write_b128 v7, v[12:15] offset:12288
 s_waitcnt vmcnt(35)
 v_perm_b32 v8, v113, v112, s73
 v_perm_b32 v9, v115, v114, s73
 v_perm_b32 v10, v113, v112, s74
 v_perm_b32 v11, v115, v114, s74
 ds_write_b128 v7, v[8:11] offset:16384
 s_waitcnt vmcnt(34)
 v_perm_b32 v12, v117, v116, s73
 v_perm_b32 v13, v119, v118, s73
 v_perm_b32 v14, v117, v116, s74
 v_perm_b32 v15, v119, v118, s74
 ds_write_b128 v7, v[12:15] offset:20480
 s_waitcnt vmcnt(33)
 v_perm_b32 v8, v121, v120, s73
 v_perm_b32 v9, v123, v122, s73
 v_perm_b32 v10, v121, v120, s74
 v_perm_b32 v11, v123, v122, s74
 ds_write_b128 v7, v[8:11] offset:24576
 s_waitcnt vmcnt(32)
 v_perm_b32 v12, v125, v124, s73
 v_perm_b32 v13, v127, v126, s73
 v_perm_b32 v14, v125, v124, s74
 v_perm_b32 v15, v127, v126, s74
 ds_write_b128 v7, v[12:15] offset:28672
 s_waitcnt vmcnt(31)
 v_perm_b32 v8, v129, v128, s73
 v_perm_b32 v9, v131, v130, s73
 v_perm_b32 v10, v129, v128, s74
 v_perm_b32 v11, v131, v130, s74
 ds_write_b128 v7, v[8:11] offset:32768
 s_waitcnt vmcnt(30)
 v_perm_b32 v12, v133, v132, s73
 v_perm_b32 v13, v135, v134, s73
 v_perm_b32 v14, v133, v132, s74
 v_perm_b32 v15, v135, v134, s74
 ds_write_b128 v7, v[12:15] offset:36864
 s_waitcnt vmcnt(29)
 v_perm_b32 v8, v137, v136, s73
 v_perm_b32 v9, v139, v138, s73
 v_perm_b32 v10, v137, v136, s74
 v_perm_b32 v11, v139, v138, s74
 ds_write_b128 v7, v[8:11] offset:40960
 s_waitcnt vmcnt(28)
 v_perm_b32 v12, v141, v140, s73
 v_perm_b32 v13, v143, v142, s73
 v_perm_b32 v14, v141, v140, s74
 v_perm_b32 v15, v143, v142, s74
 ds_write_b128 v7, v[12:15] offset:45056
 s_waitcnt vmcnt(27)
 v_perm_b32 v8, v145, v144, s73
 v_perm_b32 v9, v147, v146, s73
 v_perm_b32 v10, v145, v144, s74
 v_perm_b32 v11, v147, v146, s74
 ds_write_b128 v7, v[8:11] offset:49152
 s_waitcnt vmcnt(26)
 v_perm_b32 v12, v149, v148, s73
 v_perm_b32 v13, v151, v150, s73
 v_perm_b32 v14, v149, v148, s74
 v_perm_b32 v15, v151, v150, s74
 ds_write_b128 v7, v[12:15] offset:53248
 s_waitcnt vmcnt(25)
 v_perm_b32 v8, v153, v152, s73
 v_perm_b32 v9, v155, v154, s73
 v_perm_b32 v10, v153, v152, s74
 v_perm_b32 v11, v155, v154, s74
 ds_write_b128 v7, v[8:11] offset:57344
 s_waitcnt vmcnt(24)
 v_perm_b32 v12, v157, v156, s73
 v_perm_b32 v13, v159, v158, s73
 v_perm_b32 v14, v157, v156, s74
 v_perm_b32 v15, v159, v158, s74
 ds_write_b128 v7, v[12:15] offset:61440
 v_add_u32 v7, 0x10000, v7
 s_waitcnt vmcnt(23)
 v_perm_b32 v8, v161, v160, s73
 v_perm_b32 v9, v163, v162, s73
 v_perm_b32 v10, v161, v160, s74
 v_perm_b32 v11, v163, v162, s74
 ds_write_b128 v7, v[8:11] offset:0
 s_waitcnt vmcnt(22)
 v_perm_b32 v12, v165, v164, s73
 v_perm_b32 v13, v167, v166, s73
 v_perm_b32 v14, v165, v164, s74
 v_perm_b32 v15, v167, v166, s74
 ds_write_b128 v7, v[12:15] offset:4096
 s_waitcnt vmcnt(21)
 v_perm_b32 v8, v169, v168, s73
 v_perm_b32 v9, v171, v170, s73
 v_perm_b32 v10, v169, v168, s74
 v_perm_b32 v11, v171, v170, s74
 ds_write_b128 v7, v[8:11] offset:8192
 s_waitcnt vmcnt(20)
 v_perm_b32 v12, v173, v172, s73
 v_perm_b32 v13, v175, v174, s73
 v_perm_b32 v14, v173, v172, s74
 v_perm_b32 v15, v175, v174, s74
 ds_write_b128 v7, v[12:15] offset:12288
 s_waitcnt vmcnt(19)
 v_perm_b32 v8, v177, v176, s73
 v_perm_b32 v9, v179, v178, s73
 v_perm_b32 v10, v177, v176, s74
 v_perm_b32 v11, v179, v178, s74
 ds_write_b128 v7, v[8:11] offset:16384
 s_waitcnt vmcnt(18)
 v_perm_b32 v12, v181, v180, s73
 v_perm_b32 v13, v183, v182, s73
 v_perm_b32 v14, v181, v180, s74
 v_perm_b32 v15, v183, v182, s74
 ds_write_b128 v7, v[12:15] offset:20480
 s_waitcnt vmcnt(17)
 v_perm_b32 v8, v185, v184, s73
 v_perm_b32 v9, v187, v186, s73
 v_perm_b32 v10, v185, v184, s74
 v_perm_b32 v11, v187, v186, s74
 ds_write_b128 v7, v[8:11] offset:24576
 s_waitcnt vmcnt(16)
 v_perm_b32 v12, v189, v188, s73
 v_perm_b32 v13, v191, v190, s73
 v_perm_b32 v14, v189, v188, s74
 v_perm_b32 v15, v191, v190, s74
 ds_write_b128 v7, v[12:15] offset:28672
 s_waitcnt vmcnt(15)
 v_perm_b32 v8, v193, v192, s73
 v_perm_b32 v9, v195, v194, s73
 v_perm_b32 v10, v193, v192, s74
 v_perm_b32 v11, v195, v194, s74
 ds_write_b128 v7, v[8:11] offset:32768
 s_waitcnt vmcnt(14)
 v_perm_b32 v12, v197, v196, s73
 v_perm_b32 v13, v199, v198, s73
 v_perm_b32 v14, v197, v196, s74
 v_perm_b32 v15, v199, v198, s74
 ds_write_b128 v7, v[12:15] offset:36864
 s_waitcnt vmcnt(13)
 v_perm_b32 v8, v201, v200, s73
 v_perm_b32 v9, v203, v202, s73
 v_perm_b32 v10, v201, v200, s74
 v_perm_b32 v11, v203, v202, s74
 ds_write_b128 v7, v[8:11] offset:40960
 s_waitcnt vmcnt(12)
 v_perm_b32 v12, v205, v204, s73
 v_perm_b32 v13, v207, v206, s73
 v_perm_b32 v14, v205, v204, s74
 v_perm_b32 v15, v207, v206, s74
 ds_write_b128 v7, v[12:15] offset:45056
 s_waitcnt vmcnt(11)
 v_perm_b32 v8, v209, v208, s73
 v_perm_b32 v9, v211, v210, s73
 v_perm_b32 v10, v209, v208, s74
 v_perm_b32 v11, v211, v210, s74
 ds_write_b128 v7, v[8:11] offset:49152
 s_waitcnt vmcnt(10)
 v_perm_b32 v12, v213, v212, s73
 v_perm_b32 v13, v215, v214, s73
 v_perm_b32 v14, v213, v212, s74
 v_perm_b32 v15, v215, v214, s74
 ds_write_b128 v7, v[12:15] offset:53248
 s_waitcnt vmcnt(9)
 v_perm_b32 v8, v217, v216, s73
 v_perm_b32 v9, v219, v218, s73
 v_perm_b32 v10, v217, v216, s74
 v_perm_b32 v11, v219, v218, s74
 ds_write_b128 v7, v[8:11] offset:57344
 s_waitcnt vmcnt(8)
 v_perm_b32 v12, v221, v220, s73
 v_perm_b32 v13, v223, v222, s73
 v_perm_b32 v14, v221, v220, s74
 v_perm_b32 v15, v223, v222, s74
 ds_write_b128 v7, v[12:15] offset:61440
 v_add_u32 v7, 0x10000, v7
 s_waitcnt vmcnt(7)
 v_perm_b32 v8, v225, v224, s73
 v_perm_b32 v9, v227, v226, s73
 v_perm_b32 v10, v225, v224, s74
 v_perm_b32 v11, v227, v226, s74
 ds_write_b128 v7, v[8:11] offset:0
 s_waitcnt vmcnt(6)
 v_perm_b32 v12, v229, v228, s73
 v_perm_b32 v13, v231, v230, s73
 v_perm_b32 v14, v229, v228, s74
 v_perm_b32 v15, v231, v230, s74
 ds_write_b128 v7, v[12:15] offset:4096
 s_waitcnt vmcnt(5)
 v_perm_b32 v8, v233, v232, s73
 v_perm_b32 v9, v235, v234, s73
 v_perm_b32 v10, v233, v232, s74
 v_perm_b32 v11, v235, v234, s74
 ds_write_b128 v7, v[8:11] offset:8192
 s_waitcnt vmcnt(4)
 v_perm_b32 v12, v237, v236, s73
 v_perm_b32 v13, v239, v238, s73
 v_perm_b32 v14, v237, v236, s74
 v_perm_b32 v15, v239, v238, s74
 ds_write_b128 v7, v[12:15] offset:12288
 s_waitcnt vmcnt(3)
 v_perm_b32 v8, v241, v240, s73
 v_perm_b32 v9, v243, v242, s73
 v_perm_b32 v10, v241, v240, s74
 v_perm_b32 v11, v243, v242, s74
 ds_write_b128 v7, v[8:11] offset:16384
 s_waitcnt vmcnt(2)
 v_perm_b32 v12, v245, v244, s73
 v_perm_b32 v13, v247, v246, s73
 v_perm_b32 v14, v245, v244, s74
 v_perm_b32 v15, v247, v246, s74
 ds_write_b128 v7, v[12:15] offset:20480
 s_waitcnt vmcnt(1)
 v_perm_b32 v8, v249, v248, s73
 v_perm_b32 v9, v251, v250, s73
 v_perm_b32 v10, v249, v248, s74
 v_perm_b32 v11, v251, v250, s74
 ds_write_b128 v7, v[8:11] offset:24576
 s_waitcnt vmcnt(0)
 v_perm_b32 v12, v253, v252, s73
 v_perm_b32 v13, v255, v254, s73
 v_perm_b32 v14, v253, v252, s74
 v_perm_b32 v15, v255, v254, s74
 ds_write_b128 v7, v[12:15] offset:28672
 s_waitcnt lgkmcnt(0)
 s_barrier
 s_and_b32 s74, s66, 1
 s_lshl_b32 s74, s74, 1
 s_add_u32 s74, s74, 0
 v_bfe_u32 v3, v0, 2, 2
 v_lshrrev_b32 v2, 4, v0
 v_lshl_add_u32 v2, v2, 3, v3
 v_lshlrev_b32 v2, 8, v2
 v_xor_b32 v3, s74, v3
 v_lshl_add_u32 v2, v3, 6, v2
 v_and_b32 v3, 3, v0
 v_lshl_add_u32 v2, v3, 4, v2
 ds_read_b64_tr_b16 v[192:193], v2 offset:0
 ds_read_b64_tr_b16 v[194:195], v2 offset:1024
 ds_read_b64_tr_b16 v[196:197], v2 offset:8
 ds_read_b64_tr_b16 v[198:199], v2 offset:1032
 ds_read_b64_tr_b16 v[208:209], v2 offset:8192
 ds_read_b64_tr_b16 v[210:211], v2 offset:9216
 ds_read_b64_tr_b16 v[212:213], v2 offset:8200
 ds_read_b64_tr_b16 v[214:215], v2 offset:9224
 ds_read_b64_tr_b16 v[224:225], v2 offset:16384
 ds_read_b64_tr_b16 v[226:227], v2 offset:17408
 ds_read_b64_tr_b16 v[228:229], v2 offset:16392
 ds_read_b64_tr_b16 v[230:231], v2 offset:17416
 s_waitcnt lgkmcnt(0)
 ds_read_b64_tr_b16 v[240:241], v2 offset:24576
 ds_read_b64_tr_b16 v[242:243], v2 offset:25600
 ds_read_b64_tr_b16 v[244:245], v2 offset:24584
 ds_read_b64_tr_b16 v[246:247], v2 offset:25608
 ds_read_b64_tr_b16 a[0:1], v2 offset:32768
 ds_read_b64_tr_b16 a[2:3], v2 offset:33792
 ds_read_b64_tr_b16 a[4:5], v2 offset:32776
 ds_read_b64_tr_b16 a[6:7], v2 offset:33800
 ds_read_b64_tr_b16 a[16:17], v2 offset:40960
 ds_read_b64_tr_b16 a[18:19], v2 offset:41984
 ds_read_b64_tr_b16 a[20:21], v2 offset:40968
 ds_read_b64_tr_b16 a[22:23], v2 offset:41992
 s_waitcnt lgkmcnt(0)
 ds_read_b64_tr_b16 a[32:33], v2 offset:49152
 ds_read_b64_tr_b16 a[34:35], v2 offset:50176
 ds_read_b64_tr_b16 a[36:37], v2 offset:49160
 ds_read_b64_tr_b16 a[38:39], v2 offset:50184
 ds_read_b64_tr_b16 a[48:49], v2 offset:57344
 ds_read_b64_tr_b16 a[50:51], v2 offset:58368
 ds_read_b64_tr_b16 a[52:53], v2 offset:57352
 ds_read_b64_tr_b16 a[54:55], v2 offset:58376
 v_add_u32 v2, 0x10000, v2
 ds_read_b64_tr_b16 a[64:65], v2 offset:0
 ds_read_b64_tr_b16 a[66:67], v2 offset:1024
 ds_read_b64_tr_b16 a[68:69], v2 offset:8
 ds_read_b64_tr_b16 a[70:71], v2 offset:1032
 s_waitcnt lgkmcnt(0)
 ds_read_b64_tr_b16 a[80:81], v2 offset:8192
 ds_read_b64_tr_b16 a[82:83], v2 offset:9216
 ds_read_b64_tr_b16 a[84:85], v2 offset:8200
 ds_read_b64_tr_b16 a[86:87], v2 offset:9224
 ds_read_b64_tr_b16 a[96:97], v2 offset:16384
 ds_read_b64_tr_b16 a[98:99], v2 offset:17408
 ds_read_b64_tr_b16 a[100:101], v2 offset:16392
 ds_read_b64_tr_b16 a[102:103], v2 offset:17416
 ds_read_b64_tr_b16 a[112:113], v2 offset:24576
 ds_read_b64_tr_b16 a[114:115], v2 offset:25600
 ds_read_b64_tr_b16 a[116:117], v2 offset:24584
 ds_read_b64_tr_b16 a[118:119], v2 offset:25608
 s_waitcnt lgkmcnt(0)
 ds_read_b64_tr_b16 a[128:129], v2 offset:32768
 ds_read_b64_tr_b16 a[130:131], v2 offset:33792
 ds_read_b64_tr_b16 a[132:133], v2 offset:32776
 ds_read_b64_tr_b16 a[134:135], v2 offset:33800
 ds_read_b64_tr_b16 a[144:145], v2 offset:40960
 ds_read_b64_tr_b16 a[146:147], v2 offset:41984
 ds_read_b64_tr_b16 a[148:149], v2 offset:40968
 ds_read_b64_tr_b16 a[150:151], v2 offset:41992
 ds_read_b64_tr_b16 a[160:161], v2 offset:49152
 ds_read_b64_tr_b16 a[162:163], v2 offset:50176
 ds_read_b64_tr_b16 a[164:165], v2 offset:49160
 ds_read_b64_tr_b16 a[166:167], v2 offset:50184
 s_waitcnt lgkmcnt(0)
 ds_read_b64_tr_b16 a[176:177], v2 offset:57344
 ds_read_b64_tr_b16 a[178:179], v2 offset:58368
 ds_read_b64_tr_b16 a[180:181], v2 offset:57352
 ds_read_b64_tr_b16 a[182:183], v2 offset:58376
 v_add_u32 v2, 0x10000, v2
 ds_read_b64_tr_b16 a[192:193], v2 offset:0
 ds_read_b64_tr_b16 a[194:195], v2 offset:1024
 ds_read_b64_tr_b16 a[196:197], v2 offset:8
 ds_read_b64_tr_b16 a[198:199], v2 offset:1032
 ds_read_b64_tr_b16 a[208:209], v2 offset:8192
 ds_read_b64_tr_b16 a[210:211], v2 offset:9216
 ds_read_b64_tr_b16 a[212:213], v2 offset:8200
 ds_read_b64_tr_b16 a[214:215], v2 offset:9224
 s_waitcnt lgkmcnt(0)
 ds_read_b64_tr_b16 a[224:225], v2 offset:16384
 ds_read_b64_tr_b16 a[226:227], v2 offset:17408
 ds_read_b64_tr_b16 a[228:229], v2 offset:16392
 ds_read_b64_tr_b16 a[230:231], v2 offset:17416
 ds_read_b64_tr_b16 a[240:241], v2 offset:24576
 ds_read_b64_tr_b16 a[242:243], v2 offset:25600
 ds_read_b64_tr_b16 a[244:245], v2 offset:24584
 ds_read_b64_tr_b16 a[246:247], v2 offset:25608
 s_waitcnt lgkmcnt(0)
 s_and_b32 s74, s66, 1
 s_lshl_b32 s74, s74, 1
 s_add_u32 s74, s74, 1
 v_bfe_u32 v3, v0, 2, 2
 v_lshrrev_b32 v2, 4, v0
 v_lshl_add_u32 v2, v2, 3, v3
 v_lshlrev_b32 v2, 8, v2
 v_xor_b32 v3, s74, v3
 v_lshl_add_u32 v2, v3, 6, v2
 v_and_b32 v3, 3, v0
 v_lshl_add_u32 v2, v3, 4, v2
 ds_read_b64_tr_b16 v[200:201], v2 offset:0
 ds_read_b64_tr_b16 v[202:203], v2 offset:1024
 ds_read_b64_tr_b16 v[204:205], v2 offset:8
 ds_read_b64_tr_b16 v[206:207], v2 offset:1032
 ds_read_b64_tr_b16 v[216:217], v2 offset:8192
 ds_read_b64_tr_b16 v[218:219], v2 offset:9216
 ds_read_b64_tr_b16 v[220:221], v2 offset:8200
 ds_read_b64_tr_b16 v[222:223], v2 offset:9224
 ds_read_b64_tr_b16 v[232:233], v2 offset:16384
 ds_read_b64_tr_b16 v[234:235], v2 offset:17408
 ds_read_b64_tr_b16 v[236:237], v2 offset:16392
 ds_read_b64_tr_b16 v[238:239], v2 offset:17416
 s_waitcnt lgkmcnt(0)
 ds_read_b64_tr_b16 v[248:249], v2 offset:24576
 ds_read_b64_tr_b16 v[250:251], v2 offset:25600
 ds_read_b64_tr_b16 v[252:253], v2 offset:24584
 ds_read_b64_tr_b16 v[254:255], v2 offset:25608
 ds_read_b64_tr_b16 a[8:9], v2 offset:32768
 ds_read_b64_tr_b16 a[10:11], v2 offset:33792
 ds_read_b64_tr_b16 a[12:13], v2 offset:32776
 ds_read_b64_tr_b16 a[14:15], v2 offset:33800
 ds_read_b64_tr_b16 a[24:25], v2 offset:40960
 ds_read_b64_tr_b16 a[26:27], v2 offset:41984
 ds_read_b64_tr_b16 a[28:29], v2 offset:40968
 ds_read_b64_tr_b16 a[30:31], v2 offset:41992
 s_waitcnt lgkmcnt(0)
 ds_read_b64_tr_b16 a[40:41], v2 offset:49152
 ds_read_b64_tr_b16 a[42:43], v2 offset:50176
 ds_read_b64_tr_b16 a[44:45], v2 offset:49160
 ds_read_b64_tr_b16 a[46:47], v2 offset:50184
 ds_read_b64_tr_b16 a[56:57], v2 offset:57344
 ds_read_b64_tr_b16 a[58:59], v2 offset:58368
 ds_read_b64_tr_b16 a[60:61], v2 offset:57352
 ds_read_b64_tr_b16 a[62:63], v2 offset:58376
 v_add_u32 v2, 0x10000, v2
 ds_read_b64_tr_b16 a[72:73], v2 offset:0
 ds_read_b64_tr_b16 a[74:75], v2 offset:1024
 ds_read_b64_tr_b16 a[76:77], v2 offset:8
 ds_read_b64_tr_b16 a[78:79], v2 offset:1032
 s_waitcnt lgkmcnt(0)
 ds_read_b64_tr_b16 a[88:89], v2 offset:8192
 ds_read_b64_tr_b16 a[90:91], v2 offset:9216
 ds_read_b64_tr_b16 a[92:93], v2 offset:8200
 ds_read_b64_tr_b16 a[94:95], v2 offset:9224
 ds_read_b64_tr_b16 a[104:105], v2 offset:16384
 ds_read_b64_tr_b16 a[106:107], v2 offset:17408
 ds_read_b64_tr_b16 a[108:109], v2 offset:16392
 ds_read_b64_tr_b16 a[110:111], v2 offset:17416
 ds_read_b64_tr_b16 a[120:121], v2 offset:24576
 ds_read_b64_tr_b16 a[122:123], v2 offset:25600
 ds_read_b64_tr_b16 a[124:125], v2 offset:24584
 ds_read_b64_tr_b16 a[126:127], v2 offset:25608
 s_waitcnt lgkmcnt(0)
 ds_read_b64_tr_b16 a[136:137], v2 offset:32768
 ds_read_b64_tr_b16 a[138:139], v2 offset:33792
 ds_read_b64_tr_b16 a[140:141], v2 offset:32776
 ds_read_b64_tr_b16 a[142:143], v2 offset:33800
 ds_read_b64_tr_b16 a[152:153], v2 offset:40960
 ds_read_b64_tr_b16 a[154:155], v2 offset:41984
 ds_read_b64_tr_b16 a[156:157], v2 offset:40968
 ds_read_b64_tr_b16 a[158:159], v2 offset:41992
 ds_read_b64_tr_b16 a[168:169], v2 offset:49152
 ds_read_b64_tr_b16 a[170:171], v2 offset:50176
 ds_read_b64_tr_b16 a[172:173], v2 offset:49160
 ds_read_b64_tr_b16 a[174:175], v2 offset:50184
 s_waitcnt lgkmcnt(0)
 ds_read_b64_tr_b16 a[184:185], v2 offset:57344
 ds_read_b64_tr_b16 a[186:187], v2 offset:58368
 ds_read_b64_tr_b16 a[188:189], v2 offset:57352
 ds_read_b64_tr_b16 a[190:191], v2 offset:58376
 v_add_u32 v2, 0x10000, v2
 ds_read_b64_tr_b16 a[200:201], v2 offset:0
 ds_read_b64_tr_b16 a[202:203], v2 offset:1024
 ds_read_b64_tr_b16 a[204:205], v2 offset:8
 ds_read_b64_tr_b16 a[206:207], v2 offset:1032
 ds_read_b64_tr_b16 a[216:217], v2 offset:8192
 ds_read_b64_tr_b16 a[218:219], v2 offset:9216
 ds_read_b64_tr_b16 a[220:221], v2 offset:8200
 ds_read_b64_tr_b16 a[222:223], v2 offset:9224
 s_waitcnt lgkmcnt(0)
 ds_read_b64_tr_b16 a[232:233], v2 offset:16384
 ds_read_b64_tr_b16 a[234:235], v2 offset:17408
 ds_read_b64_tr_b16 a[236:237], v2 offset:16392
 ds_read_b64_tr_b16 a[238:239], v2 offset:17416
 ds_read_b64_tr_b16 a[248:249], v2 offset:24576
 ds_read_b64_tr_b16 a[250:251], v2 offset:25600
 ds_read_b64_tr_b16 a[252:253], v2 offset:24584
 ds_read_b64_tr_b16 a[254:255], v2 offset:25608
 s_waitcnt lgkmcnt(0)
 v_and_b32 v5, 7, v0
 v_lshlrev_b32 v5, 5, v5
wait_28:
 buffer_load_dword v4, v5, s[28:31], 4 offen sc1
 s_waitcnt vmcnt(0)
test_30:
 v_cmp_gt_u32 vcc, 24, v4
 s_and_b32 vcc_lo, vcc_lo, 0xff
 s_and_b32 vcc_hi, vcc_hi, 0x0
 s_cmp_eq_u64 vcc, 0
 s_cbranch_scc1 ready_29
 s_sleep 6
 s_add_u32 s72, s72, 1
 s_cmp_lt_u32 s72, 0x40000
 s_cbranch_scc1 wait_28
 s_branch adaLN_cond__memory_aug_recurrent_mem_tr__mixer_s_mlp__prompt_kernel_exit
ready_29:
 s_cmp_ge_u32 s6, 128
 s_cbranch_scc1 noh_31
poll_32:
 v_lshrrev_b32 v3, 4, v0
 v_lshlrev_b32 v3, 5, v3
 s_mul_i32 s73, s66, 640
 s_add_u32 s73, s73, 0x20000
 buffer_load_dwordx4 v[96:99], v3, s[8:11], s73 offen offset:0 sc1
 buffer_load_dwordx4 v[100:103], v3, s[8:11], s73 offen offset:16 sc1
 buffer_load_dwordx4 v[104:107], v3, s[8:11], s73 offen offset:128 sc1
 buffer_load_dwordx4 v[108:111], v3, s[8:11], s73 offen offset:144 sc1
 buffer_load_dwordx4 v[112:115], v3, s[8:11], s73 offen offset:256 sc1
 buffer_load_dwordx4 v[116:119], v3, s[8:11], s73 offen offset:272 sc1
 buffer_load_dwordx4 v[120:123], v3, s[8:11], s73 offen offset:384 sc1
 buffer_load_dwordx4 v[124:127], v3, s[8:11], s73 offen offset:400 sc1
 buffer_load_dwordx4 v[128:131], v3, s[8:11], s73 offen offset:512 sc1
 buffer_load_dwordx4 v[132:135], v3, s[8:11], s73 offen offset:528 sc1
 v_lshrrev_b32 v3, 4, v0
 v_lshlrev_b32 v3, 5, v3
 s_mul_i32 s73, s66, 640
 s_add_u32 s73, s73, 0x20a00
 buffer_load_dwordx4 v[136:139], v3, s[8:11], s73 offen offset:0 sc1
 buffer_load_dwordx4 v[140:143], v3, s[8:11], s73 offen offset:16 sc1
 buffer_load_dwordx4 v[144:147], v3, s[8:11], s73 offen offset:128 sc1
 buffer_load_dwordx4 v[148:151], v3, s[8:11], s73 offen offset:144 sc1
 buffer_load_dwordx4 v[152:155], v3, s[8:11], s73 offen offset:256 sc1
 buffer_load_dwordx4 v[156:159], v3, s[8:11], s73 offen offset:272 sc1
 buffer_load_dwordx4 v[160:163], v3, s[8:11], s73 offen offset:384 sc1
 buffer_load_dwordx4 v[164:167], v3, s[8:11], s73 offen offset:400 sc1
 buffer_load_dwordx4 v[168:171], v3, s[8:11], s73 offen offset:512 sc1
 buffer_load_dwordx4 v[172:175], v3, s[8:11], s73 offen offset:528 sc1
 s_waitcnt vmcnt(0)
 v_max_u32 v2, v96, v97
 v_max3_u32 v2, v2, v98, v99
 v_max3_u32 v2, v2, v100, v101
 v_max3_u32 v2, v2, v102, v103
 v_max3_u32 v2, v2, v104, v105
 v_max3_u32 v2, v2, v106, v107
 v_max3_u32 v2, v2, v108, v109
 v_max3_u32 v2, v2, v110, v111
 v_max3_u32 v2, v2, v112, v113
 v_max3_u32 v2, v2, v114, v115
 v_max3_u32 v2, v2, v116, v117
 v_max3_u32 v2, v2, v118, v119
 v_max3_u32 v2, v2, v120, v121
 v_max3_u32 v2, v2, v122, v123
 v_max3_u32 v2, v2, v124, v125
 v_max3_u32 v2, v2, v126, v127
 v_max3_u32 v2, v2, v128, v129
 v_max3_u32 v2, v2, v130, v131
 v_max3_u32 v2, v2, v132, v133
 v_max3_u32 v2, v2, v134, v135
 v_max3_u32 v2, v2, v136, v137
 v_max3_u32 v2, v2, v138, v139
 v_max3_u32 v2, v2, v140, v141
 v_max3_u32 v2, v2, v142, v143
 v_max3_u32 v2, v2, v144, v145
 v_max3_u32 v2, v2, v146, v147
 v_max3_u32 v2, v2, v148, v149
 v_max3_u32 v2, v2, v150, v151
 v_max3_u32 v2, v2, v152, v153
 v_max3_u32 v2, v2, v154, v155
 v_max3_u32 v2, v2, v156, v157
 v_max3_u32 v2, v2, v158, v159
 v_max3_u32 v2, v2, v160, v161
 v_max3_u32 v2, v2, v162, v163
 v_max3_u32 v2, v2, v164, v165
 v_max3_u32 v2, v2, v166, v167
 v_max3_u32 v2, v2, v168, v169
 v_max3_u32 v2, v2, v170, v171
 v_max3_u32 v2, v2, v172, v173
 v_max3_u32 v2, v2, v174, v175
 v_cmp_eq_u32 vcc, -1, v2
 s_cbranch_vccz written_33
 s_sleep 6
 s_add_u32 s72, s72, 1
 s_cmp_lt_u32 s72, 0x40000
 s_cbranch_scc1 poll_32
 s_branch adaLN_cond__memory_aug_recurrent_mem_tr__mixer_s_mlp__prompt_kernel_exit
written_33:
 v_pk_mul_f32 v[16:17], v[16:17], v[136:137]
 v_pk_mul_f32 v[18:19], v[18:19], v[138:139]
 v_pk_mul_f32 v[20:21], v[20:21], v[140:141]
 v_pk_mul_f32 v[22:23], v[22:23], v[142:143]
 v_pk_mul_f32 v[24:25], v[24:25], v[144:145]
 v_pk_mul_f32 v[26:27], v[26:27], v[146:147]
 v_pk_mul_f32 v[28:29], v[28:29], v[148:149]
 v_pk_mul_f32 v[30:31], v[30:31], v[150:151]
 v_pk_mul_f32 v[32:33], v[32:33], v[152:153]
 v_pk_mul_f32 v[34:35], v[34:35], v[154:155]
 v_pk_mul_f32 v[36:37], v[36:37], v[156:157]
 v_pk_mul_f32 v[38:39], v[38:39], v[158:159]
 v_pk_mul_f32 v[40:41], v[40:41], v[160:161]
 v_pk_mul_f32 v[42:43], v[42:43], v[162:163]
 v_pk_mul_f32 v[44:45], v[44:45], v[164:165]
 v_pk_mul_f32 v[46:47], v[46:47], v[166:167]
 v_pk_mul_f32 v[48:49], v[48:49], v[168:169]
 v_pk_mul_f32 v[50:51], v[50:51], v[170:171]
 v_pk_mul_f32 v[52:53], v[52:53], v[172:173]
 v_pk_mul_f32 v[54:55], v[54:55], v[174:175]
 v_cvt_pk_bf16_f32 v16, 0, v16
 v_cvt_pk_bf16_f32 v17, 0, v17
 v_cvt_pk_bf16_f32 v18, 0, v18
 v_cvt_pk_bf16_f32 v19, 0, v19
 v_cvt_pk_bf16_f32 v20, 0, v20
 v_cvt_pk_bf16_f32 v21, 0, v21
 v_cvt_pk_bf16_f32 v22, 0, v22
 v_cvt_pk_bf16_f32 v23, 0, v23
 v_cvt_pk_bf16_f32 v24, 0, v24
 v_cvt_pk_bf16_f32 v25, 0, v25
 v_cvt_pk_bf16_f32 v26, 0, v26
 v_cvt_pk_bf16_f32 v27, 0, v27
 v_cvt_pk_bf16_f32 v28, 0, v28
 v_cvt_pk_bf16_f32 v29, 0, v29
 v_cvt_pk_bf16_f32 v30, 0, v30
 v_cvt_pk_bf16_f32 v31, 0, v31
 v_cvt_pk_bf16_f32 v32, 0, v32
 v_cvt_pk_bf16_f32 v33, 0, v33
 v_cvt_pk_bf16_f32 v34, 0, v34
 v_cvt_pk_bf16_f32 v35, 0, v35
 v_cvt_pk_bf16_f32 v36, 0, v36
 v_cvt_pk_bf16_f32 v37, 0, v37
 v_cvt_pk_bf16_f32 v38, 0, v38
 v_cvt_pk_bf16_f32 v39, 0, v39
 v_cvt_pk_bf16_f32 v40, 0, v40
 v_cvt_pk_bf16_f32 v41, 0, v41
 v_cvt_pk_bf16_f32 v42, 0, v42
 v_cvt_pk_bf16_f32 v43, 0, v43
 v_cvt_pk_bf16_f32 v44, 0, v44
 v_cvt_pk_bf16_f32 v45, 0, v45
 v_cvt_pk_bf16_f32 v46, 0, v46
 v_cvt_pk_bf16_f32 v47, 0, v47
 v_cvt_pk_bf16_f32 v48, 0, v48
 v_cvt_pk_bf16_f32 v49, 0, v49
 v_cvt_pk_bf16_f32 v50, 0, v50
 v_cvt_pk_bf16_f32 v51, 0, v51
 v_cvt_pk_bf16_f32 v52, 0, v52
 v_cvt_pk_bf16_f32 v53, 0, v53
 v_cvt_pk_bf16_f32 v54, 0, v54
 v_cvt_pk_bf16_f32 v55, 0, v55
 v_pk_add_f32 v[16:17], v[16:17], v[96:97]
 v_pk_add_f32 v[18:19], v[18:19], v[98:99]
 v_pk_add_f32 v[20:21], v[20:21], v[100:101]
 v_pk_add_f32 v[22:23], v[22:23], v[102:103]
 v_pk_add_f32 v[24:25], v[24:25], v[104:105]
 v_pk_add_f32 v[26:27], v[26:27], v[106:107]
 v_pk_add_f32 v[28:29], v[28:29], v[108:109]
 v_pk_add_f32 v[30:31], v[30:31], v[110:111]
 v_pk_add_f32 v[32:33], v[32:33], v[112:113]
 v_pk_add_f32 v[34:35], v[34:35], v[114:115]
 v_pk_add_f32 v[36:37], v[36:37], v[116:117]
 v_pk_add_f32 v[38:39], v[38:39], v[118:119]
 v_pk_add_f32 v[40:41], v[40:41], v[120:121]
 v_pk_add_f32 v[42:43], v[42:43], v[122:123]
 v_pk_add_f32 v[44:45], v[44:45], v[124:125]
 v_pk_add_f32 v[46:47], v[46:47], v[126:127]
 v_pk_add_f32 v[48:49], v[48:49], v[128:129]
 v_pk_add_f32 v[50:51], v[50:51], v[130:131]
 v_pk_add_f32 v[52:53], v[52:53], v[132:133]
 v_pk_add_f32 v[54:55], v[54:55], v[134:135]
 v_cvt_pk_bf16_f32 v56, v16, v17
 v_cvt_pk_bf16_f32 v57, v18, v19
 v_cvt_pk_bf16_f32 v58, v20, v21
 v_cvt_pk_bf16_f32 v59, v22, v23
 v_cvt_pk_bf16_f32 v60, v24, v25
 v_cvt_pk_bf16_f32 v61, v26, v27
 v_cvt_pk_bf16_f32 v62, v28, v29
 v_cvt_pk_bf16_f32 v63, v30, v31
 v_cvt_pk_bf16_f32 v64, v32, v33
 v_cvt_pk_bf16_f32 v65, v34, v35
 v_cvt_pk_bf16_f32 v66, v36, v37
 v_cvt_pk_bf16_f32 v67, v38, v39
 v_cvt_pk_bf16_f32 v68, v40, v41
 v_cvt_pk_bf16_f32 v69, v42, v43
 v_cvt_pk_bf16_f32 v70, v44, v45
 v_cvt_pk_bf16_f32 v71, v46, v47
 v_cvt_pk_bf16_f32 v72, v48, v49
 v_cvt_pk_bf16_f32 v73, v50, v51
 v_cvt_pk_bf16_f32 v74, v52, v53
 v_cvt_pk_bf16_f32 v75, v54, v55
 s_mul_i32 s74, s6, 20480
 s_mul_i32 s73, s66, 5120
 s_add_u32 s73, s73, s74
 s_add_u32 s73, s73, 0xa40000
 s_add_u32 s74, s73, 4096
 buffer_store_dwordx4 v[56:59], v1, s[8:11], s73 offen offset:0 sc1
 buffer_store_dwordx4 v[60:63], v1, s[8:11], s73 offen offset:1024 sc1
 buffer_store_dwordx4 v[64:67], v1, s[8:11], s73 offen offset:2048 sc1
 buffer_store_dwordx4 v[68:71], v1, s[8:11], s73 offen offset:3072 sc1
 buffer_store_dwordx4 v[72:75], v1, s[8:11], s74 offen offset:0 sc1
 s_waitcnt vmcnt(0)
 s_barrier
 s_cmp_lg_u32 s66, 0
 s_cbranch_scc1 notw0_34
 s_lshl_b32 s73, s6, 7
 s_add_u32 s73, s73, 0
 v_mov_b32 v2, 1
 v_mov_b32 v3, 0
 s_mov_b64 exec, 1
 buffer_store_dword v2, v3, s[8:11], s73 offen sc1
 s_mov_b64 exec, -1
notw0_34:
noh_31:
 v_and_b32 v3, 31, v0
 v_lshlrev_b32 v3, 7, v3
 s_lshl_b32 s73, s66, 12
 s_add_u32 s73, s73, 0
wait_35:
 buffer_load_dword v2, v3, s[8:11], s73 offen sc1
 s_waitcnt vmcnt(0)
test_37:
 v_cmp_gt_u32 vcc, 1, v2
 s_and_b32 vcc_lo, vcc_lo, 0xffffffff
 s_and_b32 vcc_hi, vcc_hi, 0x0
 s_cmp_eq_u64 vcc, 0
 s_cbranch_scc1 ready_36
 s_sleep 3
 s_add_u32 s72, s72, 1
 s_cmp_lt_u32 s72, 0x40000
 s_cbranch_scc1 wait_35
 s_branch adaLN_cond__memory_aug_recurrent_mem_tr__mixer_s_mlp__prompt_kernel_exit
ready_36:
 s_barrier
 s_mul_i32 s73, s66, 20480
 s_mov_b32 s79, s73
 s_mul_i32 s77, s82, 81920
 s_add_u32 s77, s77, s73
 s_add_u32 s77, s77, 0xa40000
 s_lshr_b32 s73, s66, 1
 s_mul_i32 s74, s73, 40960
 v_add_u32 v8, s74, v1
 v_mov_b32 v9, 81920
 s_lshl_b32 s74, s82, 1
 s_add_u32 s73, s73, s74
 s_lshl_b32 s73, s73, 5
 s_add_u32 s73, s73, s81
 s_lshl_b32 s78, s73, 13
 s_and_b32 s73, s66, 1
 s_lshl_b32 s73, s73, 12
 s_add_u32 s78, s78, s73
 s_add_u32 s78, s78, 0x4200000
 s_add_u32 s73, s80, 1
 s_cmp_eq_u32 s73, 3
 s_cselect_b32 s73, 0, s73
 s_lshl_b32 s73, s73, 1
 s_add_u32 s73, s73, s82
 s_lshl_b32 s83, s81, 3
 s_add_u32 s83, s83, s73
 s_lshl_b32 s83, s83, 7
 s_add_u32 s83, s83, 16384
 s_mov_b32 s76, 0
 s_mov_b32 s85, 81920
 s_add_u32 m0, s79, 0
 s_add_u32 s73, s77, 0
 buffer_load_dwordx4 v1, s[8:11], s73 offen offset:0 sc1 lds
 buffer_load_dwordx4 v1, s[8:11], s73 offen offset:1024 sc1 lds
 buffer_load_dwordx4 v1, s[8:11], s73 offen offset:2048 sc1 lds
 buffer_load_dwordx4 v1, s[8:11], s73 offen offset:3072 sc1 lds
 s_add_u32 m0, s79, 4096
 s_add_u32 s73, s77, 4096
 buffer_load_dwordx4 v1, s[8:11], s73 offen offset:0 sc1 lds
 buffer_load_dwordx4 v1, s[8:11], s73 offen offset:1024 sc1 lds
 buffer_load_dwordx4 v1, s[8:11], s73 offen offset:2048 sc1 lds
 buffer_load_dwordx4 v1, s[8:11], s73 offen offset:3072 sc1 lds
 s_add_u32 m0, s79, 8192
 s_add_u32 s73, s77, 8192
 buffer_load_dwordx4 v1, s[8:11], s73 offen offset:0 sc1 lds
 buffer_load_dwordx4 v1, s[8:11], s73 offen offset:1024 sc1 lds
 buffer_load_dwordx4 v1, s[8:11], s73 offen offset:2048 sc1 lds
 buffer_load_dwordx4 v1, s[8:11], s73 offen offset:3072 sc1 lds
 s_add_u32 m0, s79, 12288
 s_add_u32 s73, s77, 12288
 buffer_load_dwordx4 v1, s[8:11], s73 offen offset:0 sc1 lds
 buffer_load_dwordx4 v1, s[8:11], s73 offen offset:1024 sc1 lds
 buffer_load_dwordx4 v1, s[8:11], s73 offen offset:2048 sc1 lds
 buffer_load_dwordx4 v1, s[8:11], s73 offen offset:3072 sc1 lds
 s_add_u32 m0, s79, 16384
 s_add_u32 s73, s77, 16384
 buffer_load_dwordx4 v1, s[8:11], s73 offen offset:0 sc1 lds
 buffer_load_dwordx4 v1, s[8:11], s73 offen offset:1024 sc1 lds
 buffer_load_dwordx4 v1, s[8:11], s73 offen offset:2048 sc1 lds
 buffer_load_dwordx4 v1, s[8:11], s73 offen offset:3072 sc1 lds
 s_add_u32 s79, s79, s85
 s_sub_u32 s85, 0, s85
 s_add_u32 s77, s77, 163840
 s_waitcnt vmcnt(0)
qkv_v_loop:
 s_cmp_lg_u32 s76, 1
 s_cbranch_scc1 qkv_v_lag
 s_waitcnt vmcnt(0)
qkv_v_lag:
 s_waitcnt vmcnt(4)
 s_barrier
 s_max_u32 s74, s76, 2
 s_sub_u32 s74, s74, 1
 s_min_u32 s74, s74, s76
 s_cmp_lg_u32 s66, 0
 s_cbranch_scc1 notw0_38
 v_mov_b32 v2, s74
 v_mov_b32 v3, 0
 s_mov_b64 exec, 1
 buffer_store_dword v2, v3, s[8:11], s83 offen sc1
 s_mov_b64 exec, -1
notw0_38:
 s_cmp_lt_u32 s76, 15
 s_cselect_b32 s77, s77, 0x40000000
 ds_read_b128 v[48:51], v8 offset:0
 ds_read_b128 v[52:55], v8 offset:20480
 ds_read_b128 v[56:59], v8 offset:1024
 ds_read_b128 v[60:63], v8 offset:21504
 s_waitcnt lgkmcnt(2)
 v_mfma_f32_16x16x32_bf16 v[16:19], v[48:51], v[192:195], 0
 v_mfma_f32_16x16x32_bf16 v[24:27], v[48:51], v[196:199], 0
 ds_read_b128 v[64:67], v8 offset:2048
 v_mfma_f32_16x16x32_bf16 v[32:35], v[48:51], v[200:203], 0
 ds_read_b128 v[68:71], v8 offset:22528
 v_mfma_f32_16x16x32_bf16 v[40:43], v[48:51], v[204:207], 0
 s_add_u32 m0, s79, 0
 v_mfma_f32_16x16x32_bf16 v[20:23], v[52:55], v[192:195], 0
 v_mfma_f32_16x16x32_bf16 v[28:31], v[52:55], v[196:199], 0
 s_add_u32 s73, s77, 0
 v_mfma_f32_16x16x32_bf16 v[36:39], v[52:55], v[200:203], 0
 v_mfma_f32_16x16x32_bf16 v[44:47], v[52:55], v[204:207], 0
 s_waitcnt lgkmcnt(2)
 v_mfma_f32_16x16x32_bf16 v[16:19], v[56:59], v[208:211], v[16:19]
 v_mfma_f32_16x16x32_bf16 v[24:27], v[56:59], v[212:215], v[24:27]
 ds_read_b128 v[48:51], v8 offset:3072
 v_mfma_f32_16x16x32_bf16 v[32:35], v[56:59], v[216:219], v[32:35]
 ds_read_b128 v[52:55], v8 offset:23552
 v_mfma_f32_16x16x32_bf16 v[40:43], v[56:59], v[220:223], v[40:43]
 buffer_load_dwordx4 v1, s[8:11], s73 offen offset:0 sc1 lds
 v_mfma_f32_16x16x32_bf16 v[20:23], v[60:63], v[208:211], v[20:23]
 v_mfma_f32_16x16x32_bf16 v[28:31], v[60:63], v[212:215], v[28:31]
 buffer_load_dwordx4 v1, s[8:11], s73 offen offset:1024 sc1 lds
 v_mfma_f32_16x16x32_bf16 v[36:39], v[60:63], v[216:219], v[36:39]
 v_mfma_f32_16x16x32_bf16 v[44:47], v[60:63], v[220:223], v[44:47]
 s_waitcnt lgkmcnt(2)
 v_mfma_f32_16x16x32_bf16 v[16:19], v[64:67], v[224:227], v[16:19]
 v_mfma_f32_16x16x32_bf16 v[24:27], v[64:67], v[228:231], v[24:27]
 ds_read_b128 v[56:59], v8 offset:4096
 v_mfma_f32_16x16x32_bf16 v[32:35], v[64:67], v[232:235], v[32:35]
 ds_read_b128 v[60:63], v8 offset:24576
 v_mfma_f32_16x16x32_bf16 v[40:43], v[64:67], v[236:239], v[40:43]
 buffer_load_dwordx4 v1, s[8:11], s73 offen offset:2048 sc1 lds
 v_mfma_f32_16x16x32_bf16 v[20:23], v[68:71], v[224:227], v[20:23]
 v_mfma_f32_16x16x32_bf16 v[28:31], v[68:71], v[228:231], v[28:31]
 buffer_load_dwordx4 v1, s[8:11], s73 offen offset:3072 sc1 lds
 v_mfma_f32_16x16x32_bf16 v[36:39], v[68:71], v[232:235], v[36:39]
 v_mfma_f32_16x16x32_bf16 v[44:47], v[68:71], v[236:239], v[44:47]
 s_waitcnt lgkmcnt(2)
 v_mfma_f32_16x16x32_bf16 v[16:19], v[48:51], v[240:243], v[16:19]
 v_mfma_f32_16x16x32_bf16 v[24:27], v[48:51], v[244:247], v[24:27]
 ds_read_b128 v[64:67], v8 offset:5120
 v_mfma_f32_16x16x32_bf16 v[32:35], v[48:51], v[248:251], v[32:35]
 ds_read_b128 v[68:71], v8 offset:25600
 v_mfma_f32_16x16x32_bf16 v[40:43], v[48:51], v[252:255], v[40:43]
 s_add_u32 m0, s79, 4096
 v_mfma_f32_16x16x32_bf16 v[20:23], v[52:55], v[240:243], v[20:23]
 v_mfma_f32_16x16x32_bf16 v[28:31], v[52:55], v[244:247], v[28:31]
 s_add_u32 s73, s77, 4096
 v_mfma_f32_16x16x32_bf16 v[36:39], v[52:55], v[248:251], v[36:39]
 v_mfma_f32_16x16x32_bf16 v[44:47], v[52:55], v[252:255], v[44:47]
 s_waitcnt lgkmcnt(2)
 v_mfma_f32_16x16x32_bf16 v[16:19], v[56:59], a[0:3], v[16:19]
 v_mfma_f32_16x16x32_bf16 v[24:27], v[56:59], a[4:7], v[24:27]
 ds_read_b128 v[48:51], v8 offset:6144
 v_mfma_f32_16x16x32_bf16 v[32:35], v[56:59], a[8:11], v[32:35]
 ds_read_b128 v[52:55], v8 offset:26624
 v_mfma_f32_16x16x32_bf16 v[40:43], v[56:59], a[12:15], v[40:43]
 buffer_load_dwordx4 v1, s[8:11], s73 offen offset:0 sc1 lds
 v_mfma_f32_16x16x32_bf16 v[20:23], v[60:63], a[0:3], v[20:23]
 v_mfma_f32_16x16x32_bf16 v[28:31], v[60:63], a[4:7], v[28:31]
 buffer_load_dwordx4 v1, s[8:11], s73 offen offset:1024 sc1 lds
 v_mfma_f32_16x16x32_bf16 v[36:39], v[60:63], a[8:11], v[36:39]
 v_mfma_f32_16x16x32_bf16 v[44:47], v[60:63], a[12:15], v[44:47]
 s_waitcnt lgkmcnt(2)
 v_mfma_f32_16x16x32_bf16 v[16:19], v[64:67], a[16:19], v[16:19]
 v_mfma_f32_16x16x32_bf16 v[24:27], v[64:67], a[20:23], v[24:27]
 ds_read_b128 v[56:59], v8 offset:7168
 v_mfma_f32_16x16x32_bf16 v[32:35], v[64:67], a[24:27], v[32:35]
 ds_read_b128 v[60:63], v8 offset:27648
 v_mfma_f32_16x16x32_bf16 v[40:43], v[64:67], a[28:31], v[40:43]
 buffer_load_dwordx4 v1, s[8:11], s73 offen offset:2048 sc1 lds
 v_mfma_f32_16x16x32_bf16 v[20:23], v[68:71], a[16:19], v[20:23]
 v_mfma_f32_16x16x32_bf16 v[28:31], v[68:71], a[20:23], v[28:31]
 buffer_load_dwordx4 v1, s[8:11], s73 offen offset:3072 sc1 lds
 v_mfma_f32_16x16x32_bf16 v[36:39], v[68:71], a[24:27], v[36:39]
 v_mfma_f32_16x16x32_bf16 v[44:47], v[68:71], a[28:31], v[44:47]
 s_waitcnt lgkmcnt(2)
 v_mfma_f32_16x16x32_bf16 v[16:19], v[48:51], a[32:35], v[16:19]
 v_mfma_f32_16x16x32_bf16 v[24:27], v[48:51], a[36:39], v[24:27]
 ds_read_b128 v[64:67], v8 offset:8192
 v_mfma_f32_16x16x32_bf16 v[32:35], v[48:51], a[40:43], v[32:35]
 ds_read_b128 v[68:71], v8 offset:28672
 v_mfma_f32_16x16x32_bf16 v[40:43], v[48:51], a[44:47], v[40:43]
 s_add_u32 m0, s79, 8192
 v_mfma_f32_16x16x32_bf16 v[20:23], v[52:55], a[32:35], v[20:23]
 v_mfma_f32_16x16x32_bf16 v[28:31], v[52:55], a[36:39], v[28:31]
 s_add_u32 s73, s77, 8192
 v_mfma_f32_16x16x32_bf16 v[36:39], v[52:55], a[40:43], v[36:39]
 v_mfma_f32_16x16x32_bf16 v[44:47], v[52:55], a[44:47], v[44:47]
 s_waitcnt lgkmcnt(2)
 v_mfma_f32_16x16x32_bf16 v[16:19], v[56:59], a[48:51], v[16:19]
 v_mfma_f32_16x16x32_bf16 v[24:27], v[56:59], a[52:55], v[24:27]
 ds_read_b128 v[48:51], v8 offset:9216
 v_mfma_f32_16x16x32_bf16 v[32:35], v[56:59], a[56:59], v[32:35]
 ds_read_b128 v[52:55], v8 offset:29696
 v_mfma_f32_16x16x32_bf16 v[40:43], v[56:59], a[60:63], v[40:43]
 buffer_load_dwordx4 v1, s[8:11], s73 offen offset:0 sc1 lds
 v_mfma_f32_16x16x32_bf16 v[20:23], v[60:63], a[48:51], v[20:23]
 v_mfma_f32_16x16x32_bf16 v[28:31], v[60:63], a[52:55], v[28:31]
 buffer_load_dwordx4 v1, s[8:11], s73 offen offset:1024 sc1 lds
 v_mfma_f32_16x16x32_bf16 v[36:39], v[60:63], a[56:59], v[36:39]
 v_mfma_f32_16x16x32_bf16 v[44:47], v[60:63], a[60:63], v[44:47]
 s_waitcnt lgkmcnt(2)
 v_mfma_f32_16x16x32_bf16 v[16:19], v[64:67], a[64:67], v[16:19]
 v_mfma_f32_16x16x32_bf16 v[24:27], v[64:67], a[68:71], v[24:27]
 ds_read_b128 v[56:59], v8 offset:10240
 v_mfma_f32_16x16x32_bf16 v[32:35], v[64:67], a[72:75], v[32:35]
 ds_read_b128 v[60:63], v8 offset:30720
 v_mfma_f32_16x16x32_bf16 v[40:43], v[64:67], a[76:79], v[40:43]
 buffer_load_dwordx4 v1, s[8:11], s73 offen offset:2048 sc1 lds
 v_mfma_f32_16x16x32_bf16 v[20:23], v[68:71], a[64:67], v[20:23]
 v_mfma_f32_16x16x32_bf16 v[28:31], v[68:71], a[68:71], v[28:31]
 buffer_load_dwordx4 v1, s[8:11], s73 offen offset:3072 sc1 lds
 v_mfma_f32_16x16x32_bf16 v[36:39], v[68:71], a[72:75], v[36:39]
 v_mfma_f32_16x16x32_bf16 v[44:47], v[68:71], a[76:79], v[44:47]
 s_waitcnt lgkmcnt(2)
 v_mfma_f32_16x16x32_bf16 v[16:19], v[48:51], a[80:83], v[16:19]
 v_mfma_f32_16x16x32_bf16 v[24:27], v[48:51], a[84:87], v[24:27]
 ds_read_b128 v[64:67], v8 offset:11264
 v_mfma_f32_16x16x32_bf16 v[32:35], v[48:51], a[88:91], v[32:35]
 ds_read_b128 v[68:71], v8 offset:31744
 v_mfma_f32_16x16x32_bf16 v[40:43], v[48:51], a[92:95], v[40:43]
 s_add_u32 m0, s79, 12288
 v_mfma_f32_16x16x32_bf16 v[20:23], v[52:55], a[80:83], v[20:23]
 v_mfma_f32_16x16x32_bf16 v[28:31], v[52:55], a[84:87], v[28:31]
 s_add_u32 s73, s77, 12288
 v_mfma_f32_16x16x32_bf16 v[36:39], v[52:55], a[88:91], v[36:39]
 v_mfma_f32_16x16x32_bf16 v[44:47], v[52:55], a[92:95], v[44:47]
 s_waitcnt lgkmcnt(2)
 v_mfma_f32_16x16x32_bf16 v[16:19], v[56:59], a[96:99], v[16:19]
 v_mfma_f32_16x16x32_bf16 v[24:27], v[56:59], a[100:103], v[24:27]
 ds_read_b128 v[48:51], v8 offset:12288
 v_mfma_f32_16x16x32_bf16 v[32:35], v[56:59], a[104:107], v[32:35]
 ds_read_b128 v[52:55], v8 offset:32768
 v_mfma_f32_16x16x32_bf16 v[40:43], v[56:59], a[108:111], v[40:43]
 buffer_load_dwordx4 v1, s[8:11], s73 offen offset:0 sc1 lds
 v_mfma_f32_16x16x32_bf16 v[20:23], v[60:63], a[96:99], v[20:23]
 v_mfma_f32_16x16x32_bf16 v[28:31], v[60:63], a[100:103], v[28:31]
 buffer_load_dwordx4 v1, s[8:11], s73 offen offset:1024 sc1 lds
 v_mfma_f32_16x16x32_bf16 v[36:39], v[60:63], a[104:107], v[36:39]
 v_mfma_f32_16x16x32_bf16 v[44:47], v[60:63], a[108:111], v[44:47]
 s_waitcnt lgkmcnt(2)
 v_mfma_f32_16x16x32_bf16 v[16:19], v[64:67], a[112:115], v[16:19]
 v_mfma_f32_16x16x32_bf16 v[24:27], v[64:67], a[116:119], v[24:27]
 ds_read_b128 v[56:59], v8 offset:13312
 v_mfma_f32_16x16x32_bf16 v[32:35], v[64:67], a[120:123], v[32:35]
 ds_read_b128 v[60:63], v8 offset:33792
 v_mfma_f32_16x16x32_bf16 v[40:43], v[64:67], a[124:127], v[40:43]
 buffer_load_dwordx4 v1, s[8:11], s73 offen offset:2048 sc1 lds
 v_mfma_f32_16x16x32_bf16 v[20:23], v[68:71], a[112:115], v[20:23]
 v_mfma_f32_16x16x32_bf16 v[28:31], v[68:71], a[116:119], v[28:31]
 buffer_load_dwordx4 v1, s[8:11], s73 offen offset:3072 sc1 lds
 v_mfma_f32_16x16x32_bf16 v[36:39], v[68:71], a[120:123], v[36:39]
 v_mfma_f32_16x16x32_bf16 v[44:47], v[68:71], a[124:127], v[44:47]
 s_waitcnt lgkmcnt(2)
 v_mfma_f32_16x16x32_bf16 v[16:19], v[48:51], a[128:131], v[16:19]
 v_mfma_f32_16x16x32_bf16 v[24:27], v[48:51], a[132:135], v[24:27]
 ds_read_b128 v[64:67], v8 offset:14336
 v_mfma_f32_16x16x32_bf16 v[32:35], v[48:51], a[136:139], v[32:35]
 ds_read_b128 v[68:71], v8 offset:34816
 v_mfma_f32_16x16x32_bf16 v[40:43], v[48:51], a[140:143], v[40:43]
 s_add_u32 m0, s79, 16384
 v_mfma_f32_16x16x32_bf16 v[20:23], v[52:55], a[128:131], v[20:23]
 v_mfma_f32_16x16x32_bf16 v[28:31], v[52:55], a[132:135], v[28:31]
 s_add_u32 s73, s77, 16384
 v_mfma_f32_16x16x32_bf16 v[36:39], v[52:55], a[136:139], v[36:39]
 v_mfma_f32_16x16x32_bf16 v[44:47], v[52:55], a[140:143], v[44:47]
 s_waitcnt lgkmcnt(2)
 v_mfma_f32_16x16x32_bf16 v[16:19], v[56:59], a[144:147], v[16:19]
 v_mfma_f32_16x16x32_bf16 v[24:27], v[56:59], a[148:151], v[24:27]
 ds_read_b128 v[48:51], v8 offset:15360
 v_mfma_f32_16x16x32_bf16 v[32:35], v[56:59], a[152:155], v[32:35]
 ds_read_b128 v[52:55], v8 offset:35840
 v_mfma_f32_16x16x32_bf16 v[40:43], v[56:59], a[156:159], v[40:43]
 buffer_load_dwordx4 v1, s[8:11], s73 offen offset:0 sc1 lds
 v_mfma_f32_16x16x32_bf16 v[20:23], v[60:63], a[144:147], v[20:23]
 v_mfma_f32_16x16x32_bf16 v[28:31], v[60:63], a[148:151], v[28:31]
 buffer_load_dwordx4 v1, s[8:11], s73 offen offset:1024 sc1 lds
 v_mfma_f32_16x16x32_bf16 v[36:39], v[60:63], a[152:155], v[36:39]
 v_mfma_f32_16x16x32_bf16 v[44:47], v[60:63], a[156:159], v[44:47]
 s_waitcnt lgkmcnt(2)
 v_mfma_f32_16x16x32_bf16 v[16:19], v[64:67], a[160:163], v[16:19]
 v_mfma_f32_16x16x32_bf16 v[24:27], v[64:67], a[164:167], v[24:27]
 ds_read_b128 v[56:59], v8 offset:16384
 v_mfma_f32_16x16x32_bf16 v[32:35], v[64:67], a[168:171], v[32:35]
 ds_read_b128 v[60:63], v8 offset:36864
 v_mfma_f32_16x16x32_bf16 v[40:43], v[64:67], a[172:175], v[40:43]
 buffer_load_dwordx4 v1, s[8:11], s73 offen offset:2048 sc1 lds
 v_mfma_f32_16x16x32_bf16 v[20:23], v[68:71], a[160:163], v[20:23]
 v_mfma_f32_16x16x32_bf16 v[28:31], v[68:71], a[164:167], v[28:31]
 buffer_load_dwordx4 v1, s[8:11], s73 offen offset:3072 sc1 lds
 v_mfma_f32_16x16x32_bf16 v[36:39], v[68:71], a[168:171], v[36:39]
 v_mfma_f32_16x16x32_bf16 v[44:47], v[68:71], a[172:175], v[44:47]
 s_waitcnt lgkmcnt(2)
 v_mfma_f32_16x16x32_bf16 v[16:19], v[48:51], a[176:179], v[16:19]
 v_mfma_f32_16x16x32_bf16 v[24:27], v[48:51], a[180:183], v[24:27]
 ds_read_b128 v[64:67], v8 offset:17408
 v_mfma_f32_16x16x32_bf16 v[32:35], v[48:51], a[184:187], v[32:35]
 ds_read_b128 v[68:71], v8 offset:37888
 v_mfma_f32_16x16x32_bf16 v[40:43], v[48:51], a[188:191], v[40:43]
 v_mfma_f32_16x16x32_bf16 v[20:23], v[52:55], a[176:179], v[20:23]
 v_mfma_f32_16x16x32_bf16 v[28:31], v[52:55], a[180:183], v[28:31]
 v_mfma_f32_16x16x32_bf16 v[36:39], v[52:55], a[184:187], v[36:39]
 v_mfma_f32_16x16x32_bf16 v[44:47], v[52:55], a[188:191], v[44:47]
 s_waitcnt lgkmcnt(2)
 v_mfma_f32_16x16x32_bf16 v[16:19], v[56:59], a[192:195], v[16:19]
 v_mfma_f32_16x16x32_bf16 v[24:27], v[56:59], a[196:199], v[24:27]
 ds_read_b128 v[48:51], v8 offset:18432
 v_mfma_f32_16x16x32_bf16 v[32:35], v[56:59], a[200:203], v[32:35]
 ds_read_b128 v[52:55], v8 offset:38912
 v_mfma_f32_16x16x32_bf16 v[40:43], v[56:59], a[204:207], v[40:43]
 v_mfma_f32_16x16x32_bf16 v[20:23], v[60:63], a[192:195], v[20:23]
 v_mfma_f32_16x16x32_bf16 v[28:31], v[60:63], a[196:199], v[28:31]
 v_mfma_f32_16x16x32_bf16 v[36:39], v[60:63], a[200:203], v[36:39]
 v_mfma_f32_16x16x32_bf16 v[44:47], v[60:63], a[204:207], v[44:47]
 s_waitcnt lgkmcnt(2)
 v_mfma_f32_16x16x32_bf16 v[16:19], v[64:67], a[208:211], v[16:19]
 v_mfma_f32_16x16x32_bf16 v[24:27], v[64:67], a[212:215], v[24:27]
 ds_read_b128 v[56:59], v8 offset:19456
 v_mfma_f32_16x16x32_bf16 v[32:35], v[64:67], a[216:219], v[32:35]
 ds_read_b128 v[60:63], v8 offset:39936
 v_mfma_f32_16x16x32_bf16 v[40:43], v[64:67], a[220:223], v[40:43]
 v_mfma_f32_16x16x32_bf16 v[20:23], v[68:71], a[208:211], v[20:23]
 v_mfma_f32_16x16x32_bf16 v[28:31], v[68:71], a[212:215], v[28:31]
 v_mfma_f32_16x16x32_bf16 v[36:39], v[68:71], a[216:219], v[36:39]
 v_mfma_f32_16x16x32_bf16 v[44:47], v[68:71], a[220:223], v[44:47]
 s_waitcnt lgkmcnt(2)
 v_mfma_f32_16x16x32_bf16 v[16:19], v[48:51], a[224:227], v[16:19]
 v_mfma_f32_16x16x32_bf16 v[24:27], v[48:51], a[228:231], v[24:27]
 v_mfma_f32_16x16x32_bf16 v[32:35], v[48:51], a[232:235], v[32:35]
 v_mfma_f32_16x16x32_bf16 v[40:43], v[48:51], a[236:239], v[40:43]
 v_mfma_f32_16x16x32_bf16 v[20:23], v[52:55], a[224:227], v[20:23]
 v_mfma_f32_16x16x32_bf16 v[28:31], v[52:55], a[228:231], v[28:31]
 v_mfma_f32_16x16x32_bf16 v[36:39], v[52:55], a[232:235], v[36:39]
 v_mfma_f32_16x16x32_bf16 v[44:47], v[52:55], a[236:239], v[44:47]
 s_waitcnt lgkmcnt(0)
 v_mfma_f32_16x16x32_bf16 v[16:19], v[56:59], a[240:243], v[16:19]
 v_mfma_f32_16x16x32_bf16 v[24:27], v[56:59], a[244:247], v[24:27]
 v_mfma_f32_16x16x32_bf16 v[32:35], v[56:59], a[248:251], v[32:35]
 v_mfma_f32_16x16x32_bf16 v[40:43], v[56:59], a[252:255], v[40:43]
 v_mfma_f32_16x16x32_bf16 v[20:23], v[60:63], a[240:243], v[20:23]
 v_mfma_f32_16x16x32_bf16 v[28:31], v[60:63], a[244:247], v[28:31]
 v_mfma_f32_16x16x32_bf16 v[36:39], v[60:63], a[248:251], v[36:39]
 v_mfma_f32_16x16x32_bf16 v[44:47], v[60:63], a[252:255], v[44:47]
 v_add_u32 v8, v8, v9
 v_sub_u32 v9, 0, v9
 s_add_u32 s79, s79, s85
 s_sub_u32 s85, 0, s85
 s_add_u32 s77, s77, 163840
 v_cvt_pk_bf16_f32 v48, v16, v17
 v_cvt_pk_bf16_f32 v49, v18, v19
 v_cvt_pk_bf16_f32 v50, v20, v21
 v_cvt_pk_bf16_f32 v51, v22, v23
 buffer_store_dwordx4 v[48:51], v1, s[8:11], s78 offen offset:0 sc1
 v_cvt_pk_bf16_f32 v52, v24, v25
 v_cvt_pk_bf16_f32 v53, v26, v27
 v_cvt_pk_bf16_f32 v54, v28, v29
 v_cvt_pk_bf16_f32 v55, v30, v31
 buffer_store_dwordx4 v[52:55], v1, s[8:11], s78 offen offset:1024 sc1
 v_cvt_pk_bf16_f32 v56, v32, v33
 v_cvt_pk_bf16_f32 v57, v34, v35
 v_cvt_pk_bf16_f32 v58, v36, v37
 v_cvt_pk_bf16_f32 v59, v38, v39
 buffer_store_dwordx4 v[56:59], v1, s[8:11], s78 offen offset:2048 sc1
 v_cvt_pk_bf16_f32 v60, v40, v41
 v_cvt_pk_bf16_f32 v61, v42, v43
 v_cvt_pk_bf16_f32 v62, v44, v45
 v_cvt_pk_bf16_f32 v63, v46, v47
 buffer_store_dwordx4 v[60:63], v1, s[8:11], s78 offen offset:3072 sc1
 s_add_u32 s78, s78, 0x100000
 s_add_u32 s76, s76, 1
 s_cmp_lt_u32 s76, 16
 s_cbranch_scc1 qkv_v_loop
 s_waitcnt vmcnt(0)
 s_barrier
 s_cmp_lg_u32 s66, 0
 s_cbranch_scc1 notw0_39
 v_mov_b32 v2, 16
 v_mov_b32 v3, 0
 s_mov_b64 exec, 1
 buffer_store_dword v2, v3, s[8:11], s83 offen sc1
 s_mov_b64 exec, -1
notw0_39:
qkv_done:
 s_barrier
 s_cmp_ge_u32 s70, 20
 s_cbranch_scc1 role_40
 s_sub_u32 s81, s70, 0
 s_mov_b32 s80, 0
 s_mov_b32 s100, 3
 s_branch t2
role_40:
 s_cmp_ge_u32 s70, 25
 s_cbranch_scc1 role_41
 s_sub_u32 s81, s70, 20
 s_mov_b32 s80, 0
 s_mov_b32 s100, 6
 s_branch t3
role_41:
 s_cmp_ge_u32 s70, 32
 s_cbranch_scc1 role_42
 s_sub_u32 s81, s70, 25
 s_mov_b32 s80, 0
 s_mov_b32 s100, 5
 s_branch t5
role_42:
 s_cmp_ge_u32 s70, 52
 s_cbranch_scc1 role_43
 s_sub_u32 s81, s70, 32
 s_mov_b32 s80, 1
 s_mov_b32 s100, 3
 s_branch t2
role_43:
 s_cmp_ge_u32 s70, 57
 s_cbranch_scc1 role_44
 s_sub_u32 s81, s70, 52
 s_mov_b32 s80, 1
 s_mov_b32 s100, 6
 s_branch t3
role_44:
 s_cmp_ge_u32 s70, 64
 s_cbranch_scc1 role_45
 s_sub_u32 s81, s70, 57
 s_mov_b32 s80, 1
 s_mov_b32 s100, 5
 s_branch t5
role_45:
 s_cmp_ge_u32 s70, 84
 s_cbranch_scc1 role_46
 s_sub_u32 s81, s70, 64
 s_mov_b32 s80, 2
 s_mov_b32 s100, 3
 s_branch t2
role_46:
 s_cmp_ge_u32 s70, 89
 s_cbranch_scc1 role_47
 s_sub_u32 s81, s70, 84
 s_mov_b32 s80, 2
 s_mov_b32 s100, 6
 s_branch t3
role_47:
 s_cmp_ge_u32 s70, 96
 s_cbranch_scc1 role_48
 s_sub_u32 s81, s70, 89
 s_mov_b32 s80, 2
 s_mov_b32 s100, 5
 s_branch t5
role_48:
 s_cmp_ge_u32 s70, 106
 s_cbranch_scc1 role_49
 s_sub_u32 s81, s70, 96
 s_mov_b32 s80, 0
 s_mov_b32 s100, 2
 s_branch t6
role_49:
 s_cmp_ge_u32 s70, 111
 s_cbranch_scc1 role_50
 s_sub_u32 s81, s70, 106
 s_mov_b32 s80, 3
 s_mov_b32 s100, 6
 s_branch t3
role_50:
 s_cmp_ge_u32 s70, 116
 s_cbranch_scc1 role_51
 s_sub_u32 s81, s70, 111
 s_mov_b32 s80, 0
 s_mov_b32 s100, 3
 s_branch t4
role_51:
 s_cmp_ge_u32 s70, 123
 s_cbranch_scc1 role_52
 s_sub_u32 s81, s70, 116
 s_mov_b32 s80, 3
 s_mov_b32 s100, 5
 s_branch t5
role_52:
 s_cmp_ge_u32 s70, 128
 s_cbranch_scc1 role_53
 s_sub_u32 s81, s70, 123
 s_branch att
role_53:
 s_cmp_ge_u32 s70, 138
 s_cbranch_scc1 role_54
 s_sub_u32 s81, s70, 128
 s_mov_b32 s80, 1
 s_mov_b32 s100, 2
 s_branch t6
role_54:
 s_cmp_ge_u32 s70, 143
 s_cbranch_scc1 role_55
 s_sub_u32 s81, s70, 138
 s_mov_b32 s80, 4
 s_mov_b32 s100, 6
 s_branch t3
role_55:
 s_cmp_ge_u32 s70, 148
 s_cbranch_scc1 role_56
 s_sub_u32 s81, s70, 143
 s_mov_b32 s80, 1
 s_mov_b32 s100, 3
 s_branch t4
role_56:
 s_cmp_ge_u32 s70, 153
 s_cbranch_scc1 role_57
 s_sub_u32 s81, s70, 148
 s_mov_b32 s80, 2
 s_mov_b32 s100, 3
 s_branch t4
role_57:
 s_cmp_ge_u32 s70, 160
 s_cbranch_scc1 role_58
 s_sub_u32 s81, s70, 148
 s_branch att
role_58:
 s_cmp_ge_u32 s70, 180
 s_cbranch_scc1 role_59
 s_sub_u32 s81, s70, 148
 s_branch att
role_59:
 s_cmp_ge_u32 s70, 187
 s_cbranch_scc1 role_60
 s_sub_u32 s81, s70, 180
 s_mov_b32 s80, 4
 s_mov_b32 s100, 5
 s_branch t5
role_60:
 s_cmp_ge_u32 s70, 192
 s_cbranch_scc1 role_61
 s_sub_u32 s81, s70, 187
 s_mov_b32 s80, 5
 s_mov_b32 s100, 6
 s_branch t3
role_61:
 s_endpgm
att:
 s_lshl_b32 s73, s81, 2
 s_add_u32 s73, s73, s66
 s_and_b32 s80, s73, 1
 s_lshr_b32 s82, s73, 6
 s_lshl_b32 s82, s82, 1
 s_add_u32 s82, s82, s80
 s_bfe_u32 s81, s73, 0x50001
 s_mov_b32 s100, 4
 v_and_b32 v2, 15, v0
 v_lshrrev_b32 v3, 4, v0
 v_bfe_u32 v4, v0, 2, 2
 s_mul_i32 s73, s66, 2304
 v_lshrrev_b32 v8, 1, v3
 v_mul_u32_u24 v8, 288, v8
 v_lshl_add_u32 v8, v2, 4, v8
 v_and_b32 v5, 1, v3
 v_lshl_add_u32 v8, v5, 3, v8
 v_add_u32 v8, s73, v8
 v_and_b32 v9, 1, v4
 v_mul_u32_u24 v9, 288, v9
 v_lshrrev_b32 v5, 1, v4
 v_lshl_add_u32 v5, v3, 2, v5
 v_lshl_add_u32 v9, v5, 4, v9
 v_and_b32 v5, 1, v0
 v_lshl_add_u32 v9, v5, 3, v9
 v_add_u32 v9, s73, v9
 v_lshlrev_b32 v10, 3, v0
 v_and_b32 v11, 7, v0
 v_lshlrev_b32 v11, 7, v11
 v_mov_b32 v12, 0xce6e6b28
 v_and_b32 v13, 1, v0
 v_lshlrev_b32 v13, 7, v13
 s_lshl_b32 s73, s80, 4
 v_add_u32 v5, s73, v2
 v_lshlrev_b32 v6, 2, v3
 v_add_u32 v7, 0, v6
 v_cmp_le_u32 s[84:85], v7, v5
 v_add_u32 v7, 1, v6
 v_cmp_le_u32 s[86:87], v7, v5
 v_add_u32 v7, 2, v6
 v_cmp_le_u32 s[88:89], v7, v5
 v_add_u32 v7, 3, v6
 v_cmp_le_u32 s[90:91], v7, v5
 v_add_u32 v7, 16, v6
 v_cmp_le_u32 s[92:93], v7, v5
 v_add_u32 v7, 17, v6
 v_cmp_le_u32 s[94:95], v7, v5
 v_add_u32 v7, 18, v6
 v_cmp_le_u32 s[96:97], v7, v5
 v_add_u32 v7, 19, v6
 v_cmp_le_u32 s[98:99], v7, v5
 s_lshl_b32 s73, s81, 10
 s_add_u32 s73, s73, 16384
wait_62:
 buffer_load_dword v2, v11, s[8:11], s73 offen sc1
 s_waitcnt vmcnt(0)
test_64:
 v_cmp_gt_u32 vcc, 16, v2
 s_and_b32 vcc_lo, vcc_lo, 0x3f
 s_and_b32 vcc_hi, vcc_hi, 0x0
 s_cmp_eq_u64 vcc, 0
 s_cbranch_scc1 ready_63
 s_sleep 1
 s_add_u32 s72, s72, 1
 s_cmp_lt_u32 s72, 0x40000
 s_cbranch_scc1 wait_62
 s_branch bail2
ready_63:
 s_lshl_b32 s4, s82, 5
 s_add_u32 s4, s4, s81
 s_lshl_b32 s4, s4, 7
 s_add_u32 s4, s4, 57344
 s_mov_b32 s3, 0
att_loop:
 s_lshr_b32 s76, s82, 1
 s_lshl_b32 s73, s76, 5
 s_add_u32 s73, s73, s81
 s_lshl_b32 s78, s73, 11
 s_lshl_b32 s77, s73, 13
 s_lshl_b32 s73, s80, 12
 s_add_u32 s73, s73, s77
 s_add_u32 s73, s73, 0x2200000
 buffer_load_dwordx4 v[16:19], v1, s[8:11], s73 offen offset:0 sc1
 buffer_load_dwordx4 v[20:23], v1, s[8:11], s73 offen offset:1024 sc1
 buffer_load_dwordx4 v[24:27], v1, s[8:11], s73 offen offset:2048 sc1
 buffer_load_dwordx4 v[28:31], v1, s[8:11], s73 offen offset:3072 sc1
 s_add_u32 s73, s77, 0x3200000
 buffer_load_dwordx4 v[32:35], v1, s[8:11], s73 offen offset:0 sc1
 buffer_load_dwordx4 v[36:39], v1, s[8:11], s73 offen offset:1024 sc1
 buffer_load_dwordx4 v[40:43], v1, s[8:11], s73 offen offset:2048 sc1
 buffer_load_dwordx4 v[44:47], v1, s[8:11], s73 offen offset:3072 sc1
 s_add_u32 s73, s77, 0x3201000
 buffer_load_dwordx4 v[48:51], v1, s[8:11], s73 offen offset:0 sc1
 buffer_load_dwordx4 v[52:55], v1, s[8:11], s73 offen offset:1024 sc1
 buffer_load_dwordx4 v[56:59], v1, s[8:11], s73 offen offset:2048 sc1
 buffer_load_dwordx4 v[60:63], v1, s[8:11], s73 offen offset:3072 sc1
 s_add_u32 s73, s77, 0x4200000
 buffer_load_dwordx4 v[64:67], v1, s[8:11], s73 offen offset:0 sc1
 buffer_load_dwordx4 v[68:71], v1, s[8:11], s73 offen offset:1024 sc1
 buffer_load_dwordx4 v[72:75], v1, s[8:11], s73 offen offset:2048 sc1
 buffer_load_dwordx4 v[76:79], v1, s[8:11], s73 offen offset:3072 sc1
 s_add_u32 s73, s77, 0x4201000
 buffer_load_dwordx4 v[80:83], v1, s[8:11], s73 offen offset:0 sc1
 buffer_load_dwordx4 v[84:87], v1, s[8:11], s73 offen offset:1024 sc1
 buffer_load_dwordx4 v[88:91], v1, s[8:11], s73 offen offset:2048 sc1
 buffer_load_dwordx4 v[92:95], v1, s[8:11], s73 offen offset:3072 sc1
 s_waitcnt vmcnt(20)
 v_mov_b32 v4, s3
 v_mov_b32 v5, 0
 s_mov_b64 exec, 1
 buffer_store_dword v4, v5, s[8:11], s4 offen sc1
 s_mov_b64 exec, -1
 s_waitcnt vmcnt(9)
 v_mfma_f32_16x16x32_bf16 v[128:131], v[32:35], v[16:19], 0
 v_mfma_f32_16x16x32_bf16 v[132:135], v[48:51], v[16:19], 0
 v_mfma_f32_16x16x32_bf16 v[128:131], v[36:39], v[20:23], v[128:131]
 v_mfma_f32_16x16x32_bf16 v[132:135], v[52:55], v[20:23], v[132:135]
 v_mfma_f32_16x16x32_bf16 v[128:131], v[40:43], v[24:27], v[128:131]
 v_mfma_f32_16x16x32_bf16 v[132:135], v[56:59], v[24:27], v[132:135]
 v_mfma_f32_16x16x32_bf16 v[128:131], v[44:47], v[28:31], v[128:131]
 v_mfma_f32_16x16x32_bf16 v[132:135], v[60:63], v[28:31], v[132:135]
 s_lshl_b32 s73, s81, 8
 s_add_u32 s73, s73, 49152
 s_add_u32 s76, s76, 1
wait_65:
 buffer_load_dword v2, v13, s[8:11], s73 offen sc1
 s_waitcnt vmcnt(0)
test_67:
 v_cmp_gt_u32 vcc, s76, v2
 s_and_b32 vcc_lo, vcc_lo, 0x3
 s_and_b32 vcc_hi, vcc_hi, 0x0
 s_cmp_eq_u64 vcc, 0
 s_cbranch_scc1 ready_66
 s_sleep 1
 s_add_u32 s72, s72, 1
 s_cmp_lt_u32 s72, 0x40000
 s_cbranch_scc1 wait_65
 s_branch bail2
ready_66:
 s_add_u32 s73, s78, 0x240000
 buffer_load_dwordx2 v[120:121], v10, s[8:11], s73 offen offset:0 sc1
 buffer_load_dwordx2 v[122:123], v10, s[8:11], s73 offen offset:512 sc1
 buffer_load_dwordx2 v[124:125], v10, s[8:11], s73 offen offset:1024 sc1
 buffer_load_dwordx2 v[126:127], v10, s[8:11], s73 offen offset:1536 sc1
 s_add_u32 s73, s78, 0x640000
 buffer_load_dwordx2 v[112:113], v10, s[8:11], s73 offen offset:0 sc1
 buffer_load_dwordx2 v[114:115], v10, s[8:11], s73 offen offset:512 sc1
 buffer_load_dwordx2 v[116:117], v10, s[8:11], s73 offen offset:1024 sc1
 buffer_load_dwordx2 v[118:119], v10, s[8:11], s73 offen offset:1536 sc1
 v_cvt_pk_bf16_f32 v128, 0, v128
 v_cvt_pk_bf16_f32 v129, 0, v129
 v_cvt_pk_bf16_f32 v130, 0, v130
 v_cvt_pk_bf16_f32 v131, 0, v131
 v_cvt_pk_bf16_f32 v132, 0, v132
 v_cvt_pk_bf16_f32 v133, 0, v133
 v_cvt_pk_bf16_f32 v134, 0, v134
 v_cvt_pk_bf16_f32 v135, 0, v135
 v_mul_f32 v128, 0x3db504f3, v128
 v_mul_f32 v129, 0x3db504f3, v129
 v_mul_f32 v130, 0x3db504f3, v130
 v_mul_f32 v131, 0x3db504f3, v131
 v_mul_f32 v132, 0x3db504f3, v132
 v_mul_f32 v133, 0x3db504f3, v133
 v_mul_f32 v134, 0x3db504f3, v134
 v_mul_f32 v135, 0x3db504f3, v135
 v_cvt_pk_bf16_f32 v128, 0, v128
 v_cvt_pk_bf16_f32 v129, 0, v129
 v_cvt_pk_bf16_f32 v130, 0, v130
 v_cvt_pk_bf16_f32 v131, 0, v131
 v_cvt_pk_bf16_f32 v132, 0, v132
 v_cvt_pk_bf16_f32 v133, 0, v133
 v_cvt_pk_bf16_f32 v134, 0, v134
 v_cvt_pk_bf16_f32 v135, 0, v135
 v_cndmask_b32 v128, v12, v128, s[84:85]
 v_cndmask_b32 v129, v12, v129, s[86:87]
 v_cndmask_b32 v130, v12, v130, s[88:89]
 v_cndmask_b32 v131, v12, v131, s[90:91]
 v_cndmask_b32 v132, v12, v132, s[92:93]
 v_cndmask_b32 v133, v12, v133, s[94:95]
 v_cndmask_b32 v134, v12, v134, s[96:97]
 v_cndmask_b32 v135, v12, v135, s[98:99]
 v_max3_f32 v180, v128, v129, v130
 v_max3_f32 v180, v180, v131, v132
 v_max3_f32 v180, v180, v133, v134
 v_max_f32 v180, v180, v135
 v_mov_b64 v[144:145], 0
 v_mov_b64 v[146:147], 0
 s_waitcnt vmcnt(4)
 ds_write_b64 v8, v[120:121] offset:0
 ds_write_b64 v8, v[122:123] offset:576
 ds_write_b64 v8, v[124:125] offset:1152
 ds_write_b64 v8, v[126:127] offset:1728
 ds_read_b64_tr_b16 v[96:97], v9 offset:0
 ds_read_b64_tr_b16 v[98:99], v9 offset:32
 ds_read_b64_tr_b16 v[100:101], v9 offset:576
 ds_read_b64_tr_b16 v[102:103], v9 offset:608
 ds_read_b64_tr_b16 v[104:105], v9 offset:1152
 ds_read_b64_tr_b16 v[106:107], v9 offset:1184
 ds_read_b64_tr_b16 v[108:109], v9 offset:1728
 ds_read_b64_tr_b16 v[110:111], v9 offset:1760
 s_waitcnt lgkmcnt(6)
 v_mfma_f32_16x16x32_bf16 v[136:139], v[96:99], v[16:19], 0
 s_waitcnt lgkmcnt(4)
 v_mfma_f32_16x16x32_bf16 v[136:139], v[100:103], v[20:23], v[136:139]
 s_waitcnt lgkmcnt(2)
 v_mfma_f32_16x16x32_bf16 v[136:139], v[104:107], v[24:27], v[136:139]
 s_waitcnt lgkmcnt(0)
 v_mfma_f32_16x16x32_bf16 v[136:139], v[108:111], v[28:31], v[136:139]
 s_nop 7
 v_cvt_pk_bf16_f32 v136, 0, v136
 v_cvt_pk_bf16_f32 v137, 0, v137
 v_cvt_pk_bf16_f32 v138, 0, v138
 v_cvt_pk_bf16_f32 v139, 0, v139
 v_mul_f32 v136, 0x3db504f3, v136
 v_mul_f32 v137, 0x3db504f3, v137
 v_mul_f32 v138, 0x3db504f3, v138
 v_mul_f32 v139, 0x3db504f3, v139
 v_cvt_pk_bf16_f32 v136, 0, v136
 v_cvt_pk_bf16_f32 v137, 0, v137
 v_cvt_pk_bf16_f32 v138, 0, v138
 v_cvt_pk_bf16_f32 v139, 0, v139
 v_max3_f32 v180, v180, v136, v137
 v_max3_f32 v180, v180, v138, v139
 v_mov_b32 v181, v180
 s_nop 1
 v_permlane16_swap_b32 v180, v181
 v_max_f32 v180, v180, v181
 v_mov_b32 v181, v180
 s_nop 1
 v_permlane32_swap_b32 v180, v181
 v_max_f32 v180, v180, v181
 v_sub_f32 v128, v128, v180
 v_sub_f32 v129, v129, v180
 v_sub_f32 v130, v130, v180
 v_sub_f32 v131, v131, v180
 v_sub_f32 v132, v132, v180
 v_sub_f32 v133, v133, v180
 v_sub_f32 v134, v134, v180
 v_sub_f32 v135, v135, v180
 v_sub_f32 v136, v136, v180
 v_sub_f32 v137, v137, v180
 v_sub_f32 v138, v138, v180
 v_sub_f32 v139, v139, v180
 v_mul_f32 v128, 0x3fb8aa3b, v128
 v_mul_f32 v129, 0x3fb8aa3b, v129
 v_mul_f32 v130, 0x3fb8aa3b, v130
 v_mul_f32 v131, 0x3fb8aa3b, v131
 v_mul_f32 v132, 0x3fb8aa3b, v132
 v_mul_f32 v133, 0x3fb8aa3b, v133
 v_mul_f32 v134, 0x3fb8aa3b, v134
 v_mul_f32 v135, 0x3fb8aa3b, v135
 v_mul_f32 v136, 0x3fb8aa3b, v136
 v_mul_f32 v137, 0x3fb8aa3b, v137
 v_mul_f32 v138, 0x3fb8aa3b, v138
 v_mul_f32 v139, 0x3fb8aa3b, v139
 v_exp_f32 v128, v128
 v_exp_f32 v129, v129
 v_exp_f32 v130, v130
 v_exp_f32 v131, v131
 v_exp_f32 v132, v132
 v_exp_f32 v133, v133
 v_exp_f32 v134, v134
 v_exp_f32 v135, v135
 v_exp_f32 v136, v136
 v_exp_f32 v137, v137
 v_exp_f32 v138, v138
 v_exp_f32 v139, v139
 v_pk_add_f32 v[180:181], v[128:129], v[130:131]
 v_pk_add_f32 v[182:183], v[132:133], v[134:135]
 v_pk_add_f32 v[184:185], v[136:137], v[138:139]
 v_pk_add_f32 v[180:181], v[180:181], v[182:183]
 v_add_f32 v184, v184, v185
 v_add_f32 v180, v180, v181
 v_fma_f32 v180, v184, 0.5, v180
 v_mov_b32 v181, v180
 s_nop 1
 v_permlane16_swap_b32 v180, v181
 v_add_f32 v180, v180, v181
 v_mov_b32 v181, v180
 s_nop 1
 v_permlane32_swap_b32 v180, v181
 v_add_f32 v180, v180, v181
 v_rcp_f32 v180, v180
 s_nop 0
 v_pk_mul_f32 v[128:129], v[128:129], v[180:181] op_sel_hi:[1,0]
 v_pk_mul_f32 v[130:131], v[130:131], v[180:181] op_sel_hi:[1,0]
 v_pk_mul_f32 v[132:133], v[132:133], v[180:181] op_sel_hi:[1,0]
 v_pk_mul_f32 v[134:135], v[134:135], v[180:181] op_sel_hi:[1,0]
 v_pk_mul_f32 v[136:137], v[136:137], v[180:181] op_sel_hi:[1,0]
 v_pk_mul_f32 v[138:139], v[138:139], v[180:181] op_sel_hi:[1,0]
 v_cvt_pk_bf16_f32 v140, v128, v129
 v_cvt_pk_bf16_f32 v141, v130, v131
 v_cvt_pk_bf16_f32 v142, v132, v133
 v_cvt_pk_bf16_f32 v143, v134, v135
 v_cvt_pk_bf16_f32 v180, v136, v137
 v_cvt_pk_bf16_f32 v181, v138, v139
 s_nop 0
 v_mov_b32_dpp v144, v180 quad_perm:[0,1,2,3] row_mask:0x3 bank_mask:0xf
 v_mov_b32_dpp v146, v180 quad_perm:[0,1,2,3] row_mask:0xc bank_mask:0xf
 v_mov_b32_dpp v145, v181 quad_perm:[0,1,2,3] row_mask:0x3 bank_mask:0xf
 v_mov_b32_dpp v147, v181 quad_perm:[0,1,2,3] row_mask:0xc bank_mask:0xf
 v_mfma_f32_16x16x32_bf16 v[148:151], v[64:67], v[140:143], 0
 v_mfma_f32_16x16x32_bf16 v[152:155], v[68:71], v[140:143], 0
 v_mfma_f32_16x16x32_bf16 v[156:159], v[72:75], v[140:143], 0
 v_mfma_f32_16x16x32_bf16 v[160:163], v[76:79], v[140:143], 0
 v_mfma_f32_16x16x32_bf16 v[164:167], v[80:83], v[140:143], 0
 v_mfma_f32_16x16x32_bf16 v[168:171], v[84:87], v[140:143], 0
 v_mfma_f32_16x16x32_bf16 v[172:175], v[88:91], v[140:143], 0
 v_mfma_f32_16x16x32_bf16 v[176:179], v[92:95], v[140:143], 0
 s_waitcnt vmcnt(0)
 v_mfma_f32_16x16x16_bf16 v[148:151], v[112:113], v[144:145], v[148:151]
 v_mfma_f32_16x16x16_bf16 v[152:155], v[112:113], v[146:147], v[152:155]
 v_mfma_f32_16x16x16_bf16 v[156:159], v[114:115], v[144:145], v[156:159]
 v_mfma_f32_16x16x16_bf16 v[160:163], v[114:115], v[146:147], v[160:163]
 v_mfma_f32_16x16x16_bf16 v[164:167], v[116:117], v[144:145], v[164:167]
 v_mfma_f32_16x16x16_bf16 v[168:171], v[116:117], v[146:147], v[168:171]
 v_mfma_f32_16x16x16_bf16 v[172:175], v[118:119], v[144:145], v[172:175]
 v_mfma_f32_16x16x16_bf16 v[176:179], v[118:119], v[146:147], v[176:179]
 s_lshl_b32 s73, s82, 5
 s_add_u32 s73, s73, s81
 s_lshl_b32 s73, s73, 12
 s_add_u32 s73, s73, 0x5200000
 v_cvt_pk_bf16_f32 v96, v148, v152
 v_cvt_pk_bf16_f32 v97, v149, v153
 v_cvt_pk_bf16_f32 v98, v150, v154
 v_cvt_pk_bf16_f32 v99, v151, v155
 buffer_store_dwordx4 v[96:99], v1, s[8:11], s73 offen offset:0 sc1
 v_cvt_pk_bf16_f32 v100, v156, v160
 v_cvt_pk_bf16_f32 v101, v157, v161
 v_cvt_pk_bf16_f32 v102, v158, v162
 v_cvt_pk_bf16_f32 v103, v159, v163
 buffer_store_dwordx4 v[100:103], v1, s[8:11], s73 offen offset:1024 sc1
 v_cvt_pk_bf16_f32 v104, v164, v168
 v_cvt_pk_bf16_f32 v105, v165, v169
 v_cvt_pk_bf16_f32 v106, v166, v170
 v_cvt_pk_bf16_f32 v107, v167, v171
 buffer_store_dwordx4 v[104:107], v1, s[8:11], s73 offen offset:2048 sc1
 v_cvt_pk_bf16_f32 v108, v172, v176
 v_cvt_pk_bf16_f32 v109, v173, v177
 v_cvt_pk_bf16_f32 v110, v174, v178
 v_cvt_pk_bf16_f32 v111, v175, v179
 buffer_store_dwordx4 v[108:111], v1, s[8:11], s73 offen offset:3072 sc1
 s_add_u32 s3, s82, 1
 s_add_u32 s82, s82, s100
 s_cmp_lt_u32 s82, 128
 s_cbranch_scc1 att_loop
 s_waitcnt vmcnt(0)
 v_mov_b32 v4, s3
 v_mov_b32 v5, 0
 s_mov_b64 exec, 1
 buffer_store_dword v4, v5, s[8:11], s4 offen sc1
 s_mov_b64 exec, -1
 s_waitcnt vmcnt(0)
 s_endpgm
t2:
 s_mov_b32 s12, s42
 s_and_b32 s13, s43, 0xffff
 s_mov_b32 s14, 0x500000
 s_mov_b32 s15, 0x20000
 s_mov_b32 s16, s32
 s_and_b32 s17, s33, 0xffff
 s_mov_b32 s18, 0x280000
 s_mov_b32 s19, 0x20000
 s_mov_b32 s82, s80
 s_mul_i32 s77, s66, 32
 v_lshrrev_b32 v2, 2, v0
 v_mul_u32_u24 v2, 1280, v2
 v_and_b32 v3, 3, v0
 v_lshl_add_u32 v2, v3, 4, v2
 s_lshl_b32 s73, s66, 15
 v_add_u32 v4, s73, v1
 v_lshrrev_b32 v5, 4, v0
 v_bfe_u32 v6, v0, 2, 2
 v_lshl_add_u32 v5, v5, 3, v6
 v_lshlrev_b32 v5, 6, v5
 v_and_b32 v3, 3, v0
 v_lshl_add_u32 v5, v3, 4, v5
 v_add_u32 v5, s73, v5
 s_mul_i32 s74, s77, 40960
 s_lshl_b32 s73, s81, 6
 s_add_u32 s74, s74, s73
 s_add_u32 s73, s74, 0
 buffer_load_dwordx4 v[16:19], v2, s[12:15], s73 offen
 s_add_u32 s73, s74, 20480
 buffer_load_dwordx4 v[20:23], v2, s[12:15], s73 offen
 s_add_u32 s73, s74, 40960
 buffer_load_dwordx4 v[24:27], v2, s[12:15], s73 offen
 s_add_u32 s73, s74, 61440
 buffer_load_dwordx4 v[28:31], v2, s[12:15], s73 offen
 s_add_u32 s73, s74, 81920
 buffer_load_dwordx4 v[32:35], v2, s[12:15], s73 offen
 s_add_u32 s73, s74, 102400
 buffer_load_dwordx4 v[36:39], v2, s[12:15], s73 offen
 s_add_u32 s73, s74, 122880
 buffer_load_dwordx4 v[40:43], v2, s[12:15], s73 offen
 s_add_u32 s73, s74, 143360
 buffer_load_dwordx4 v[44:47], v2, s[12:15], s73 offen
 s_add_u32 s73, s74, 163840
 buffer_load_dwordx4 v[48:51], v2, s[12:15], s73 offen
 s_add_u32 s73, s74, 184320
 buffer_load_dwordx4 v[52:55], v2, s[12:15], s73 offen
 s_add_u32 s73, s74, 204800
 buffer_load_dwordx4 v[56:59], v2, s[12:15], s73 offen
 s_add_u32 s73, s74, 225280
 buffer_load_dwordx4 v[60:63], v2, s[12:15], s73 offen
 s_add_u32 s73, s74, 245760
 buffer_load_dwordx4 v[64:67], v2, s[12:15], s73 offen
 s_add_u32 s73, s74, 266240
 buffer_load_dwordx4 v[68:71], v2, s[12:15], s73 offen
 s_add_u32 s73, s74, 286720
 buffer_load_dwordx4 v[72:75], v2, s[12:15], s73 offen
 s_add_u32 s73, s74, 307200
 buffer_load_dwordx4 v[76:79], v2, s[12:15], s73 offen
 s_add_u32 s73, s74, 327680
 buffer_load_dwordx4 v[80:83], v2, s[12:15], s73 offen
 s_add_u32 s73, s74, 348160
 buffer_load_dwordx4 v[84:87], v2, s[12:15], s73 offen
 s_add_u32 s73, s74, 368640
 buffer_load_dwordx4 v[88:91], v2, s[12:15], s73 offen
 s_add_u32 s73, s74, 389120
 buffer_load_dwordx4 v[92:95], v2, s[12:15], s73 offen
 s_add_u32 s73, s74, 409600
 buffer_load_dwordx4 v[96:99], v2, s[12:15], s73 offen
 s_add_u32 s73, s74, 430080
 buffer_load_dwordx4 v[100:103], v2, s[12:15], s73 offen
 s_add_u32 s73, s74, 450560
 buffer_load_dwordx4 v[104:107], v2, s[12:15], s73 offen
 s_add_u32 s73, s74, 471040
 buffer_load_dwordx4 v[108:111], v2, s[12:15], s73 offen
 s_add_u32 s73, s74, 491520
 buffer_load_dwordx4 v[112:115], v2, s[12:15], s73 offen
 s_add_u32 s73, s74, 512000
 buffer_load_dwordx4 v[116:119], v2, s[12:15], s73 offen
 s_add_u32 s73, s74, 532480
 buffer_load_dwordx4 v[120:123], v2, s[12:15], s73 offen
 s_add_u32 s73, s74, 552960
 buffer_load_dwordx4 v[124:127], v2, s[12:15], s73 offen
 s_add_u32 s73, s74, 573440
 buffer_load_dwordx4 v[128:131], v2, s[12:15], s73 offen
 s_add_u32 s73, s74, 593920
 buffer_load_dwordx4 v[132:135], v2, s[12:15], s73 offen
 s_add_u32 s73, s74, 614400
 buffer_load_dwordx4 v[136:139], v2, s[12:15], s73 offen
 s_add_u32 s73, s74, 634880
 buffer_load_dwordx4 v[140:143], v2, s[12:15], s73 offen
 s_waitcnt vmcnt(31)
 ds_write_b128 v4, v[16:19] offset:0
 s_waitcnt vmcnt(30)
 ds_write_b128 v4, v[20:23] offset:1024
 s_waitcnt vmcnt(29)
 ds_write_b128 v4, v[24:27] offset:2048
 s_waitcnt vmcnt(28)
 ds_write_b128 v4, v[28:31] offset:3072
 s_waitcnt vmcnt(27)
 ds_write_b128 v4, v[32:35] offset:4096
 s_waitcnt vmcnt(26)
 ds_write_b128 v4, v[36:39] offset:5120
 s_waitcnt vmcnt(25)
 ds_write_b128 v4, v[40:43] offset:6144
 s_waitcnt vmcnt(24)
 ds_write_b128 v4, v[44:47] offset:7168
 s_waitcnt vmcnt(23)
 ds_write_b128 v4, v[48:51] offset:8192
 s_waitcnt vmcnt(22)
 ds_write_b128 v4, v[52:55] offset:9216
 s_waitcnt vmcnt(21)
 ds_write_b128 v4, v[56:59] offset:10240
 s_waitcnt vmcnt(20)
 ds_write_b128 v4, v[60:63] offset:11264
 s_waitcnt vmcnt(19)
 ds_write_b128 v4, v[64:67] offset:12288
 s_waitcnt vmcnt(18)
 ds_write_b128 v4, v[68:71] offset:13312
 s_waitcnt vmcnt(17)
 ds_write_b128 v4, v[72:75] offset:14336
 s_waitcnt vmcnt(16)
 ds_write_b128 v4, v[76:79] offset:15360
 s_waitcnt vmcnt(15)
 ds_write_b128 v4, v[80:83] offset:16384
 s_waitcnt vmcnt(14)
 ds_write_b128 v4, v[84:87] offset:17408
 s_waitcnt vmcnt(13)
 ds_write_b128 v4, v[88:91] offset:18432
 s_waitcnt vmcnt(12)
 ds_write_b128 v4, v[92:95] offset:19456
 s_waitcnt vmcnt(11)
 ds_write_b128 v4, v[96:99] offset:20480
 s_waitcnt vmcnt(10)
 ds_write_b128 v4, v[100:103] offset:21504
 s_waitcnt vmcnt(9)
 ds_write_b128 v4, v[104:107] offset:22528
 s_waitcnt vmcnt(8)
 ds_write_b128 v4, v[108:111] offset:23552
 s_waitcnt vmcnt(7)
 ds_write_b128 v4, v[112:115] offset:24576
 s_waitcnt vmcnt(6)
 ds_write_b128 v4, v[116:119] offset:25600
 s_waitcnt vmcnt(5)
 ds_write_b128 v4, v[120:123] offset:26624
 s_waitcnt vmcnt(4)
 ds_write_b128 v4, v[124:127] offset:27648
 s_waitcnt vmcnt(3)
 ds_write_b128 v4, v[128:131] offset:28672
 s_waitcnt vmcnt(2)
 ds_write_b128 v4, v[132:135] offset:29696
 s_waitcnt vmcnt(1)
 ds_write_b128 v4, v[136:139] offset:30720
 s_waitcnt vmcnt(0)
 ds_write_b128 v4, v[140:143] offset:31744
 ds_read_b64_tr_b16 a[0:1], v5 offset:0
 ds_read_b64_tr_b16 a[2:3], v5 offset:256
 ds_read_b64_tr_b16 a[4:5], v5 offset:8
 ds_read_b64_tr_b16 a[6:7], v5 offset:264
 ds_read_b64_tr_b16 a[8:9], v5 offset:2048
 ds_read_b64_tr_b16 a[10:11], v5 offset:2304
 ds_read_b64_tr_b16 a[12:13], v5 offset:2056
 ds_read_b64_tr_b16 a[14:15], v5 offset:2312
 ds_read_b64_tr_b16 a[16:17], v5 offset:4096
 ds_read_b64_tr_b16 a[18:19], v5 offset:4352
 ds_read_b64_tr_b16 a[20:21], v5 offset:4104
 ds_read_b64_tr_b16 a[22:23], v5 offset:4360
 s_waitcnt lgkmcnt(0)
 ds_read_b64_tr_b16 a[24:25], v5 offset:6144
 ds_read_b64_tr_b16 a[26:27], v5 offset:6400
 ds_read_b64_tr_b16 a[28:29], v5 offset:6152
 ds_read_b64_tr_b16 a[30:31], v5 offset:6408
 ds_read_b64_tr_b16 a[32:33], v5 offset:8192
 ds_read_b64_tr_b16 a[34:35], v5 offset:8448
 ds_read_b64_tr_b16 a[36:37], v5 offset:8200
 ds_read_b64_tr_b16 a[38:39], v5 offset:8456
 ds_read_b64_tr_b16 a[40:41], v5 offset:10240
 ds_read_b64_tr_b16 a[42:43], v5 offset:10496
 ds_read_b64_tr_b16 a[44:45], v5 offset:10248
 ds_read_b64_tr_b16 a[46:47], v5 offset:10504
 s_waitcnt lgkmcnt(0)
 ds_read_b64_tr_b16 a[48:49], v5 offset:12288
 ds_read_b64_tr_b16 a[50:51], v5 offset:12544
 ds_read_b64_tr_b16 a[52:53], v5 offset:12296
 ds_read_b64_tr_b16 a[54:55], v5 offset:12552
 ds_read_b64_tr_b16 a[56:57], v5 offset:14336
 ds_read_b64_tr_b16 a[58:59], v5 offset:14592
 ds_read_b64_tr_b16 a[60:61], v5 offset:14344
 ds_read_b64_tr_b16 a[62:63], v5 offset:14600
 ds_read_b64_tr_b16 a[64:65], v5 offset:16384
 ds_read_b64_tr_b16 a[66:67], v5 offset:16640
 ds_read_b64_tr_b16 a[68:69], v5 offset:16392
 ds_read_b64_tr_b16 a[70:71], v5 offset:16648
 s_waitcnt lgkmcnt(0)
 ds_read_b64_tr_b16 a[72:73], v5 offset:18432
 ds_read_b64_tr_b16 a[74:75], v5 offset:18688
 ds_read_b64_tr_b16 a[76:77], v5 offset:18440
 ds_read_b64_tr_b16 a[78:79], v5 offset:18696
 ds_read_b64_tr_b16 a[80:81], v5 offset:20480
 ds_read_b64_tr_b16 a[82:83], v5 offset:20736
 ds_read_b64_tr_b16 a[84:85], v5 offset:20488
 ds_read_b64_tr_b16 a[86:87], v5 offset:20744
 ds_read_b64_tr_b16 a[88:89], v5 offset:22528
 ds_read_b64_tr_b16 a[90:91], v5 offset:22784
 ds_read_b64_tr_b16 a[92:93], v5 offset:22536
 ds_read_b64_tr_b16 a[94:95], v5 offset:22792
 s_waitcnt lgkmcnt(0)
 ds_read_b64_tr_b16 a[96:97], v5 offset:24576
 ds_read_b64_tr_b16 a[98:99], v5 offset:24832
 ds_read_b64_tr_b16 a[100:101], v5 offset:24584
 ds_read_b64_tr_b16 a[102:103], v5 offset:24840
 ds_read_b64_tr_b16 a[104:105], v5 offset:26624
 ds_read_b64_tr_b16 a[106:107], v5 offset:26880
 ds_read_b64_tr_b16 a[108:109], v5 offset:26632
 ds_read_b64_tr_b16 a[110:111], v5 offset:26888
 ds_read_b64_tr_b16 a[112:113], v5 offset:28672
 ds_read_b64_tr_b16 a[114:115], v5 offset:28928
 ds_read_b64_tr_b16 a[116:117], v5 offset:28680
 ds_read_b64_tr_b16 a[118:119], v5 offset:28936
 s_waitcnt lgkmcnt(0)
 ds_read_b64_tr_b16 a[120:121], v5 offset:30720
 ds_read_b64_tr_b16 a[122:123], v5 offset:30976
 ds_read_b64_tr_b16 a[124:125], v5 offset:30728
 ds_read_b64_tr_b16 a[126:127], v5 offset:30984
 s_waitcnt lgkmcnt(0)
 s_add_u32 s73, s74, 655360
 buffer_load_dwordx4 v[16:19], v2, s[12:15], s73 offen
 s_add_u32 s73, s74, 675840
 buffer_load_dwordx4 v[20:23], v2, s[12:15], s73 offen
 s_add_u32 s73, s74, 696320
 buffer_load_dwordx4 v[24:27], v2, s[12:15], s73 offen
 s_add_u32 s73, s74, 716800
 buffer_load_dwordx4 v[28:31], v2, s[12:15], s73 offen
 s_add_u32 s73, s74, 737280
 buffer_load_dwordx4 v[32:35], v2, s[12:15], s73 offen
 s_add_u32 s73, s74, 757760
 buffer_load_dwordx4 v[36:39], v2, s[12:15], s73 offen
 s_add_u32 s73, s74, 778240
 buffer_load_dwordx4 v[40:43], v2, s[12:15], s73 offen
 s_add_u32 s73, s74, 798720
 buffer_load_dwordx4 v[44:47], v2, s[12:15], s73 offen
 s_add_u32 s73, s74, 819200
 buffer_load_dwordx4 v[48:51], v2, s[12:15], s73 offen
 s_add_u32 s73, s74, 839680
 buffer_load_dwordx4 v[52:55], v2, s[12:15], s73 offen
 s_add_u32 s73, s74, 860160
 buffer_load_dwordx4 v[56:59], v2, s[12:15], s73 offen
 s_add_u32 s73, s74, 880640
 buffer_load_dwordx4 v[60:63], v2, s[12:15], s73 offen
 s_add_u32 s73, s74, 901120
 buffer_load_dwordx4 v[64:67], v2, s[12:15], s73 offen
 s_add_u32 s73, s74, 921600
 buffer_load_dwordx4 v[68:71], v2, s[12:15], s73 offen
 s_add_u32 s73, s74, 942080
 buffer_load_dwordx4 v[72:75], v2, s[12:15], s73 offen
 s_add_u32 s73, s74, 962560
 buffer_load_dwordx4 v[76:79], v2, s[12:15], s73 offen
 s_add_u32 s73, s74, 983040
 buffer_load_dwordx4 v[80:83], v2, s[12:15], s73 offen
 s_add_u32 s73, s74, 1003520
 buffer_load_dwordx4 v[84:87], v2, s[12:15], s73 offen
 s_add_u32 s73, s74, 1024000
 buffer_load_dwordx4 v[88:91], v2, s[12:15], s73 offen
 s_add_u32 s73, s74, 1044480
 buffer_load_dwordx4 v[92:95], v2, s[12:15], s73 offen
 s_add_u32 s73, s74, 1064960
 buffer_load_dwordx4 v[96:99], v2, s[12:15], s73 offen
 s_add_u32 s73, s74, 1085440
 buffer_load_dwordx4 v[100:103], v2, s[12:15], s73 offen
 s_add_u32 s73, s74, 1105920
 buffer_load_dwordx4 v[104:107], v2, s[12:15], s73 offen
 s_add_u32 s73, s74, 1126400
 buffer_load_dwordx4 v[108:111], v2, s[12:15], s73 offen
 s_add_u32 s73, s74, 1146880
 buffer_load_dwordx4 v[112:115], v2, s[12:15], s73 offen
 s_add_u32 s73, s74, 1167360
 buffer_load_dwordx4 v[116:119], v2, s[12:15], s73 offen
 s_add_u32 s73, s74, 1187840
 buffer_load_dwordx4 v[120:123], v2, s[12:15], s73 offen
 s_add_u32 s73, s74, 1208320
 buffer_load_dwordx4 v[124:127], v2, s[12:15], s73 offen
 s_add_u32 s73, s74, 1228800
 buffer_load_dwordx4 v[128:131], v2, s[12:15], s73 offen
 s_add_u32 s73, s74, 1249280
 buffer_load_dwordx4 v[132:135], v2, s[12:15], s73 offen
 s_add_u32 s73, s74, 1269760
 buffer_load_dwordx4 v[136:139], v2, s[12:15], s73 offen
 s_add_u32 s73, s74, 1290240
 buffer_load_dwordx4 v[140:143], v2, s[12:15], s73 offen
 s_waitcnt vmcnt(31)
 ds_write_b128 v4, v[16:19] offset:0
 s_waitcnt vmcnt(30)
 ds_write_b128 v4, v[20:23] offset:1024
 s_waitcnt vmcnt(29)
 ds_write_b128 v4, v[24:27] offset:2048
 s_waitcnt vmcnt(28)
 ds_write_b128 v4, v[28:31] offset:3072
 s_waitcnt vmcnt(27)
 ds_write_b128 v4, v[32:35] offset:4096
 s_waitcnt vmcnt(26)
 ds_write_b128 v4, v[36:39] offset:5120
 s_waitcnt vmcnt(25)
 ds_write_b128 v4, v[40:43] offset:6144
 s_waitcnt vmcnt(24)
 ds_write_b128 v4, v[44:47] offset:7168
 s_waitcnt vmcnt(23)
 ds_write_b128 v4, v[48:51] offset:8192
 s_waitcnt vmcnt(22)
 ds_write_b128 v4, v[52:55] offset:9216
 s_waitcnt vmcnt(21)
 ds_write_b128 v4, v[56:59] offset:10240
 s_waitcnt vmcnt(20)
 ds_write_b128 v4, v[60:63] offset:11264
 s_waitcnt vmcnt(19)
 ds_write_b128 v4, v[64:67] offset:12288
 s_waitcnt vmcnt(18)
 ds_write_b128 v4, v[68:71] offset:13312
 s_waitcnt vmcnt(17)
 ds_write_b128 v4, v[72:75] offset:14336
 s_waitcnt vmcnt(16)
 ds_write_b128 v4, v[76:79] offset:15360
 s_waitcnt vmcnt(15)
 ds_write_b128 v4, v[80:83] offset:16384
 s_waitcnt vmcnt(14)
 ds_write_b128 v4, v[84:87] offset:17408
 s_waitcnt vmcnt(13)
 ds_write_b128 v4, v[88:91] offset:18432
 s_waitcnt vmcnt(12)
 ds_write_b128 v4, v[92:95] offset:19456
 s_waitcnt vmcnt(11)
 ds_write_b128 v4, v[96:99] offset:20480
 s_waitcnt vmcnt(10)
 ds_write_b128 v4, v[100:103] offset:21504
 s_waitcnt vmcnt(9)
 ds_write_b128 v4, v[104:107] offset:22528
 s_waitcnt vmcnt(8)
 ds_write_b128 v4, v[108:111] offset:23552
 s_waitcnt vmcnt(7)
 ds_write_b128 v4, v[112:115] offset:24576
 s_waitcnt vmcnt(6)
 ds_write_b128 v4, v[116:119] offset:25600
 s_waitcnt vmcnt(5)
 ds_write_b128 v4, v[120:123] offset:26624
 s_waitcnt vmcnt(4)
 ds_write_b128 v4, v[124:127] offset:27648
 s_waitcnt vmcnt(3)
 ds_write_b128 v4, v[128:131] offset:28672
 s_waitcnt vmcnt(2)
 ds_write_b128 v4, v[132:135] offset:29696
 s_waitcnt vmcnt(1)
 ds_write_b128 v4, v[136:139] offset:30720
 s_waitcnt vmcnt(0)
 ds_write_b128 v4, v[140:143] offset:31744
 ds_read_b64_tr_b16 a[128:129], v5 offset:0
 ds_read_b64_tr_b16 a[130:131], v5 offset:256
 ds_read_b64_tr_b16 a[132:133], v5 offset:8
 ds_read_b64_tr_b16 a[134:135], v5 offset:264
 ds_read_b64_tr_b16 a[136:137], v5 offset:2048
 ds_read_b64_tr_b16 a[138:139], v5 offset:2304
 ds_read_b64_tr_b16 a[140:141], v5 offset:2056
 ds_read_b64_tr_b16 a[142:143], v5 offset:2312
 ds_read_b64_tr_b16 a[144:145], v5 offset:4096
 ds_read_b64_tr_b16 a[146:147], v5 offset:4352
 ds_read_b64_tr_b16 a[148:149], v5 offset:4104
 ds_read_b64_tr_b16 a[150:151], v5 offset:4360
 s_waitcnt lgkmcnt(0)
 ds_read_b64_tr_b16 a[152:153], v5 offset:6144
 ds_read_b64_tr_b16 a[154:155], v5 offset:6400
 ds_read_b64_tr_b16 a[156:157], v5 offset:6152
 ds_read_b64_tr_b16 a[158:159], v5 offset:6408
 ds_read_b64_tr_b16 a[160:161], v5 offset:8192
 ds_read_b64_tr_b16 a[162:163], v5 offset:8448
 ds_read_b64_tr_b16 a[164:165], v5 offset:8200
 ds_read_b64_tr_b16 a[166:167], v5 offset:8456
 ds_read_b64_tr_b16 a[168:169], v5 offset:10240
 ds_read_b64_tr_b16 a[170:171], v5 offset:10496
 ds_read_b64_tr_b16 a[172:173], v5 offset:10248
 ds_read_b64_tr_b16 a[174:175], v5 offset:10504
 s_waitcnt lgkmcnt(0)
 ds_read_b64_tr_b16 a[176:177], v5 offset:12288
 ds_read_b64_tr_b16 a[178:179], v5 offset:12544
 ds_read_b64_tr_b16 a[180:181], v5 offset:12296
 ds_read_b64_tr_b16 a[182:183], v5 offset:12552
 ds_read_b64_tr_b16 a[184:185], v5 offset:14336
 ds_read_b64_tr_b16 a[186:187], v5 offset:14592
 ds_read_b64_tr_b16 a[188:189], v5 offset:14344
 ds_read_b64_tr_b16 a[190:191], v5 offset:14600
 ds_read_b64_tr_b16 a[192:193], v5 offset:16384
 ds_read_b64_tr_b16 a[194:195], v5 offset:16640
 ds_read_b64_tr_b16 a[196:197], v5 offset:16392
 ds_read_b64_tr_b16 a[198:199], v5 offset:16648
 s_waitcnt lgkmcnt(0)
 ds_read_b64_tr_b16 a[200:201], v5 offset:18432
 ds_read_b64_tr_b16 a[202:203], v5 offset:18688
 ds_read_b64_tr_b16 a[204:205], v5 offset:18440
 ds_read_b64_tr_b16 a[206:207], v5 offset:18696
 ds_read_b64_tr_b16 a[208:209], v5 offset:20480
 ds_read_b64_tr_b16 a[210:211], v5 offset:20736
 ds_read_b64_tr_b16 a[212:213], v5 offset:20488
 ds_read_b64_tr_b16 a[214:215], v5 offset:20744
 ds_read_b64_tr_b16 a[216:217], v5 offset:22528
 ds_read_b64_tr_b16 a[218:219], v5 offset:22784
 ds_read_b64_tr_b16 a[220:221], v5 offset:22536
 ds_read_b64_tr_b16 a[222:223], v5 offset:22792
 s_waitcnt lgkmcnt(0)
 ds_read_b64_tr_b16 a[224:225], v5 offset:24576
 ds_read_b64_tr_b16 a[226:227], v5 offset:24832
 ds_read_b64_tr_b16 a[228:229], v5 offset:24584
 ds_read_b64_tr_b16 a[230:231], v5 offset:24840
 ds_read_b64_tr_b16 a[232:233], v5 offset:26624
 ds_read_b64_tr_b16 a[234:235], v5 offset:26880
 ds_read_b64_tr_b16 a[236:237], v5 offset:26632
 ds_read_b64_tr_b16 a[238:239], v5 offset:26888
 ds_read_b64_tr_b16 a[240:241], v5 offset:28672
 ds_read_b64_tr_b16 a[242:243], v5 offset:28928
 ds_read_b64_tr_b16 a[244:245], v5 offset:28680
 ds_read_b64_tr_b16 a[246:247], v5 offset:28936
 s_waitcnt lgkmcnt(0)
 ds_read_b64_tr_b16 a[248:249], v5 offset:30720
 ds_read_b64_tr_b16 a[250:251], v5 offset:30976
 ds_read_b64_tr_b16 a[252:253], v5 offset:30728
 ds_read_b64_tr_b16 a[254:255], v5 offset:30984
 s_waitcnt lgkmcnt(0)
 s_barrier
 s_min_u32 s85, s66, 0
 s_lshl_b32 s73, s85, 11
 v_add_u32 v11, s73, v1
 s_mul_i32 s73, s81, 1
 s_add_u32 s85, s85, s73
 v_lshrrev_b32 v3, 4, v0
 v_lshlrev_b32 v2, 5, v3
 s_lshl_b32 s73, s85, 7
 s_add_u32 s73, s73, 0x21400
poll_68:
 buffer_load_dwordx4 v[192:195], v2, s[8:11], s73 offen offset:0 sc1
 buffer_load_dwordx4 v[196:199], v2, s[8:11], s73 offen offset:16 sc1
 s_waitcnt vmcnt(0)
 v_max_u32 v4, v192, v193
 v_max3_u32 v4, v4, v194, v195
 v_max3_u32 v4, v4, v196, v197
 v_max3_u32 v4, v4, v198, v199
 v_cmp_eq_u32 vcc, -1, v4
 s_cbranch_vccz written_69
 s_sleep 6
 s_add_u32 s72, s72, 1
 s_cmp_lt_u32 s72, 0x40000
 s_cbranch_scc1 poll_68
 s_branch bail2
written_69:
 v_and_b32 v8, 15, v0
 v_mul_u32_u24 v8, 1280, v8
 v_lshl_add_u32 v8, v3, 4, v8
 s_lshl_b32 s73, s85, 6
 v_add_u32 v8, s73, v8
 v_and_b32 v9, 7, v0
 v_lshlrev_b32 v9, 7, v9
 s_lshl_b32 s73, s66, 10
 v_add_u32 v9, s73, v9
 s_mul_i32 s4, s80, 20
 s_add_u32 s4, s4, s81
 s_lshl_b32 s4, s4, 7
 s_add_u32 s4, s4, 73728
 s_mov_b32 s3, 0
 s_cmp_eq_u32 s66, 0
 s_cselect_b32 s4, s4, 0x40000000
 v_mov_b32 v12, 0
 s_lshl_b32 s73, s66, 11
 v_add_u32 v10, s73, v1
 s_waitcnt vmcnt(0)
t2_loop:
 s_add_u32 s5, s82, 1
 v_cmp_gt_u32 vcc, s5, v12
 s_and_b32 vcc_lo, vcc_lo, 0xff
 s_cbranch_scc1 slow_71
go_70:
 s_mul_i32 s78, s82, 20480
 s_cmp_ge_u32 s66, 1
 s_cbranch_scc1 noext_72
 s_lshl_b32 s83, s85, 10
 s_add_u32 s83, s83, s78
 s_add_u32 s83, s83, 0xcc0000
 buffer_load_dwordx4 v[184:187], v8, s[16:19], s78 offen
noext_72:
 s_mul_i32 s79, s82, 128
 s_add_u32 s79, s79, s77
 s_lshl_b32 s79, s79, 10
 s_add_u32 s79, s79, 0x5200000
 s_add_u32 s73, s79, 0
 buffer_load_dwordx4 v[16:19], v1, s[8:11], s73 offen offset:0 sc1
 buffer_load_dwordx4 v[20:23], v1, s[8:11], s73 offen offset:1024 sc1
 buffer_load_dwordx4 v[24:27], v1, s[8:11], s73 offen offset:2048 sc1
 buffer_load_dwordx4 v[28:31], v1, s[8:11], s73 offen offset:3072 sc1
 s_add_u32 s73, s79, 4096
 buffer_load_dwordx4 v[32:35], v1, s[8:11], s73 offen offset:0 sc1
 buffer_load_dwordx4 v[36:39], v1, s[8:11], s73 offen offset:1024 sc1
 buffer_load_dwordx4 v[40:43], v1, s[8:11], s73 offen offset:2048 sc1
 buffer_load_dwordx4 v[44:47], v1, s[8:11], s73 offen offset:3072 sc1
 s_add_u32 s73, s79, 8192
 buffer_load_dwordx4 v[48:51], v1, s[8:11], s73 offen offset:0 sc1
 buffer_load_dwordx4 v[52:55], v1, s[8:11], s73 offen offset:1024 sc1
 buffer_load_dwordx4 v[56:59], v1, s[8:11], s73 offen offset:2048 sc1
 buffer_load_dwordx4 v[60:63], v1, s[8:11], s73 offen offset:3072 sc1
 s_add_u32 s73, s79, 12288
 buffer_load_dwordx4 v[64:67], v1, s[8:11], s73 offen offset:0 sc1
 buffer_load_dwordx4 v[68:71], v1, s[8:11], s73 offen offset:1024 sc1
 buffer_load_dwordx4 v[72:75], v1, s[8:11], s73 offen offset:2048 sc1
 buffer_load_dwordx4 v[76:79], v1, s[8:11], s73 offen offset:3072 sc1
 s_add_u32 s73, s79, 16384
 buffer_load_dwordx4 v[80:83], v1, s[8:11], s73 offen offset:0 sc1
 buffer_load_dwordx4 v[84:87], v1, s[8:11], s73 offen offset:1024 sc1
 buffer_load_dwordx4 v[88:91], v1, s[8:11], s73 offen offset:2048 sc1
 buffer_load_dwordx4 v[92:95], v1, s[8:11], s73 offen offset:3072 sc1
 s_add_u32 s73, s79, 20480
 buffer_load_dwordx4 v[96:99], v1, s[8:11], s73 offen offset:0 sc1
 buffer_load_dwordx4 v[100:103], v1, s[8:11], s73 offen offset:1024 sc1
 buffer_load_dwordx4 v[104:107], v1, s[8:11], s73 offen offset:2048 sc1
 buffer_load_dwordx4 v[108:111], v1, s[8:11], s73 offen offset:3072 sc1
 s_add_u32 s73, s79, 24576
 buffer_load_dwordx4 v[112:115], v1, s[8:11], s73 offen offset:0 sc1
 buffer_load_dwordx4 v[116:119], v1, s[8:11], s73 offen offset:1024 sc1
 buffer_load_dwordx4 v[120:123], v1, s[8:11], s73 offen offset:2048 sc1
 buffer_load_dwordx4 v[124:127], v1, s[8:11], s73 offen offset:3072 sc1
 s_add_u32 s73, s79, 28672
 buffer_load_dwordx4 v[128:131], v1, s[8:11], s73 offen offset:0 sc1
 buffer_load_dwordx4 v[132:135], v1, s[8:11], s73 offen offset:1024 sc1
 buffer_load_dwordx4 v[136:139], v1, s[8:11], s73 offen offset:2048 sc1
 buffer_load_dwordx4 v[140:143], v1, s[8:11], s73 offen offset:3072 sc1
 s_add_u32 s74, s82, s100
 s_and_b32 s73, s74, 3
 s_mul_i32 s73, s73, 4096
 s_add_u32 s73, s73, 57344
 buffer_load_dword v12, v9, s[8:11], s73 offen sc1
 s_waitcnt vmcnt(33)
 v_mov_b32 v4, s3
 v_mov_b32 v5, 0
 s_mov_b64 exec, 1
 buffer_store_dword v4, v5, s[8:11], s4 offen sc1
 s_mov_b64 exec, -1
 s_waitcnt vmcnt(33)
 v_mfma_f32_16x16x32_bf16 v[144:147], a[0:3], v[16:19], 0
 v_mfma_f32_16x16x32_bf16 v[148:151], a[4:7], v[16:19], 0
 s_waitcnt vmcnt(32)
 v_mfma_f32_16x16x32_bf16 v[144:147], a[8:11], v[20:23], v[144:147]
 v_mfma_f32_16x16x32_bf16 v[148:151], a[12:15], v[20:23], v[148:151]
 s_waitcnt vmcnt(31)
 v_mfma_f32_16x16x32_bf16 v[144:147], a[16:19], v[24:27], v[144:147]
 v_mfma_f32_16x16x32_bf16 v[148:151], a[20:23], v[24:27], v[148:151]
 s_waitcnt vmcnt(30)
 v_mfma_f32_16x16x32_bf16 v[144:147], a[24:27], v[28:31], v[144:147]
 v_mfma_f32_16x16x32_bf16 v[148:151], a[28:31], v[28:31], v[148:151]
 s_waitcnt vmcnt(29)
 v_mfma_f32_16x16x32_bf16 v[144:147], a[32:35], v[32:35], v[144:147]
 v_mfma_f32_16x16x32_bf16 v[148:151], a[36:39], v[32:35], v[148:151]
 s_waitcnt vmcnt(28)
 v_mfma_f32_16x16x32_bf16 v[144:147], a[40:43], v[36:39], v[144:147]
 v_mfma_f32_16x16x32_bf16 v[148:151], a[44:47], v[36:39], v[148:151]
 s_waitcnt vmcnt(27)
 v_mfma_f32_16x16x32_bf16 v[144:147], a[48:51], v[40:43], v[144:147]
 v_mfma_f32_16x16x32_bf16 v[148:151], a[52:55], v[40:43], v[148:151]
 s_waitcnt vmcnt(26)
 v_mfma_f32_16x16x32_bf16 v[144:147], a[56:59], v[44:47], v[144:147]
 v_mfma_f32_16x16x32_bf16 v[148:151], a[60:63], v[44:47], v[148:151]
 s_waitcnt vmcnt(25)
 v_mfma_f32_16x16x32_bf16 v[144:147], a[64:67], v[48:51], v[144:147]
 v_mfma_f32_16x16x32_bf16 v[148:151], a[68:71], v[48:51], v[148:151]
 s_waitcnt vmcnt(24)
 v_mfma_f32_16x16x32_bf16 v[144:147], a[72:75], v[52:55], v[144:147]
 v_mfma_f32_16x16x32_bf16 v[148:151], a[76:79], v[52:55], v[148:151]
 s_waitcnt vmcnt(23)
 v_mfma_f32_16x16x32_bf16 v[144:147], a[80:83], v[56:59], v[144:147]
 v_mfma_f32_16x16x32_bf16 v[148:151], a[84:87], v[56:59], v[148:151]
 s_waitcnt vmcnt(22)
 v_mfma_f32_16x16x32_bf16 v[144:147], a[88:91], v[60:63], v[144:147]
 v_mfma_f32_16x16x32_bf16 v[148:151], a[92:95], v[60:63], v[148:151]
 s_waitcnt vmcnt(21)
 v_mfma_f32_16x16x32_bf16 v[144:147], a[96:99], v[64:67], v[144:147]
 v_mfma_f32_16x16x32_bf16 v[148:151], a[100:103], v[64:67], v[148:151]
 s_waitcnt vmcnt(20)
 v_mfma_f32_16x16x32_bf16 v[144:147], a[104:107], v[68:71], v[144:147]
 v_mfma_f32_16x16x32_bf16 v[148:151], a[108:111], v[68:71], v[148:151]
 s_waitcnt vmcnt(19)
 v_mfma_f32_16x16x32_bf16 v[144:147], a[112:115], v[72:75], v[144:147]
 v_mfma_f32_16x16x32_bf16 v[148:151], a[116:119], v[72:75], v[148:151]
 s_waitcnt vmcnt(18)
 v_mfma_f32_16x16x32_bf16 v[144:147], a[120:123], v[76:79], v[144:147]
 v_mfma_f32_16x16x32_bf16 v[148:151], a[124:127], v[76:79], v[148:151]
 s_waitcnt vmcnt(17)
 v_mfma_f32_16x16x32_bf16 v[144:147], a[128:131], v[80:83], v[144:147]
 v_mfma_f32_16x16x32_bf16 v[148:151], a[132:135], v[80:83], v[148:151]
 s_waitcnt vmcnt(16)
 v_mfma_f32_16x16x32_bf16 v[144:147], a[136:139], v[84:87], v[144:147]
 v_mfma_f32_16x16x32_bf16 v[148:151], a[140:143], v[84:87], v[148:151]
 s_waitcnt vmcnt(15)
 v_mfma_f32_16x16x32_bf16 v[144:147], a[144:147], v[88:91], v[144:147]
 v_mfma_f32_16x16x32_bf16 v[148:151], a[148:151], v[88:91], v[148:151]
 s_waitcnt vmcnt(14)
 v_mfma_f32_16x16x32_bf16 v[144:147], a[152:155], v[92:95], v[144:147]
 v_mfma_f32_16x16x32_bf16 v[148:151], a[156:159], v[92:95], v[148:151]
 s_waitcnt vmcnt(13)
 v_mfma_f32_16x16x32_bf16 v[144:147], a[160:163], v[96:99], v[144:147]
 v_mfma_f32_16x16x32_bf16 v[148:151], a[164:167], v[96:99], v[148:151]
 s_waitcnt vmcnt(12)
 v_mfma_f32_16x16x32_bf16 v[144:147], a[168:171], v[100:103], v[144:147]
 v_mfma_f32_16x16x32_bf16 v[148:151], a[172:175], v[100:103], v[148:151]
 s_waitcnt vmcnt(11)
 v_mfma_f32_16x16x32_bf16 v[144:147], a[176:179], v[104:107], v[144:147]
 v_mfma_f32_16x16x32_bf16 v[148:151], a[180:183], v[104:107], v[148:151]
 s_waitcnt vmcnt(10)
 v_mfma_f32_16x16x32_bf16 v[144:147], a[184:187], v[108:111], v[144:147]
 v_mfma_f32_16x16x32_bf16 v[148:151], a[188:191], v[108:111], v[148:151]
 s_waitcnt vmcnt(9)
 v_mfma_f32_16x16x32_bf16 v[144:147], a[192:195], v[112:115], v[144:147]
 v_mfma_f32_16x16x32_bf16 v[148:151], a[196:199], v[112:115], v[148:151]
 s_waitcnt vmcnt(8)
 v_mfma_f32_16x16x32_bf16 v[144:147], a[200:203], v[116:119], v[144:147]
 v_mfma_f32_16x16x32_bf16 v[148:151], a[204:207], v[116:119], v[148:151]
 s_waitcnt vmcnt(7)
 v_mfma_f32_16x16x32_bf16 v[144:147], a[208:211], v[120:123], v[144:147]
 v_mfma_f32_16x16x32_bf16 v[148:151], a[212:215], v[120:123], v[148:151]
 s_waitcnt vmcnt(6)
 v_mfma_f32_16x16x32_bf16 v[144:147], a[216:219], v[124:127], v[144:147]
 v_mfma_f32_16x16x32_bf16 v[148:151], a[220:223], v[124:127], v[148:151]
 s_waitcnt vmcnt(5)
 v_mfma_f32_16x16x32_bf16 v[144:147], a[224:227], v[128:131], v[144:147]
 v_mfma_f32_16x16x32_bf16 v[148:151], a[228:231], v[128:131], v[148:151]
 s_waitcnt vmcnt(4)
 v_mfma_f32_16x16x32_bf16 v[144:147], a[232:235], v[132:135], v[144:147]
 v_mfma_f32_16x16x32_bf16 v[148:151], a[236:239], v[132:135], v[148:151]
 s_waitcnt vmcnt(3)
 v_mfma_f32_16x16x32_bf16 v[144:147], a[240:243], v[136:139], v[144:147]
 v_mfma_f32_16x16x32_bf16 v[148:151], a[244:247], v[136:139], v[148:151]
 s_waitcnt vmcnt(2)
 v_mfma_f32_16x16x32_bf16 v[144:147], a[248:251], v[140:143], v[144:147]
 v_mfma_f32_16x16x32_bf16 v[148:151], a[252:255], v[140:143], v[148:151]
 s_waitcnt vmcnt(1)
 s_nop 2
 ds_write_b128 v10, v[144:147] offset:0
 s_nop 2
 ds_write_b128 v10, v[148:151] offset:1024
 s_waitcnt lgkmcnt(0)
 s_barrier
 s_cmp_lt_u32 s66, 1
 s_cbranch_scc1 fin_73
 s_barrier
 s_branch join_74
fin_73:
 ds_read_b128 v[144:147], v11 offset:0
 ds_read_b128 v[148:151], v11 offset:1024
 ds_read_b128 v[160:163], v11 offset:2048
 ds_read_b128 v[164:167], v11 offset:3072
 ds_read_b128 v[168:171], v11 offset:4096
 ds_read_b128 v[172:175], v11 offset:5120
 ds_read_b128 v[176:179], v11 offset:6144
 ds_read_b128 v[180:183], v11 offset:7168
 v_and_b32 v207, 0xffff0000, v187
 v_lshlrev_b32 v206, 16, v187
 v_and_b32 v205, 0xffff0000, v186
 v_lshlrev_b32 v204, 16, v186
 v_and_b32 v203, 0xffff0000, v185
 v_lshlrev_b32 v202, 16, v185
 v_and_b32 v201, 0xffff0000, v184
 v_lshlrev_b32 v200, 16, v184
 s_waitcnt lgkmcnt(0)
 s_barrier
 v_pk_add_f32 v[144:145], v[144:145], v[160:161]
 v_pk_add_f32 v[146:147], v[146:147], v[162:163]
 v_pk_add_f32 v[148:149], v[148:149], v[164:165]
 v_pk_add_f32 v[150:151], v[150:151], v[166:167]
 v_pk_add_f32 v[144:145], v[144:145], v[168:169]
 v_pk_add_f32 v[146:147], v[146:147], v[170:171]
 v_pk_add_f32 v[148:149], v[148:149], v[172:173]
 v_pk_add_f32 v[150:151], v[150:151], v[174:175]
 v_pk_add_f32 v[144:145], v[144:145], v[176:177]
 v_pk_add_f32 v[146:147], v[146:147], v[178:179]
 v_pk_add_f32 v[148:149], v[148:149], v[180:181]
 v_pk_add_f32 v[150:151], v[150:151], v[182:183]
 v_cvt_pk_bf16_f32 v144, 0, v144
 v_cvt_pk_bf16_f32 v145, 0, v145
 v_cvt_pk_bf16_f32 v146, 0, v146
 v_cvt_pk_bf16_f32 v147, 0, v147
 v_cvt_pk_bf16_f32 v148, 0, v148
 v_cvt_pk_bf16_f32 v149, 0, v149
 v_cvt_pk_bf16_f32 v150, 0, v150
 v_cvt_pk_bf16_f32 v151, 0, v151
 v_pk_mul_f32 v[144:145], v[144:145], v[192:193]
 v_pk_mul_f32 v[146:147], v[146:147], v[194:195]
 v_pk_mul_f32 v[148:149], v[148:149], v[196:197]
 v_pk_mul_f32 v[150:151], v[150:151], v[198:199]
 v_cvt_pk_bf16_f32 v144, 0, v144
 v_cvt_pk_bf16_f32 v145, 0, v145
 v_cvt_pk_bf16_f32 v146, 0, v146
 v_cvt_pk_bf16_f32 v147, 0, v147
 v_cvt_pk_bf16_f32 v148, 0, v148
 v_cvt_pk_bf16_f32 v149, 0, v149
 v_cvt_pk_bf16_f32 v150, 0, v150
 v_cvt_pk_bf16_f32 v151, 0, v151
 v_pk_add_f32 v[144:145], v[144:145], v[200:201]
 v_pk_add_f32 v[146:147], v[146:147], v[202:203]
 v_pk_add_f32 v[148:149], v[148:149], v[204:205]
 v_pk_add_f32 v[150:151], v[150:151], v[206:207]
 v_cvt_pk_bf16_f32 v160, v144, v145
 v_cvt_pk_bf16_f32 v161, v146, v147
 v_cvt_pk_bf16_f32 v162, v148, v149
 v_cvt_pk_bf16_f32 v163, v150, v151
 buffer_store_dwordx4 v[160:163], v1, s[8:11], s83 offen sc1
 s_mov_b32 s3, s5
join_74:
 s_add_u32 s82, s82, s100
 s_cmp_lt_u32 s82, 128
 s_cbranch_scc1 t2_loop
 s_waitcnt vmcnt(0)
 s_cmp_lg_u32 s66, 0
 s_cbranch_scc1 notw0_75
 v_mov_b32 v4, s3
 v_mov_b32 v5, 0
 s_mov_b64 exec, 1
 buffer_store_dword v4, v5, s[8:11], s4 offen sc1
 s_mov_b64 exec, -1
notw0_75:
 s_waitcnt vmcnt(0)
 s_endpgm
slow_71:
 s_and_b32 s73, s82, 3
 s_mul_i32 s73, s73, 4096
 s_add_u32 s73, s73, 57344
 buffer_load_dword v2, v9, s[8:11], s73 offen sc1
 s_waitcnt vmcnt(0)
 s_cmp_lg_u32 s66, 0
 s_cbranch_scc1 notw0_79
 v_mov_b32 v4, s3
 v_mov_b32 v5, 0
 s_mov_b64 exec, 1
 buffer_store_dword v4, v5, s[8:11], s4 offen sc1
 s_mov_b64 exec, -1
notw0_79:
 s_branch test_78
wait_76:
 buffer_load_dword v2, v9, s[8:11], s73 offen sc1
 s_waitcnt vmcnt(0)
test_78:
 v_cmp_gt_u32 vcc, s5, v2
 s_and_b32 vcc_lo, vcc_lo, 0xff
 s_and_b32 vcc_hi, vcc_hi, 0x0
 s_cmp_eq_u64 vcc, 0
 s_cbranch_scc1 ready_77
 s_sleep 1
 s_add_u32 s72, s72, 1
 s_cmp_lt_u32 s72, 0x40000
 s_cbranch_scc1 wait_76
 s_branch bail2
ready_77:
 s_branch go_70
t6:
 s_mov_b32 s12, s54
 s_and_b32 s13, s55, 0xffff
 s_mov_b32 s14, 0x21c000
 s_mov_b32 s15, 0x20000
 s_mov_b32 s16, s60
 s_and_b32 s17, s61, 0xffff
 s_mov_b32 s18, 0x280000
 s_mov_b32 s19, 0x20000
 s_mov_b32 s82, s80
 s_mul_i32 s77, s66, 14
 v_lshrrev_b32 v2, 3, v0
 v_mul_u32_u24 v2, 1280, v2
 v_and_b32 v3, 7, v0
 v_lshl_add_u32 v2, v3, 4, v2
 s_lshl_b32 s73, s66, 15
 v_add_u32 v4, s73, v1
 v_lshrrev_b32 v5, 4, v0
 v_bfe_u32 v6, v0, 2, 2
 v_lshl_add_u32 v5, v5, 3, v6
 v_lshlrev_b32 v5, 7, v5
 v_and_b32 v3, 3, v0
 v_lshl_add_u32 v5, v3, 4, v5
 v_add_u32 v5, s73, v5
 s_mul_i32 s74, s77, 40960
 s_lshl_b32 s73, s81, 7
 s_add_u32 s74, s74, s73
 s_add_u32 s73, s74, 0
 buffer_load_dwordx4 v[16:19], v2, s[12:15], s73 offen
 s_add_u32 s73, s74, 10240
 buffer_load_dwordx4 v[20:23], v2, s[12:15], s73 offen
 s_add_u32 s73, s74, 20480
 buffer_load_dwordx4 v[24:27], v2, s[12:15], s73 offen
 s_add_u32 s73, s74, 30720
 buffer_load_dwordx4 v[28:31], v2, s[12:15], s73 offen
 s_add_u32 s73, s74, 40960
 buffer_load_dwordx4 v[32:35], v2, s[12:15], s73 offen
 s_add_u32 s73, s74, 51200
 buffer_load_dwordx4 v[36:39], v2, s[12:15], s73 offen
 s_add_u32 s73, s74, 61440
 buffer_load_dwordx4 v[40:43], v2, s[12:15], s73 offen
 s_add_u32 s73, s74, 71680
 buffer_load_dwordx4 v[44:47], v2, s[12:15], s73 offen
 s_add_u32 s73, s74, 81920
 buffer_load_dwordx4 v[48:51], v2, s[12:15], s73 offen
 s_add_u32 s73, s74, 92160
 buffer_load_dwordx4 v[52:55], v2, s[12:15], s73 offen
 s_add_u32 s73, s74, 102400
 buffer_load_dwordx4 v[56:59], v2, s[12:15], s73 offen
 s_add_u32 s73, s74, 112640
 buffer_load_dwordx4 v[60:63], v2, s[12:15], s73 offen
 s_add_u32 s73, s74, 122880
 buffer_load_dwordx4 v[64:67], v2, s[12:15], s73 offen
 s_add_u32 s73, s74, 133120
 buffer_load_dwordx4 v[68:71], v2, s[12:15], s73 offen
 s_add_u32 s73, s74, 143360
 buffer_load_dwordx4 v[72:75], v2, s[12:15], s73 offen
 s_add_u32 s73, s74, 153600
 buffer_load_dwordx4 v[76:79], v2, s[12:15], s73 offen
 s_add_u32 s73, s74, 163840
 buffer_load_dwordx4 v[80:83], v2, s[12:15], s73 offen
 s_add_u32 s73, s74, 174080
 buffer_load_dwordx4 v[84:87], v2, s[12:15], s73 offen
 s_add_u32 s73, s74, 184320
 buffer_load_dwordx4 v[88:91], v2, s[12:15], s73 offen
 s_add_u32 s73, s74, 194560
 buffer_load_dwordx4 v[92:95], v2, s[12:15], s73 offen
 s_add_u32 s73, s74, 204800
 buffer_load_dwordx4 v[96:99], v2, s[12:15], s73 offen
 s_add_u32 s73, s74, 215040
 buffer_load_dwordx4 v[100:103], v2, s[12:15], s73 offen
 s_add_u32 s73, s74, 225280
 buffer_load_dwordx4 v[104:107], v2, s[12:15], s73 offen
 s_add_u32 s73, s74, 235520
 buffer_load_dwordx4 v[108:111], v2, s[12:15], s73 offen
 s_add_u32 s73, s74, 245760
 buffer_load_dwordx4 v[112:115], v2, s[12:15], s73 offen
 s_add_u32 s73, s74, 256000
 buffer_load_dwordx4 v[116:119], v2, s[12:15], s73 offen
 s_add_u32 s73, s74, 266240
 buffer_load_dwordx4 v[120:123], v2, s[12:15], s73 offen
 s_add_u32 s73, s74, 276480
 buffer_load_dwordx4 v[124:127], v2, s[12:15], s73 offen
 s_add_u32 s73, s74, 286720
 buffer_load_dwordx4 v[128:131], v2, s[12:15], s73 offen
 s_add_u32 s73, s74, 296960
 buffer_load_dwordx4 v[132:135], v2, s[12:15], s73 offen
 s_add_u32 s73, s74, 307200
 buffer_load_dwordx4 v[136:139], v2, s[12:15], s73 offen
 s_add_u32 s73, s74, 317440
 buffer_load_dwordx4 v[140:143], v2, s[12:15], s73 offen
 s_waitcnt vmcnt(31)
 ds_write_b128 v4, v[16:19] offset:0
 s_waitcnt vmcnt(30)
 ds_write_b128 v4, v[20:23] offset:1024
 s_waitcnt vmcnt(29)
 ds_write_b128 v4, v[24:27] offset:2048
 s_waitcnt vmcnt(28)
 ds_write_b128 v4, v[28:31] offset:3072
 s_waitcnt vmcnt(27)
 ds_write_b128 v4, v[32:35] offset:4096
 s_waitcnt vmcnt(26)
 ds_write_b128 v4, v[36:39] offset:5120
 s_waitcnt vmcnt(25)
 ds_write_b128 v4, v[40:43] offset:6144
 s_waitcnt vmcnt(24)
 ds_write_b128 v4, v[44:47] offset:7168
 s_waitcnt vmcnt(23)
 ds_write_b128 v4, v[48:51] offset:8192
 s_waitcnt vmcnt(22)
 ds_write_b128 v4, v[52:55] offset:9216
 s_waitcnt vmcnt(21)
 ds_write_b128 v4, v[56:59] offset:10240
 s_waitcnt vmcnt(20)
 ds_write_b128 v4, v[60:63] offset:11264
 s_waitcnt vmcnt(19)
 ds_write_b128 v4, v[64:67] offset:12288
 s_waitcnt vmcnt(18)
 ds_write_b128 v4, v[68:71] offset:13312
 s_waitcnt vmcnt(17)
 ds_write_b128 v4, v[72:75] offset:14336
 s_waitcnt vmcnt(16)
 ds_write_b128 v4, v[76:79] offset:15360
 s_waitcnt vmcnt(15)
 ds_write_b128 v4, v[80:83] offset:16384
 s_waitcnt vmcnt(14)
 ds_write_b128 v4, v[84:87] offset:17408
 s_waitcnt vmcnt(13)
 ds_write_b128 v4, v[88:91] offset:18432
 s_waitcnt vmcnt(12)
 ds_write_b128 v4, v[92:95] offset:19456
 s_waitcnt vmcnt(11)
 ds_write_b128 v4, v[96:99] offset:20480
 s_waitcnt vmcnt(10)
 ds_write_b128 v4, v[100:103] offset:21504
 s_waitcnt vmcnt(9)
 ds_write_b128 v4, v[104:107] offset:22528
 s_waitcnt vmcnt(8)
 ds_write_b128 v4, v[108:111] offset:23552
 s_waitcnt vmcnt(7)
 ds_write_b128 v4, v[112:115] offset:24576
 s_waitcnt vmcnt(6)
 ds_write_b128 v4, v[116:119] offset:25600
 s_waitcnt vmcnt(5)
 ds_write_b128 v4, v[120:123] offset:26624
 s_waitcnt vmcnt(4)
 ds_write_b128 v4, v[124:127] offset:27648
 s_waitcnt vmcnt(3)
 ds_write_b128 v4, v[128:131] offset:28672
 s_waitcnt vmcnt(2)
 ds_write_b128 v4, v[132:135] offset:29696
 s_waitcnt vmcnt(1)
 ds_write_b128 v4, v[136:139] offset:30720
 s_waitcnt vmcnt(0)
 ds_write_b128 v4, v[140:143] offset:31744
 ds_read_b64_tr_b16 a[32:33], v5 offset:0
 ds_read_b64_tr_b16 a[34:35], v5 offset:512
 ds_read_b64_tr_b16 a[36:37], v5 offset:8
 ds_read_b64_tr_b16 a[38:39], v5 offset:520
 ds_read_b64_tr_b16 a[40:41], v5 offset:64
 ds_read_b64_tr_b16 a[42:43], v5 offset:576
 ds_read_b64_tr_b16 a[44:45], v5 offset:72
 ds_read_b64_tr_b16 a[46:47], v5 offset:584
 s_waitcnt lgkmcnt(0)
 ds_read_b64_tr_b16 a[48:49], v5 offset:4096
 ds_read_b64_tr_b16 a[50:51], v5 offset:4608
 ds_read_b64_tr_b16 a[52:53], v5 offset:4104
 ds_read_b64_tr_b16 a[54:55], v5 offset:4616
 ds_read_b64_tr_b16 a[56:57], v5 offset:4160
 ds_read_b64_tr_b16 a[58:59], v5 offset:4672
 ds_read_b64_tr_b16 a[60:61], v5 offset:4168
 ds_read_b64_tr_b16 a[62:63], v5 offset:4680
 s_waitcnt lgkmcnt(0)
 ds_read_b64_tr_b16 a[64:65], v5 offset:8192
 ds_read_b64_tr_b16 a[66:67], v5 offset:8704
 ds_read_b64_tr_b16 a[68:69], v5 offset:8200
 ds_read_b64_tr_b16 a[70:71], v5 offset:8712
 ds_read_b64_tr_b16 a[72:73], v5 offset:8256
 ds_read_b64_tr_b16 a[74:75], v5 offset:8768
 ds_read_b64_tr_b16 a[76:77], v5 offset:8264
 ds_read_b64_tr_b16 a[78:79], v5 offset:8776
 s_waitcnt lgkmcnt(0)
 ds_read_b64_tr_b16 a[80:81], v5 offset:12288
 ds_read_b64_tr_b16 a[82:83], v5 offset:12800
 ds_read_b64_tr_b16 a[84:85], v5 offset:12296
 ds_read_b64_tr_b16 a[86:87], v5 offset:12808
 ds_read_b64_tr_b16 a[88:89], v5 offset:12352
 ds_read_b64_tr_b16 a[90:91], v5 offset:12864
 ds_read_b64_tr_b16 a[92:93], v5 offset:12360
 ds_read_b64_tr_b16 a[94:95], v5 offset:12872
 s_waitcnt lgkmcnt(0)
 ds_read_b64_tr_b16 a[96:97], v5 offset:16384
 ds_read_b64_tr_b16 a[98:99], v5 offset:16896
 ds_read_b64_tr_b16 a[100:101], v5 offset:16392
 ds_read_b64_tr_b16 a[102:103], v5 offset:16904
 ds_read_b64_tr_b16 a[104:105], v5 offset:16448
 ds_read_b64_tr_b16 a[106:107], v5 offset:16960
 ds_read_b64_tr_b16 a[108:109], v5 offset:16456
 ds_read_b64_tr_b16 a[110:111], v5 offset:16968
 s_waitcnt lgkmcnt(0)
 ds_read_b64_tr_b16 a[112:113], v5 offset:20480
 ds_read_b64_tr_b16 a[114:115], v5 offset:20992
 ds_read_b64_tr_b16 a[116:117], v5 offset:20488
 ds_read_b64_tr_b16 a[118:119], v5 offset:21000
 ds_read_b64_tr_b16 a[120:121], v5 offset:20544
 ds_read_b64_tr_b16 a[122:123], v5 offset:21056
 ds_read_b64_tr_b16 a[124:125], v5 offset:20552
 ds_read_b64_tr_b16 a[126:127], v5 offset:21064
 s_waitcnt lgkmcnt(0)
 ds_read_b64_tr_b16 a[128:129], v5 offset:24576
 ds_read_b64_tr_b16 a[130:131], v5 offset:25088
 ds_read_b64_tr_b16 a[132:133], v5 offset:24584
 ds_read_b64_tr_b16 a[134:135], v5 offset:25096
 ds_read_b64_tr_b16 a[136:137], v5 offset:24640
 ds_read_b64_tr_b16 a[138:139], v5 offset:25152
 ds_read_b64_tr_b16 a[140:141], v5 offset:24648
 ds_read_b64_tr_b16 a[142:143], v5 offset:25160
 s_waitcnt lgkmcnt(0)
 ds_read_b64_tr_b16 a[144:145], v5 offset:28672
 ds_read_b64_tr_b16 a[146:147], v5 offset:29184
 ds_read_b64_tr_b16 a[148:149], v5 offset:28680
 ds_read_b64_tr_b16 a[150:151], v5 offset:29192
 ds_read_b64_tr_b16 a[152:153], v5 offset:28736
 ds_read_b64_tr_b16 a[154:155], v5 offset:29248
 ds_read_b64_tr_b16 a[156:157], v5 offset:28744
 ds_read_b64_tr_b16 a[158:159], v5 offset:29256
 s_waitcnt lgkmcnt(0)
 s_waitcnt lgkmcnt(0)
 s_add_u32 s73, s74, 327680
 buffer_load_dwordx4 v[16:19], v2, s[12:15], s73 offen
 s_add_u32 s73, s74, 337920
 buffer_load_dwordx4 v[20:23], v2, s[12:15], s73 offen
 s_add_u32 s73, s74, 348160
 buffer_load_dwordx4 v[24:27], v2, s[12:15], s73 offen
 s_add_u32 s73, s74, 358400
 buffer_load_dwordx4 v[28:31], v2, s[12:15], s73 offen
 s_add_u32 s73, s74, 368640
 buffer_load_dwordx4 v[32:35], v2, s[12:15], s73 offen
 s_add_u32 s73, s74, 378880
 buffer_load_dwordx4 v[36:39], v2, s[12:15], s73 offen
 s_add_u32 s73, s74, 389120
 buffer_load_dwordx4 v[40:43], v2, s[12:15], s73 offen
 s_add_u32 s73, s74, 399360
 buffer_load_dwordx4 v[44:47], v2, s[12:15], s73 offen
 s_add_u32 s73, s74, 409600
 buffer_load_dwordx4 v[48:51], v2, s[12:15], s73 offen
 s_add_u32 s73, s74, 419840
 buffer_load_dwordx4 v[52:55], v2, s[12:15], s73 offen
 s_add_u32 s73, s74, 430080
 buffer_load_dwordx4 v[56:59], v2, s[12:15], s73 offen
 s_add_u32 s73, s74, 440320
 buffer_load_dwordx4 v[60:63], v2, s[12:15], s73 offen
 s_add_u32 s73, s74, 450560
 buffer_load_dwordx4 v[64:67], v2, s[12:15], s73 offen
 s_add_u32 s73, s74, 460800
 buffer_load_dwordx4 v[68:71], v2, s[12:15], s73 offen
 s_add_u32 s73, s74, 471040
 buffer_load_dwordx4 v[72:75], v2, s[12:15], s73 offen
 s_add_u32 s73, s74, 481280
 buffer_load_dwordx4 v[76:79], v2, s[12:15], s73 offen
 s_add_u32 s73, s74, 491520
 buffer_load_dwordx4 v[80:83], v2, s[12:15], s73 offen
 s_add_u32 s73, s74, 501760
 buffer_load_dwordx4 v[84:87], v2, s[12:15], s73 offen
 s_add_u32 s73, s74, 512000
 buffer_load_dwordx4 v[88:91], v2, s[12:15], s73 offen
 s_add_u32 s73, s74, 522240
 buffer_load_dwordx4 v[92:95], v2, s[12:15], s73 offen
 s_add_u32 s73, s74, 532480
 buffer_load_dwordx4 v[96:99], v2, s[12:15], s73 offen
 s_add_u32 s73, s74, 542720
 buffer_load_dwordx4 v[100:103], v2, s[12:15], s73 offen
 s_add_u32 s73, s74, 552960
 buffer_load_dwordx4 v[104:107], v2, s[12:15], s73 offen
 s_add_u32 s73, s74, 563200
 buffer_load_dwordx4 v[108:111], v2, s[12:15], s73 offen
 s_waitcnt vmcnt(23)
 ds_write_b128 v4, v[16:19] offset:0
 s_waitcnt vmcnt(22)
 ds_write_b128 v4, v[20:23] offset:1024
 s_waitcnt vmcnt(21)
 ds_write_b128 v4, v[24:27] offset:2048
 s_waitcnt vmcnt(20)
 ds_write_b128 v4, v[28:31] offset:3072
 s_waitcnt vmcnt(19)
 ds_write_b128 v4, v[32:35] offset:4096
 s_waitcnt vmcnt(18)
 ds_write_b128 v4, v[36:39] offset:5120
 s_waitcnt vmcnt(17)
 ds_write_b128 v4, v[40:43] offset:6144
 s_waitcnt vmcnt(16)
 ds_write_b128 v4, v[44:47] offset:7168
 s_waitcnt vmcnt(15)
 ds_write_b128 v4, v[48:51] offset:8192
 s_waitcnt vmcnt(14)
 ds_write_b128 v4, v[52:55] offset:9216
 s_waitcnt vmcnt(13)
 ds_write_b128 v4, v[56:59] offset:10240
 s_waitcnt vmcnt(12)
 ds_write_b128 v4, v[60:63] offset:11264
 s_waitcnt vmcnt(11)
 ds_write_b128 v4, v[64:67] offset:12288
 s_waitcnt vmcnt(10)
 ds_write_b128 v4, v[68:71] offset:13312
 s_waitcnt vmcnt(9)
 ds_write_b128 v4, v[72:75] offset:14336
 s_waitcnt vmcnt(8)
 ds_write_b128 v4, v[76:79] offset:15360
 s_waitcnt vmcnt(7)
 ds_write_b128 v4, v[80:83] offset:16384
 s_waitcnt vmcnt(6)
 ds_write_b128 v4, v[84:87] offset:17408
 s_waitcnt vmcnt(5)
 ds_write_b128 v4, v[88:91] offset:18432
 s_waitcnt vmcnt(4)
 ds_write_b128 v4, v[92:95] offset:19456
 s_waitcnt vmcnt(3)
 ds_write_b128 v4, v[96:99] offset:20480
 s_waitcnt vmcnt(2)
 ds_write_b128 v4, v[100:103] offset:21504
 s_waitcnt vmcnt(1)
 ds_write_b128 v4, v[104:107] offset:22528
 s_waitcnt vmcnt(0)
 ds_write_b128 v4, v[108:111] offset:23552
 ds_read_b64_tr_b16 a[160:161], v5 offset:0
 ds_read_b64_tr_b16 a[162:163], v5 offset:512
 ds_read_b64_tr_b16 a[164:165], v5 offset:8
 ds_read_b64_tr_b16 a[166:167], v5 offset:520
 ds_read_b64_tr_b16 a[168:169], v5 offset:64
 ds_read_b64_tr_b16 a[170:171], v5 offset:576
 ds_read_b64_tr_b16 a[172:173], v5 offset:72
 ds_read_b64_tr_b16 a[174:175], v5 offset:584
 s_waitcnt lgkmcnt(0)
 ds_read_b64_tr_b16 a[176:177], v5 offset:4096
 ds_read_b64_tr_b16 a[178:179], v5 offset:4608
 ds_read_b64_tr_b16 a[180:181], v5 offset:4104
 ds_read_b64_tr_b16 a[182:183], v5 offset:4616
 ds_read_b64_tr_b16 a[184:185], v5 offset:4160
 ds_read_b64_tr_b16 a[186:187], v5 offset:4672
 ds_read_b64_tr_b16 a[188:189], v5 offset:4168
 ds_read_b64_tr_b16 a[190:191], v5 offset:4680
 s_waitcnt lgkmcnt(0)
 ds_read_b64_tr_b16 a[192:193], v5 offset:8192
 ds_read_b64_tr_b16 a[194:195], v5 offset:8704
 ds_read_b64_tr_b16 a[196:197], v5 offset:8200
 ds_read_b64_tr_b16 a[198:199], v5 offset:8712
 ds_read_b64_tr_b16 a[200:201], v5 offset:8256
 ds_read_b64_tr_b16 a[202:203], v5 offset:8768
 ds_read_b64_tr_b16 a[204:205], v5 offset:8264
 ds_read_b64_tr_b16 a[206:207], v5 offset:8776
 s_waitcnt lgkmcnt(0)
 ds_read_b64_tr_b16 a[208:209], v5 offset:12288
 ds_read_b64_tr_b16 a[210:211], v5 offset:12800
 ds_read_b64_tr_b16 a[212:213], v5 offset:12296
 ds_read_b64_tr_b16 a[214:215], v5 offset:12808
 ds_read_b64_tr_b16 a[216:217], v5 offset:12352
 ds_read_b64_tr_b16 a[218:219], v5 offset:12864
 ds_read_b64_tr_b16 a[220:221], v5 offset:12360
 ds_read_b64_tr_b16 a[222:223], v5 offset:12872
 s_waitcnt lgkmcnt(0)
 ds_read_b64_tr_b16 a[224:225], v5 offset:16384
 ds_read_b64_tr_b16 a[226:227], v5 offset:16896
 ds_read_b64_tr_b16 a[228:229], v5 offset:16392
 ds_read_b64_tr_b16 a[230:231], v5 offset:16904
 ds_read_b64_tr_b16 a[232:233], v5 offset:16448
 ds_read_b64_tr_b16 a[234:235], v5 offset:16960
 ds_read_b64_tr_b16 a[236:237], v5 offset:16456
 ds_read_b64_tr_b16 a[238:239], v5 offset:16968
 s_waitcnt lgkmcnt(0)
 ds_read_b64_tr_b16 a[240:241], v5 offset:20480
 ds_read_b64_tr_b16 a[242:243], v5 offset:20992
 ds_read_b64_tr_b16 a[244:245], v5 offset:20488
 ds_read_b64_tr_b16 a[246:247], v5 offset:21000
 ds_read_b64_tr_b16 a[248:249], v5 offset:20544
 ds_read_b64_tr_b16 a[250:251], v5 offset:21056
 ds_read_b64_tr_b16 a[252:253], v5 offset:20552
 ds_read_b64_tr_b16 a[254:255], v5 offset:21064
 s_waitcnt lgkmcnt(0)
 s_waitcnt lgkmcnt(0)
 s_barrier
 s_min_u32 s85, s66, 1
 s_lshl_b32 s73, s85, 11
 v_add_u32 v11, s73, v1
 s_mul_i32 s73, s81, 2
 s_add_u32 s85, s85, s73
 v_lshrrev_b32 v3, 4, v0
 v_lshlrev_b32 v2, 5, v3
 s_lshl_b32 s73, s85, 7
 s_add_u32 s73, s73, 0x23200
poll_80:
 buffer_load_dwordx4 v[192:195], v2, s[8:11], s73 offen offset:0 sc1
 buffer_load_dwordx4 v[196:199], v2, s[8:11], s73 offen offset:16 sc1
 s_waitcnt vmcnt(0)
 v_max_u32 v4, v192, v193
 v_max3_u32 v4, v4, v194, v195
 v_max3_u32 v4, v4, v196, v197
 v_max3_u32 v4, v4, v198, v199
 v_cmp_eq_u32 vcc, -1, v4
 s_cbranch_vccz written_81
 s_sleep 6
 s_add_u32 s72, s72, 1
 s_cmp_lt_u32 s72, 0x40000
 s_cbranch_scc1 poll_80
 s_branch bail2
written_81:
 v_and_b32 v8, 15, v0
 v_mul_u32_u24 v8, 1280, v8
 v_lshl_add_u32 v8, v3, 4, v8
 s_lshl_b32 s73, s85, 6
 v_add_u32 v8, s73, v8
 v_and_b32 v9, 7, v0
 v_lshlrev_b32 v9, 7, v9
 v_mov_b32 v12, 0
 s_lshl_b32 s73, s66, 12
 v_add_u32 v10, s73, v1
 s_waitcnt vmcnt(0)
t6_loop:
 s_add_u32 s5, s82, 1
 v_cmp_gt_u32 vcc, s5, v12
 s_and_b32 vcc_lo, vcc_lo, 0x7f
 s_cbranch_scc1 slow_83
go_82:
 s_mul_i32 s78, s82, 20480
 s_cmp_ge_u32 s66, 2
 s_cbranch_scc1 noext_84
 s_lshl_b32 s83, s85, 10
 s_add_u32 s83, s83, s78
 s_add_u32 s83, s83, 0xcc0000
 s_add_u32 s74, s83, 0xa00000
 buffer_load_dwordx4 v[184:187], v1, s[8:11], s74 offen sc1
 buffer_load_dwordx4 v[188:191], v1, s[8:11], s83 offen sc1
noext_84:
 s_mul_i32 s79, s82, 54
 s_add_u32 s79, s79, s77
 s_lshl_b32 s79, s79, 10
 s_add_u32 s79, s79, 0x1a00000
 s_add_u32 s73, s79, 0
 buffer_load_dwordx4 v[16:19], v1, s[8:11], s73 offen offset:0 sc1
 buffer_load_dwordx4 v[20:23], v1, s[8:11], s73 offen offset:1024 sc1
 buffer_load_dwordx4 v[24:27], v1, s[8:11], s73 offen offset:2048 sc1
 buffer_load_dwordx4 v[28:31], v1, s[8:11], s73 offen offset:3072 sc1
 s_add_u32 s73, s79, 4096
 buffer_load_dwordx4 v[32:35], v1, s[8:11], s73 offen offset:0 sc1
 buffer_load_dwordx4 v[36:39], v1, s[8:11], s73 offen offset:1024 sc1
 buffer_load_dwordx4 v[40:43], v1, s[8:11], s73 offen offset:2048 sc1
 buffer_load_dwordx4 v[44:47], v1, s[8:11], s73 offen offset:3072 sc1
 s_add_u32 s73, s79, 8192
 buffer_load_dwordx4 v[48:51], v1, s[8:11], s73 offen offset:0 sc1
 buffer_load_dwordx4 v[52:55], v1, s[8:11], s73 offen offset:1024 sc1
 buffer_load_dwordx4 v[56:59], v1, s[8:11], s73 offen offset:2048 sc1
 buffer_load_dwordx4 v[60:63], v1, s[8:11], s73 offen offset:3072 sc1
 s_add_u32 s73, s79, 12288
 s_cmp_eq_u32 s66, 3
 s_cselect_b32 s73, 0x40000000, s73
 buffer_load_dwordx4 v[64:67], v1, s[8:11], s73 offen offset:0 sc1
 buffer_load_dwordx4 v[68:71], v1, s[8:11], s73 offen offset:1024 sc1
 s_add_u32 s74, s82, s100
 s_cmp_eq_u32 s74, 125
 s_cselect_b32 s74, 127, s74
 s_min_u32 s74, s74, 129
 s_mul_i32 s73, s74, 205
 s_lshr_b32 s73, s73, 10
 s_mul_i32 s73, s73, 5
 s_sub_u32 s73, s74, s73
 s_mul_i32 s73, s73, 896
 s_add_u32 s73, s73, 88576
 buffer_load_dword v12, v9, s[8:11], s73 offen sc1
 s_waitcnt vmcnt(14)
 v_mfma_f32_16x16x32_bf16 v[144:147], a[32:35], v[16:19], 0
 v_mfma_f32_16x16x32_bf16 v[148:151], a[36:39], v[16:19], 0
 v_mfma_f32_16x16x32_bf16 v[152:155], a[40:43], v[16:19], 0
 v_mfma_f32_16x16x32_bf16 v[156:159], a[44:47], v[16:19], 0
 s_waitcnt vmcnt(13)
 v_mfma_f32_16x16x32_bf16 v[144:147], a[48:51], v[20:23], v[144:147]
 v_mfma_f32_16x16x32_bf16 v[148:151], a[52:55], v[20:23], v[148:151]
 v_mfma_f32_16x16x32_bf16 v[152:155], a[56:59], v[20:23], v[152:155]
 v_mfma_f32_16x16x32_bf16 v[156:159], a[60:63], v[20:23], v[156:159]
 s_waitcnt vmcnt(12)
 v_mfma_f32_16x16x32_bf16 v[144:147], a[64:67], v[24:27], v[144:147]
 v_mfma_f32_16x16x32_bf16 v[148:151], a[68:71], v[24:27], v[148:151]
 v_mfma_f32_16x16x32_bf16 v[152:155], a[72:75], v[24:27], v[152:155]
 v_mfma_f32_16x16x32_bf16 v[156:159], a[76:79], v[24:27], v[156:159]
 s_waitcnt vmcnt(11)
 v_mfma_f32_16x16x32_bf16 v[144:147], a[80:83], v[28:31], v[144:147]
 v_mfma_f32_16x16x32_bf16 v[148:151], a[84:87], v[28:31], v[148:151]
 v_mfma_f32_16x16x32_bf16 v[152:155], a[88:91], v[28:31], v[152:155]
 v_mfma_f32_16x16x32_bf16 v[156:159], a[92:95], v[28:31], v[156:159]
 s_waitcnt vmcnt(10)
 v_mfma_f32_16x16x32_bf16 v[144:147], a[96:99], v[32:35], v[144:147]
 v_mfma_f32_16x16x32_bf16 v[148:151], a[100:103], v[32:35], v[148:151]
 v_mfma_f32_16x16x32_bf16 v[152:155], a[104:107], v[32:35], v[152:155]
 v_mfma_f32_16x16x32_bf16 v[156:159], a[108:111], v[32:35], v[156:159]
 s_waitcnt vmcnt(9)
 v_mfma_f32_16x16x32_bf16 v[144:147], a[112:115], v[36:39], v[144:147]
 v_mfma_f32_16x16x32_bf16 v[148:151], a[116:119], v[36:39], v[148:151]
 v_mfma_f32_16x16x32_bf16 v[152:155], a[120:123], v[36:39], v[152:155]
 v_mfma_f32_16x16x32_bf16 v[156:159], a[124:127], v[36:39], v[156:159]
 s_waitcnt vmcnt(8)
 v_mfma_f32_16x16x32_bf16 v[144:147], a[128:131], v[40:43], v[144:147]
 v_mfma_f32_16x16x32_bf16 v[148:151], a[132:135], v[40:43], v[148:151]
 v_mfma_f32_16x16x32_bf16 v[152:155], a[136:139], v[40:43], v[152:155]
 v_mfma_f32_16x16x32_bf16 v[156:159], a[140:143], v[40:43], v[156:159]
 s_waitcnt vmcnt(7)
 v_mfma_f32_16x16x32_bf16 v[144:147], a[144:147], v[44:47], v[144:147]
 v_mfma_f32_16x16x32_bf16 v[148:151], a[148:151], v[44:47], v[148:151]
 v_mfma_f32_16x16x32_bf16 v[152:155], a[152:155], v[44:47], v[152:155]
 v_mfma_f32_16x16x32_bf16 v[156:159], a[156:159], v[44:47], v[156:159]
 s_waitcnt vmcnt(6)
 v_mfma_f32_16x16x32_bf16 v[144:147], a[160:163], v[48:51], v[144:147]
 v_mfma_f32_16x16x32_bf16 v[148:151], a[164:167], v[48:51], v[148:151]
 v_mfma_f32_16x16x32_bf16 v[152:155], a[168:171], v[48:51], v[152:155]
 v_mfma_f32_16x16x32_bf16 v[156:159], a[172:175], v[48:51], v[156:159]
 s_waitcnt vmcnt(5)
 v_mfma_f32_16x16x32_bf16 v[144:147], a[176:179], v[52:55], v[144:147]
 v_mfma_f32_16x16x32_bf16 v[148:151], a[180:183], v[52:55], v[148:151]
 v_mfma_f32_16x16x32_bf16 v[152:155], a[184:187], v[52:55], v[152:155]
 v_mfma_f32_16x16x32_bf16 v[156:159], a[188:191], v[52:55], v[156:159]
 s_waitcnt vmcnt(4)
 v_mfma_f32_16x16x32_bf16 v[144:147], a[192:195], v[56:59], v[144:147]
 v_mfma_f32_16x16x32_bf16 v[148:151], a[196:199], v[56:59], v[148:151]
 v_mfma_f32_16x16x32_bf16 v[152:155], a[200:203], v[56:59], v[152:155]
 v_mfma_f32_16x16x32_bf16 v[156:159], a[204:207], v[56:59], v[156:159]
 s_waitcnt vmcnt(3)
 v_mfma_f32_16x16x32_bf16 v[144:147], a[208:211], v[60:63], v[144:147]
 v_mfma_f32_16x16x32_bf16 v[148:151], a[212:215], v[60:63], v[148:151]
 v_mfma_f32_16x16x32_bf16 v[152:155], a[216:219], v[60:63], v[152:155]
 v_mfma_f32_16x16x32_bf16 v[156:159], a[220:223], v[60:63], v[156:159]
 s_waitcnt vmcnt(2)
 v_mfma_f32_16x16x32_bf16 v[144:147], a[224:227], v[64:67], v[144:147]
 v_mfma_f32_16x16x32_bf16 v[148:151], a[228:231], v[64:67], v[148:151]
 v_mfma_f32_16x16x32_bf16 v[152:155], a[232:235], v[64:67], v[152:155]
 v_mfma_f32_16x16x32_bf16 v[156:159], a[236:239], v[64:67], v[156:159]
 s_waitcnt vmcnt(1)
 v_mfma_f32_16x16x32_bf16 v[144:147], a[240:243], v[68:71], v[144:147]
 v_mfma_f32_16x16x32_bf16 v[148:151], a[244:247], v[68:71], v[148:151]
 v_mfma_f32_16x16x32_bf16 v[152:155], a[248:251], v[68:71], v[152:155]
 v_mfma_f32_16x16x32_bf16 v[156:159], a[252:255], v[68:71], v[156:159]
 s_waitcnt vmcnt(0)
 ds_write_b128 v10, v[144:147] offset:0
 ds_write_b128 v10, v[148:151] offset:1024
 s_nop 0
 ds_write_b128 v10, v[152:155] offset:2048
 s_nop 2
 ds_write_b128 v10, v[156:159] offset:3072
 s_waitcnt lgkmcnt(0)
 s_barrier
 s_cmp_lt_u32 s66, 2
 s_cbranch_scc1 fin_85
 s_barrier
 s_branch join_86
fin_85:
 ds_read_b128 v[144:147], v11 offset:0
 ds_read_b128 v[148:151], v11 offset:1024
 ds_read_b128 v[160:163], v11 offset:4096
 ds_read_b128 v[164:167], v11 offset:5120
 ds_read_b128 v[168:171], v11 offset:8192
 ds_read_b128 v[172:175], v11 offset:9216
 ds_read_b128 v[176:179], v11 offset:12288
 ds_read_b128 v[180:183], v11 offset:13312
 v_and_b32 v207, 0xffff0000, v187
 v_lshlrev_b32 v206, 16, v187
 v_and_b32 v205, 0xffff0000, v186
 v_lshlrev_b32 v204, 16, v186
 v_and_b32 v203, 0xffff0000, v185
 v_lshlrev_b32 v202, 16, v185
 v_and_b32 v201, 0xffff0000, v184
 v_lshlrev_b32 v200, 16, v184
 v_and_b32 v215, 0xffff0000, v191
 v_lshlrev_b32 v214, 16, v191
 v_and_b32 v213, 0xffff0000, v190
 v_lshlrev_b32 v212, 16, v190
 v_and_b32 v211, 0xffff0000, v189
 v_lshlrev_b32 v210, 16, v189
 v_and_b32 v209, 0xffff0000, v188
 v_lshlrev_b32 v208, 16, v188
 s_waitcnt lgkmcnt(0)
 s_barrier
 v_pk_add_f32 v[144:145], v[144:145], v[160:161]
 v_pk_add_f32 v[146:147], v[146:147], v[162:163]
 v_pk_add_f32 v[148:149], v[148:149], v[164:165]
 v_pk_add_f32 v[150:151], v[150:151], v[166:167]
 v_pk_add_f32 v[144:145], v[144:145], v[168:169]
 v_pk_add_f32 v[146:147], v[146:147], v[170:171]
 v_pk_add_f32 v[148:149], v[148:149], v[172:173]
 v_pk_add_f32 v[150:151], v[150:151], v[174:175]
 v_pk_add_f32 v[144:145], v[144:145], v[176:177]
 v_pk_add_f32 v[146:147], v[146:147], v[178:179]
 v_pk_add_f32 v[148:149], v[148:149], v[180:181]
 v_pk_add_f32 v[150:151], v[150:151], v[182:183]
 v_cvt_pk_bf16_f32 v144, 0, v144
 v_cvt_pk_bf16_f32 v145, 0, v145
 v_cvt_pk_bf16_f32 v146, 0, v146
 v_cvt_pk_bf16_f32 v147, 0, v147
 v_cvt_pk_bf16_f32 v148, 0, v148
 v_cvt_pk_bf16_f32 v149, 0, v149
 v_cvt_pk_bf16_f32 v150, 0, v150
 v_cvt_pk_bf16_f32 v151, 0, v151
 v_pk_add_f32 v[144:145], v[144:145], v[200:201]
 v_pk_add_f32 v[146:147], v[146:147], v[202:203]
 v_pk_add_f32 v[148:149], v[148:149], v[204:205]
 v_pk_add_f32 v[150:151], v[150:151], v[206:207]
 v_cvt_pk_bf16_f32 v144, 0, v144
 v_cvt_pk_bf16_f32 v145, 0, v145
 v_cvt_pk_bf16_f32 v146, 0, v146
 v_cvt_pk_bf16_f32 v147, 0, v147
 v_cvt_pk_bf16_f32 v148, 0, v148
 v_cvt_pk_bf16_f32 v149, 0, v149
 v_cvt_pk_bf16_f32 v150, 0, v150
 v_cvt_pk_bf16_f32 v151, 0, v151
 v_pk_mul_f32 v[144:145], v[144:145], v[192:193]
 v_pk_mul_f32 v[146:147], v[146:147], v[194:195]
 v_pk_mul_f32 v[148:149], v[148:149], v[196:197]
 v_pk_mul_f32 v[150:151], v[150:151], v[198:199]
 v_cvt_pk_bf16_f32 v144, 0, v144
 v_cvt_pk_bf16_f32 v145, 0, v145
 v_cvt_pk_bf16_f32 v146, 0, v146
 v_cvt_pk_bf16_f32 v147, 0, v147
 v_cvt_pk_bf16_f32 v148, 0, v148
 v_cvt_pk_bf16_f32 v149, 0, v149
 v_cvt_pk_bf16_f32 v150, 0, v150
 v_cvt_pk_bf16_f32 v151, 0, v151
 v_pk_add_f32 v[144:145], v[144:145], v[208:209]
 v_pk_add_f32 v[146:147], v[146:147], v[210:211]
 v_pk_add_f32 v[148:149], v[148:149], v[212:213]
 v_pk_add_f32 v[150:151], v[150:151], v[214:215]
 v_cvt_pk_bf16_f32 v160, v144, v145
 v_cvt_pk_bf16_f32 v161, v146, v147
 v_cvt_pk_bf16_f32 v162, v148, v149
 v_cvt_pk_bf16_f32 v163, v150, v151
 buffer_store_dwordx4 v[160:163], v8, s[16:19], s78 offen
join_86:
 s_add_u32 s82, s82, s100
 s_cmp_eq_u32 s82, 125
 s_cselect_b32 s82, 127, s82
 s_cmp_lt_u32 s82, 128
 s_cbranch_scc1 t6_loop
 s_waitcnt vmcnt(0)
 s_waitcnt vmcnt(0)
 s_endpgm
slow_83:
 s_mul_i32 s73, s82, 205
 s_lshr_b32 s73, s73, 10
 s_mul_i32 s73, s73, 5
 s_sub_u32 s73, s82, s73
 s_mul_i32 s73, s73, 896
 s_add_u32 s73, s73, 88576
wait_87:
 buffer_load_dword v2, v9, s[8:11], s73 offen sc1
 s_waitcnt vmcnt(0)
test_89:
 v_cmp_gt_u32 vcc, s5, v2
 s_and_b32 vcc_lo, vcc_lo, 0x7f
 s_and_b32 vcc_hi, vcc_hi, 0x0
 s_cmp_eq_u64 vcc, 0
 s_cbranch_scc1 ready_88
 s_sleep 1
 s_add_u32 s72, s72, 1
 s_cmp_lt_u32 s72, 0x40000
 s_cbranch_scc1 wait_87
 s_branch bail2
ready_88:
 s_branch go_82
t3:
 s_mov_b32 s12, s48
 s_and_b32 s13, s49, 0xffff
 s_mov_b32 s14, 0xc8000
 s_mov_b32 s15, 0x20000
 s_mov_b32 s82, s80
 s_lshl_b32 s75, s81, 8
 s_add_u32 s75, s75, 0
 s_lshl_b32 s73, s66, 2
 v_lshrrev_b32 v7, 4, v0
 v_add_u32 v4, s73, v7
 v_and_b32 v5, 15, v0
 s_mov_b32 s73, 1280
 v_mul_lo_u32 v6, v4, s73
 v_lshl_add_u32 v6, v5, 4, v6
 v_lshlrev_b32 v7, 2, v7
 v_xor_b32 v7, v7, v5
 v_lshlrev_b32 v7, 4, v7
 v_lshl_add_u32 v7, v4, 8, v7
 s_add_u32 s73, s75, 0
 buffer_load_dwordx4 v[16:19], v6, s[12:15], s73 offen
 s_add_u32 s73, s75, 20480
 buffer_load_dwordx4 v[20:23], v6, s[12:15], s73 offen
 s_add_u32 s73, s75, 40960
 buffer_load_dwordx4 v[24:27], v6, s[12:15], s73 offen
 s_add_u32 s73, s75, 61440
 buffer_load_dwordx4 v[28:31], v6, s[12:15], s73 offen
 s_add_u32 s73, s75, 81920
 buffer_load_dwordx4 v[32:35], v6, s[12:15], s73 offen
 s_add_u32 s73, s75, 102400
 buffer_load_dwordx4 v[36:39], v6, s[12:15], s73 offen
 s_add_u32 s73, s75, 122880
 buffer_load_dwordx4 v[40:43], v6, s[12:15], s73 offen
 s_add_u32 s73, s75, 143360
 buffer_load_dwordx4 v[44:47], v6, s[12:15], s73 offen
 s_add_u32 s73, s75, 163840
 buffer_load_dwordx4 v[48:51], v6, s[12:15], s73 offen
 s_add_u32 s73, s75, 184320
 buffer_load_dwordx4 v[52:55], v6, s[12:15], s73 offen
 s_add_u32 s73, s75, 204800
 buffer_load_dwordx4 v[56:59], v6, s[12:15], s73 offen
 s_add_u32 s73, s75, 225280
 buffer_load_dwordx4 v[60:63], v6, s[12:15], s73 offen
 s_add_u32 s73, s75, 245760
 buffer_load_dwordx4 v[64:67], v6, s[12:15], s73 offen
 s_add_u32 s73, s75, 266240
 buffer_load_dwordx4 v[68:71], v6, s[12:15], s73 offen
 s_add_u32 s73, s75, 286720
 buffer_load_dwordx4 v[72:75], v6, s[12:15], s73 offen
 s_add_u32 s73, s75, 307200
 buffer_load_dwordx4 v[76:79], v6, s[12:15], s73 offen
 s_add_u32 s73, s75, 327680
 buffer_load_dwordx4 v[80:83], v6, s[12:15], s73 offen
 s_add_u32 s73, s75, 348160
 buffer_load_dwordx4 v[84:87], v6, s[12:15], s73 offen
 s_add_u32 s73, s75, 368640
 buffer_load_dwordx4 v[88:91], v6, s[12:15], s73 offen
 s_add_u32 s73, s75, 389120
 buffer_load_dwordx4 v[92:95], v6, s[12:15], s73 offen
 s_add_u32 s73, s75, 409600
 buffer_load_dwordx4 v[96:99], v6, s[12:15], s73 offen
 s_add_u32 s73, s75, 430080
 buffer_load_dwordx4 v[100:103], v6, s[12:15], s73 offen
 s_add_u32 s73, s75, 450560
 buffer_load_dwordx4 v[104:107], v6, s[12:15], s73 offen
 s_add_u32 s73, s75, 471040
 buffer_load_dwordx4 v[108:111], v6, s[12:15], s73 offen
 s_add_u32 s73, s75, 491520
 buffer_load_dwordx4 v[112:115], v6, s[12:15], s73 offen
 s_add_u32 s73, s75, 512000
 buffer_load_dwordx4 v[116:119], v6, s[12:15], s73 offen
 s_add_u32 s73, s75, 532480
 buffer_load_dwordx4 v[120:123], v6, s[12:15], s73 offen
 s_add_u32 s73, s75, 552960
 buffer_load_dwordx4 v[124:127], v6, s[12:15], s73 offen
 s_add_u32 s73, s75, 573440
 buffer_load_dwordx4 v[128:131], v6, s[12:15], s73 offen
 s_add_u32 s73, s75, 593920
 buffer_load_dwordx4 v[132:135], v6, s[12:15], s73 offen
 s_add_u32 s73, s75, 614400
 buffer_load_dwordx4 v[136:139], v6, s[12:15], s73 offen
 s_add_u32 s73, s75, 634880
 buffer_load_dwordx4 v[140:143], v6, s[12:15], s73 offen
 s_add_u32 s73, s75, 655360
 buffer_load_dwordx4 v[144:147], v6, s[12:15], s73 offen
 s_add_u32 s73, s75, 675840
 buffer_load_dwordx4 v[148:151], v6, s[12:15], s73 offen
 s_add_u32 s73, s75, 696320
 buffer_load_dwordx4 v[152:155], v6, s[12:15], s73 offen
 s_add_u32 s73, s75, 716800
 buffer_load_dwordx4 v[156:159], v6, s[12:15], s73 offen
 s_add_u32 s73, s75, 737280
 buffer_load_dwordx4 v[160:163], v6, s[12:15], s73 offen
 s_add_u32 s73, s75, 757760
 buffer_load_dwordx4 v[164:167], v6, s[12:15], s73 offen
 s_add_u32 s73, s75, 778240
 buffer_load_dwordx4 v[168:171], v6, s[12:15], s73 offen
 s_add_u32 s73, s75, 798720
 buffer_load_dwordx4 v[172:175], v6, s[12:15], s73 offen
 s_waitcnt vmcnt(39)
 ds_write_b128 v7, v[16:19] offset:0
 s_waitcnt vmcnt(38)
 ds_write_b128 v7, v[20:23] offset:4096
 s_waitcnt vmcnt(37)
 ds_write_b128 v7, v[24:27] offset:8192
 s_waitcnt vmcnt(36)
 ds_write_b128 v7, v[28:31] offset:12288
 s_waitcnt vmcnt(35)
 ds_write_b128 v7, v[32:35] offset:16384
 s_waitcnt vmcnt(34)
 ds_write_b128 v7, v[36:39] offset:20480
 s_waitcnt vmcnt(33)
 ds_write_b128 v7, v[40:43] offset:24576
 s_waitcnt vmcnt(32)
 ds_write_b128 v7, v[44:47] offset:28672
 s_waitcnt vmcnt(31)
 ds_write_b128 v7, v[48:51] offset:32768
 s_waitcnt vmcnt(30)
 ds_write_b128 v7, v[52:55] offset:36864
 s_waitcnt vmcnt(29)
 ds_write_b128 v7, v[56:59] offset:40960
 s_waitcnt vmcnt(28)
 ds_write_b128 v7, v[60:63] offset:45056
 s_waitcnt vmcnt(27)
 ds_write_b128 v7, v[64:67] offset:49152
 s_waitcnt vmcnt(26)
 ds_write_b128 v7, v[68:71] offset:53248
 s_waitcnt vmcnt(25)
 ds_write_b128 v7, v[72:75] offset:57344
 s_waitcnt vmcnt(24)
 ds_write_b128 v7, v[76:79] offset:61440
 v_add_u32 v7, 0x10000, v7
 s_waitcnt vmcnt(23)
 ds_write_b128 v7, v[80:83] offset:0
 s_waitcnt vmcnt(22)
 ds_write_b128 v7, v[84:87] offset:4096
 s_waitcnt vmcnt(21)
 ds_write_b128 v7, v[88:91] offset:8192
 s_waitcnt vmcnt(20)
 ds_write_b128 v7, v[92:95] offset:12288
 s_waitcnt vmcnt(19)
 ds_write_b128 v7, v[96:99] offset:16384
 s_waitcnt vmcnt(18)
 ds_write_b128 v7, v[100:103] offset:20480
 s_waitcnt vmcnt(17)
 ds_write_b128 v7, v[104:107] offset:24576
 s_waitcnt vmcnt(16)
 ds_write_b128 v7, v[108:111] offset:28672
 s_waitcnt vmcnt(15)
 ds_write_b128 v7, v[112:115] offset:32768
 s_waitcnt vmcnt(14)
 ds_write_b128 v7, v[116:119] offset:36864
 s_waitcnt vmcnt(13)
 ds_write_b128 v7, v[120:123] offset:40960
 s_waitcnt vmcnt(12)
 ds_write_b128 v7, v[124:127] offset:45056
 s_waitcnt vmcnt(11)
 ds_write_b128 v7, v[128:131] offset:49152
 s_waitcnt vmcnt(10)
 ds_write_b128 v7, v[132:135] offset:53248
 s_waitcnt vmcnt(9)
 ds_write_b128 v7, v[136:139] offset:57344
 s_waitcnt vmcnt(8)
 ds_write_b128 v7, v[140:143] offset:61440
 v_add_u32 v7, 0x10000, v7
 s_waitcnt vmcnt(7)
 ds_write_b128 v7, v[144:147] offset:0
 s_waitcnt vmcnt(6)
 ds_write_b128 v7, v[148:151] offset:4096
 s_waitcnt vmcnt(5)
 ds_write_b128 v7, v[152:155] offset:8192
 s_waitcnt vmcnt(4)
 ds_write_b128 v7, v[156:159] offset:12288
 s_waitcnt vmcnt(3)
 ds_write_b128 v7, v[160:163] offset:16384
 s_waitcnt vmcnt(2)
 ds_write_b128 v7, v[164:167] offset:20480
 s_waitcnt vmcnt(1)
 ds_write_b128 v7, v[168:171] offset:24576
 s_waitcnt vmcnt(0)
 ds_write_b128 v7, v[172:175] offset:28672
 s_waitcnt lgkmcnt(0)
 s_barrier
 v_bfe_u32 v3, v0, 2, 2
 v_lshrrev_b32 v2, 4, v0
 v_lshl_add_u32 v2, v2, 3, v3
 v_lshlrev_b32 v2, 8, v2
 v_xor_b32 v3, s66, v3
 v_lshl_add_u32 v2, v3, 6, v2
 v_and_b32 v3, 3, v0
 v_lshl_add_u32 v2, v3, 4, v2
 ds_read_b64_tr_b16 a[96:97], v2 offset:0
 ds_read_b64_tr_b16 a[98:99], v2 offset:1024
 ds_read_b64_tr_b16 a[100:101], v2 offset:8
 ds_read_b64_tr_b16 a[102:103], v2 offset:1032
 ds_read_b64_tr_b16 a[104:105], v2 offset:8192
 ds_read_b64_tr_b16 a[106:107], v2 offset:9216
 ds_read_b64_tr_b16 a[108:109], v2 offset:8200
 ds_read_b64_tr_b16 a[110:111], v2 offset:9224
 ds_read_b64_tr_b16 a[112:113], v2 offset:16384
 ds_read_b64_tr_b16 a[114:115], v2 offset:17408
 ds_read_b64_tr_b16 a[116:117], v2 offset:16392
 ds_read_b64_tr_b16 a[118:119], v2 offset:17416
 s_waitcnt lgkmcnt(0)
 ds_read_b64_tr_b16 a[120:121], v2 offset:24576
 ds_read_b64_tr_b16 a[122:123], v2 offset:25600
 ds_read_b64_tr_b16 a[124:125], v2 offset:24584
 ds_read_b64_tr_b16 a[126:127], v2 offset:25608
 ds_read_b64_tr_b16 a[128:129], v2 offset:32768
 ds_read_b64_tr_b16 a[130:131], v2 offset:33792
 ds_read_b64_tr_b16 a[132:133], v2 offset:32776
 ds_read_b64_tr_b16 a[134:135], v2 offset:33800
 ds_read_b64_tr_b16 a[136:137], v2 offset:40960
 ds_read_b64_tr_b16 a[138:139], v2 offset:41984
 ds_read_b64_tr_b16 a[140:141], v2 offset:40968
 ds_read_b64_tr_b16 a[142:143], v2 offset:41992
 s_waitcnt lgkmcnt(0)
 ds_read_b64_tr_b16 a[144:145], v2 offset:49152
 ds_read_b64_tr_b16 a[146:147], v2 offset:50176
 ds_read_b64_tr_b16 a[148:149], v2 offset:49160
 ds_read_b64_tr_b16 a[150:151], v2 offset:50184
 ds_read_b64_tr_b16 a[152:153], v2 offset:57344
 ds_read_b64_tr_b16 a[154:155], v2 offset:58368
 ds_read_b64_tr_b16 a[156:157], v2 offset:57352
 ds_read_b64_tr_b16 a[158:159], v2 offset:58376
 v_add_u32 v2, 0x10000, v2
 ds_read_b64_tr_b16 a[160:161], v2 offset:0
 ds_read_b64_tr_b16 a[162:163], v2 offset:1024
 ds_read_b64_tr_b16 a[164:165], v2 offset:8
 ds_read_b64_tr_b16 a[166:167], v2 offset:1032
 s_waitcnt lgkmcnt(0)
 ds_read_b64_tr_b16 a[168:169], v2 offset:8192
 ds_read_b64_tr_b16 a[170:171], v2 offset:9216
 ds_read_b64_tr_b16 a[172:173], v2 offset:8200
 ds_read_b64_tr_b16 a[174:175], v2 offset:9224
 ds_read_b64_tr_b16 a[176:177], v2 offset:16384
 ds_read_b64_tr_b16 a[178:179], v2 offset:17408
 ds_read_b64_tr_b16 a[180:181], v2 offset:16392
 ds_read_b64_tr_b16 a[182:183], v2 offset:17416
 ds_read_b64_tr_b16 a[184:185], v2 offset:24576
 ds_read_b64_tr_b16 a[186:187], v2 offset:25600
 ds_read_b64_tr_b16 a[188:189], v2 offset:24584
 ds_read_b64_tr_b16 a[190:191], v2 offset:25608
 s_waitcnt lgkmcnt(0)
 ds_read_b64_tr_b16 a[192:193], v2 offset:32768
 ds_read_b64_tr_b16 a[194:195], v2 offset:33792
 ds_read_b64_tr_b16 a[196:197], v2 offset:32776
 ds_read_b64_tr_b16 a[198:199], v2 offset:33800
 ds_read_b64_tr_b16 a[200:201], v2 offset:40960
 ds_read_b64_tr_b16 a[202:203], v2 offset:41984
 ds_read_b64_tr_b16 a[204:205], v2 offset:40968
 ds_read_b64_tr_b16 a[206:207], v2 offset:41992
 ds_read_b64_tr_b16 a[208:209], v2 offset:49152
 ds_read_b64_tr_b16 a[210:211], v2 offset:50176
 ds_read_b64_tr_b16 a[212:213], v2 offset:49160
 ds_read_b64_tr_b16 a[214:215], v2 offset:50184
 s_waitcnt lgkmcnt(0)
 ds_read_b64_tr_b16 a[216:217], v2 offset:57344
 ds_read_b64_tr_b16 a[218:219], v2 offset:58368
 ds_read_b64_tr_b16 a[220:221], v2 offset:57352
 ds_read_b64_tr_b16 a[222:223], v2 offset:58376
 v_add_u32 v2, 0x10000, v2
 ds_read_b64_tr_b16 a[224:225], v2 offset:0
 ds_read_b64_tr_b16 a[226:227], v2 offset:1024
 ds_read_b64_tr_b16 a[228:229], v2 offset:8
 ds_read_b64_tr_b16 a[230:231], v2 offset:1032
 ds_read_b64_tr_b16 a[232:233], v2 offset:8192
 ds_read_b64_tr_b16 a[234:235], v2 offset:9216
 ds_read_b64_tr_b16 a[236:237], v2 offset:8200
 ds_read_b64_tr_b16 a[238:239], v2 offset:9224
 s_waitcnt lgkmcnt(0)
 ds_read_b64_tr_b16 a[240:241], v2 offset:16384
 ds_read_b64_tr_b16 a[242:243], v2 offset:17408
 ds_read_b64_tr_b16 a[244:245], v2 offset:16392
 ds_read_b64_tr_b16 a[246:247], v2 offset:17416
 ds_read_b64_tr_b16 a[248:249], v2 offset:24576
 ds_read_b64_tr_b16 a[250:251], v2 offset:25600
 ds_read_b64_tr_b16 a[252:253], v2 offset:24584
 ds_read_b64_tr_b16 a[254:255], v2 offset:25608
 s_waitcnt lgkmcnt(0)
 s_barrier
 v_and_b32 v76, 7, v0
 v_lshlrev_b32 v76, 7, v76
 s_mul_i32 s73, s66, 640
 v_add_u32 v76, s73, v76
 s_mul_i32 s4, s80, 5
 s_add_u32 s4, s4, s81
 s_lshl_b32 s4, s4, 7
 s_add_u32 s4, s4, 81920
 s_mov_b32 s3, 0
 s_mul_i32 s101, s66, 5120
 s_add_u32 s73, s101, 1024
 v_add_u32 v77, s73, v1
 s_lshl_b32 s77, s81, 2
 s_add_u32 s77, s77, s66
 s_lshl_b32 s77, s77, 10
 v_and_b32 v7, 15, v0
 v_lshlrev_b32 v7, 4, v7
 s_lshl_b32 s73, s66, 2
 v_add_u32 v6, s73, v7
poll_90:
 v_lshrrev_b32 v3, 4, v0
 v_lshlrev_b32 v3, 5, v3
 s_mul_i32 s73, s66, 640
 s_add_u32 s73, s73, 0x21e00
 buffer_load_dwordx4 v[80:83], v3, s[8:11], s73 offen offset:0 sc1
 buffer_load_dwordx4 v[84:87], v3, s[8:11], s73 offen offset:16 sc1
 buffer_load_dwordx4 v[88:91], v3, s[8:11], s73 offen offset:128 sc1
 buffer_load_dwordx4 v[92:95], v3, s[8:11], s73 offen offset:144 sc1
 buffer_load_dwordx4 v[96:99], v3, s[8:11], s73 offen offset:256 sc1
 buffer_load_dwordx4 v[100:103], v3, s[8:11], s73 offen offset:272 sc1
 buffer_load_dwordx4 v[104:107], v3, s[8:11], s73 offen offset:384 sc1
 buffer_load_dwordx4 v[108:111], v3, s[8:11], s73 offen offset:400 sc1
 buffer_load_dwordx4 v[112:115], v3, s[8:11], s73 offen offset:512 sc1
 buffer_load_dwordx4 v[116:119], v3, s[8:11], s73 offen offset:528 sc1
 v_lshrrev_b32 v3, 4, v0
 v_lshlrev_b32 v3, 5, v3
 s_mul_i32 s73, s66, 640
 s_add_u32 s73, s73, 0x22800
 buffer_load_dwordx4 v[120:123], v3, s[8:11], s73 offen offset:0 sc1
 buffer_load_dwordx4 v[124:127], v3, s[8:11], s73 offen offset:16 sc1
 buffer_load_dwordx4 v[128:131], v3, s[8:11], s73 offen offset:128 sc1
 buffer_load_dwordx4 v[132:135], v3, s[8:11], s73 offen offset:144 sc1
 buffer_load_dwordx4 v[136:139], v3, s[8:11], s73 offen offset:256 sc1
 buffer_load_dwordx4 v[140:143], v3, s[8:11], s73 offen offset:272 sc1
 buffer_load_dwordx4 v[144:147], v3, s[8:11], s73 offen offset:384 sc1
 buffer_load_dwordx4 v[148:151], v3, s[8:11], s73 offen offset:400 sc1
 buffer_load_dwordx4 v[152:155], v3, s[8:11], s73 offen offset:512 sc1
 buffer_load_dwordx4 v[156:159], v3, s[8:11], s73 offen offset:528 sc1
 s_waitcnt vmcnt(0)
 v_max_u32 v2, v80, v81
 v_max3_u32 v2, v2, v82, v83
 v_max3_u32 v2, v2, v84, v85
 v_max3_u32 v2, v2, v86, v87
 v_max3_u32 v2, v2, v88, v89
 v_max3_u32 v2, v2, v90, v91
 v_max3_u32 v2, v2, v92, v93
 v_max3_u32 v2, v2, v94, v95
 v_max3_u32 v2, v2, v96, v97
 v_max3_u32 v2, v2, v98, v99
 v_max3_u32 v2, v2, v100, v101
 v_max3_u32 v2, v2, v102, v103
 v_max3_u32 v2, v2, v104, v105
 v_max3_u32 v2, v2, v106, v107
 v_max3_u32 v2, v2, v108, v109
 v_max3_u32 v2, v2, v110, v111
 v_max3_u32 v2, v2, v112, v113
 v_max3_u32 v2, v2, v114, v115
 v_max3_u32 v2, v2, v116, v117
 v_max3_u32 v2, v2, v118, v119
 v_max3_u32 v2, v2, v120, v121
 v_max3_u32 v2, v2, v122, v123
 v_max3_u32 v2, v2, v124, v125
 v_max3_u32 v2, v2, v126, v127
 v_max3_u32 v2, v2, v128, v129
 v_max3_u32 v2, v2, v130, v131
 v_max3_u32 v2, v2, v132, v133
 v_max3_u32 v2, v2, v134, v135
 v_max3_u32 v2, v2, v136, v137
 v_max3_u32 v2, v2, v138, v139
 v_max3_u32 v2, v2, v140, v141
 v_max3_u32 v2, v2, v142, v143
 v_max3_u32 v2, v2, v144, v145
 v_max3_u32 v2, v2, v146, v147
 v_max3_u32 v2, v2, v148, v149
 v_max3_u32 v2, v2, v150, v151
 v_max3_u32 v2, v2, v152, v153
 v_max3_u32 v2, v2, v154, v155
 v_max3_u32 v2, v2, v156, v157
 v_max3_u32 v2, v2, v158, v159
 v_cmp_eq_u32 vcc, -1, v2
 s_cbranch_vccz written_91
 s_sleep 6
 s_add_u32 s72, s72, 1
 s_cmp_lt_u32 s72, 0x40000
 s_cbranch_scc1 poll_90
 s_branch bail2
written_91:
t3_loop:
 s_mul_i32 s78, s82, 20480
 s_mul_i32 s73, s82, 171
 s_lshr_b32 s73, s73, 9
 s_mul_i32 s73, s73, 3
 s_sub_u32 s73, s82, s73
 s_mul_i32 s73, s73, 2560
 s_add_u32 s73, s73, 73728
 s_add_u32 s5, s82, 1
 buffer_load_dword v2, v76, s[8:11], s73 offen sc1
 s_waitcnt vmcnt(0)
 s_barrier
 s_cmp_lg_u32 s66, 0
 s_cbranch_scc1 notw0_95
 v_mov_b32 v4, s3
 v_mov_b32 v5, 0
 s_mov_b64 exec, 1
 buffer_store_dword v4, v5, s[8:11], s4 offen sc1
 s_mov_b64 exec, -1
notw0_95:
 s_branch test_94
wait_92:
 buffer_load_dword v2, v76, s[8:11], s73 offen sc1
 s_waitcnt vmcnt(0)
test_94:
 v_cmp_gt_u32 vcc, s5, v2
 s_and_b32 vcc_lo, vcc_lo, 0x1f
 s_and_b32 vcc_hi, vcc_hi, 0x0
 s_cmp_eq_u64 vcc, 0
 s_cbranch_scc1 ready_93
 s_sleep 1
 s_add_u32 s72, s72, 1
 s_cmp_lt_u32 s72, 0x40000
 s_cbranch_scc1 wait_92
 s_branch bail2
ready_93:
 s_add_u32 s79, s101, s78
 s_add_u32 s73, s79, 0xcc0000
 s_add_u32 s74, s73, 4096
 buffer_load_dwordx4 v[56:59], v1, s[8:11], s73 offen offset:0 sc1
 buffer_load_dwordx4 v[60:63], v1, s[8:11], s73 offen offset:1024 sc1
 buffer_load_dwordx4 v[64:67], v1, s[8:11], s73 offen offset:2048 sc1
 buffer_load_dwordx4 v[68:71], v1, s[8:11], s73 offen offset:3072 sc1
 buffer_load_dwordx4 v[72:75], v1, s[8:11], s74 offen offset:0 sc1
 s_waitcnt vmcnt(0)
 v_and_b32 v55, 0xffff0000, v75
 v_lshlrev_b32 v54, 16, v75
 v_and_b32 v53, 0xffff0000, v74
 v_lshlrev_b32 v52, 16, v74
 v_and_b32 v51, 0xffff0000, v73
 v_lshlrev_b32 v50, 16, v73
 v_and_b32 v49, 0xffff0000, v72
 v_lshlrev_b32 v48, 16, v72
 v_and_b32 v47, 0xffff0000, v71
 v_lshlrev_b32 v46, 16, v71
 v_and_b32 v45, 0xffff0000, v70
 v_lshlrev_b32 v44, 16, v70
 v_and_b32 v43, 0xffff0000, v69
 v_lshlrev_b32 v42, 16, v69
 v_and_b32 v41, 0xffff0000, v68
 v_lshlrev_b32 v40, 16, v68
 v_and_b32 v39, 0xffff0000, v67
 v_lshlrev_b32 v38, 16, v67
 v_and_b32 v37, 0xffff0000, v66
 v_lshlrev_b32 v36, 16, v66
 v_and_b32 v35, 0xffff0000, v65
 v_lshlrev_b32 v34, 16, v65
 v_and_b32 v33, 0xffff0000, v64
 v_lshlrev_b32 v32, 16, v64
 v_and_b32 v31, 0xffff0000, v63
 v_lshlrev_b32 v30, 16, v63
 v_and_b32 v29, 0xffff0000, v62
 v_lshlrev_b32 v28, 16, v62
 v_and_b32 v27, 0xffff0000, v61
 v_lshlrev_b32 v26, 16, v61
 v_and_b32 v25, 0xffff0000, v60
 v_lshlrev_b32 v24, 16, v60
 v_and_b32 v23, 0xffff0000, v59
 v_lshlrev_b32 v22, 16, v59
 v_and_b32 v21, 0xffff0000, v58
 v_lshlrev_b32 v20, 16, v58
 v_and_b32 v19, 0xffff0000, v57
 v_lshlrev_b32 v18, 16, v57
 v_and_b32 v17, 0xffff0000, v56
 v_lshlrev_b32 v16, 16, v56
 v_pk_add_f32 v[10:11], v[16:17], v[18:19]
 v_pk_add_f32 v[10:11], v[10:11], v[20:21]
 v_pk_add_f32 v[10:11], v[10:11], v[22:23]
 v_pk_add_f32 v[10:11], v[10:11], v[24:25]
 v_pk_add_f32 v[10:11], v[10:11], v[26:27]
 v_pk_add_f32 v[10:11], v[10:11], v[28:29]
 v_pk_add_f32 v[10:11], v[10:11], v[30:31]
 v_pk_add_f32 v[10:11], v[10:11], v[32:33]
 v_pk_add_f32 v[10:11], v[10:11], v[34:35]
 v_pk_add_f32 v[10:11], v[10:11], v[36:37]
 v_pk_add_f32 v[10:11], v[10:11], v[38:39]
 v_pk_add_f32 v[10:11], v[10:11], v[40:41]
 v_pk_add_f32 v[10:11], v[10:11], v[42:43]
 v_pk_add_f32 v[10:11], v[10:11], v[44:45]
 v_pk_add_f32 v[10:11], v[10:11], v[46:47]
 v_pk_add_f32 v[10:11], v[10:11], v[48:49]
 v_pk_add_f32 v[10:11], v[10:11], v[50:51]
 v_pk_add_f32 v[10:11], v[10:11], v[52:53]
 v_pk_add_f32 v[10:11], v[10:11], v[54:55]
 v_add_f32 v10, v10, v11
 v_mov_b32 v11, v10
 s_nop 1
 v_permlane16_swap_b32 v10, v11
 v_add_f32 v10, v10, v11
 v_mov_b32 v11, v10
 s_nop 1
 v_permlane32_swap_b32 v10, v11
 v_add_f32 v10, v10, v11
 ds_write_b32 v6, v10 offset:0
 s_waitcnt lgkmcnt(0)
 s_barrier
 ds_read_b128 v[10:13], v7 offset:0
 s_waitcnt lgkmcnt(0)
 v_pk_add_f32 v[10:11], v[10:11], v[12:13]
 v_add_f32 v10, v10, v11
 v_mul_f32 v10, 0x3acccccd, v10
 v_mov_b32 v8, v10
 v_pk_add_f32 v[12:13], v[16:17], v[8:9] op_sel_hi:[1,0] neg_lo:[0,1] neg_hi:[0,1]
 v_pk_mul_f32 v[10:11], v[12:13], v[12:13]
 v_pk_add_f32 v[12:13], v[18:19], v[8:9] op_sel_hi:[1,0] neg_lo:[0,1] neg_hi:[0,1]
 v_pk_fma_f32 v[10:11], v[12:13], v[12:13], v[10:11]
 v_pk_add_f32 v[12:13], v[20:21], v[8:9] op_sel_hi:[1,0] neg_lo:[0,1] neg_hi:[0,1]
 v_pk_fma_f32 v[10:11], v[12:13], v[12:13], v[10:11]
 v_pk_add_f32 v[12:13], v[22:23], v[8:9] op_sel_hi:[1,0] neg_lo:[0,1] neg_hi:[0,1]
 v_pk_fma_f32 v[10:11], v[12:13], v[12:13], v[10:11]
 v_pk_add_f32 v[12:13], v[24:25], v[8:9] op_sel_hi:[1,0] neg_lo:[0,1] neg_hi:[0,1]
 v_pk_fma_f32 v[10:11], v[12:13], v[12:13], v[10:11]
 v_pk_add_f32 v[12:13], v[26:27], v[8:9] op_sel_hi:[1,0] neg_lo:[0,1] neg_hi:[0,1]
 v_pk_fma_f32 v[10:11], v[12:13], v[12:13], v[10:11]
 v_pk_add_f32 v[12:13], v[28:29], v[8:9] op_sel_hi:[1,0] neg_lo:[0,1] neg_hi:[0,1]
 v_pk_fma_f32 v[10:11], v[12:13], v[12:13], v[10:11]
 v_pk_add_f32 v[12:13], v[30:31], v[8:9] op_sel_hi:[1,0] neg_lo:[0,1] neg_hi:[0,1]
 v_pk_fma_f32 v[10:11], v[12:13], v[12:13], v[10:11]
 v_pk_add_f32 v[12:13], v[32:33], v[8:9] op_sel_hi:[1,0] neg_lo:[0,1] neg_hi:[0,1]
 v_pk_fma_f32 v[10:11], v[12:13], v[12:13], v[10:11]
 v_pk_add_f32 v[12:13], v[34:35], v[8:9] op_sel_hi:[1,0] neg_lo:[0,1] neg_hi:[0,1]
 v_pk_fma_f32 v[10:11], v[12:13], v[12:13], v[10:11]
 v_pk_add_f32 v[12:13], v[36:37], v[8:9] op_sel_hi:[1,0] neg_lo:[0,1] neg_hi:[0,1]
 v_pk_fma_f32 v[10:11], v[12:13], v[12:13], v[10:11]
 v_pk_add_f32 v[12:13], v[38:39], v[8:9] op_sel_hi:[1,0] neg_lo:[0,1] neg_hi:[0,1]
 v_pk_fma_f32 v[10:11], v[12:13], v[12:13], v[10:11]
 v_pk_add_f32 v[12:13], v[40:41], v[8:9] op_sel_hi:[1,0] neg_lo:[0,1] neg_hi:[0,1]
 v_pk_fma_f32 v[10:11], v[12:13], v[12:13], v[10:11]
 v_pk_add_f32 v[12:13], v[42:43], v[8:9] op_sel_hi:[1,0] neg_lo:[0,1] neg_hi:[0,1]
 v_pk_fma_f32 v[10:11], v[12:13], v[12:13], v[10:11]
 v_pk_add_f32 v[12:13], v[44:45], v[8:9] op_sel_hi:[1,0] neg_lo:[0,1] neg_hi:[0,1]
 v_pk_fma_f32 v[10:11], v[12:13], v[12:13], v[10:11]
 v_pk_add_f32 v[12:13], v[46:47], v[8:9] op_sel_hi:[1,0] neg_lo:[0,1] neg_hi:[0,1]
 v_pk_fma_f32 v[10:11], v[12:13], v[12:13], v[10:11]
 v_pk_add_f32 v[12:13], v[48:49], v[8:9] op_sel_hi:[1,0] neg_lo:[0,1] neg_hi:[0,1]
 v_pk_fma_f32 v[10:11], v[12:13], v[12:13], v[10:11]
 v_pk_add_f32 v[12:13], v[50:51], v[8:9] op_sel_hi:[1,0] neg_lo:[0,1] neg_hi:[0,1]
 v_pk_fma_f32 v[10:11], v[12:13], v[12:13], v[10:11]
 v_pk_add_f32 v[12:13], v[52:53], v[8:9] op_sel_hi:[1,0] neg_lo:[0,1] neg_hi:[0,1]
 v_pk_fma_f32 v[10:11], v[12:13], v[12:13], v[10:11]
 v_pk_add_f32 v[12:13], v[54:55], v[8:9] op_sel_hi:[1,0] neg_lo:[0,1] neg_hi:[0,1]
 v_pk_fma_f32 v[10:11], v[12:13], v[12:13], v[10:11]
 v_add_f32 v10, v10, v11
 v_mov_b32 v11, v10
 s_nop 1
 v_permlane16_swap_b32 v10, v11
 v_add_f32 v10, v10, v11
 v_mov_b32 v11, v10
 s_nop 1
 v_permlane32_swap_b32 v10, v11
 v_add_f32 v10, v10, v11
 ds_write_b32 v6, v10 offset:256
 s_waitcnt lgkmcnt(0)
 s_barrier
 ds_read_b128 v[10:13], v7 offset:256
 s_waitcnt lgkmcnt(0)
 v_pk_add_f32 v[10:11], v[10:11], v[12:13]
 v_add_f32 v10, v10, v11
 v_mul_f32 v10, 0x3acccccd, v10
 v_cvt_pk_bf16_f32 v10, 0, v10
 v_add_f32 v10, 0x3727c5ac, v10
 v_cvt_pk_bf16_f32 v10, 0, v10
 v_sqrt_f32 v10, v10
 v_cvt_pk_bf16_f32 v8, 0, v8
 v_cvt_pk_bf16_f32 v10, 0, v10
 v_rcp_f32 v10, v10
 v_pk_add_f32 v[16:17], v[16:17], v[8:9] op_sel_hi:[1,0] neg_lo:[0,1] neg_hi:[0,1]
 v_pk_add_f32 v[18:19], v[18:19], v[8:9] op_sel_hi:[1,0] neg_lo:[0,1] neg_hi:[0,1]
 v_pk_add_f32 v[20:21], v[20:21], v[8:9] op_sel_hi:[1,0] neg_lo:[0,1] neg_hi:[0,1]
 v_pk_add_f32 v[22:23], v[22:23], v[8:9] op_sel_hi:[1,0] neg_lo:[0,1] neg_hi:[0,1]
 v_pk_add_f32 v[24:25], v[24:25], v[8:9] op_sel_hi:[1,0] neg_lo:[0,1] neg_hi:[0,1]
 v_pk_add_f32 v[26:27], v[26:27], v[8:9] op_sel_hi:[1,0] neg_lo:[0,1] neg_hi:[0,1]
 v_pk_add_f32 v[28:29], v[28:29], v[8:9] op_sel_hi:[1,0] neg_lo:[0,1] neg_hi:[0,1]
 v_pk_add_f32 v[30:31], v[30:31], v[8:9] op_sel_hi:[1,0] neg_lo:[0,1] neg_hi:[0,1]
 v_pk_add_f32 v[32:33], v[32:33], v[8:9] op_sel_hi:[1,0] neg_lo:[0,1] neg_hi:[0,1]
 v_pk_add_f32 v[34:35], v[34:35], v[8:9] op_sel_hi:[1,0] neg_lo:[0,1] neg_hi:[0,1]
 v_pk_add_f32 v[36:37], v[36:37], v[8:9] op_sel_hi:[1,0] neg_lo:[0,1] neg_hi:[0,1]
 v_pk_add_f32 v[38:39], v[38:39], v[8:9] op_sel_hi:[1,0] neg_lo:[0,1] neg_hi:[0,1]
 v_pk_add_f32 v[40:41], v[40:41], v[8:9] op_sel_hi:[1,0] neg_lo:[0,1] neg_hi:[0,1]
 v_pk_add_f32 v[42:43], v[42:43], v[8:9] op_sel_hi:[1,0] neg_lo:[0,1] neg_hi:[0,1]
 v_pk_add_f32 v[44:45], v[44:45], v[8:9] op_sel_hi:[1,0] neg_lo:[0,1] neg_hi:[0,1]
 v_pk_add_f32 v[46:47], v[46:47], v[8:9] op_sel_hi:[1,0] neg_lo:[0,1] neg_hi:[0,1]
 v_pk_add_f32 v[48:49], v[48:49], v[8:9] op_sel_hi:[1,0] neg_lo:[0,1] neg_hi:[0,1]
 v_pk_add_f32 v[50:51], v[50:51], v[8:9] op_sel_hi:[1,0] neg_lo:[0,1] neg_hi:[0,1]
 v_pk_add_f32 v[52:53], v[52:53], v[8:9] op_sel_hi:[1,0] neg_lo:[0,1] neg_hi:[0,1]
 v_pk_add_f32 v[54:55], v[54:55], v[8:9] op_sel_hi:[1,0] neg_lo:[0,1] neg_hi:[0,1]
 v_cvt_pk_bf16_f32 v16, 0, v16
 v_cvt_pk_bf16_f32 v17, 0, v17
 v_cvt_pk_bf16_f32 v18, 0, v18
 v_cvt_pk_bf16_f32 v19, 0, v19
 v_cvt_pk_bf16_f32 v20, 0, v20
 v_cvt_pk_bf16_f32 v21, 0, v21
 v_cvt_pk_bf16_f32 v22, 0, v22
 v_cvt_pk_bf16_f32 v23, 0, v23
 v_cvt_pk_bf16_f32 v24, 0, v24
 v_cvt_pk_bf16_f32 v25, 0, v25
 v_cvt_pk_bf16_f32 v26, 0, v26
 v_cvt_pk_bf16_f32 v27, 0, v27
 v_cvt_pk_bf16_f32 v28, 0, v28
 v_cvt_pk_bf16_f32 v29, 0, v29
 v_cvt_pk_bf16_f32 v30, 0, v30
 v_cvt_pk_bf16_f32 v31, 0, v31
 v_cvt_pk_bf16_f32 v32, 0, v32
 v_cvt_pk_bf16_f32 v33, 0, v33
 v_cvt_pk_bf16_f32 v34, 0, v34
 v_cvt_pk_bf16_f32 v35, 0, v35
 v_cvt_pk_bf16_f32 v36, 0, v36
 v_cvt_pk_bf16_f32 v37, 0, v37
 v_cvt_pk_bf16_f32 v38, 0, v38
 v_cvt_pk_bf16_f32 v39, 0, v39
 v_cvt_pk_bf16_f32 v40, 0, v40
 v_cvt_pk_bf16_f32 v41, 0, v41
 v_cvt_pk_bf16_f32 v42, 0, v42
 v_cvt_pk_bf16_f32 v43, 0, v43
 v_cvt_pk_bf16_f32 v44, 0, v44
 v_cvt_pk_bf16_f32 v45, 0, v45
 v_cvt_pk_bf16_f32 v46, 0, v46
 v_cvt_pk_bf16_f32 v47, 0, v47
 v_cvt_pk_bf16_f32 v48, 0, v48
 v_cvt_pk_bf16_f32 v49, 0, v49
 v_cvt_pk_bf16_f32 v50, 0, v50
 v_cvt_pk_bf16_f32 v51, 0, v51
 v_cvt_pk_bf16_f32 v52, 0, v52
 v_cvt_pk_bf16_f32 v53, 0, v53
 v_cvt_pk_bf16_f32 v54, 0, v54
 v_cvt_pk_bf16_f32 v55, 0, v55
 v_pk_mul_f32 v[16:17], v[16:17], v[10:11] op_sel_hi:[1,0]
 v_pk_mul_f32 v[18:19], v[18:19], v[10:11] op_sel_hi:[1,0]
 v_pk_mul_f32 v[20:21], v[20:21], v[10:11] op_sel_hi:[1,0]
 v_pk_mul_f32 v[22:23], v[22:23], v[10:11] op_sel_hi:[1,0]
 v_pk_mul_f32 v[24:25], v[24:25], v[10:11] op_sel_hi:[1,0]
 v_pk_mul_f32 v[26:27], v[26:27], v[10:11] op_sel_hi:[1,0]
 v_pk_mul_f32 v[28:29], v[28:29], v[10:11] op_sel_hi:[1,0]
 v_pk_mul_f32 v[30:31], v[30:31], v[10:11] op_sel_hi:[1,0]
 v_pk_mul_f32 v[32:33], v[32:33], v[10:11] op_sel_hi:[1,0]
 v_pk_mul_f32 v[34:35], v[34:35], v[10:11] op_sel_hi:[1,0]
 v_pk_mul_f32 v[36:37], v[36:37], v[10:11] op_sel_hi:[1,0]
 v_pk_mul_f32 v[38:39], v[38:39], v[10:11] op_sel_hi:[1,0]
 v_pk_mul_f32 v[40:41], v[40:41], v[10:11] op_sel_hi:[1,0]
 v_pk_mul_f32 v[42:43], v[42:43], v[10:11] op_sel_hi:[1,0]
 v_pk_mul_f32 v[44:45], v[44:45], v[10:11] op_sel_hi:[1,0]
 v_pk_mul_f32 v[46:47], v[46:47], v[10:11] op_sel_hi:[1,0]
 v_pk_mul_f32 v[48:49], v[48:49], v[10:11] op_sel_hi:[1,0]
 v_pk_mul_f32 v[50:51], v[50:51], v[10:11] op_sel_hi:[1,0]
 v_pk_mul_f32 v[52:53], v[52:53], v[10:11] op_sel_hi:[1,0]
 v_pk_mul_f32 v[54:55], v[54:55], v[10:11] op_sel_hi:[1,0]
 v_cvt_pk_bf16_f32 v16, 0, v16
 v_cvt_pk_bf16_f32 v17, 0, v17
 v_cvt_pk_bf16_f32 v18, 0, v18
 v_cvt_pk_bf16_f32 v19, 0, v19
 v_cvt_pk_bf16_f32 v20, 0, v20
 v_cvt_pk_bf16_f32 v21, 0, v21
 v_cvt_pk_bf16_f32 v22, 0, v22
 v_cvt_pk_bf16_f32 v23, 0, v23
 v_cvt_pk_bf16_f32 v24, 0, v24
 v_cvt_pk_bf16_f32 v25, 0, v25
 v_cvt_pk_bf16_f32 v26, 0, v26
 v_cvt_pk_bf16_f32 v27, 0, v27
 v_cvt_pk_bf16_f32 v28, 0, v28
 v_cvt_pk_bf16_f32 v29, 0, v29
 v_cvt_pk_bf16_f32 v30, 0, v30
 v_cvt_pk_bf16_f32 v31, 0, v31
 v_cvt_pk_bf16_f32 v32, 0, v32
 v_cvt_pk_bf16_f32 v33, 0, v33
 v_cvt_pk_bf16_f32 v34, 0, v34
 v_cvt_pk_bf16_f32 v35, 0, v35
 v_cvt_pk_bf16_f32 v36, 0, v36
 v_cvt_pk_bf16_f32 v37, 0, v37
 v_cvt_pk_bf16_f32 v38, 0, v38
 v_cvt_pk_bf16_f32 v39, 0, v39
 v_cvt_pk_bf16_f32 v40, 0, v40
 v_cvt_pk_bf16_f32 v41, 0, v41
 v_cvt_pk_bf16_f32 v42, 0, v42
 v_cvt_pk_bf16_f32 v43, 0, v43
 v_cvt_pk_bf16_f32 v44, 0, v44
 v_cvt_pk_bf16_f32 v45, 0, v45
 v_cvt_pk_bf16_f32 v46, 0, v46
 v_cvt_pk_bf16_f32 v47, 0, v47
 v_cvt_pk_bf16_f32 v48, 0, v48
 v_cvt_pk_bf16_f32 v49, 0, v49
 v_cvt_pk_bf16_f32 v50, 0, v50
 v_cvt_pk_bf16_f32 v51, 0, v51
 v_cvt_pk_bf16_f32 v52, 0, v52
 v_cvt_pk_bf16_f32 v53, 0, v53
 v_cvt_pk_bf16_f32 v54, 0, v54
 v_cvt_pk_bf16_f32 v55, 0, v55
 v_pk_mul_f32 v[16:17], v[16:17], v[120:121]
 v_pk_mul_f32 v[18:19], v[18:19], v[122:123]
 v_pk_mul_f32 v[20:21], v[20:21], v[124:125]
 v_pk_mul_f32 v[22:23], v[22:23], v[126:127]
 v_pk_mul_f32 v[24:25], v[24:25], v[128:129]
 v_pk_mul_f32 v[26:27], v[26:27], v[130:131]
 v_pk_mul_f32 v[28:29], v[28:29], v[132:133]
 v_pk_mul_f32 v[30:31], v[30:31], v[134:135]
 v_pk_mul_f32 v[32:33], v[32:33], v[136:137]
 v_pk_mul_f32 v[34:35], v[34:35], v[138:139]
 v_pk_mul_f32 v[36:37], v[36:37], v[140:141]
 v_pk_mul_f32 v[38:39], v[38:39], v[142:143]
 v_pk_mul_f32 v[40:41], v[40:41], v[144:145]
 v_pk_mul_f32 v[42:43], v[42:43], v[146:147]
 v_pk_mul_f32 v[44:45], v[44:45], v[148:149]
 v_pk_mul_f32 v[46:47], v[46:47], v[150:151]
 v_pk_mul_f32 v[48:49], v[48:49], v[152:153]
 v_pk_mul_f32 v[50:51], v[50:51], v[154:155]
 v_pk_mul_f32 v[52:53], v[52:53], v[156:157]
 v_pk_mul_f32 v[54:55], v[54:55], v[158:159]
 v_cvt_pk_bf16_f32 v16, 0, v16
 v_cvt_pk_bf16_f32 v17, 0, v17
 v_cvt_pk_bf16_f32 v18, 0, v18
 v_cvt_pk_bf16_f32 v19, 0, v19
 v_cvt_pk_bf16_f32 v20, 0, v20
 v_cvt_pk_bf16_f32 v21, 0, v21
 v_cvt_pk_bf16_f32 v22, 0, v22
 v_cvt_pk_bf16_f32 v23, 0, v23
 v_cvt_pk_bf16_f32 v24, 0, v24
 v_cvt_pk_bf16_f32 v25, 0, v25
 v_cvt_pk_bf16_f32 v26, 0, v26
 v_cvt_pk_bf16_f32 v27, 0, v27
 v_cvt_pk_bf16_f32 v28, 0, v28
 v_cvt_pk_bf16_f32 v29, 0, v29
 v_cvt_pk_bf16_f32 v30, 0, v30
 v_cvt_pk_bf16_f32 v31, 0, v31
 v_cvt_pk_bf16_f32 v32, 0, v32
 v_cvt_pk_bf16_f32 v33, 0, v33
 v_cvt_pk_bf16_f32 v34, 0, v34
 v_cvt_pk_bf16_f32 v35, 0, v35
 v_cvt_pk_bf16_f32 v36, 0, v36
 v_cvt_pk_bf16_f32 v37, 0, v37
 v_cvt_pk_bf16_f32 v38, 0, v38
 v_cvt_pk_bf16_f32 v39, 0, v39
 v_cvt_pk_bf16_f32 v40, 0, v40
 v_cvt_pk_bf16_f32 v41, 0, v41
 v_cvt_pk_bf16_f32 v42, 0, v42
 v_cvt_pk_bf16_f32 v43, 0, v43
 v_cvt_pk_bf16_f32 v44, 0, v44
 v_cvt_pk_bf16_f32 v45, 0, v45
 v_cvt_pk_bf16_f32 v46, 0, v46
 v_cvt_pk_bf16_f32 v47, 0, v47
 v_cvt_pk_bf16_f32 v48, 0, v48
 v_cvt_pk_bf16_f32 v49, 0, v49
 v_cvt_pk_bf16_f32 v50, 0, v50
 v_cvt_pk_bf16_f32 v51, 0, v51
 v_cvt_pk_bf16_f32 v52, 0, v52
 v_cvt_pk_bf16_f32 v53, 0, v53
 v_cvt_pk_bf16_f32 v54, 0, v54
 v_cvt_pk_bf16_f32 v55, 0, v55
 v_pk_add_f32 v[16:17], v[16:17], v[80:81]
 v_pk_add_f32 v[18:19], v[18:19], v[82:83]
 v_pk_add_f32 v[20:21], v[20:21], v[84:85]
 v_pk_add_f32 v[22:23], v[22:23], v[86:87]
 v_pk_add_f32 v[24:25], v[24:25], v[88:89]
 v_pk_add_f32 v[26:27], v[26:27], v[90:91]
 v_pk_add_f32 v[28:29], v[28:29], v[92:93]
 v_pk_add_f32 v[30:31], v[30:31], v[94:95]
 v_pk_add_f32 v[32:33], v[32:33], v[96:97]
 v_pk_add_f32 v[34:35], v[34:35], v[98:99]
 v_pk_add_f32 v[36:37], v[36:37], v[100:101]
 v_pk_add_f32 v[38:39], v[38:39], v[102:103]
 v_pk_add_f32 v[40:41], v[40:41], v[104:105]
 v_pk_add_f32 v[42:43], v[42:43], v[106:107]
 v_pk_add_f32 v[44:45], v[44:45], v[108:109]
 v_pk_add_f32 v[46:47], v[46:47], v[110:111]
 v_pk_add_f32 v[48:49], v[48:49], v[112:113]
 v_pk_add_f32 v[50:51], v[50:51], v[114:115]
 v_pk_add_f32 v[52:53], v[52:53], v[116:117]
 v_pk_add_f32 v[54:55], v[54:55], v[118:119]
 v_cvt_pk_bf16_f32 v56, v16, v17
 v_cvt_pk_bf16_f32 v57, v18, v19
 v_cvt_pk_bf16_f32 v58, v20, v21
 v_cvt_pk_bf16_f32 v59, v22, v23
 v_cvt_pk_bf16_f32 v60, v24, v25
 v_cvt_pk_bf16_f32 v61, v26, v27
 v_cvt_pk_bf16_f32 v62, v28, v29
 v_cvt_pk_bf16_f32 v63, v30, v31
 v_cvt_pk_bf16_f32 v64, v32, v33
 v_cvt_pk_bf16_f32 v65, v34, v35
 v_cvt_pk_bf16_f32 v66, v36, v37
 v_cvt_pk_bf16_f32 v67, v38, v39
 v_cvt_pk_bf16_f32 v68, v40, v41
 v_cvt_pk_bf16_f32 v69, v42, v43
 v_cvt_pk_bf16_f32 v70, v44, v45
 v_cvt_pk_bf16_f32 v71, v46, v47
 v_cvt_pk_bf16_f32 v72, v48, v49
 v_cvt_pk_bf16_f32 v73, v50, v51
 v_cvt_pk_bf16_f32 v74, v52, v53
 v_cvt_pk_bf16_f32 v75, v54, v55
 s_add_u32 s73, s79, 0xf40000
 s_cmp_eq_u32 s81, 0
 s_cselect_b32 s73, s73, 0x40000000
 s_add_u32 s74, s73, 4096
 buffer_store_dwordx4 v[56:59], v1, s[8:11], s73 offen offset:0 sc1
 buffer_store_dwordx4 v[60:63], v1, s[8:11], s73 offen offset:1024 sc1
 buffer_store_dwordx4 v[64:67], v1, s[8:11], s73 offen offset:2048 sc1
 buffer_store_dwordx4 v[68:71], v1, s[8:11], s73 offen offset:3072 sc1
 buffer_store_dwordx4 v[72:75], v1, s[8:11], s74 offen offset:0 sc1
 v_and_b32 v55, 0xffff0000, v75
 v_lshlrev_b32 v54, 16, v75
 v_and_b32 v53, 0xffff0000, v74
 v_lshlrev_b32 v52, 16, v74
 v_and_b32 v51, 0xffff0000, v73
 v_lshlrev_b32 v50, 16, v73
 v_and_b32 v49, 0xffff0000, v72
 v_lshlrev_b32 v48, 16, v72
 v_and_b32 v47, 0xffff0000, v71
 v_lshlrev_b32 v46, 16, v71
 v_and_b32 v45, 0xffff0000, v70
 v_lshlrev_b32 v44, 16, v70
 v_and_b32 v43, 0xffff0000, v69
 v_lshlrev_b32 v42, 16, v69
 v_and_b32 v41, 0xffff0000, v68
 v_lshlrev_b32 v40, 16, v68
 v_and_b32 v39, 0xffff0000, v67
 v_lshlrev_b32 v38, 16, v67
 v_and_b32 v37, 0xffff0000, v66
 v_lshlrev_b32 v36, 16, v66
 v_and_b32 v35, 0xffff0000, v65
 v_lshlrev_b32 v34, 16, v65
 v_and_b32 v33, 0xffff0000, v64
 v_lshlrev_b32 v32, 16, v64
 v_and_b32 v31, 0xffff0000, v63
 v_lshlrev_b32 v30, 16, v63
 v_and_b32 v29, 0xffff0000, v62
 v_lshlrev_b32 v28, 16, v62
 v_and_b32 v27, 0xffff0000, v61
 v_lshlrev_b32 v26, 16, v61
 v_and_b32 v25, 0xffff0000, v60
 v_lshlrev_b32 v24, 16, v60
 v_and_b32 v23, 0xffff0000, v59
 v_lshlrev_b32 v22, 16, v59
 v_and_b32 v21, 0xffff0000, v58
 v_lshlrev_b32 v20, 16, v58
 v_and_b32 v19, 0xffff0000, v57
 v_lshlrev_b32 v18, 16, v57
 v_and_b32 v17, 0xffff0000, v56
 v_lshlrev_b32 v16, 16, v56
 v_pk_add_f32 v[10:11], v[16:17], v[18:19]
 v_pk_add_f32 v[10:11], v[10:11], v[20:21]
 v_pk_add_f32 v[10:11], v[10:11], v[22:23]
 v_pk_add_f32 v[10:11], v[10:11], v[24:25]
 v_pk_add_f32 v[10:11], v[10:11], v[26:27]
 v_pk_add_f32 v[10:11], v[10:11], v[28:29]
 v_pk_add_f32 v[10:11], v[10:11], v[30:31]
 v_pk_add_f32 v[10:11], v[10:11], v[32:33]
 v_pk_add_f32 v[10:11], v[10:11], v[34:35]
 v_pk_add_f32 v[10:11], v[10:11], v[36:37]
 v_pk_add_f32 v[10:11], v[10:11], v[38:39]
 v_pk_add_f32 v[10:11], v[10:11], v[40:41]
 v_pk_add_f32 v[10:11], v[10:11], v[42:43]
 v_pk_add_f32 v[10:11], v[10:11], v[44:45]
 v_pk_add_f32 v[10:11], v[10:11], v[46:47]
 v_pk_add_f32 v[10:11], v[10:11], v[48:49]
 v_pk_add_f32 v[10:11], v[10:11], v[50:51]
 v_pk_add_f32 v[10:11], v[10:11], v[52:53]
 v_pk_add_f32 v[10:11], v[10:11], v[54:55]
 v_add_f32 v10, v10, v11
 v_mov_b32 v11, v10
 s_nop 1
 v_permlane16_swap_b32 v10, v11
 v_add_f32 v10, v10, v11
 v_mov_b32 v11, v10
 s_nop 1
 v_permlane32_swap_b32 v10, v11
 v_add_f32 v10, v10, v11
 ds_write_b32 v6, v10 offset:0
 s_waitcnt lgkmcnt(0)
 s_barrier
 ds_read_b128 v[10:13], v7 offset:0
 s_waitcnt lgkmcnt(0)
 v_pk_add_f32 v[10:11], v[10:11], v[12:13]
 v_add_f32 v10, v10, v11
 v_mul_f32 v10, 0x3acccccd, v10
 v_mov_b32 v8, v10
 v_pk_add_f32 v[12:13], v[16:17], v[8:9] op_sel_hi:[1,0] neg_lo:[0,1] neg_hi:[0,1]
 v_pk_mul_f32 v[10:11], v[12:13], v[12:13]
 v_pk_add_f32 v[12:13], v[18:19], v[8:9] op_sel_hi:[1,0] neg_lo:[0,1] neg_hi:[0,1]
 v_pk_fma_f32 v[10:11], v[12:13], v[12:13], v[10:11]
 v_pk_add_f32 v[12:13], v[20:21], v[8:9] op_sel_hi:[1,0] neg_lo:[0,1] neg_hi:[0,1]
 v_pk_fma_f32 v[10:11], v[12:13], v[12:13], v[10:11]
 v_pk_add_f32 v[12:13], v[22:23], v[8:9] op_sel_hi:[1,0] neg_lo:[0,1] neg_hi:[0,1]
 v_pk_fma_f32 v[10:11], v[12:13], v[12:13], v[10:11]
 v_pk_add_f32 v[12:13], v[24:25], v[8:9] op_sel_hi:[1,0] neg_lo:[0,1] neg_hi:[0,1]
 v_pk_fma_f32 v[10:11], v[12:13], v[12:13], v[10:11]
 v_pk_add_f32 v[12:13], v[26:27], v[8:9] op_sel_hi:[1,0] neg_lo:[0,1] neg_hi:[0,1]
 v_pk_fma_f32 v[10:11], v[12:13], v[12:13], v[10:11]
 v_pk_add_f32 v[12:13], v[28:29], v[8:9] op_sel_hi:[1,0] neg_lo:[0,1] neg_hi:[0,1]
 v_pk_fma_f32 v[10:11], v[12:13], v[12:13], v[10:11]
 v_pk_add_f32 v[12:13], v[30:31], v[8:9] op_sel_hi:[1,0] neg_lo:[0,1] neg_hi:[0,1]
 v_pk_fma_f32 v[10:11], v[12:13], v[12:13], v[10:11]
 v_pk_add_f32 v[12:13], v[32:33], v[8:9] op_sel_hi:[1,0] neg_lo:[0,1] neg_hi:[0,1]
 v_pk_fma_f32 v[10:11], v[12:13], v[12:13], v[10:11]
 v_pk_add_f32 v[12:13], v[34:35], v[8:9] op_sel_hi:[1,0] neg_lo:[0,1] neg_hi:[0,1]
 v_pk_fma_f32 v[10:11], v[12:13], v[12:13], v[10:11]
 v_pk_add_f32 v[12:13], v[36:37], v[8:9] op_sel_hi:[1,0] neg_lo:[0,1] neg_hi:[0,1]
 v_pk_fma_f32 v[10:11], v[12:13], v[12:13], v[10:11]
 v_pk_add_f32 v[12:13], v[38:39], v[8:9] op_sel_hi:[1,0] neg_lo:[0,1] neg_hi:[0,1]
 v_pk_fma_f32 v[10:11], v[12:13], v[12:13], v[10:11]
 v_pk_add_f32 v[12:13], v[40:41], v[8:9] op_sel_hi:[1,0] neg_lo:[0,1] neg_hi:[0,1]
 v_pk_fma_f32 v[10:11], v[12:13], v[12:13], v[10:11]
 v_pk_add_f32 v[12:13], v[42:43], v[8:9] op_sel_hi:[1,0] neg_lo:[0,1] neg_hi:[0,1]
 v_pk_fma_f32 v[10:11], v[12:13], v[12:13], v[10:11]
 v_pk_add_f32 v[12:13], v[44:45], v[8:9] op_sel_hi:[1,0] neg_lo:[0,1] neg_hi:[0,1]
 v_pk_fma_f32 v[10:11], v[12:13], v[12:13], v[10:11]
 v_pk_add_f32 v[12:13], v[46:47], v[8:9] op_sel_hi:[1,0] neg_lo:[0,1] neg_hi:[0,1]
 v_pk_fma_f32 v[10:11], v[12:13], v[12:13], v[10:11]
 v_pk_add_f32 v[12:13], v[48:49], v[8:9] op_sel_hi:[1,0] neg_lo:[0,1] neg_hi:[0,1]
 v_pk_fma_f32 v[10:11], v[12:13], v[12:13], v[10:11]
 v_pk_add_f32 v[12:13], v[50:51], v[8:9] op_sel_hi:[1,0] neg_lo:[0,1] neg_hi:[0,1]
 v_pk_fma_f32 v[10:11], v[12:13], v[12:13], v[10:11]
 v_pk_add_f32 v[12:13], v[52:53], v[8:9] op_sel_hi:[1,0] neg_lo:[0,1] neg_hi:[0,1]
 v_pk_fma_f32 v[10:11], v[12:13], v[12:13], v[10:11]
 v_pk_add_f32 v[12:13], v[54:55], v[8:9] op_sel_hi:[1,0] neg_lo:[0,1] neg_hi:[0,1]
 v_pk_fma_f32 v[10:11], v[12:13], v[12:13], v[10:11]
 v_add_f32 v10, v10, v11
 v_mov_b32 v11, v10
 s_nop 1
 v_permlane16_swap_b32 v10, v11
 v_add_f32 v10, v10, v11
 v_mov_b32 v11, v10
 s_nop 1
 v_permlane32_swap_b32 v10, v11
 v_add_f32 v10, v10, v11
 ds_write_b32 v6, v10 offset:256
 s_waitcnt lgkmcnt(0)
 s_barrier
 ds_read_b128 v[10:13], v7 offset:256
 s_waitcnt lgkmcnt(0)
 v_pk_add_f32 v[10:11], v[10:11], v[12:13]
 v_add_f32 v10, v10, v11
 v_mul_f32 v10, 0x3acccccd, v10
 v_cvt_pk_bf16_f32 v10, 0, v10
 v_add_f32 v10, 0x3727c5ac, v10
 v_cvt_pk_bf16_f32 v10, 0, v10
 v_sqrt_f32 v10, v10
 v_cvt_pk_bf16_f32 v8, 0, v8
 v_cvt_pk_bf16_f32 v10, 0, v10
 v_rcp_f32 v10, v10
 v_pk_add_f32 v[16:17], v[16:17], v[8:9] op_sel_hi:[1,0] neg_lo:[0,1] neg_hi:[0,1]
 v_pk_add_f32 v[18:19], v[18:19], v[8:9] op_sel_hi:[1,0] neg_lo:[0,1] neg_hi:[0,1]
 v_pk_add_f32 v[20:21], v[20:21], v[8:9] op_sel_hi:[1,0] neg_lo:[0,1] neg_hi:[0,1]
 v_pk_add_f32 v[22:23], v[22:23], v[8:9] op_sel_hi:[1,0] neg_lo:[0,1] neg_hi:[0,1]
 v_pk_add_f32 v[24:25], v[24:25], v[8:9] op_sel_hi:[1,0] neg_lo:[0,1] neg_hi:[0,1]
 v_pk_add_f32 v[26:27], v[26:27], v[8:9] op_sel_hi:[1,0] neg_lo:[0,1] neg_hi:[0,1]
 v_pk_add_f32 v[28:29], v[28:29], v[8:9] op_sel_hi:[1,0] neg_lo:[0,1] neg_hi:[0,1]
 v_pk_add_f32 v[30:31], v[30:31], v[8:9] op_sel_hi:[1,0] neg_lo:[0,1] neg_hi:[0,1]
 v_pk_add_f32 v[32:33], v[32:33], v[8:9] op_sel_hi:[1,0] neg_lo:[0,1] neg_hi:[0,1]
 v_pk_add_f32 v[34:35], v[34:35], v[8:9] op_sel_hi:[1,0] neg_lo:[0,1] neg_hi:[0,1]
 v_pk_add_f32 v[36:37], v[36:37], v[8:9] op_sel_hi:[1,0] neg_lo:[0,1] neg_hi:[0,1]
 v_pk_add_f32 v[38:39], v[38:39], v[8:9] op_sel_hi:[1,0] neg_lo:[0,1] neg_hi:[0,1]
 v_pk_add_f32 v[40:41], v[40:41], v[8:9] op_sel_hi:[1,0] neg_lo:[0,1] neg_hi:[0,1]
 v_pk_add_f32 v[42:43], v[42:43], v[8:9] op_sel_hi:[1,0] neg_lo:[0,1] neg_hi:[0,1]
 v_pk_add_f32 v[44:45], v[44:45], v[8:9] op_sel_hi:[1,0] neg_lo:[0,1] neg_hi:[0,1]
 v_pk_add_f32 v[46:47], v[46:47], v[8:9] op_sel_hi:[1,0] neg_lo:[0,1] neg_hi:[0,1]
 v_pk_add_f32 v[48:49], v[48:49], v[8:9] op_sel_hi:[1,0] neg_lo:[0,1] neg_hi:[0,1]
 v_pk_add_f32 v[50:51], v[50:51], v[8:9] op_sel_hi:[1,0] neg_lo:[0,1] neg_hi:[0,1]
 v_pk_add_f32 v[52:53], v[52:53], v[8:9] op_sel_hi:[1,0] neg_lo:[0,1] neg_hi:[0,1]
 v_pk_add_f32 v[54:55], v[54:55], v[8:9] op_sel_hi:[1,0] neg_lo:[0,1] neg_hi:[0,1]
 v_cvt_pk_bf16_f32 v16, 0, v16
 v_cvt_pk_bf16_f32 v17, 0, v17
 v_cvt_pk_bf16_f32 v18, 0, v18
 v_cvt_pk_bf16_f32 v19, 0, v19
 v_cvt_pk_bf16_f32 v20, 0, v20
 v_cvt_pk_bf16_f32 v21, 0, v21
 v_cvt_pk_bf16_f32 v22, 0, v22
 v_cvt_pk_bf16_f32 v23, 0, v23
 v_cvt_pk_bf16_f32 v24, 0, v24
 v_cvt_pk_bf16_f32 v25, 0, v25
 v_cvt_pk_bf16_f32 v26, 0, v26
 v_cvt_pk_bf16_f32 v27, 0, v27
 v_cvt_pk_bf16_f32 v28, 0, v28
 v_cvt_pk_bf16_f32 v29, 0, v29
 v_cvt_pk_bf16_f32 v30, 0, v30
 v_cvt_pk_bf16_f32 v31, 0, v31
 v_cvt_pk_bf16_f32 v32, 0, v32
 v_cvt_pk_bf16_f32 v33, 0, v33
 v_cvt_pk_bf16_f32 v34, 0, v34
 v_cvt_pk_bf16_f32 v35, 0, v35
 v_cvt_pk_bf16_f32 v36, 0, v36
 v_cvt_pk_bf16_f32 v37, 0, v37
 v_cvt_pk_bf16_f32 v38, 0, v38
 v_cvt_pk_bf16_f32 v39, 0, v39
 v_cvt_pk_bf16_f32 v40, 0, v40
 v_cvt_pk_bf16_f32 v41, 0, v41
 v_cvt_pk_bf16_f32 v42, 0, v42
 v_cvt_pk_bf16_f32 v43, 0, v43
 v_cvt_pk_bf16_f32 v44, 0, v44
 v_cvt_pk_bf16_f32 v45, 0, v45
 v_cvt_pk_bf16_f32 v46, 0, v46
 v_cvt_pk_bf16_f32 v47, 0, v47
 v_cvt_pk_bf16_f32 v48, 0, v48
 v_cvt_pk_bf16_f32 v49, 0, v49
 v_cvt_pk_bf16_f32 v50, 0, v50
 v_cvt_pk_bf16_f32 v51, 0, v51
 v_cvt_pk_bf16_f32 v52, 0, v52
 v_cvt_pk_bf16_f32 v53, 0, v53
 v_cvt_pk_bf16_f32 v54, 0, v54
 v_cvt_pk_bf16_f32 v55, 0, v55
 v_pk_mul_f32 v[16:17], v[16:17], v[10:11] op_sel_hi:[1,0]
 v_pk_mul_f32 v[18:19], v[18:19], v[10:11] op_sel_hi:[1,0]
 v_pk_mul_f32 v[20:21], v[20:21], v[10:11] op_sel_hi:[1,0]
 v_pk_mul_f32 v[22:23], v[22:23], v[10:11] op_sel_hi:[1,0]
 v_pk_mul_f32 v[24:25], v[24:25], v[10:11] op_sel_hi:[1,0]
 v_pk_mul_f32 v[26:27], v[26:27], v[10:11] op_sel_hi:[1,0]
 v_pk_mul_f32 v[28:29], v[28:29], v[10:11] op_sel_hi:[1,0]
 v_pk_mul_f32 v[30:31], v[30:31], v[10:11] op_sel_hi:[1,0]
 v_pk_mul_f32 v[32:33], v[32:33], v[10:11] op_sel_hi:[1,0]
 v_pk_mul_f32 v[34:35], v[34:35], v[10:11] op_sel_hi:[1,0]
 v_pk_mul_f32 v[36:37], v[36:37], v[10:11] op_sel_hi:[1,0]
 v_pk_mul_f32 v[38:39], v[38:39], v[10:11] op_sel_hi:[1,0]
 v_pk_mul_f32 v[40:41], v[40:41], v[10:11] op_sel_hi:[1,0]
 v_pk_mul_f32 v[42:43], v[42:43], v[10:11] op_sel_hi:[1,0]
 v_pk_mul_f32 v[44:45], v[44:45], v[10:11] op_sel_hi:[1,0]
 v_pk_mul_f32 v[46:47], v[46:47], v[10:11] op_sel_hi:[1,0]
 v_pk_mul_f32 v[48:49], v[48:49], v[10:11] op_sel_hi:[1,0]
 v_pk_mul_f32 v[50:51], v[50:51], v[10:11] op_sel_hi:[1,0]
 v_pk_mul_f32 v[52:53], v[52:53], v[10:11] op_sel_hi:[1,0]
 v_pk_mul_f32 v[54:55], v[54:55], v[10:11] op_sel_hi:[1,0]
 v_cvt_pk_bf16_f32 v56, v16, v17
 v_cvt_pk_bf16_f32 v57, v18, v19
 v_cvt_pk_bf16_f32 v58, v20, v21
 v_cvt_pk_bf16_f32 v59, v22, v23
 v_cvt_pk_bf16_f32 v60, v24, v25
 v_cvt_pk_bf16_f32 v61, v26, v27
 v_cvt_pk_bf16_f32 v62, v28, v29
 v_cvt_pk_bf16_f32 v63, v30, v31
 v_cvt_pk_bf16_f32 v64, v32, v33
 v_cvt_pk_bf16_f32 v65, v34, v35
 v_cvt_pk_bf16_f32 v66, v36, v37
 v_cvt_pk_bf16_f32 v67, v38, v39
 v_cvt_pk_bf16_f32 v68, v40, v41
 v_cvt_pk_bf16_f32 v69, v42, v43
 v_cvt_pk_bf16_f32 v70, v44, v45
 v_cvt_pk_bf16_f32 v71, v46, v47
 v_cvt_pk_bf16_f32 v72, v48, v49
 v_cvt_pk_bf16_f32 v73, v50, v51
 v_cvt_pk_bf16_f32 v74, v52, v53
 v_cvt_pk_bf16_f32 v75, v54, v55
 ds_write_b128 v77, v[56:59] offset:0
 ds_write_b128 v77, v[60:63] offset:1024
 ds_write_b128 v77, v[64:67] offset:2048
 ds_write_b128 v77, v[68:71] offset:3072
 ds_write_b128 v77, v[72:75] offset:4096
 s_waitcnt lgkmcnt(0)
 s_barrier
 ds_read_b128 v[160:163], v1 offset:1024
 ds_read_b128 v[164:167], v1 offset:2048
 s_waitcnt lgkmcnt(1)
 v_mfma_f32_16x16x32_bf16 v[172:175], a[96:99], v[160:163], 0
 ds_read_b128 v[168:171], v1 offset:3072
 v_mfma_f32_16x16x32_bf16 v[176:179], a[100:103], v[160:163], 0
 s_waitcnt lgkmcnt(1)
 v_mfma_f32_16x16x32_bf16 v[172:175], a[104:107], v[164:167], v[172:175]
 ds_read_b128 v[160:163], v1 offset:4096
 v_mfma_f32_16x16x32_bf16 v[176:179], a[108:111], v[164:167], v[176:179]
 s_waitcnt lgkmcnt(1)
 v_mfma_f32_16x16x32_bf16 v[172:175], a[112:115], v[168:171], v[172:175]
 ds_read_b128 v[164:167], v1 offset:5120
 v_mfma_f32_16x16x32_bf16 v[176:179], a[116:119], v[168:171], v[176:179]
 s_waitcnt lgkmcnt(1)
 v_mfma_f32_16x16x32_bf16 v[172:175], a[120:123], v[160:163], v[172:175]
 ds_read_b128 v[168:171], v1 offset:6144
 v_mfma_f32_16x16x32_bf16 v[176:179], a[124:127], v[160:163], v[176:179]
 s_waitcnt lgkmcnt(1)
 v_mfma_f32_16x16x32_bf16 v[172:175], a[128:131], v[164:167], v[172:175]
 ds_read_b128 v[160:163], v1 offset:7168
 v_mfma_f32_16x16x32_bf16 v[176:179], a[132:135], v[164:167], v[176:179]
 s_waitcnt lgkmcnt(1)
 v_mfma_f32_16x16x32_bf16 v[172:175], a[136:139], v[168:171], v[172:175]
 ds_read_b128 v[164:167], v1 offset:8192
 v_mfma_f32_16x16x32_bf16 v[176:179], a[140:143], v[168:171], v[176:179]
 s_waitcnt lgkmcnt(1)
 v_mfma_f32_16x16x32_bf16 v[172:175], a[144:147], v[160:163], v[172:175]
 ds_read_b128 v[168:171], v1 offset:9216
 v_mfma_f32_16x16x32_bf16 v[176:179], a[148:151], v[160:163], v[176:179]
 s_waitcnt lgkmcnt(1)
 v_mfma_f32_16x16x32_bf16 v[172:175], a[152:155], v[164:167], v[172:175]
 ds_read_b128 v[160:163], v1 offset:10240
 v_mfma_f32_16x16x32_bf16 v[176:179], a[156:159], v[164:167], v[176:179]
 s_waitcnt lgkmcnt(1)
 v_mfma_f32_16x16x32_bf16 v[172:175], a[160:163], v[168:171], v[172:175]
 ds_read_b128 v[164:167], v1 offset:11264
 v_mfma_f32_16x16x32_bf16 v[176:179], a[164:167], v[168:171], v[176:179]
 s_waitcnt lgkmcnt(1)
 v_mfma_f32_16x16x32_bf16 v[172:175], a[168:171], v[160:163], v[172:175]
 ds_read_b128 v[168:171], v1 offset:12288
 v_mfma_f32_16x16x32_bf16 v[176:179], a[172:175], v[160:163], v[176:179]
 s_waitcnt lgkmcnt(1)
 v_mfma_f32_16x16x32_bf16 v[172:175], a[176:179], v[164:167], v[172:175]
 ds_read_b128 v[160:163], v1 offset:13312
 v_mfma_f32_16x16x32_bf16 v[176:179], a[180:183], v[164:167], v[176:179]
 s_waitcnt lgkmcnt(1)
 v_mfma_f32_16x16x32_bf16 v[172:175], a[184:187], v[168:171], v[172:175]
 ds_read_b128 v[164:167], v1 offset:14336
 v_mfma_f32_16x16x32_bf16 v[176:179], a[188:191], v[168:171], v[176:179]
 s_waitcnt lgkmcnt(1)
 v_mfma_f32_16x16x32_bf16 v[172:175], a[192:195], v[160:163], v[172:175]
 ds_read_b128 v[168:171], v1 offset:15360
 v_mfma_f32_16x16x32_bf16 v[176:179], a[196:199], v[160:163], v[176:179]
 s_waitcnt lgkmcnt(1)
 v_mfma_f32_16x16x32_bf16 v[172:175], a[200:203], v[164:167], v[172:175]
 ds_read_b128 v[160:163], v1 offset:16384
 v_mfma_f32_16x16x32_bf16 v[176:179], a[204:207], v[164:167], v[176:179]
 s_waitcnt lgkmcnt(1)
 v_mfma_f32_16x16x32_bf16 v[172:175], a[208:211], v[168:171], v[172:175]
 ds_read_b128 v[164:167], v1 offset:17408
 v_mfma_f32_16x16x32_bf16 v[176:179], a[212:215], v[168:171], v[176:179]
 s_waitcnt lgkmcnt(1)
 v_mfma_f32_16x16x32_bf16 v[172:175], a[216:219], v[160:163], v[172:175]
 ds_read_b128 v[168:171], v1 offset:18432
 v_mfma_f32_16x16x32_bf16 v[176:179], a[220:223], v[160:163], v[176:179]
 s_waitcnt lgkmcnt(1)
 v_mfma_f32_16x16x32_bf16 v[172:175], a[224:227], v[164:167], v[172:175]
 ds_read_b128 v[160:163], v1 offset:19456
 v_mfma_f32_16x16x32_bf16 v[176:179], a[228:231], v[164:167], v[176:179]
 s_waitcnt lgkmcnt(1)
 v_mfma_f32_16x16x32_bf16 v[172:175], a[232:235], v[168:171], v[172:175]
 ds_read_b128 v[164:167], v1 offset:20480
 v_mfma_f32_16x16x32_bf16 v[176:179], a[236:239], v[168:171], v[176:179]
 s_waitcnt lgkmcnt(1)
 v_mfma_f32_16x16x32_bf16 v[172:175], a[240:243], v[160:163], v[172:175]
 v_mfma_f32_16x16x32_bf16 v[176:179], a[244:247], v[160:163], v[176:179]
 s_waitcnt lgkmcnt(0)
 v_mfma_f32_16x16x32_bf16 v[172:175], a[248:251], v[164:167], v[172:175]
 v_mfma_f32_16x16x32_bf16 v[176:179], a[252:255], v[164:167], v[176:179]
 s_mov_b32 s84, 0xbdd2d3e8
 v_mov_b32 v188, 0xc0135761
 s_nop 1
 v_cvt_pk_bf16_f32 v172, 0, v172
 v_cvt_pk_bf16_f32 v173, 0, v173
 v_cvt_pk_bf16_f32 v174, 0, v174
 v_cvt_pk_bf16_f32 v175, 0, v175
 v_cvt_pk_bf16_f32 v176, 0, v176
 v_cvt_pk_bf16_f32 v177, 0, v177
 v_cvt_pk_bf16_f32 v178, 0, v178
 v_cvt_pk_bf16_f32 v179, 0, v179
 v_mul_f32 v180, v172, v172
 v_mul_f32 v181, v173, v173
 v_mul_f32 v182, v174, v174
 v_mul_f32 v183, v175, v175
 v_mul_f32 v184, v176, v176
 v_mul_f32 v185, v177, v177
 v_mul_f32 v186, v178, v178
 v_mul_f32 v187, v179, v179
 v_fma_f32 v180, v180, s84, v188
 v_fma_f32 v181, v181, s84, v188
 v_fma_f32 v182, v182, s84, v188
 v_fma_f32 v183, v183, s84, v188
 v_fma_f32 v184, v184, s84, v188
 v_fma_f32 v185, v185, s84, v188
 v_fma_f32 v186, v186, s84, v188
 v_fma_f32 v187, v187, s84, v188
 v_mul_f32 v180, v180, v172
 v_mul_f32 v181, v181, v173
 v_mul_f32 v182, v182, v174
 v_mul_f32 v183, v183, v175
 v_mul_f32 v184, v184, v176
 v_mul_f32 v185, v185, v177
 v_mul_f32 v186, v186, v178
 v_mul_f32 v187, v187, v179
 v_exp_f32 v180, v180
 v_exp_f32 v181, v181
 v_exp_f32 v182, v182
 v_exp_f32 v183, v183
 v_exp_f32 v184, v184
 v_exp_f32 v185, v185
 v_exp_f32 v186, v186
 v_exp_f32 v187, v187
 v_add_f32 v180, 1.0, v180
 v_add_f32 v181, 1.0, v181
 v_add_f32 v182, 1.0, v182
 v_add_f32 v183, 1.0, v183
 v_add_f32 v184, 1.0, v184
 v_add_f32 v185, 1.0, v185
 v_add_f32 v186, 1.0, v186
 v_add_f32 v187, 1.0, v187
 v_rcp_f32 v180, v180
 v_rcp_f32 v181, v181
 v_rcp_f32 v182, v182
 v_rcp_f32 v183, v183
 v_rcp_f32 v184, v184
 v_rcp_f32 v185, v185
 v_rcp_f32 v186, v186
 v_rcp_f32 v187, v187
 v_mul_f32 v172, v172, v180
 v_mul_f32 v173, v173, v181
 v_mul_f32 v174, v174, v182
 v_mul_f32 v175, v175, v183
 v_mul_f32 v176, v176, v184
 v_mul_f32 v177, v177, v185
 v_mul_f32 v178, v178, v186
 v_mul_f32 v179, v179, v187
 v_cvt_pk_bf16_f32 v192, v172, v173
 v_cvt_pk_bf16_f32 v193, v174, v175
 v_cvt_pk_bf16_f32 v194, v176, v177
 v_cvt_pk_bf16_f32 v195, v178, v179
 s_add_u32 s78, s78, 0x1440000
 s_add_u32 s73, s77, s78
 buffer_store_dwordx4 v[192:195], v1, s[8:11], s73 offen sc1
 s_add_u32 s3, s82, 1
 s_add_u32 s82, s82, s100
 s_cmp_lt_u32 s82, 128
 s_cbranch_scc1 t3_loop
 s_waitcnt vmcnt(0)
 s_barrier
 s_cmp_lg_u32 s66, 0
 s_cbranch_scc1 notw0_96
 v_mov_b32 v4, s3
 v_mov_b32 v5, 0
 s_mov_b64 exec, 1
 buffer_store_dword v4, v5, s[8:11], s4 offen sc1
 s_mov_b64 exec, -1
notw0_96:
 s_waitcnt vmcnt(0)
 s_endpgm
t4:
 s_mov_b32 s12, s50
 s_and_b32 s13, s51, 0xffff
 s_mov_b32 s14, 0xc8000
 s_mov_b32 s15, 0x20000
 s_mov_b32 s82, s80
 s_min_u32 s80, s80, 3
 s_lshl_b32 s75, s81, 8
 s_add_u32 s75, s75, 0
 s_lshl_b32 s73, s66, 2
 v_lshrrev_b32 v7, 4, v0
 v_add_u32 v4, s73, v7
 v_and_b32 v5, 15, v0
 s_mov_b32 s73, 1280
 v_mul_lo_u32 v6, v4, s73
 v_lshl_add_u32 v6, v5, 4, v6
 v_lshlrev_b32 v7, 2, v7
 v_xor_b32 v7, v7, v5
 v_lshlrev_b32 v7, 4, v7
 v_lshl_add_u32 v7, v4, 8, v7
 s_add_u32 s73, s75, 0
 buffer_load_dwordx4 v[16:19], v6, s[12:15], s73 offen
 s_add_u32 s73, s75, 20480
 buffer_load_dwordx4 v[20:23], v6, s[12:15], s73 offen
 s_add_u32 s73, s75, 40960
 buffer_load_dwordx4 v[24:27], v6, s[12:15], s73 offen
 s_add_u32 s73, s75, 61440
 buffer_load_dwordx4 v[28:31], v6, s[12:15], s73 offen
 s_add_u32 s73, s75, 81920
 buffer_load_dwordx4 v[32:35], v6, s[12:15], s73 offen
 s_add_u32 s73, s75, 102400
 buffer_load_dwordx4 v[36:39], v6, s[12:15], s73 offen
 s_add_u32 s73, s75, 122880
 buffer_load_dwordx4 v[40:43], v6, s[12:15], s73 offen
 s_add_u32 s73, s75, 143360
 buffer_load_dwordx4 v[44:47], v6, s[12:15], s73 offen
 s_add_u32 s73, s75, 163840
 buffer_load_dwordx4 v[48:51], v6, s[12:15], s73 offen
 s_add_u32 s73, s75, 184320
 buffer_load_dwordx4 v[52:55], v6, s[12:15], s73 offen
 s_add_u32 s73, s75, 204800
 buffer_load_dwordx4 v[56:59], v6, s[12:15], s73 offen
 s_add_u32 s73, s75, 225280
 buffer_load_dwordx4 v[60:63], v6, s[12:15], s73 offen
 s_add_u32 s73, s75, 245760
 buffer_load_dwordx4 v[64:67], v6, s[12:15], s73 offen
 s_add_u32 s73, s75, 266240
 buffer_load_dwordx4 v[68:71], v6, s[12:15], s73 offen
 s_add_u32 s73, s75, 286720
 buffer_load_dwordx4 v[72:75], v6, s[12:15], s73 offen
 s_add_u32 s73, s75, 307200
 buffer_load_dwordx4 v[76:79], v6, s[12:15], s73 offen
 s_add_u32 s73, s75, 327680
 buffer_load_dwordx4 v[80:83], v6, s[12:15], s73 offen
 s_add_u32 s73, s75, 348160
 buffer_load_dwordx4 v[84:87], v6, s[12:15], s73 offen
 s_add_u32 s73, s75, 368640
 buffer_load_dwordx4 v[88:91], v6, s[12:15], s73 offen
 s_add_u32 s73, s75, 389120
 buffer_load_dwordx4 v[92:95], v6, s[12:15], s73 offen
 s_add_u32 s73, s75, 409600
 buffer_load_dwordx4 v[96:99], v6, s[12:15], s73 offen
 s_add_u32 s73, s75, 430080
 buffer_load_dwordx4 v[100:103], v6, s[12:15], s73 offen
 s_add_u32 s73, s75, 450560
 buffer_load_dwordx4 v[104:107], v6, s[12:15], s73 offen
 s_add_u32 s73, s75, 471040
 buffer_load_dwordx4 v[108:111], v6, s[12:15], s73 offen
 s_add_u32 s73, s75, 491520
 buffer_load_dwordx4 v[112:115], v6, s[12:15], s73 offen
 s_add_u32 s73, s75, 512000
 buffer_load_dwordx4 v[116:119], v6, s[12:15], s73 offen
 s_add_u32 s73, s75, 532480
 buffer_load_dwordx4 v[120:123], v6, s[12:15], s73 offen
 s_add_u32 s73, s75, 552960
 buffer_load_dwordx4 v[124:127], v6, s[12:15], s73 offen
 s_add_u32 s73, s75, 573440
 buffer_load_dwordx4 v[128:131], v6, s[12:15], s73 offen
 s_add_u32 s73, s75, 593920
 buffer_load_dwordx4 v[132:135], v6, s[12:15], s73 offen
 s_add_u32 s73, s75, 614400
 buffer_load_dwordx4 v[136:139], v6, s[12:15], s73 offen
 s_add_u32 s73, s75, 634880
 buffer_load_dwordx4 v[140:143], v6, s[12:15], s73 offen
 s_add_u32 s73, s75, 655360
 buffer_load_dwordx4 v[144:147], v6, s[12:15], s73 offen
 s_add_u32 s73, s75, 675840
 buffer_load_dwordx4 v[148:151], v6, s[12:15], s73 offen
 s_add_u32 s73, s75, 696320
 buffer_load_dwordx4 v[152:155], v6, s[12:15], s73 offen
 s_add_u32 s73, s75, 716800
 buffer_load_dwordx4 v[156:159], v6, s[12:15], s73 offen
 s_add_u32 s73, s75, 737280
 buffer_load_dwordx4 v[160:163], v6, s[12:15], s73 offen
 s_add_u32 s73, s75, 757760
 buffer_load_dwordx4 v[164:167], v6, s[12:15], s73 offen
 s_add_u32 s73, s75, 778240
 buffer_load_dwordx4 v[168:171], v6, s[12:15], s73 offen
 s_add_u32 s73, s75, 798720
 buffer_load_dwordx4 v[172:175], v6, s[12:15], s73 offen
 s_waitcnt vmcnt(39)
 ds_write_b128 v7, v[16:19] offset:0
 s_waitcnt vmcnt(38)
 ds_write_b128 v7, v[20:23] offset:4096
 s_waitcnt vmcnt(37)
 ds_write_b128 v7, v[24:27] offset:8192
 s_waitcnt vmcnt(36)
 ds_write_b128 v7, v[28:31] offset:12288
 s_waitcnt vmcnt(35)
 ds_write_b128 v7, v[32:35] offset:16384
 s_waitcnt vmcnt(34)
 ds_write_b128 v7, v[36:39] offset:20480
 s_waitcnt vmcnt(33)
 ds_write_b128 v7, v[40:43] offset:24576
 s_waitcnt vmcnt(32)
 ds_write_b128 v7, v[44:47] offset:28672
 s_waitcnt vmcnt(31)
 ds_write_b128 v7, v[48:51] offset:32768
 s_waitcnt vmcnt(30)
 ds_write_b128 v7, v[52:55] offset:36864
 s_waitcnt vmcnt(29)
 ds_write_b128 v7, v[56:59] offset:40960
 s_waitcnt vmcnt(28)
 ds_write_b128 v7, v[60:63] offset:45056
 s_waitcnt vmcnt(27)
 ds_write_b128 v7, v[64:67] offset:49152
 s_waitcnt vmcnt(26)
 ds_write_b128 v7, v[68:71] offset:53248
 s_waitcnt vmcnt(25)
 ds_write_b128 v7, v[72:75] offset:57344
 s_waitcnt vmcnt(24)
 ds_write_b128 v7, v[76:79] offset:61440
 v_add_u32 v7, 0x10000, v7
 s_waitcnt vmcnt(23)
 ds_write_b128 v7, v[80:83] offset:0
 s_waitcnt vmcnt(22)
 ds_write_b128 v7, v[84:87] offset:4096
 s_waitcnt vmcnt(21)
 ds_write_b128 v7, v[88:91] offset:8192
 s_waitcnt vmcnt(20)
 ds_write_b128 v7, v[92:95] offset:12288
 s_waitcnt vmcnt(19)
 ds_write_b128 v7, v[96:99] offset:16384
 s_waitcnt vmcnt(18)
 ds_write_b128 v7, v[100:103] offset:20480
 s_waitcnt vmcnt(17)
 ds_write_b128 v7, v[104:107] offset:24576
 s_waitcnt vmcnt(16)
 ds_write_b128 v7, v[108:111] offset:28672
 s_waitcnt vmcnt(15)
 ds_write_b128 v7, v[112:115] offset:32768
 s_waitcnt vmcnt(14)
 ds_write_b128 v7, v[116:119] offset:36864
 s_waitcnt vmcnt(13)
 ds_write_b128 v7, v[120:123] offset:40960
 s_waitcnt vmcnt(12)
 ds_write_b128 v7, v[124:127] offset:45056
 s_waitcnt vmcnt(11)
 ds_write_b128 v7, v[128:131] offset:49152
 s_waitcnt vmcnt(10)
 ds_write_b128 v7, v[132:135] offset:53248
 s_waitcnt vmcnt(9)
 ds_write_b128 v7, v[136:139] offset:57344
 s_waitcnt vmcnt(8)
 ds_write_b128 v7, v[140:143] offset:61440
 v_add_u32 v7, 0x10000, v7
 s_waitcnt vmcnt(7)
 ds_write_b128 v7, v[144:147] offset:0
 s_waitcnt vmcnt(6)
 ds_write_b128 v7, v[148:151] offset:4096
 s_waitcnt vmcnt(5)
 ds_write_b128 v7, v[152:155] offset:8192
 s_waitcnt vmcnt(4)
 ds_write_b128 v7, v[156:159] offset:12288
 s_waitcnt vmcnt(3)
 ds_write_b128 v7, v[160:163] offset:16384
 s_waitcnt vmcnt(2)
 ds_write_b128 v7, v[164:167] offset:20480
 s_waitcnt vmcnt(1)
 ds_write_b128 v7, v[168:171] offset:24576
 s_waitcnt vmcnt(0)
 ds_write_b128 v7, v[172:175] offset:28672
 s_waitcnt lgkmcnt(0)
 s_barrier
 v_bfe_u32 v3, v0, 2, 2
 v_lshrrev_b32 v2, 4, v0
 v_lshl_add_u32 v2, v2, 3, v3
 v_lshlrev_b32 v2, 8, v2
 v_xor_b32 v3, s66, v3
 v_lshl_add_u32 v2, v3, 6, v2
 v_and_b32 v3, 3, v0
 v_lshl_add_u32 v2, v3, 4, v2
 ds_read_b64_tr_b16 a[96:97], v2 offset:0
 ds_read_b64_tr_b16 a[98:99], v2 offset:1024
 ds_read_b64_tr_b16 a[100:101], v2 offset:8
 ds_read_b64_tr_b16 a[102:103], v2 offset:1032
 ds_read_b64_tr_b16 a[104:105], v2 offset:8192
 ds_read_b64_tr_b16 a[106:107], v2 offset:9216
 ds_read_b64_tr_b16 a[108:109], v2 offset:8200
 ds_read_b64_tr_b16 a[110:111], v2 offset:9224
 ds_read_b64_tr_b16 a[112:113], v2 offset:16384
 ds_read_b64_tr_b16 a[114:115], v2 offset:17408
 ds_read_b64_tr_b16 a[116:117], v2 offset:16392
 ds_read_b64_tr_b16 a[118:119], v2 offset:17416
 s_waitcnt lgkmcnt(0)
 ds_read_b64_tr_b16 a[120:121], v2 offset:24576
 ds_read_b64_tr_b16 a[122:123], v2 offset:25600
 ds_read_b64_tr_b16 a[124:125], v2 offset:24584
 ds_read_b64_tr_b16 a[126:127], v2 offset:25608
 ds_read_b64_tr_b16 a[128:129], v2 offset:32768
 ds_read_b64_tr_b16 a[130:131], v2 offset:33792
 ds_read_b64_tr_b16 a[132:133], v2 offset:32776
 ds_read_b64_tr_b16 a[134:135], v2 offset:33800
 ds_read_b64_tr_b16 a[136:137], v2 offset:40960
 ds_read_b64_tr_b16 a[138:139], v2 offset:41984
 ds_read_b64_tr_b16 a[140:141], v2 offset:40968
 ds_read_b64_tr_b16 a[142:143], v2 offset:41992
 s_waitcnt lgkmcnt(0)
 ds_read_b64_tr_b16 a[144:145], v2 offset:49152
 ds_read_b64_tr_b16 a[146:147], v2 offset:50176
 ds_read_b64_tr_b16 a[148:149], v2 offset:49160
 ds_read_b64_tr_b16 a[150:151], v2 offset:50184
 ds_read_b64_tr_b16 a[152:153], v2 offset:57344
 ds_read_b64_tr_b16 a[154:155], v2 offset:58368
 ds_read_b64_tr_b16 a[156:157], v2 offset:57352
 ds_read_b64_tr_b16 a[158:159], v2 offset:58376
 v_add_u32 v2, 0x10000, v2
 ds_read_b64_tr_b16 a[160:161], v2 offset:0
 ds_read_b64_tr_b16 a[162:163], v2 offset:1024
 ds_read_b64_tr_b16 a[164:165], v2 offset:8
 ds_read_b64_tr_b16 a[166:167], v2 offset:1032
 s_waitcnt lgkmcnt(0)
 ds_read_b64_tr_b16 a[168:169], v2 offset:8192
 ds_read_b64_tr_b16 a[170:171], v2 offset:9216
 ds_read_b64_tr_b16 a[172:173], v2 offset:8200
 ds_read_b64_tr_b16 a[174:175], v2 offset:9224
 ds_read_b64_tr_b16 a[176:177], v2 offset:16384
 ds_read_b64_tr_b16 a[178:179], v2 offset:17408
 ds_read_b64_tr_b16 a[180:181], v2 offset:16392
 ds_read_b64_tr_b16 a[182:183], v2 offset:17416
 ds_read_b64_tr_b16 a[184:185], v2 offset:24576
 ds_read_b64_tr_b16 a[186:187], v2 offset:25600
 ds_read_b64_tr_b16 a[188:189], v2 offset:24584
 ds_read_b64_tr_b16 a[190:191], v2 offset:25608
 s_waitcnt lgkmcnt(0)
 ds_read_b64_tr_b16 a[192:193], v2 offset:32768
 ds_read_b64_tr_b16 a[194:195], v2 offset:33792
 ds_read_b64_tr_b16 a[196:197], v2 offset:32776
 ds_read_b64_tr_b16 a[198:199], v2 offset:33800
 ds_read_b64_tr_b16 a[200:201], v2 offset:40960
 ds_read_b64_tr_b16 a[202:203], v2 offset:41984
 ds_read_b64_tr_b16 a[204:205], v2 offset:40968
 ds_read_b64_tr_b16 a[206:207], v2 offset:41992
 ds_read_b64_tr_b16 a[208:209], v2 offset:49152
 ds_read_b64_tr_b16 a[210:211], v2 offset:50176
 ds_read_b64_tr_b16 a[212:213], v2 offset:49160
 ds_read_b64_tr_b16 a[214:215], v2 offset:50184
 s_waitcnt lgkmcnt(0)
 ds_read_b64_tr_b16 a[216:217], v2 offset:57344
 ds_read_b64_tr_b16 a[218:219], v2 offset:58368
 ds_read_b64_tr_b16 a[220:221], v2 offset:57352
 ds_read_b64_tr_b16 a[222:223], v2 offset:58376
 v_add_u32 v2, 0x10000, v2
 ds_read_b64_tr_b16 a[224:225], v2 offset:0
 ds_read_b64_tr_b16 a[226:227], v2 offset:1024
 ds_read_b64_tr_b16 a[228:229], v2 offset:8
 ds_read_b64_tr_b16 a[230:231], v2 offset:1032
 ds_read_b64_tr_b16 a[232:233], v2 offset:8192
 ds_read_b64_tr_b16 a[234:235], v2 offset:9216
 ds_read_b64_tr_b16 a[236:237], v2 offset:8200
 ds_read_b64_tr_b16 a[238:239], v2 offset:9224
 s_waitcnt lgkmcnt(0)
 ds_read_b64_tr_b16 a[240:241], v2 offset:16384
 ds_read_b64_tr_b16 a[242:243], v2 offset:17408
 ds_read_b64_tr_b16 a[244:245], v2 offset:16392
 ds_read_b64_tr_b16 a[246:247], v2 offset:17416
 ds_read_b64_tr_b16 a[248:249], v2 offset:24576
 ds_read_b64_tr_b16 a[250:251], v2 offset:25600
 ds_read_b64_tr_b16 a[252:253], v2 offset:24584
 ds_read_b64_tr_b16 a[254:255], v2 offset:25608
 s_waitcnt lgkmcnt(0)
 s_barrier
 v_and_b32 v76, 7, v0
 v_lshlrev_b32 v76, 7, v76
 s_mul_i32 s4, s80, 5
 s_add_u32 s4, s4, s81
 s_lshl_b32 s4, s4, 7
 s_add_u32 s4, s4, 86016
 s_mov_b32 s3, 0
 s_mul_i32 s101, s66, 5120
 s_add_u32 s73, s101, 1024
 v_add_u32 v77, s73, v1
 s_lshl_b32 s77, s81, 2
 s_add_u32 s77, s77, s66
 s_lshl_b32 s77, s77, 10
 v_and_b32 v2, 7, v0
 v_cmp_gt_u32 s[86:87], 5, v2
 s_and_b32 s86, s86, 0xffffff
 s_and_b32 s73, s66, 1
 s_lshl_b32 s73, s73, 1
 s_sub_u32 s73, s73, 1
 s_lshr_b32 s74, s66, 1
 s_lshl_b32 s73, s73, s74
 v_and_b32 v2, 15, v0
 v_add_u32 v80, s73, v2
t4_loop:
 s_mul_i32 s78, s82, 20480
 s_add_u32 s74, s82, -1
 s_cmp_lt_u32 s74, 128
 s_cselect_b32 s74, s74, -1
 s_add_u32 s5, s74, 1
 s_max_i32 s74, s74, 0
 s_mul_i32 s73, s74, 171
 s_lshr_b32 s73, s73, 10
 s_mul_i32 s73, s73, 6
 s_sub_u32 s73, s74, s73
 s_mul_i32 s73, s73, 640
 s_add_u32 s73, s73, 81920
 v_add_u32 v81, s73, v76
 v_mov_b32 v82, s5
 s_add_u32 s74, s82, 0
 s_cmp_lt_u32 s74, 128
 s_cselect_b32 s74, s74, -1
 s_add_u32 s5, s74, 1
 s_max_i32 s74, s74, 0
 s_mul_i32 s73, s74, 171
 s_lshr_b32 s73, s73, 10
 s_mul_i32 s73, s73, 6
 s_sub_u32 s73, s74, s73
 s_mul_i32 s73, s73, 640
 s_add_u32 s73, s73, 81920
 s_mov_b32 exec_lo, 0xffffff00
 v_add_u32 v81, s73, v76
 v_mov_b32 v82, s5
 s_add_u32 s74, s82, 1
 s_cmp_lt_u32 s74, 128
 s_cselect_b32 s74, s74, -1
 s_add_u32 s5, s74, 1
 s_max_i32 s74, s74, 0
 s_mul_i32 s73, s74, 171
 s_lshr_b32 s73, s73, 10
 s_mul_i32 s73, s73, 6
 s_sub_u32 s73, s74, s73
 s_mul_i32 s73, s73, 640
 s_add_u32 s73, s73, 81920
 s_mov_b32 exec_lo, 0xffff0000
 v_add_u32 v81, s73, v76
 v_mov_b32 v82, s5
 s_mov_b64 exec, -1
 buffer_load_dword v2, v81, s[8:11], 0 offen sc1
 s_waitcnt vmcnt(0)
 s_barrier
 s_cmp_lg_u32 s66, 0
 s_cbranch_scc1 notw0_100
 v_mov_b32 v4, s3
 v_mov_b32 v5, 0
 s_mov_b64 exec, 1
 buffer_store_dword v4, v5, s[8:11], s4 offen sc1
 s_mov_b64 exec, -1
notw0_100:
 s_branch test_99
wait_97:
 buffer_load_dword v2, v81, s[8:11], 0 offen sc1
 s_waitcnt vmcnt(0)
test_99:
 v_cmp_gt_u32 vcc, v82, v2
 s_and_b32 s74, vcc_lo, s86
 s_cbranch_scc0 ready_98
 s_sleep 1
 s_add_u32 s72, s72, 1
 s_cmp_lt_u32 s72, 0x40000
 s_cbranch_scc1 wait_97
 s_branch bail2
ready_98:
 s_lshl_b32 s73, s82, 4
 v_add_u32 v2, s73, v80
 v_lshrrev_b32 v3, 4, v2
 v_mul_u32_u24 v3, 20480, v3
 v_and_b32 v4, 15, v2
 v_and_b32 v5, 48, v0
 v_add_u32 v4, v4, v5
 v_lshl_add_u32 v3, v4, 4, v3
 v_cmp_gt_u32 vcc, 2048, v2
 v_mov_b32 v4, 0x40000000
 s_nop 0
 v_cndmask_b32 v3, v4, v3, vcc
 s_add_u32 s73, s101, 0x1440000
 s_add_u32 m0, s101, 1024
 s_nop 0
 buffer_load_dwordx4 v3, s[8:11], s73 offen offset:0 sc1 lds
 buffer_load_dwordx4 v3, s[8:11], s73 offen offset:1024 sc1 lds
 buffer_load_dwordx4 v3, s[8:11], s73 offen offset:2048 sc1 lds
 buffer_load_dwordx4 v3, s[8:11], s73 offen offset:3072 sc1 lds
 s_add_u32 s73, s73, 4096
 s_add_u32 m0, s101, 5120
 s_nop 0
 buffer_load_dwordx4 v3, s[8:11], s73 offen offset:0 sc1 lds
 s_add_u32 s73, s77, s78
 s_add_u32 s73, s73, 0xf40000
 buffer_load_dwordx4 v[192:195], v1, s[8:11], s73 offen sc1
 s_waitcnt vmcnt(0)
 s_barrier
 ds_read_b128 v[160:163], v1 offset:1024
 ds_read_b128 v[164:167], v1 offset:2048
 s_waitcnt lgkmcnt(1)
 v_mfma_f32_16x16x32_bf16 v[172:175], a[96:99], v[160:163], 0
 ds_read_b128 v[168:171], v1 offset:3072
 v_mfma_f32_16x16x32_bf16 v[176:179], a[100:103], v[160:163], 0
 s_waitcnt lgkmcnt(1)
 v_mfma_f32_16x16x32_bf16 v[172:175], a[104:107], v[164:167], v[172:175]
 ds_read_b128 v[160:163], v1 offset:4096
 v_mfma_f32_16x16x32_bf16 v[176:179], a[108:111], v[164:167], v[176:179]
 s_waitcnt lgkmcnt(1)
 v_mfma_f32_16x16x32_bf16 v[172:175], a[112:115], v[168:171], v[172:175]
 ds_read_b128 v[164:167], v1 offset:5120
 v_mfma_f32_16x16x32_bf16 v[176:179], a[116:119], v[168:171], v[176:179]
 s_waitcnt lgkmcnt(1)
 v_mfma_f32_16x16x32_bf16 v[172:175], a[120:123], v[160:163], v[172:175]
 ds_read_b128 v[168:171], v1 offset:6144
 v_mfma_f32_16x16x32_bf16 v[176:179], a[124:127], v[160:163], v[176:179]
 s_waitcnt lgkmcnt(1)
 v_mfma_f32_16x16x32_bf16 v[172:175], a[128:131], v[164:167], v[172:175]
 ds_read_b128 v[160:163], v1 offset:7168
 v_mfma_f32_16x16x32_bf16 v[176:179], a[132:135], v[164:167], v[176:179]
 s_waitcnt lgkmcnt(1)
 v_mfma_f32_16x16x32_bf16 v[172:175], a[136:139], v[168:171], v[172:175]
 ds_read_b128 v[164:167], v1 offset:8192
 v_mfma_f32_16x16x32_bf16 v[176:179], a[140:143], v[168:171], v[176:179]
 s_waitcnt lgkmcnt(1)
 v_mfma_f32_16x16x32_bf16 v[172:175], a[144:147], v[160:163], v[172:175]
 ds_read_b128 v[168:171], v1 offset:9216
 v_mfma_f32_16x16x32_bf16 v[176:179], a[148:151], v[160:163], v[176:179]
 s_waitcnt lgkmcnt(1)
 v_mfma_f32_16x16x32_bf16 v[172:175], a[152:155], v[164:167], v[172:175]
 ds_read_b128 v[160:163], v1 offset:10240
 v_mfma_f32_16x16x32_bf16 v[176:179], a[156:159], v[164:167], v[176:179]
 s_waitcnt lgkmcnt(1)
 v_mfma_f32_16x16x32_bf16 v[172:175], a[160:163], v[168:171], v[172:175]
 ds_read_b128 v[164:167], v1 offset:11264
 v_mfma_f32_16x16x32_bf16 v[176:179], a[164:167], v[168:171], v[176:179]
 s_waitcnt lgkmcnt(1)
 v_mfma_f32_16x16x32_bf16 v[172:175], a[168:171], v[160:163], v[172:175]
 ds_read_b128 v[168:171], v1 offset:12288
 v_mfma_f32_16x16x32_bf16 v[176:179], a[172:175], v[160:163], v[176:179]
 s_waitcnt lgkmcnt(1)
 v_mfma_f32_16x16x32_bf16 v[172:175], a[176:179], v[164:167], v[172:175]
 ds_read_b128 v[160:163], v1 offset:13312
 v_mfma_f32_16x16x32_bf16 v[176:179], a[180:183], v[164:167], v[176:179]
 s_waitcnt lgkmcnt(1)
 v_mfma_f32_16x16x32_bf16 v[172:175], a[184:187], v[168:171], v[172:175]
 ds_read_b128 v[164:167], v1 offset:14336
 v_mfma_f32_16x16x32_bf16 v[176:179], a[188:191], v[168:171], v[176:179]
 s_waitcnt lgkmcnt(1)
 v_mfma_f32_16x16x32_bf16 v[172:175], a[192:195], v[160:163], v[172:175]
 ds_read_b128 v[168:171], v1 offset:15360
 v_mfma_f32_16x16x32_bf16 v[176:179], a[196:199], v[160:163], v[176:179]
 s_waitcnt lgkmcnt(1)
 v_mfma_f32_16x16x32_bf16 v[172:175], a[200:203], v[164:167], v[172:175]
 ds_read_b128 v[160:163], v1 offset:16384
 v_mfma_f32_16x16x32_bf16 v[176:179], a[204:207], v[164:167], v[176:179]
 s_waitcnt lgkmcnt(1)
 v_mfma_f32_16x16x32_bf16 v[172:175], a[208:211], v[168:171], v[172:175]
 ds_read_b128 v[164:167], v1 offset:17408
 v_mfma_f32_16x16x32_bf16 v[176:179], a[212:215], v[168:171], v[176:179]
 s_waitcnt lgkmcnt(1)
 v_mfma_f32_16x16x32_bf16 v[172:175], a[216:219], v[160:163], v[172:175]
 ds_read_b128 v[168:171], v1 offset:18432
 v_mfma_f32_16x16x32_bf16 v[176:179], a[220:223], v[160:163], v[176:179]
 s_waitcnt lgkmcnt(1)
 v_mfma_f32_16x16x32_bf16 v[172:175], a[224:227], v[164:167], v[172:175]
 ds_read_b128 v[160:163], v1 offset:19456
 v_mfma_f32_16x16x32_bf16 v[176:179], a[228:231], v[164:167], v[176:179]
 s_waitcnt lgkmcnt(1)
 v_mfma_f32_16x16x32_bf16 v[172:175], a[232:235], v[168:171], v[172:175]
 ds_read_b128 v[164:167], v1 offset:20480
 v_mfma_f32_16x16x32_bf16 v[176:179], a[236:239], v[168:171], v[176:179]
 s_waitcnt lgkmcnt(1)
 v_mfma_f32_16x16x32_bf16 v[172:175], a[240:243], v[160:163], v[172:175]
 v_mfma_f32_16x16x32_bf16 v[176:179], a[244:247], v[160:163], v[176:179]
 s_waitcnt lgkmcnt(0)
 v_mfma_f32_16x16x32_bf16 v[172:175], a[248:251], v[164:167], v[172:175]
 v_mfma_f32_16x16x32_bf16 v[176:179], a[252:255], v[164:167], v[176:179]
 v_and_b32 v187, 0xffff0000, v195
 v_lshlrev_b32 v186, 16, v195
 v_and_b32 v185, 0xffff0000, v194
 v_lshlrev_b32 v184, 16, v194
 v_and_b32 v183, 0xffff0000, v193
 v_lshlrev_b32 v182, 16, v193
 v_and_b32 v181, 0xffff0000, v192
 v_lshlrev_b32 v180, 16, v192
 v_cvt_pk_bf16_f32 v172, 0, v172
 v_cvt_pk_bf16_f32 v173, 0, v173
 v_cvt_pk_bf16_f32 v174, 0, v174
 v_cvt_pk_bf16_f32 v175, 0, v175
 v_cvt_pk_bf16_f32 v176, 0, v176
 v_cvt_pk_bf16_f32 v177, 0, v177
 v_cvt_pk_bf16_f32 v178, 0, v178
 v_cvt_pk_bf16_f32 v179, 0, v179
 v_pk_add_f32 v[172:173], v[172:173], v[180:181]
 v_pk_add_f32 v[174:175], v[174:175], v[182:183]
 v_pk_add_f32 v[176:177], v[176:177], v[184:185]
 v_pk_add_f32 v[178:179], v[178:179], v[186:187]
 v_cvt_pk_bf16_f32 v192, v172, v173
 v_cvt_pk_bf16_f32 v193, v174, v175
 v_cvt_pk_bf16_f32 v194, v176, v177
 v_cvt_pk_bf16_f32 v195, v178, v179
 s_add_u32 s78, s78, 0x16c0000
 s_add_u32 s73, s77, s78
 buffer_store_dwordx4 v[192:195], v1, s[8:11], s73 offen sc1
 s_add_u32 s3, s82, 1
 s_add_u32 s82, s82, s100
 s_cmp_eq_u32 s82, 124
 s_cselect_b32 s82, 127, s82
 s_cmp_lt_u32 s82, 128
 s_cbranch_scc1 t4_loop
 s_waitcnt vmcnt(0)
 s_barrier
 s_cmp_lg_u32 s66, 0
 s_cbranch_scc1 notw0_101
 v_mov_b32 v4, s3
 v_mov_b32 v5, 0
 s_mov_b64 exec, 1
 buffer_store_dword v4, v5, s[8:11], s4 offen sc1
 s_mov_b64 exec, -1
notw0_101:
 s_waitcnt vmcnt(0)
 s_endpgm
t5:
 s_mov_b32 s12, s52
 s_and_b32 s13, s53, 0xffff
 s_mov_b32 s14, 0x21c000
 s_mov_b32 s15, 0x20000
 s_mov_b32 s82, s80
 s_lshl_b32 s75, s81, 9
 s_add_u32 s75, s75, 0
 s_lshl_b32 s73, s66, 2
 v_lshrrev_b32 v7, 4, v0
 v_add_u32 v4, s73, v7
 v_and_b32 v5, 15, v0
 s_mov_b32 s73, 3456
 v_mul_lo_u32 v6, v4, s73
 v_lshl_add_u32 v6, v5, 4, v6
 v_lshlrev_b32 v7, 2, v7
 v_xor_b32 v7, v7, v5
 v_lshlrev_b32 v7, 4, v7
 v_lshl_add_u32 v7, v4, 8, v7
 s_add_u32 s73, s75, 0
 buffer_load_dwordx4 v[16:19], v6, s[12:15], s73 offen
 s_add_u32 s73, s75, 55296
 buffer_load_dwordx4 v[20:23], v6, s[12:15], s73 offen
 s_add_u32 s73, s75, 110592
 buffer_load_dwordx4 v[24:27], v6, s[12:15], s73 offen
 s_add_u32 s73, s75, 165888
 buffer_load_dwordx4 v[28:31], v6, s[12:15], s73 offen
 s_add_u32 s73, s75, 221184
 buffer_load_dwordx4 v[32:35], v6, s[12:15], s73 offen
 s_add_u32 s73, s75, 276480
 buffer_load_dwordx4 v[36:39], v6, s[12:15], s73 offen
 s_add_u32 s73, s75, 331776
 buffer_load_dwordx4 v[40:43], v6, s[12:15], s73 offen
 s_add_u32 s73, s75, 387072
 buffer_load_dwordx4 v[44:47], v6, s[12:15], s73 offen
 s_add_u32 s73, s75, 442368
 buffer_load_dwordx4 v[48:51], v6, s[12:15], s73 offen
 s_add_u32 s73, s75, 497664
 buffer_load_dwordx4 v[52:55], v6, s[12:15], s73 offen
 s_add_u32 s73, s75, 552960
 buffer_load_dwordx4 v[56:59], v6, s[12:15], s73 offen
 s_add_u32 s73, s75, 608256
 buffer_load_dwordx4 v[60:63], v6, s[12:15], s73 offen
 s_add_u32 s73, s75, 663552
 buffer_load_dwordx4 v[64:67], v6, s[12:15], s73 offen
 s_add_u32 s73, s75, 718848
 buffer_load_dwordx4 v[68:71], v6, s[12:15], s73 offen
 s_add_u32 s73, s75, 774144
 buffer_load_dwordx4 v[72:75], v6, s[12:15], s73 offen
 s_add_u32 s73, s75, 829440
 buffer_load_dwordx4 v[76:79], v6, s[12:15], s73 offen
 s_add_u32 s73, s75, 884736
 buffer_load_dwordx4 v[80:83], v6, s[12:15], s73 offen
 s_add_u32 s73, s75, 940032
 buffer_load_dwordx4 v[84:87], v6, s[12:15], s73 offen
 s_add_u32 s73, s75, 995328
 buffer_load_dwordx4 v[88:91], v6, s[12:15], s73 offen
 s_add_u32 s73, s75, 1050624
 buffer_load_dwordx4 v[92:95], v6, s[12:15], s73 offen
 s_add_u32 s73, s75, 1105920
 buffer_load_dwordx4 v[96:99], v6, s[12:15], s73 offen
 s_add_u32 s73, s75, 1161216
 buffer_load_dwordx4 v[100:103], v6, s[12:15], s73 offen
 s_add_u32 s73, s75, 1216512
 buffer_load_dwordx4 v[104:107], v6, s[12:15], s73 offen
 s_add_u32 s73, s75, 1271808
 buffer_load_dwordx4 v[108:111], v6, s[12:15], s73 offen
 s_add_u32 s73, s75, 1327104
 buffer_load_dwordx4 v[112:115], v6, s[12:15], s73 offen
 s_add_u32 s73, s75, 1382400
 buffer_load_dwordx4 v[116:119], v6, s[12:15], s73 offen
 s_add_u32 s73, s75, 1437696
 buffer_load_dwordx4 v[120:123], v6, s[12:15], s73 offen
 s_add_u32 s73, s75, 1492992
 buffer_load_dwordx4 v[124:127], v6, s[12:15], s73 offen
 s_add_u32 s73, s75, 1548288
 buffer_load_dwordx4 v[128:131], v6, s[12:15], s73 offen
 s_add_u32 s73, s75, 1603584
 buffer_load_dwordx4 v[132:135], v6, s[12:15], s73 offen
 s_add_u32 s73, s75, 1658880
 buffer_load_dwordx4 v[136:139], v6, s[12:15], s73 offen
 s_add_u32 s73, s75, 1714176
 buffer_load_dwordx4 v[140:143], v6, s[12:15], s73 offen
 s_add_u32 s73, s75, 1769472
 buffer_load_dwordx4 v[144:147], v6, s[12:15], s73 offen
 s_add_u32 s73, s75, 1824768
 buffer_load_dwordx4 v[148:151], v6, s[12:15], s73 offen
 s_add_u32 s73, s75, 1880064
 buffer_load_dwordx4 v[152:155], v6, s[12:15], s73 offen
 s_add_u32 s73, s75, 1935360
 buffer_load_dwordx4 v[156:159], v6, s[12:15], s73 offen
 s_add_u32 s73, s75, 1990656
 buffer_load_dwordx4 v[160:163], v6, s[12:15], s73 offen
 s_add_u32 s73, s75, 2045952
 buffer_load_dwordx4 v[164:167], v6, s[12:15], s73 offen
 s_add_u32 s73, s75, 2101248
 buffer_load_dwordx4 v[168:171], v6, s[12:15], s73 offen
 s_add_u32 s73, s75, 2156544
 buffer_load_dwordx4 v[172:175], v6, s[12:15], s73 offen
 s_waitcnt vmcnt(39)
 ds_write_b128 v7, v[16:19] offset:0
 s_waitcnt vmcnt(38)
 ds_write_b128 v7, v[20:23] offset:4096
 s_waitcnt vmcnt(37)
 ds_write_b128 v7, v[24:27] offset:8192
 s_waitcnt vmcnt(36)
 ds_write_b128 v7, v[28:31] offset:12288
 s_waitcnt vmcnt(35)
 ds_write_b128 v7, v[32:35] offset:16384
 s_waitcnt vmcnt(34)
 ds_write_b128 v7, v[36:39] offset:20480
 s_waitcnt vmcnt(33)
 ds_write_b128 v7, v[40:43] offset:24576
 s_waitcnt vmcnt(32)
 ds_write_b128 v7, v[44:47] offset:28672
 s_waitcnt vmcnt(31)
 ds_write_b128 v7, v[48:51] offset:32768
 s_waitcnt vmcnt(30)
 ds_write_b128 v7, v[52:55] offset:36864
 s_waitcnt vmcnt(29)
 ds_write_b128 v7, v[56:59] offset:40960
 s_waitcnt vmcnt(28)
 ds_write_b128 v7, v[60:63] offset:45056
 s_waitcnt vmcnt(27)
 ds_write_b128 v7, v[64:67] offset:49152
 s_waitcnt vmcnt(26)
 ds_write_b128 v7, v[68:71] offset:53248
 s_waitcnt vmcnt(25)
 ds_write_b128 v7, v[72:75] offset:57344
 s_waitcnt vmcnt(24)
 ds_write_b128 v7, v[76:79] offset:61440
 v_add_u32 v7, 0x10000, v7
 s_waitcnt vmcnt(23)
 ds_write_b128 v7, v[80:83] offset:0
 s_waitcnt vmcnt(22)
 ds_write_b128 v7, v[84:87] offset:4096
 s_waitcnt vmcnt(21)
 ds_write_b128 v7, v[88:91] offset:8192
 s_waitcnt vmcnt(20)
 ds_write_b128 v7, v[92:95] offset:12288
 s_waitcnt vmcnt(19)
 ds_write_b128 v7, v[96:99] offset:16384
 s_waitcnt vmcnt(18)
 ds_write_b128 v7, v[100:103] offset:20480
 s_waitcnt vmcnt(17)
 ds_write_b128 v7, v[104:107] offset:24576
 s_waitcnt vmcnt(16)
 ds_write_b128 v7, v[108:111] offset:28672
 s_waitcnt vmcnt(15)
 ds_write_b128 v7, v[112:115] offset:32768
 s_waitcnt vmcnt(14)
 ds_write_b128 v7, v[116:119] offset:36864
 s_waitcnt vmcnt(13)
 ds_write_b128 v7, v[120:123] offset:40960
 s_waitcnt vmcnt(12)
 ds_write_b128 v7, v[124:127] offset:45056
 s_waitcnt vmcnt(11)
 ds_write_b128 v7, v[128:131] offset:49152
 s_waitcnt vmcnt(10)
 ds_write_b128 v7, v[132:135] offset:53248
 s_waitcnt vmcnt(9)
 ds_write_b128 v7, v[136:139] offset:57344
 s_waitcnt vmcnt(8)
 ds_write_b128 v7, v[140:143] offset:61440
 v_add_u32 v7, 0x10000, v7
 s_waitcnt vmcnt(7)
 ds_write_b128 v7, v[144:147] offset:0
 s_waitcnt vmcnt(6)
 ds_write_b128 v7, v[148:151] offset:4096
 s_waitcnt vmcnt(5)
 ds_write_b128 v7, v[152:155] offset:8192
 s_waitcnt vmcnt(4)
 ds_write_b128 v7, v[156:159] offset:12288
 s_waitcnt vmcnt(3)
 ds_write_b128 v7, v[160:163] offset:16384
 s_waitcnt vmcnt(2)
 ds_write_b128 v7, v[164:167] offset:20480
 s_waitcnt vmcnt(1)
 ds_write_b128 v7, v[168:171] offset:24576
 s_waitcnt vmcnt(0)
 ds_write_b128 v7, v[172:175] offset:28672
 s_waitcnt lgkmcnt(0)
 s_barrier
 v_bfe_u32 v3, v0, 2, 2
 v_lshrrev_b32 v2, 4, v0
 v_lshl_add_u32 v2, v2, 3, v3
 v_lshlrev_b32 v2, 8, v2
 v_xor_b32 v3, s66, v3
 v_lshl_add_u32 v2, v3, 6, v2
 v_and_b32 v3, 3, v0
 v_lshl_add_u32 v2, v3, 4, v2
 ds_read_b64_tr_b16 v[192:193], v2 offset:0
 ds_read_b64_tr_b16 v[194:195], v2 offset:1024
 ds_read_b64_tr_b16 v[196:197], v2 offset:8
 ds_read_b64_tr_b16 v[198:199], v2 offset:1032
 ds_read_b64_tr_b16 v[208:209], v2 offset:8192
 ds_read_b64_tr_b16 v[210:211], v2 offset:9216
 ds_read_b64_tr_b16 v[212:213], v2 offset:8200
 ds_read_b64_tr_b16 v[214:215], v2 offset:9224
 ds_read_b64_tr_b16 v[224:225], v2 offset:16384
 ds_read_b64_tr_b16 v[226:227], v2 offset:17408
 ds_read_b64_tr_b16 v[228:229], v2 offset:16392
 ds_read_b64_tr_b16 v[230:231], v2 offset:17416
 s_waitcnt lgkmcnt(0)
 ds_read_b64_tr_b16 v[240:241], v2 offset:24576
 ds_read_b64_tr_b16 v[242:243], v2 offset:25600
 ds_read_b64_tr_b16 v[244:245], v2 offset:24584
 ds_read_b64_tr_b16 v[246:247], v2 offset:25608
 ds_read_b64_tr_b16 a[0:1], v2 offset:32768
 ds_read_b64_tr_b16 a[2:3], v2 offset:33792
 ds_read_b64_tr_b16 a[4:5], v2 offset:32776
 ds_read_b64_tr_b16 a[6:7], v2 offset:33800
 ds_read_b64_tr_b16 a[16:17], v2 offset:40960
 ds_read_b64_tr_b16 a[18:19], v2 offset:41984
 ds_read_b64_tr_b16 a[20:21], v2 offset:40968
 ds_read_b64_tr_b16 a[22:23], v2 offset:41992
 s_waitcnt lgkmcnt(0)
 ds_read_b64_tr_b16 a[32:33], v2 offset:49152
 ds_read_b64_tr_b16 a[34:35], v2 offset:50176
 ds_read_b64_tr_b16 a[36:37], v2 offset:49160
 ds_read_b64_tr_b16 a[38:39], v2 offset:50184
 ds_read_b64_tr_b16 a[48:49], v2 offset:57344
 ds_read_b64_tr_b16 a[50:51], v2 offset:58368
 ds_read_b64_tr_b16 a[52:53], v2 offset:57352
 ds_read_b64_tr_b16 a[54:55], v2 offset:58376
 v_add_u32 v2, 0x10000, v2
 ds_read_b64_tr_b16 a[64:65], v2 offset:0
 ds_read_b64_tr_b16 a[66:67], v2 offset:1024
 ds_read_b64_tr_b16 a[68:69], v2 offset:8
 ds_read_b64_tr_b16 a[70:71], v2 offset:1032
 s_waitcnt lgkmcnt(0)
 ds_read_b64_tr_b16 a[80:81], v2 offset:8192
 ds_read_b64_tr_b16 a[82:83], v2 offset:9216
 ds_read_b64_tr_b16 a[84:85], v2 offset:8200
 ds_read_b64_tr_b16 a[86:87], v2 offset:9224
 ds_read_b64_tr_b16 a[96:97], v2 offset:16384
 ds_read_b64_tr_b16 a[98:99], v2 offset:17408
 ds_read_b64_tr_b16 a[100:101], v2 offset:16392
 ds_read_b64_tr_b16 a[102:103], v2 offset:17416
 ds_read_b64_tr_b16 a[112:113], v2 offset:24576
 ds_read_b64_tr_b16 a[114:115], v2 offset:25600
 ds_read_b64_tr_b16 a[116:117], v2 offset:24584
 ds_read_b64_tr_b16 a[118:119], v2 offset:25608
 s_waitcnt lgkmcnt(0)
 ds_read_b64_tr_b16 a[128:129], v2 offset:32768
 ds_read_b64_tr_b16 a[130:131], v2 offset:33792
 ds_read_b64_tr_b16 a[132:133], v2 offset:32776
 ds_read_b64_tr_b16 a[134:135], v2 offset:33800
 ds_read_b64_tr_b16 a[144:145], v2 offset:40960
 ds_read_b64_tr_b16 a[146:147], v2 offset:41984
 ds_read_b64_tr_b16 a[148:149], v2 offset:40968
 ds_read_b64_tr_b16 a[150:151], v2 offset:41992
 ds_read_b64_tr_b16 a[160:161], v2 offset:49152
 ds_read_b64_tr_b16 a[162:163], v2 offset:50176
 ds_read_b64_tr_b16 a[164:165], v2 offset:49160
 ds_read_b64_tr_b16 a[166:167], v2 offset:50184
 s_waitcnt lgkmcnt(0)
 ds_read_b64_tr_b16 a[176:177], v2 offset:57344
 ds_read_b64_tr_b16 a[178:179], v2 offset:58368
 ds_read_b64_tr_b16 a[180:181], v2 offset:57352
 ds_read_b64_tr_b16 a[182:183], v2 offset:58376
 v_add_u32 v2, 0x10000, v2
 ds_read_b64_tr_b16 a[192:193], v2 offset:0
 ds_read_b64_tr_b16 a[194:195], v2 offset:1024
 ds_read_b64_tr_b16 a[196:197], v2 offset:8
 ds_read_b64_tr_b16 a[198:199], v2 offset:1032
 ds_read_b64_tr_b16 a[208:209], v2 offset:8192
 ds_read_b64_tr_b16 a[210:211], v2 offset:9216
 ds_read_b64_tr_b16 a[212:213], v2 offset:8200
 ds_read_b64_tr_b16 a[214:215], v2 offset:9224
 s_waitcnt lgkmcnt(0)
 ds_read_b64_tr_b16 a[224:225], v2 offset:16384
 ds_read_b64_tr_b16 a[226:227], v2 offset:17408
 ds_read_b64_tr_b16 a[228:229], v2 offset:16392
 ds_read_b64_tr_b16 a[230:231], v2 offset:17416
 ds_read_b64_tr_b16 a[240:241], v2 offset:24576
 ds_read_b64_tr_b16 a[242:243], v2 offset:25600
 ds_read_b64_tr_b16 a[244:245], v2 offset:24584
 ds_read_b64_tr_b16 a[246:247], v2 offset:25608
 s_waitcnt lgkmcnt(0)
 s_barrier
 s_lshl_b32 s75, s81, 9
 s_add_u32 s75, s75, 256
 s_lshl_b32 s73, s66, 2
 v_lshrrev_b32 v7, 4, v0
 v_add_u32 v4, s73, v7
 v_and_b32 v5, 15, v0
 s_mov_b32 s73, 3456
 v_mul_lo_u32 v6, v4, s73
 v_lshl_add_u32 v6, v5, 4, v6
 v_lshlrev_b32 v7, 2, v7
 v_xor_b32 v7, v7, v5
 v_lshlrev_b32 v7, 4, v7
 v_lshl_add_u32 v7, v4, 8, v7
 s_add_u32 s73, s75, 0
 buffer_load_dwordx4 v[16:19], v6, s[12:15], s73 offen
 s_add_u32 s73, s75, 55296
 buffer_load_dwordx4 v[20:23], v6, s[12:15], s73 offen
 s_add_u32 s73, s75, 110592
 buffer_load_dwordx4 v[24:27], v6, s[12:15], s73 offen
 s_add_u32 s73, s75, 165888
 buffer_load_dwordx4 v[28:31], v6, s[12:15], s73 offen
 s_add_u32 s73, s75, 221184
 buffer_load_dwordx4 v[32:35], v6, s[12:15], s73 offen
 s_add_u32 s73, s75, 276480
 buffer_load_dwordx4 v[36:39], v6, s[12:15], s73 offen
 s_add_u32 s73, s75, 331776
 buffer_load_dwordx4 v[40:43], v6, s[12:15], s73 offen
 s_add_u32 s73, s75, 387072
 buffer_load_dwordx4 v[44:47], v6, s[12:15], s73 offen
 s_add_u32 s73, s75, 442368
 buffer_load_dwordx4 v[48:51], v6, s[12:15], s73 offen
 s_add_u32 s73, s75, 497664
 buffer_load_dwordx4 v[52:55], v6, s[12:15], s73 offen
 s_add_u32 s73, s75, 552960
 buffer_load_dwordx4 v[56:59], v6, s[12:15], s73 offen
 s_add_u32 s73, s75, 608256
 buffer_load_dwordx4 v[60:63], v6, s[12:15], s73 offen
 s_add_u32 s73, s75, 663552
 buffer_load_dwordx4 v[64:67], v6, s[12:15], s73 offen
 s_add_u32 s73, s75, 718848
 buffer_load_dwordx4 v[68:71], v6, s[12:15], s73 offen
 s_add_u32 s73, s75, 774144
 buffer_load_dwordx4 v[72:75], v6, s[12:15], s73 offen
 s_add_u32 s73, s75, 829440
 buffer_load_dwordx4 v[76:79], v6, s[12:15], s73 offen
 s_add_u32 s73, s75, 884736
 buffer_load_dwordx4 v[80:83], v6, s[12:15], s73 offen
 s_add_u32 s73, s75, 940032
 buffer_load_dwordx4 v[84:87], v6, s[12:15], s73 offen
 s_add_u32 s73, s75, 995328
 buffer_load_dwordx4 v[88:91], v6, s[12:15], s73 offen
 s_add_u32 s73, s75, 1050624
 buffer_load_dwordx4 v[92:95], v6, s[12:15], s73 offen
 s_add_u32 s73, s75, 1105920
 buffer_load_dwordx4 v[96:99], v6, s[12:15], s73 offen
 s_add_u32 s73, s75, 1161216
 buffer_load_dwordx4 v[100:103], v6, s[12:15], s73 offen
 s_add_u32 s73, s75, 1216512
 buffer_load_dwordx4 v[104:107], v6, s[12:15], s73 offen
 s_add_u32 s73, s75, 1271808
 buffer_load_dwordx4 v[108:111], v6, s[12:15], s73 offen
 s_add_u32 s73, s75, 1327104
 buffer_load_dwordx4 v[112:115], v6, s[12:15], s73 offen
 s_add_u32 s73, s75, 1382400
 buffer_load_dwordx4 v[116:119], v6, s[12:15], s73 offen
 s_add_u32 s73, s75, 1437696
 buffer_load_dwordx4 v[120:123], v6, s[12:15], s73 offen
 s_add_u32 s73, s75, 1492992
 buffer_load_dwordx4 v[124:127], v6, s[12:15], s73 offen
 s_add_u32 s73, s75, 1548288
 buffer_load_dwordx4 v[128:131], v6, s[12:15], s73 offen
 s_add_u32 s73, s75, 1603584
 buffer_load_dwordx4 v[132:135], v6, s[12:15], s73 offen
 s_add_u32 s73, s75, 1658880
 buffer_load_dwordx4 v[136:139], v6, s[12:15], s73 offen
 s_add_u32 s73, s75, 1714176
 buffer_load_dwordx4 v[140:143], v6, s[12:15], s73 offen
 s_add_u32 s73, s75, 1769472
 buffer_load_dwordx4 v[144:147], v6, s[12:15], s73 offen
 s_add_u32 s73, s75, 1824768
 buffer_load_dwordx4 v[148:151], v6, s[12:15], s73 offen
 s_add_u32 s73, s75, 1880064
 buffer_load_dwordx4 v[152:155], v6, s[12:15], s73 offen
 s_add_u32 s73, s75, 1935360
 buffer_load_dwordx4 v[156:159], v6, s[12:15], s73 offen
 s_add_u32 s73, s75, 1990656
 buffer_load_dwordx4 v[160:163], v6, s[12:15], s73 offen
 s_add_u32 s73, s75, 2045952
 buffer_load_dwordx4 v[164:167], v6, s[12:15], s73 offen
 s_add_u32 s73, s75, 2101248
 buffer_load_dwordx4 v[168:171], v6, s[12:15], s73 offen
 s_add_u32 s73, s75, 2156544
 buffer_load_dwordx4 v[172:175], v6, s[12:15], s73 offen
 s_waitcnt vmcnt(39)
 ds_write_b128 v7, v[16:19] offset:0
 s_waitcnt vmcnt(38)
 ds_write_b128 v7, v[20:23] offset:4096
 s_waitcnt vmcnt(37)
 ds_write_b128 v7, v[24:27] offset:8192
 s_waitcnt vmcnt(36)
 ds_write_b128 v7, v[28:31] offset:12288
 s_waitcnt vmcnt(35)
 ds_write_b128 v7, v[32:35] offset:16384
 s_waitcnt vmcnt(34)
 ds_write_b128 v7, v[36:39] offset:20480
 s_waitcnt vmcnt(33)
 ds_write_b128 v7, v[40:43] offset:24576
 s_waitcnt vmcnt(32)
 ds_write_b128 v7, v[44:47] offset:28672
 s_waitcnt vmcnt(31)
 ds_write_b128 v7, v[48:51] offset:32768
 s_waitcnt vmcnt(30)
 ds_write_b128 v7, v[52:55] offset:36864
 s_waitcnt vmcnt(29)
 ds_write_b128 v7, v[56:59] offset:40960
 s_waitcnt vmcnt(28)
 ds_write_b128 v7, v[60:63] offset:45056
 s_waitcnt vmcnt(27)
 ds_write_b128 v7, v[64:67] offset:49152
 s_waitcnt vmcnt(26)
 ds_write_b128 v7, v[68:71] offset:53248
 s_waitcnt vmcnt(25)
 ds_write_b128 v7, v[72:75] offset:57344
 s_waitcnt vmcnt(24)
 ds_write_b128 v7, v[76:79] offset:61440
 v_add_u32 v7, 0x10000, v7
 s_waitcnt vmcnt(23)
 ds_write_b128 v7, v[80:83] offset:0
 s_waitcnt vmcnt(22)
 ds_write_b128 v7, v[84:87] offset:4096
 s_waitcnt vmcnt(21)
 ds_write_b128 v7, v[88:91] offset:8192
 s_waitcnt vmcnt(20)
 ds_write_b128 v7, v[92:95] offset:12288
 s_waitcnt vmcnt(19)
 ds_write_b128 v7, v[96:99] offset:16384
 s_waitcnt vmcnt(18)
 ds_write_b128 v7, v[100:103] offset:20480
 s_waitcnt vmcnt(17)
 ds_write_b128 v7, v[104:107] offset:24576
 s_waitcnt vmcnt(16)
 ds_write_b128 v7, v[108:111] offset:28672
 s_waitcnt vmcnt(15)
 ds_write_b128 v7, v[112:115] offset:32768
 s_waitcnt vmcnt(14)
 ds_write_b128 v7, v[116:119] offset:36864
 s_waitcnt vmcnt(13)
 ds_write_b128 v7, v[120:123] offset:40960
 s_waitcnt vmcnt(12)
 ds_write_b128 v7, v[124:127] offset:45056
 s_waitcnt vmcnt(11)
 ds_write_b128 v7, v[128:131] offset:49152
 s_waitcnt vmcnt(10)
 ds_write_b128 v7, v[132:135] offset:53248
 s_waitcnt vmcnt(9)
 ds_write_b128 v7, v[136:139] offset:57344
 s_waitcnt vmcnt(8)
 ds_write_b128 v7, v[140:143] offset:61440
 v_add_u32 v7, 0x10000, v7
 s_waitcnt vmcnt(7)
 ds_write_b128 v7, v[144:147] offset:0
 s_waitcnt vmcnt(6)
 ds_write_b128 v7, v[148:151] offset:4096
 s_waitcnt vmcnt(5)
 ds_write_b128 v7, v[152:155] offset:8192
 s_waitcnt vmcnt(4)
 ds_write_b128 v7, v[156:159] offset:12288
 s_waitcnt vmcnt(3)
 ds_write_b128 v7, v[160:163] offset:16384
 s_waitcnt vmcnt(2)
 ds_write_b128 v7, v[164:167] offset:20480
 s_waitcnt vmcnt(1)
 ds_write_b128 v7, v[168:171] offset:24576
 s_waitcnt vmcnt(0)
 ds_write_b128 v7, v[172:175] offset:28672
 s_waitcnt lgkmcnt(0)
 s_barrier
 v_bfe_u32 v3, v0, 2, 2
 v_lshrrev_b32 v2, 4, v0
 v_lshl_add_u32 v2, v2, 3, v3
 v_lshlrev_b32 v2, 8, v2
 v_xor_b32 v3, s66, v3
 v_lshl_add_u32 v2, v3, 6, v2
 v_and_b32 v3, 3, v0
 v_lshl_add_u32 v2, v3, 4, v2
 ds_read_b64_tr_b16 v[200:201], v2 offset:0
 ds_read_b64_tr_b16 v[202:203], v2 offset:1024
 ds_read_b64_tr_b16 v[204:205], v2 offset:8
 ds_read_b64_tr_b16 v[206:207], v2 offset:1032
 ds_read_b64_tr_b16 v[216:217], v2 offset:8192
 ds_read_b64_tr_b16 v[218:219], v2 offset:9216
 ds_read_b64_tr_b16 v[220:221], v2 offset:8200
 ds_read_b64_tr_b16 v[222:223], v2 offset:9224
 ds_read_b64_tr_b16 v[232:233], v2 offset:16384
 ds_read_b64_tr_b16 v[234:235], v2 offset:17408
 ds_read_b64_tr_b16 v[236:237], v2 offset:16392
 ds_read_b64_tr_b16 v[238:239], v2 offset:17416
 s_waitcnt lgkmcnt(0)
 ds_read_b64_tr_b16 v[248:249], v2 offset:24576
 ds_read_b64_tr_b16 v[250:251], v2 offset:25600
 ds_read_b64_tr_b16 v[252:253], v2 offset:24584
 ds_read_b64_tr_b16 v[254:255], v2 offset:25608
 ds_read_b64_tr_b16 a[8:9], v2 offset:32768
 ds_read_b64_tr_b16 a[10:11], v2 offset:33792
 ds_read_b64_tr_b16 a[12:13], v2 offset:32776
 ds_read_b64_tr_b16 a[14:15], v2 offset:33800
 ds_read_b64_tr_b16 a[24:25], v2 offset:40960
 ds_read_b64_tr_b16 a[26:27], v2 offset:41984
 ds_read_b64_tr_b16 a[28:29], v2 offset:40968
 ds_read_b64_tr_b16 a[30:31], v2 offset:41992
 s_waitcnt lgkmcnt(0)
 ds_read_b64_tr_b16 a[40:41], v2 offset:49152
 ds_read_b64_tr_b16 a[42:43], v2 offset:50176
 ds_read_b64_tr_b16 a[44:45], v2 offset:49160
 ds_read_b64_tr_b16 a[46:47], v2 offset:50184
 ds_read_b64_tr_b16 a[56:57], v2 offset:57344
 ds_read_b64_tr_b16 a[58:59], v2 offset:58368
 ds_read_b64_tr_b16 a[60:61], v2 offset:57352
 ds_read_b64_tr_b16 a[62:63], v2 offset:58376
 v_add_u32 v2, 0x10000, v2
 ds_read_b64_tr_b16 a[72:73], v2 offset:0
 ds_read_b64_tr_b16 a[74:75], v2 offset:1024
 ds_read_b64_tr_b16 a[76:77], v2 offset:8
 ds_read_b64_tr_b16 a[78:79], v2 offset:1032
 s_waitcnt lgkmcnt(0)
 ds_read_b64_tr_b16 a[88:89], v2 offset:8192
 ds_read_b64_tr_b16 a[90:91], v2 offset:9216
 ds_read_b64_tr_b16 a[92:93], v2 offset:8200
 ds_read_b64_tr_b16 a[94:95], v2 offset:9224
 ds_read_b64_tr_b16 a[104:105], v2 offset:16384
 ds_read_b64_tr_b16 a[106:107], v2 offset:17408
 ds_read_b64_tr_b16 a[108:109], v2 offset:16392
 ds_read_b64_tr_b16 a[110:111], v2 offset:17416
 ds_read_b64_tr_b16 a[120:121], v2 offset:24576
 ds_read_b64_tr_b16 a[122:123], v2 offset:25600
 ds_read_b64_tr_b16 a[124:125], v2 offset:24584
 ds_read_b64_tr_b16 a[126:127], v2 offset:25608
 s_waitcnt lgkmcnt(0)
 ds_read_b64_tr_b16 a[136:137], v2 offset:32768
 ds_read_b64_tr_b16 a[138:139], v2 offset:33792
 ds_read_b64_tr_b16 a[140:141], v2 offset:32776
 ds_read_b64_tr_b16 a[142:143], v2 offset:33800
 ds_read_b64_tr_b16 a[152:153], v2 offset:40960
 ds_read_b64_tr_b16 a[154:155], v2 offset:41984
 ds_read_b64_tr_b16 a[156:157], v2 offset:40968
 ds_read_b64_tr_b16 a[158:159], v2 offset:41992
 ds_read_b64_tr_b16 a[168:169], v2 offset:49152
 ds_read_b64_tr_b16 a[170:171], v2 offset:50176
 ds_read_b64_tr_b16 a[172:173], v2 offset:49160
 ds_read_b64_tr_b16 a[174:175], v2 offset:50184
 s_waitcnt lgkmcnt(0)
 ds_read_b64_tr_b16 a[184:185], v2 offset:57344
 ds_read_b64_tr_b16 a[186:187], v2 offset:58368
 ds_read_b64_tr_b16 a[188:189], v2 offset:57352
 ds_read_b64_tr_b16 a[190:191], v2 offset:58376
 v_add_u32 v2, 0x10000, v2
 ds_read_b64_tr_b16 a[200:201], v2 offset:0
 ds_read_b64_tr_b16 a[202:203], v2 offset:1024
 ds_read_b64_tr_b16 a[204:205], v2 offset:8
 ds_read_b64_tr_b16 a[206:207], v2 offset:1032
 ds_read_b64_tr_b16 a[216:217], v2 offset:8192
 ds_read_b64_tr_b16 a[218:219], v2 offset:9216
 ds_read_b64_tr_b16 a[220:221], v2 offset:8200
 ds_read_b64_tr_b16 a[222:223], v2 offset:9224
 s_waitcnt lgkmcnt(0)
 ds_read_b64_tr_b16 a[232:233], v2 offset:16384
 ds_read_b64_tr_b16 a[234:235], v2 offset:17408
 ds_read_b64_tr_b16 a[236:237], v2 offset:16392
 ds_read_b64_tr_b16 a[238:239], v2 offset:17416
 ds_read_b64_tr_b16 a[248:249], v2 offset:24576
 ds_read_b64_tr_b16 a[250:251], v2 offset:25600
 ds_read_b64_tr_b16 a[252:253], v2 offset:24584
 ds_read_b64_tr_b16 a[254:255], v2 offset:25608
 s_waitcnt lgkmcnt(0)
 s_barrier
 v_and_b32 v76, 7, v0
 v_lshlrev_b32 v76, 7, v76
 s_mul_i32 s4, s80, 7
 s_add_u32 s4, s4, s81
 s_lshl_b32 s4, s4, 7
 s_add_u32 s4, s4, 88576
 s_mov_b32 s3, 0
 s_mul_i32 s101, s66, 5120
 s_add_u32 s73, s101, 1024
 v_add_u32 v77, s73, v1
 s_lshl_b32 s77, s81, 3
 s_add_u32 s77, s77, s66
 s_add_u32 s86, s77, 4
 s_cmp_lt_u32 s86, 54
 s_cselect_b32 s86, s86, 0x100000
 s_lshl_b32 s86, s86, 10
 s_lshl_b32 s77, s77, 10
 v_and_b32 v7, 15, v0
 v_lshlrev_b32 v7, 4, v7
 s_lshl_b32 s73, s66, 2
 v_add_u32 v6, s73, v7
t5_loop:
 s_mul_i32 s78, s82, 20480
 s_mul_i32 s73, s82, 171
 s_lshr_b32 s73, s73, 9
 s_mul_i32 s73, s73, 3
 s_sub_u32 s73, s82, s73
 s_mul_i32 s73, s73, 640
 s_add_u32 s73, s73, 86016
 s_cmp_eq_u32 s82, 124
 s_cselect_b32 s73, 87936, s73
 s_add_u32 s5, s82, 1
 buffer_load_dword v2, v76, s[8:11], s73 offen sc1
 s_waitcnt vmcnt(0)
 s_barrier
 s_cmp_lg_u32 s66, 0
 s_cbranch_scc1 notw0_105
 v_mov_b32 v4, s3
 v_mov_b32 v5, 0
 s_mov_b64 exec, 1
 buffer_store_dword v4, v5, s[8:11], s4 offen sc1
 s_mov_b64 exec, -1
notw0_105:
 s_branch test_104
wait_102:
 buffer_load_dword v2, v76, s[8:11], s73 offen sc1
 s_waitcnt vmcnt(0)
test_104:
 v_cmp_gt_u32 vcc, s5, v2
 s_and_b32 vcc_lo, vcc_lo, 0x1f
 s_and_b32 vcc_hi, vcc_hi, 0x0
 s_cmp_eq_u64 vcc, 0
 s_cbranch_scc1 ready_103
 s_sleep 1
 s_add_u32 s72, s72, 1
 s_cmp_lt_u32 s72, 0x40000
 s_cbranch_scc1 wait_102
 s_branch bail2
ready_103:
 s_add_u32 s79, s101, s78
 s_add_u32 s73, s79, 0x16c0000
 s_add_u32 s74, s73, 4096
 buffer_load_dwordx4 v[56:59], v1, s[8:11], s73 offen offset:0 sc1
 buffer_load_dwordx4 v[60:63], v1, s[8:11], s73 offen offset:1024 sc1
 buffer_load_dwordx4 v[64:67], v1, s[8:11], s73 offen offset:2048 sc1
 buffer_load_dwordx4 v[68:71], v1, s[8:11], s73 offen offset:3072 sc1
 buffer_load_dwordx4 v[72:75], v1, s[8:11], s74 offen offset:0 sc1
 s_waitcnt vmcnt(0)
 v_and_b32 v55, 0xffff0000, v75
 v_lshlrev_b32 v54, 16, v75
 v_and_b32 v53, 0xffff0000, v74
 v_lshlrev_b32 v52, 16, v74
 v_and_b32 v51, 0xffff0000, v73
 v_lshlrev_b32 v50, 16, v73
 v_and_b32 v49, 0xffff0000, v72
 v_lshlrev_b32 v48, 16, v72
 v_and_b32 v47, 0xffff0000, v71
 v_lshlrev_b32 v46, 16, v71
 v_and_b32 v45, 0xffff0000, v70
 v_lshlrev_b32 v44, 16, v70
 v_and_b32 v43, 0xffff0000, v69
 v_lshlrev_b32 v42, 16, v69
 v_and_b32 v41, 0xffff0000, v68
 v_lshlrev_b32 v40, 16, v68
 v_and_b32 v39, 0xffff0000, v67
 v_lshlrev_b32 v38, 16, v67
 v_and_b32 v37, 0xffff0000, v66
 v_lshlrev_b32 v36, 16, v66
 v_and_b32 v35, 0xffff0000, v65
 v_lshlrev_b32 v34, 16, v65
 v_and_b32 v33, 0xffff0000, v64
 v_lshlrev_b32 v32, 16, v64
 v_and_b32 v31, 0xffff0000, v63
 v_lshlrev_b32 v30, 16, v63
 v_and_b32 v29, 0xffff0000, v62
 v_lshlrev_b32 v28, 16, v62
 v_and_b32 v27, 0xffff0000, v61
 v_lshlrev_b32 v26, 16, v61
 v_and_b32 v25, 0xffff0000, v60
 v_lshlrev_b32 v24, 16, v60
 v_and_b32 v23, 0xffff0000, v59
 v_lshlrev_b32 v22, 16, v59
 v_and_b32 v21, 0xffff0000, v58
 v_lshlrev_b32 v20, 16, v58
 v_and_b32 v19, 0xffff0000, v57
 v_lshlrev_b32 v18, 16, v57
 v_and_b32 v17, 0xffff0000, v56
 v_lshlrev_b32 v16, 16, v56
 v_pk_add_f32 v[10:11], v[16:17], v[18:19]
 v_pk_add_f32 v[10:11], v[10:11], v[20:21]
 v_pk_add_f32 v[10:11], v[10:11], v[22:23]
 v_pk_add_f32 v[10:11], v[10:11], v[24:25]
 v_pk_add_f32 v[10:11], v[10:11], v[26:27]
 v_pk_add_f32 v[10:11], v[10:11], v[28:29]
 v_pk_add_f32 v[10:11], v[10:11], v[30:31]
 v_pk_add_f32 v[10:11], v[10:11], v[32:33]
 v_pk_add_f32 v[10:11], v[10:11], v[34:35]
 v_pk_add_f32 v[10:11], v[10:11], v[36:37]
 v_pk_add_f32 v[10:11], v[10:11], v[38:39]
 v_pk_add_f32 v[10:11], v[10:11], v[40:41]
 v_pk_add_f32 v[10:11], v[10:11], v[42:43]
 v_pk_add_f32 v[10:11], v[10:11], v[44:45]
 v_pk_add_f32 v[10:11], v[10:11], v[46:47]
 v_pk_add_f32 v[10:11], v[10:11], v[48:49]
 v_pk_add_f32 v[10:11], v[10:11], v[50:51]
 v_pk_add_f32 v[10:11], v[10:11], v[52:53]
 v_pk_add_f32 v[10:11], v[10:11], v[54:55]
 v_add_f32 v10, v10, v11
 v_mov_b32 v11, v10
 s_nop 1
 v_permlane16_swap_b32 v10, v11
 v_add_f32 v10, v10, v11
 v_mov_b32 v11, v10
 s_nop 1
 v_permlane32_swap_b32 v10, v11
 v_add_f32 v10, v10, v11
 ds_write_b32 v6, v10 offset:0
 s_waitcnt lgkmcnt(0)
 s_barrier
 ds_read_b128 v[10:13], v7 offset:0
 s_waitcnt lgkmcnt(0)
 v_pk_add_f32 v[10:11], v[10:11], v[12:13]
 v_add_f32 v10, v10, v11
 v_mul_f32 v10, 0x3acccccd, v10
 v_mov_b32 v8, v10
 v_pk_add_f32 v[12:13], v[16:17], v[8:9] op_sel_hi:[1,0] neg_lo:[0,1] neg_hi:[0,1]
 v_pk_mul_f32 v[10:11], v[12:13], v[12:13]
 v_pk_add_f32 v[12:13], v[18:19], v[8:9] op_sel_hi:[1,0] neg_lo:[0,1] neg_hi:[0,1]
 v_pk_fma_f32 v[10:11], v[12:13], v[12:13], v[10:11]
 v_pk_add_f32 v[12:13], v[20:21], v[8:9] op_sel_hi:[1,0] neg_lo:[0,1] neg_hi:[0,1]
 v_pk_fma_f32 v[10:11], v[12:13], v[12:13], v[10:11]
 v_pk_add_f32 v[12:13], v[22:23], v[8:9] op_sel_hi:[1,0] neg_lo:[0,1] neg_hi:[0,1]
 v_pk_fma_f32 v[10:11], v[12:13], v[12:13], v[10:11]
 v_pk_add_f32 v[12:13], v[24:25], v[8:9] op_sel_hi:[1,0] neg_lo:[0,1] neg_hi:[0,1]
 v_pk_fma_f32 v[10:11], v[12:13], v[12:13], v[10:11]
 v_pk_add_f32 v[12:13], v[26:27], v[8:9] op_sel_hi:[1,0] neg_lo:[0,1] neg_hi:[0,1]
 v_pk_fma_f32 v[10:11], v[12:13], v[12:13], v[10:11]
 v_pk_add_f32 v[12:13], v[28:29], v[8:9] op_sel_hi:[1,0] neg_lo:[0,1] neg_hi:[0,1]
 v_pk_fma_f32 v[10:11], v[12:13], v[12:13], v[10:11]
 v_pk_add_f32 v[12:13], v[30:31], v[8:9] op_sel_hi:[1,0] neg_lo:[0,1] neg_hi:[0,1]
 v_pk_fma_f32 v[10:11], v[12:13], v[12:13], v[10:11]
 v_pk_add_f32 v[12:13], v[32:33], v[8:9] op_sel_hi:[1,0] neg_lo:[0,1] neg_hi:[0,1]
 v_pk_fma_f32 v[10:11], v[12:13], v[12:13], v[10:11]
 v_pk_add_f32 v[12:13], v[34:35], v[8:9] op_sel_hi:[1,0] neg_lo:[0,1] neg_hi:[0,1]
 v_pk_fma_f32 v[10:11], v[12:13], v[12:13], v[10:11]
 v_pk_add_f32 v[12:13], v[36:37], v[8:9] op_sel_hi:[1,0] neg_lo:[0,1] neg_hi:[0,1]
 v_pk_fma_f32 v[10:11], v[12:13], v[12:13], v[10:11]
 v_pk_add_f32 v[12:13], v[38:39], v[8:9] op_sel_hi:[1,0] neg_lo:[0,1] neg_hi:[0,1]
 v_pk_fma_f32 v[10:11], v[12:13], v[12:13], v[10:11]
 v_pk_add_f32 v[12:13], v[40:41], v[8:9] op_sel_hi:[1,0] neg_lo:[0,1] neg_hi:[0,1]
 v_pk_fma_f32 v[10:11], v[12:13], v[12:13], v[10:11]
 v_pk_add_f32 v[12:13], v[42:43], v[8:9] op_sel_hi:[1,0] neg_lo:[0,1] neg_hi:[0,1]
 v_pk_fma_f32 v[10:11], v[12:13], v[12:13], v[10:11]
 v_pk_add_f32 v[12:13], v[44:45], v[8:9] op_sel_hi:[1,0] neg_lo:[0,1] neg_hi:[0,1]
 v_pk_fma_f32 v[10:11], v[12:13], v[12:13], v[10:11]
 v_pk_add_f32 v[12:13], v[46:47], v[8:9] op_sel_hi:[1,0] neg_lo:[0,1] neg_hi:[0,1]
 v_pk_fma_f32 v[10:11], v[12:13], v[12:13], v[10:11]
 v_pk_add_f32 v[12:13], v[48:49], v[8:9] op_sel_hi:[1,0] neg_lo:[0,1] neg_hi:[0,1]
 v_pk_fma_f32 v[10:11], v[12:13], v[12:13], v[10:11]
 v_pk_add_f32 v[12:13], v[50:51], v[8:9] op_sel_hi:[1,0] neg_lo:[0,1] neg_hi:[0,1]
 v_pk_fma_f32 v[10:11], v[12:13], v[12:13], v[10:11]
 v_pk_add_f32 v[12:13], v[52:53], v[8:9] op_sel_hi:[1,0] neg_lo:[0,1] neg_hi:[0,1]
 v_pk_fma_f32 v[10:11], v[12:13], v[12:13], v[10:11]
 v_pk_add_f32 v[12:13], v[54:55], v[8:9] op_sel_hi:[1,0] neg_lo:[0,1] neg_hi:[0,1]
 v_pk_fma_f32 v[10:11], v[12:13], v[12:13], v[10:11]
 v_add_f32 v10, v10, v11
 v_mov_b32 v11, v10
 s_nop 1
 v_permlane16_swap_b32 v10, v11
 v_add_f32 v10, v10, v11
 v_mov_b32 v11, v10
 s_nop 1
 v_permlane32_swap_b32 v10, v11
 v_add_f32 v10, v10, v11
 ds_write_b32 v6, v10 offset:256
 s_waitcnt lgkmcnt(0)
 s_barrier
 ds_read_b128 v[10:13], v7 offset:256
 s_waitcnt lgkmcnt(0)
 v_pk_add_f32 v[10:11], v[10:11], v[12:13]
 v_add_f32 v10, v10, v11
 v_mul_f32 v10, 0x3acccccd, v10
 v_cvt_pk_bf16_f32 v10, 0, v10
 v_add_f32 v10, 0x3727c5ac, v10
 v_cvt_pk_bf16_f32 v10, 0, v10
 v_sqrt_f32 v10, v10
 v_cvt_pk_bf16_f32 v8, 0, v8
 v_cvt_pk_bf16_f32 v10, 0, v10
 v_rcp_f32 v10, v10
 v_pk_add_f32 v[16:17], v[16:17], v[8:9] op_sel_hi:[1,0] neg_lo:[0,1] neg_hi:[0,1]
 v_pk_add_f32 v[18:19], v[18:19], v[8:9] op_sel_hi:[1,0] neg_lo:[0,1] neg_hi:[0,1]
 v_pk_add_f32 v[20:21], v[20:21], v[8:9] op_sel_hi:[1,0] neg_lo:[0,1] neg_hi:[0,1]
 v_pk_add_f32 v[22:23], v[22:23], v[8:9] op_sel_hi:[1,0] neg_lo:[0,1] neg_hi:[0,1]
 v_pk_add_f32 v[24:25], v[24:25], v[8:9] op_sel_hi:[1,0] neg_lo:[0,1] neg_hi:[0,1]
 v_pk_add_f32 v[26:27], v[26:27], v[8:9] op_sel_hi:[1,0] neg_lo:[0,1] neg_hi:[0,1]
 v_pk_add_f32 v[28:29], v[28:29], v[8:9] op_sel_hi:[1,0] neg_lo:[0,1] neg_hi:[0,1]
 v_pk_add_f32 v[30:31], v[30:31], v[8:9] op_sel_hi:[1,0] neg_lo:[0,1] neg_hi:[0,1]
 v_pk_add_f32 v[32:33], v[32:33], v[8:9] op_sel_hi:[1,0] neg_lo:[0,1] neg_hi:[0,1]
 v_pk_add_f32 v[34:35], v[34:35], v[8:9] op_sel_hi:[1,0] neg_lo:[0,1] neg_hi:[0,1]
 v_pk_add_f32 v[36:37], v[36:37], v[8:9] op_sel_hi:[1,0] neg_lo:[0,1] neg_hi:[0,1]
 v_pk_add_f32 v[38:39], v[38:39], v[8:9] op_sel_hi:[1,0] neg_lo:[0,1] neg_hi:[0,1]
 v_pk_add_f32 v[40:41], v[40:41], v[8:9] op_sel_hi:[1,0] neg_lo:[0,1] neg_hi:[0,1]
 v_pk_add_f32 v[42:43], v[42:43], v[8:9] op_sel_hi:[1,0] neg_lo:[0,1] neg_hi:[0,1]
 v_pk_add_f32 v[44:45], v[44:45], v[8:9] op_sel_hi:[1,0] neg_lo:[0,1] neg_hi:[0,1]
 v_pk_add_f32 v[46:47], v[46:47], v[8:9] op_sel_hi:[1,0] neg_lo:[0,1] neg_hi:[0,1]
 v_pk_add_f32 v[48:49], v[48:49], v[8:9] op_sel_hi:[1,0] neg_lo:[0,1] neg_hi:[0,1]
 v_pk_add_f32 v[50:51], v[50:51], v[8:9] op_sel_hi:[1,0] neg_lo:[0,1] neg_hi:[0,1]
 v_pk_add_f32 v[52:53], v[52:53], v[8:9] op_sel_hi:[1,0] neg_lo:[0,1] neg_hi:[0,1]
 v_pk_add_f32 v[54:55], v[54:55], v[8:9] op_sel_hi:[1,0] neg_lo:[0,1] neg_hi:[0,1]
 v_cvt_pk_bf16_f32 v16, 0, v16
 v_cvt_pk_bf16_f32 v17, 0, v17
 v_cvt_pk_bf16_f32 v18, 0, v18
 v_cvt_pk_bf16_f32 v19, 0, v19
 v_cvt_pk_bf16_f32 v20, 0, v20
 v_cvt_pk_bf16_f32 v21, 0, v21
 v_cvt_pk_bf16_f32 v22, 0, v22
 v_cvt_pk_bf16_f32 v23, 0, v23
 v_cvt_pk_bf16_f32 v24, 0, v24
 v_cvt_pk_bf16_f32 v25, 0, v25
 v_cvt_pk_bf16_f32 v26, 0, v26
 v_cvt_pk_bf16_f32 v27, 0, v27
 v_cvt_pk_bf16_f32 v28, 0, v28
 v_cvt_pk_bf16_f32 v29, 0, v29
 v_cvt_pk_bf16_f32 v30, 0, v30
 v_cvt_pk_bf16_f32 v31, 0, v31
 v_cvt_pk_bf16_f32 v32, 0, v32
 v_cvt_pk_bf16_f32 v33, 0, v33
 v_cvt_pk_bf16_f32 v34, 0, v34
 v_cvt_pk_bf16_f32 v35, 0, v35
 v_cvt_pk_bf16_f32 v36, 0, v36
 v_cvt_pk_bf16_f32 v37, 0, v37
 v_cvt_pk_bf16_f32 v38, 0, v38
 v_cvt_pk_bf16_f32 v39, 0, v39
 v_cvt_pk_bf16_f32 v40, 0, v40
 v_cvt_pk_bf16_f32 v41, 0, v41
 v_cvt_pk_bf16_f32 v42, 0, v42
 v_cvt_pk_bf16_f32 v43, 0, v43
 v_cvt_pk_bf16_f32 v44, 0, v44
 v_cvt_pk_bf16_f32 v45, 0, v45
 v_cvt_pk_bf16_f32 v46, 0, v46
 v_cvt_pk_bf16_f32 v47, 0, v47
 v_cvt_pk_bf16_f32 v48, 0, v48
 v_cvt_pk_bf16_f32 v49, 0, v49
 v_cvt_pk_bf16_f32 v50, 0, v50
 v_cvt_pk_bf16_f32 v51, 0, v51
 v_cvt_pk_bf16_f32 v52, 0, v52
 v_cvt_pk_bf16_f32 v53, 0, v53
 v_cvt_pk_bf16_f32 v54, 0, v54
 v_cvt_pk_bf16_f32 v55, 0, v55
 v_pk_mul_f32 v[16:17], v[16:17], v[10:11] op_sel_hi:[1,0]
 v_pk_mul_f32 v[18:19], v[18:19], v[10:11] op_sel_hi:[1,0]
 v_pk_mul_f32 v[20:21], v[20:21], v[10:11] op_sel_hi:[1,0]
 v_pk_mul_f32 v[22:23], v[22:23], v[10:11] op_sel_hi:[1,0]
 v_pk_mul_f32 v[24:25], v[24:25], v[10:11] op_sel_hi:[1,0]
 v_pk_mul_f32 v[26:27], v[26:27], v[10:11] op_sel_hi:[1,0]
 v_pk_mul_f32 v[28:29], v[28:29], v[10:11] op_sel_hi:[1,0]
 v_pk_mul_f32 v[30:31], v[30:31], v[10:11] op_sel_hi:[1,0]
 v_pk_mul_f32 v[32:33], v[32:33], v[10:11] op_sel_hi:[1,0]
 v_pk_mul_f32 v[34:35], v[34:35], v[10:11] op_sel_hi:[1,0]
 v_pk_mul_f32 v[36:37], v[36:37], v[10:11] op_sel_hi:[1,0]
 v_pk_mul_f32 v[38:39], v[38:39], v[10:11] op_sel_hi:[1,0]
 v_pk_mul_f32 v[40:41], v[40:41], v[10:11] op_sel_hi:[1,0]
 v_pk_mul_f32 v[42:43], v[42:43], v[10:11] op_sel_hi:[1,0]
 v_pk_mul_f32 v[44:45], v[44:45], v[10:11] op_sel_hi:[1,0]
 v_pk_mul_f32 v[46:47], v[46:47], v[10:11] op_sel_hi:[1,0]
 v_pk_mul_f32 v[48:49], v[48:49], v[10:11] op_sel_hi:[1,0]
 v_pk_mul_f32 v[50:51], v[50:51], v[10:11] op_sel_hi:[1,0]
 v_pk_mul_f32 v[52:53], v[52:53], v[10:11] op_sel_hi:[1,0]
 v_pk_mul_f32 v[54:55], v[54:55], v[10:11] op_sel_hi:[1,0]
 v_cvt_pk_bf16_f32 v56, v16, v17
 v_cvt_pk_bf16_f32 v57, v18, v19
 v_cvt_pk_bf16_f32 v58, v20, v21
 v_cvt_pk_bf16_f32 v59, v22, v23
 v_cvt_pk_bf16_f32 v60, v24, v25
 v_cvt_pk_bf16_f32 v61, v26, v27
 v_cvt_pk_bf16_f32 v62, v28, v29
 v_cvt_pk_bf16_f32 v63, v30, v31
 v_cvt_pk_bf16_f32 v64, v32, v33
 v_cvt_pk_bf16_f32 v65, v34, v35
 v_cvt_pk_bf16_f32 v66, v36, v37
 v_cvt_pk_bf16_f32 v67, v38, v39
 v_cvt_pk_bf16_f32 v68, v40, v41
 v_cvt_pk_bf16_f32 v69, v42, v43
 v_cvt_pk_bf16_f32 v70, v44, v45
 v_cvt_pk_bf16_f32 v71, v46, v47
 v_cvt_pk_bf16_f32 v72, v48, v49
 v_cvt_pk_bf16_f32 v73, v50, v51
 v_cvt_pk_bf16_f32 v74, v52, v53
 v_cvt_pk_bf16_f32 v75, v54, v55
 ds_write_b128 v77, v[56:59] offset:0
 ds_write_b128 v77, v[60:63] offset:1024
 ds_write_b128 v77, v[64:67] offset:2048
 ds_write_b128 v77, v[68:71] offset:3072
 ds_write_b128 v77, v[72:75] offset:4096
 s_waitcnt lgkmcnt(0)
 s_barrier
 ds_read_b128 v[160:163], v1 offset:1024
 ds_read_b128 v[164:167], v1 offset:2048
 s_waitcnt lgkmcnt(1)
 v_mfma_f32_16x16x32_bf16 v[80:83], v[192:195], v[160:163], 0
 ds_read_b128 v[168:171], v1 offset:3072
 v_mfma_f32_16x16x32_bf16 v[84:87], v[196:199], v[160:163], 0
 v_mfma_f32_16x16x32_bf16 v[88:91], v[200:203], v[160:163], 0
 v_mfma_f32_16x16x32_bf16 v[92:95], v[204:207], v[160:163], 0
 s_waitcnt lgkmcnt(1)
 v_mfma_f32_16x16x32_bf16 v[80:83], v[208:211], v[164:167], v[80:83]
 ds_read_b128 v[160:163], v1 offset:4096
 v_mfma_f32_16x16x32_bf16 v[84:87], v[212:215], v[164:167], v[84:87]
 v_mfma_f32_16x16x32_bf16 v[88:91], v[216:219], v[164:167], v[88:91]
 v_mfma_f32_16x16x32_bf16 v[92:95], v[220:223], v[164:167], v[92:95]
 s_waitcnt lgkmcnt(1)
 v_mfma_f32_16x16x32_bf16 v[80:83], v[224:227], v[168:171], v[80:83]
 ds_read_b128 v[164:167], v1 offset:5120
 v_mfma_f32_16x16x32_bf16 v[84:87], v[228:231], v[168:171], v[84:87]
 v_mfma_f32_16x16x32_bf16 v[88:91], v[232:235], v[168:171], v[88:91]
 v_mfma_f32_16x16x32_bf16 v[92:95], v[236:239], v[168:171], v[92:95]
 s_waitcnt lgkmcnt(1)
 v_mfma_f32_16x16x32_bf16 v[80:83], v[240:243], v[160:163], v[80:83]
 ds_read_b128 v[168:171], v1 offset:6144
 v_mfma_f32_16x16x32_bf16 v[84:87], v[244:247], v[160:163], v[84:87]
 v_mfma_f32_16x16x32_bf16 v[88:91], v[248:251], v[160:163], v[88:91]
 v_mfma_f32_16x16x32_bf16 v[92:95], v[252:255], v[160:163], v[92:95]
 s_waitcnt lgkmcnt(1)
 v_mfma_f32_16x16x32_bf16 v[80:83], a[0:3], v[164:167], v[80:83]
 ds_read_b128 v[160:163], v1 offset:7168
 v_mfma_f32_16x16x32_bf16 v[84:87], a[4:7], v[164:167], v[84:87]
 v_mfma_f32_16x16x32_bf16 v[88:91], a[8:11], v[164:167], v[88:91]
 v_mfma_f32_16x16x32_bf16 v[92:95], a[12:15], v[164:167], v[92:95]
 s_waitcnt lgkmcnt(1)
 v_mfma_f32_16x16x32_bf16 v[80:83], a[16:19], v[168:171], v[80:83]
 ds_read_b128 v[164:167], v1 offset:8192
 v_mfma_f32_16x16x32_bf16 v[84:87], a[20:23], v[168:171], v[84:87]
 v_mfma_f32_16x16x32_bf16 v[88:91], a[24:27], v[168:171], v[88:91]
 v_mfma_f32_16x16x32_bf16 v[92:95], a[28:31], v[168:171], v[92:95]
 s_waitcnt lgkmcnt(1)
 v_mfma_f32_16x16x32_bf16 v[80:83], a[32:35], v[160:163], v[80:83]
 ds_read_b128 v[168:171], v1 offset:9216
 v_mfma_f32_16x16x32_bf16 v[84:87], a[36:39], v[160:163], v[84:87]
 v_mfma_f32_16x16x32_bf16 v[88:91], a[40:43], v[160:163], v[88:91]
 v_mfma_f32_16x16x32_bf16 v[92:95], a[44:47], v[160:163], v[92:95]
 s_waitcnt lgkmcnt(1)
 v_mfma_f32_16x16x32_bf16 v[80:83], a[48:51], v[164:167], v[80:83]
 ds_read_b128 v[160:163], v1 offset:10240
 v_mfma_f32_16x16x32_bf16 v[84:87], a[52:55], v[164:167], v[84:87]
 v_mfma_f32_16x16x32_bf16 v[88:91], a[56:59], v[164:167], v[88:91]
 v_mfma_f32_16x16x32_bf16 v[92:95], a[60:63], v[164:167], v[92:95]
 s_waitcnt lgkmcnt(1)
 v_mfma_f32_16x16x32_bf16 v[80:83], a[64:67], v[168:171], v[80:83]
 ds_read_b128 v[164:167], v1 offset:11264
 v_mfma_f32_16x16x32_bf16 v[84:87], a[68:71], v[168:171], v[84:87]
 v_mfma_f32_16x16x32_bf16 v[88:91], a[72:75], v[168:171], v[88:91]
 v_mfma_f32_16x16x32_bf16 v[92:95], a[76:79], v[168:171], v[92:95]
 s_waitcnt lgkmcnt(1)
 v_mfma_f32_16x16x32_bf16 v[80:83], a[80:83], v[160:163], v[80:83]
 ds_read_b128 v[168:171], v1 offset:12288
 v_mfma_f32_16x16x32_bf16 v[84:87], a[84:87], v[160:163], v[84:87]
 v_mfma_f32_16x16x32_bf16 v[88:91], a[88:91], v[160:163], v[88:91]
 v_mfma_f32_16x16x32_bf16 v[92:95], a[92:95], v[160:163], v[92:95]
 s_waitcnt lgkmcnt(1)
 v_mfma_f32_16x16x32_bf16 v[80:83], a[96:99], v[164:167], v[80:83]
 ds_read_b128 v[160:163], v1 offset:13312
 v_mfma_f32_16x16x32_bf16 v[84:87], a[100:103], v[164:167], v[84:87]
 v_mfma_f32_16x16x32_bf16 v[88:91], a[104:107], v[164:167], v[88:91]
 v_mfma_f32_16x16x32_bf16 v[92:95], a[108:111], v[164:167], v[92:95]
 s_waitcnt lgkmcnt(1)
 v_mfma_f32_16x16x32_bf16 v[80:83], a[112:115], v[168:171], v[80:83]
 ds_read_b128 v[164:167], v1 offset:14336
 v_mfma_f32_16x16x32_bf16 v[84:87], a[116:119], v[168:171], v[84:87]
 v_mfma_f32_16x16x32_bf16 v[88:91], a[120:123], v[168:171], v[88:91]
 v_mfma_f32_16x16x32_bf16 v[92:95], a[124:127], v[168:171], v[92:95]
 s_waitcnt lgkmcnt(1)
 v_mfma_f32_16x16x32_bf16 v[80:83], a[128:131], v[160:163], v[80:83]
 ds_read_b128 v[168:171], v1 offset:15360
 v_mfma_f32_16x16x32_bf16 v[84:87], a[132:135], v[160:163], v[84:87]
 v_mfma_f32_16x16x32_bf16 v[88:91], a[136:139], v[160:163], v[88:91]
 v_mfma_f32_16x16x32_bf16 v[92:95], a[140:143], v[160:163], v[92:95]
 s_waitcnt lgkmcnt(1)
 v_mfma_f32_16x16x32_bf16 v[80:83], a[144:147], v[164:167], v[80:83]
 ds_read_b128 v[160:163], v1 offset:16384
 v_mfma_f32_16x16x32_bf16 v[84:87], a[148:151], v[164:167], v[84:87]
 v_mfma_f32_16x16x32_bf16 v[88:91], a[152:155], v[164:167], v[88:91]
 v_mfma_f32_16x16x32_bf16 v[92:95], a[156:159], v[164:167], v[92:95]
 s_waitcnt lgkmcnt(1)
 v_mfma_f32_16x16x32_bf16 v[80:83], a[160:163], v[168:171], v[80:83]
 ds_read_b128 v[164:167], v1 offset:17408
 v_mfma_f32_16x16x32_bf16 v[84:87], a[164:167], v[168:171], v[84:87]
 v_mfma_f32_16x16x32_bf16 v[88:91], a[168:171], v[168:171], v[88:91]
 v_mfma_f32_16x16x32_bf16 v[92:95], a[172:175], v[168:171], v[92:95]
 s_waitcnt lgkmcnt(1)
 v_mfma_f32_16x16x32_bf16 v[80:83], a[176:179], v[160:163], v[80:83]
 ds_read_b128 v[168:171], v1 offset:18432
 v_mfma_f32_16x16x32_bf16 v[84:87], a[180:183], v[160:163], v[84:87]
 v_mfma_f32_16x16x32_bf16 v[88:91], a[184:187], v[160:163], v[88:91]
 v_mfma_f32_16x16x32_bf16 v[92:95], a[188:191], v[160:163], v[92:95]
 s_waitcnt lgkmcnt(1)
 v_mfma_f32_16x16x32_bf16 v[80:83], a[192:195], v[164:167], v[80:83]
 ds_read_b128 v[160:163], v1 offset:19456
 v_mfma_f32_16x16x32_bf16 v[84:87], a[196:199], v[164:167], v[84:87]
 v_mfma_f32_16x16x32_bf16 v[88:91], a[200:203], v[164:167], v[88:91]
 v_mfma_f32_16x16x32_bf16 v[92:95], a[204:207], v[164:167], v[92:95]
 s_waitcnt lgkmcnt(1)
 v_mfma_f32_16x16x32_bf16 v[80:83], a[208:211], v[168:171], v[80:83]
 ds_read_b128 v[164:167], v1 offset:20480
 v_mfma_f32_16x16x32_bf16 v[84:87], a[212:215], v[168:171], v[84:87]
 v_mfma_f32_16x16x32_bf16 v[88:91], a[216:219], v[168:171], v[88:91]
 v_mfma_f32_16x16x32_bf16 v[92:95], a[220:223], v[168:171], v[92:95]
 s_waitcnt lgkmcnt(1)
 v_mfma_f32_16x16x32_bf16 v[80:83], a[224:227], v[160:163], v[80:83]
 v_mfma_f32_16x16x32_bf16 v[84:87], a[228:231], v[160:163], v[84:87]
 v_mfma_f32_16x16x32_bf16 v[88:91], a[232:235], v[160:163], v[88:91]
 v_mfma_f32_16x16x32_bf16 v[92:95], a[236:239], v[160:163], v[92:95]
 s_waitcnt lgkmcnt(0)
 v_mfma_f32_16x16x32_bf16 v[80:83], a[240:243], v[164:167], v[80:83]
 v_mfma_f32_16x16x32_bf16 v[84:87], a[244:247], v[164:167], v[84:87]
 v_mfma_f32_16x16x32_bf16 v[88:91], a[248:251], v[164:167], v[88:91]
 v_mfma_f32_16x16x32_bf16 v[92:95], a[252:255], v[164:167], v[92:95]
 s_mov_b32 s84, 0xbdd2d3e8
 v_mov_b32 v116, 0xc0135761
 v_cvt_pk_bf16_f32 v80, 0, v80
 v_cvt_pk_bf16_f32 v81, 0, v81
 v_cvt_pk_bf16_f32 v82, 0, v82
 v_cvt_pk_bf16_f32 v83, 0, v83
 v_cvt_pk_bf16_f32 v84, 0, v84
 v_cvt_pk_bf16_f32 v85, 0, v85
 v_cvt_pk_bf16_f32 v86, 0, v86
 v_cvt_pk_bf16_f32 v87, 0, v87
 v_cvt_pk_bf16_f32 v88, 0, v88
 v_cvt_pk_bf16_f32 v89, 0, v89
 v_cvt_pk_bf16_f32 v90, 0, v90
 v_cvt_pk_bf16_f32 v91, 0, v91
 v_cvt_pk_bf16_f32 v92, 0, v92
 v_cvt_pk_bf16_f32 v93, 0, v93
 v_cvt_pk_bf16_f32 v94, 0, v94
 v_cvt_pk_bf16_f32 v95, 0, v95
 v_mul_f32 v100, v80, v80
 v_mul_f32 v101, v81, v81
 v_mul_f32 v102, v82, v82
 v_mul_f32 v103, v83, v83
 v_mul_f32 v104, v84, v84
 v_mul_f32 v105, v85, v85
 v_mul_f32 v106, v86, v86
 v_mul_f32 v107, v87, v87
 v_mul_f32 v108, v88, v88
 v_mul_f32 v109, v89, v89
 v_mul_f32 v110, v90, v90
 v_mul_f32 v111, v91, v91
 v_mul_f32 v112, v92, v92
 v_mul_f32 v113, v93, v93
 v_mul_f32 v114, v94, v94
 v_mul_f32 v115, v95, v95
 v_fma_f32 v100, v100, s84, v116
 v_fma_f32 v101, v101, s84, v116
 v_fma_f32 v102, v102, s84, v116
 v_fma_f32 v103, v103, s84, v116
 v_fma_f32 v104, v104, s84, v116
 v_fma_f32 v105, v105, s84, v116
 v_fma_f32 v106, v106, s84, v116
 v_fma_f32 v107, v107, s84, v116
 v_fma_f32 v108, v108, s84, v116
 v_fma_f32 v109, v109, s84, v116
 v_fma_f32 v110, v110, s84, v116
 v_fma_f32 v111, v111, s84, v116
 v_fma_f32 v112, v112, s84, v116
 v_fma_f32 v113, v113, s84, v116
 v_fma_f32 v114, v114, s84, v116
 v_fma_f32 v115, v115, s84, v116
 v_mul_f32 v100, v100, v80
 v_mul_f32 v101, v101, v81
 v_mul_f32 v102, v102, v82
 v_mul_f32 v103, v103, v83
 v_mul_f32 v104, v104, v84
 v_mul_f32 v105, v105, v85
 v_mul_f32 v106, v106, v86
 v_mul_f32 v107, v107, v87
 v_mul_f32 v108, v108, v88
 v_mul_f32 v109, v109, v89
 v_mul_f32 v110, v110, v90
 v_mul_f32 v111, v111, v91
 v_mul_f32 v112, v112, v92
 v_mul_f32 v113, v113, v93
 v_mul_f32 v114, v114, v94
 v_mul_f32 v115, v115, v95
 v_exp_f32 v100, v100
 v_exp_f32 v101, v101
 v_exp_f32 v102, v102
 v_exp_f32 v103, v103
 v_exp_f32 v104, v104
 v_exp_f32 v105, v105
 v_exp_f32 v106, v106
 v_exp_f32 v107, v107
 v_exp_f32 v108, v108
 v_exp_f32 v109, v109
 v_exp_f32 v110, v110
 v_exp_f32 v111, v111
 v_exp_f32 v112, v112
 v_exp_f32 v113, v113
 v_exp_f32 v114, v114
 v_exp_f32 v115, v115
 v_add_f32 v100, 1.0, v100
 v_add_f32 v101, 1.0, v101
 v_add_f32 v102, 1.0, v102
 v_add_f32 v103, 1.0, v103
 v_add_f32 v104, 1.0, v104
 v_add_f32 v105, 1.0, v105
 v_add_f32 v106, 1.0, v106
 v_add_f32 v107, 1.0, v107
 v_add_f32 v108, 1.0, v108
 v_add_f32 v109, 1.0, v109
 v_add_f32 v110, 1.0, v110
 v_add_f32 v111, 1.0, v111
 v_add_f32 v112, 1.0, v112
 v_add_f32 v113, 1.0, v113
 v_add_f32 v114, 1.0, v114
 v_add_f32 v115, 1.0, v115
 v_rcp_f32 v100, v100
 v_rcp_f32 v101, v101
 v_rcp_f32 v102, v102
 v_rcp_f32 v103, v103
 v_rcp_f32 v104, v104
 v_rcp_f32 v105, v105
 v_rcp_f32 v106, v106
 v_rcp_f32 v107, v107
 v_rcp_f32 v108, v108
 v_rcp_f32 v109, v109
 v_rcp_f32 v110, v110
 v_rcp_f32 v111, v111
 v_rcp_f32 v112, v112
 v_rcp_f32 v113, v113
 v_rcp_f32 v114, v114
 v_rcp_f32 v115, v115
 v_mul_f32 v80, v80, v100
 v_mul_f32 v81, v81, v101
 v_mul_f32 v82, v82, v102
 v_mul_f32 v83, v83, v103
 v_mul_f32 v84, v84, v104
 v_mul_f32 v85, v85, v105
 v_mul_f32 v86, v86, v106
 v_mul_f32 v87, v87, v107
 v_mul_f32 v88, v88, v108
 v_mul_f32 v89, v89, v109
 v_mul_f32 v90, v90, v110
 v_mul_f32 v91, v91, v111
 v_mul_f32 v92, v92, v112
 v_mul_f32 v93, v93, v113
 v_mul_f32 v94, v94, v114
 v_mul_f32 v95, v95, v115
 v_cvt_pk_bf16_f32 v120, v80, v81
 v_cvt_pk_bf16_f32 v121, v82, v83
 v_cvt_pk_bf16_f32 v122, v84, v85
 v_cvt_pk_bf16_f32 v123, v86, v87
 v_cvt_pk_bf16_f32 v124, v88, v89
 v_cvt_pk_bf16_f32 v125, v90, v91
 v_cvt_pk_bf16_f32 v126, v92, v93
 v_cvt_pk_bf16_f32 v127, v94, v95
 s_mul_i32 s78, s82, 55296
 s_add_u32 s78, s78, 0x1a00000
 s_add_u32 s73, s77, s78
 buffer_store_dwordx4 v[120:123], v1, s[8:11], s73 offen sc1
 s_add_u32 s73, s86, s78
 buffer_store_dwordx4 v[124:127], v1, s[8:11], s73 offen sc1
 s_add_u32 s3, s82, 1
 s_add_u32 s82, s82, s100
 s_cmp_lt_u32 s82, 128
 s_cbranch_scc1 t5_loop
 s_waitcnt vmcnt(0)
 s_barrier
 s_cmp_lg_u32 s66, 0
 s_cbranch_scc1 notw0_106
 v_mov_b32 v4, s3
 v_mov_b32 v5, 0
 s_mov_b64 exec, 1
 buffer_store_dword v4, v5, s[8:11], s4 offen sc1
 s_mov_b64 exec, -1
notw0_106:
 s_waitcnt vmcnt(0)
 s_endpgm
rec_helper:
 s_cmp_lg_u32 s67, 0
 s_cbranch_scc1 bail2
 s_cmp_ge_u32 s68, 15
 s_cbranch_scc1 bail2
 v_mbcnt_lo_u32_b32 v0, -1, 0
 v_mbcnt_hi_u32_b32 v0, -1, v0
 v_lshlrev_b32 v1, 4, v0
 s_mov_b32 s72, 0
 s_mov_b32 s81, s68
 s_mov_b32 s80, 125
 s_mov_b32 s100, 128
 s_barrier
 s_cmp_lt_u32 s68, 10
 s_cbranch_scc1 t6
 s_sub_u32 s81, s68, 10
 s_mov_b32 s80, 124
 s_branch t4
bail2:
 s_endpgm
rec_role:
 s_mov_b32 s12, s34
 s_and_b32 s13, s35, 0xffff
 s_mov_b32 s14, 0x2800
 s_mov_b32 s15, 0x20000
 v_and_b32 v72, 7, v0
 v_lshrrev_b32 v73, 3, v0
 v_lshrrev_b32 v74, 3, v73
 v_lshl_add_u32 v74, v74, 3, v72
 v_and_b32 v1, 7, v73
 v_lshlrev_b32 v74, 4, v74
 v_lshl_add_u32 v74, v1, 1, v74
 v_and_b32 v75, 16, v73
 v_and_b32 v1, 3, v73
 v_lshl_add_u32 v75, v1, 2, v75
 v_bfe_u32 v1, v73, 2, 1
 v_lshl_add_u32 v75, v1, 1, v75
 v_bfe_u32 v1, v73, 3, 1
 v_add_u32 v75, v1, v75
 v_mul_u32_u24 v72, 640, v72
 v_add_lshl_u32 v72, v72, v75, 1
 s_mul_i32 s87, s67, 640
 s_sub_u32 s88, 640, s87
 buffer_load_ushort v32, v72, s[12:15], s87 offen offset:0
 buffer_load_ushort v33, v72, s[12:15], s87 offen offset:64
 buffer_load_ushort v34, v72, s[12:15], s87 offen offset:128
 buffer_load_ushort v35, v72, s[12:15], s87 offen offset:192
 buffer_load_ushort v36, v72, s[12:15], s87 offen offset:256
 buffer_load_ushort v37, v72, s[12:15], s87 offen offset:320
 buffer_load_ushort v38, v72, s[12:15], s87 offen offset:384
 buffer_load_ushort v39, v72, s[12:15], s87 offen offset:448
 buffer_load_ushort v40, v72, s[12:15], s87 offen offset:512
 buffer_load_ushort v41, v72, s[12:15], s87 offen offset:576
 buffer_load_ushort v42, v72, s[12:15], s88 offen offset:0
 buffer_load_ushort v43, v72, s[12:15], s88 offen offset:64
 buffer_load_ushort v44, v72, s[12:15], s88 offen offset:128
 buffer_load_ushort v45, v72, s[12:15], s88 offen offset:192
 buffer_load_ushort v46, v72, s[12:15], s88 offen offset:256
 buffer_load_ushort v47, v72, s[12:15], s88 offen offset:320
 buffer_load_ushort v48, v72, s[12:15], s88 offen offset:384
 buffer_load_ushort v49, v72, s[12:15], s88 offen offset:448
 buffer_load_ushort v50, v72, s[12:15], s88 offen offset:512
 buffer_load_ushort v51, v72, s[12:15], s88 offen offset:576
 s_waitcnt vmcnt(19)
 ds_write_b16 v74, v32 offset:0
 s_waitcnt vmcnt(18)
 ds_write_b16 v74, v33 offset:512
 s_waitcnt vmcnt(17)
 ds_write_b16 v74, v34 offset:1024
 s_waitcnt vmcnt(16)
 ds_write_b16 v74, v35 offset:1536
 s_waitcnt vmcnt(15)
 ds_write_b16 v74, v36 offset:2048
 s_waitcnt vmcnt(14)
 ds_write_b16 v74, v37 offset:2560
 s_waitcnt vmcnt(13)
 ds_write_b16 v74, v38 offset:3072
 s_waitcnt vmcnt(12)
 ds_write_b16 v74, v39 offset:3584
 s_waitcnt vmcnt(11)
 ds_write_b16 v74, v40 offset:4096
 s_waitcnt vmcnt(10)
 ds_write_b16 v74, v41 offset:4608
 s_waitcnt vmcnt(9)
 ds_write_b16 v74, v42 offset:5120
 s_waitcnt vmcnt(8)
 ds_write_b16 v74, v43 offset:5632
 s_waitcnt vmcnt(7)
 ds_write_b16 v74, v44 offset:6144
 s_waitcnt vmcnt(6)
 ds_write_b16 v74, v45 offset:6656
 s_waitcnt vmcnt(5)
 ds_write_b16 v74, v46 offset:7168
 s_waitcnt vmcnt(4)
 ds_write_b16 v74, v47 offset:7680
 s_waitcnt vmcnt(3)
 ds_write_b16 v74, v48 offset:8192
 s_waitcnt vmcnt(2)
 ds_write_b16 v74, v49 offset:8704
 s_waitcnt vmcnt(1)
 ds_write_b16 v74, v50 offset:9216
 s_waitcnt vmcnt(0)
 ds_write_b16 v74, v51 offset:9728
 s_mov_b32 s12, s36
 s_and_b32 s13, s37, 0xffff
 s_mov_b32 s14, 0x500000
 s_mov_b32 s15, 0x20000
 s_mov_b32 s16, s38
 s_and_b32 s17, s39, 0xffff
 s_mov_b32 s18, 0x500000
 s_mov_b32 s19, 0x20000
 s_mov_b32 s20, s40
 s_and_b32 s21, s41, 0xffff
 s_mov_b32 s22, 0x500000
 s_mov_b32 s23, 0x20000
 s_mov_b32 s24, s42
 s_and_b32 s25, s43, 0xffff
 s_mov_b32 s26, 0x500000
 s_mov_b32 s27, 0x20000
 v_and_b32 v0, 63, v0
 v_and_b32 v72, 15, v0
 v_lshrrev_b32 v73, 4, v0
 v_bfe_u32 v74, v0, 2, 2
 v_and_b32 v75, 1, v0
 v_bfe_u32 v1, v0, 3, 1
 v_mul_u32_u24 v1, 0x5555, v1
 v_add_u32 v1, 0x8888, v1
 v_lshlrev_b32 v6, 4, v0
 v_and_b32 v2, 7, v0
 v_lshl_add_u32 v2, v73, 3, v2
 v_lshlrev_b32 v2, 4, v2
 s_mul_i32 s81, s66, 36864
 s_mul_i32 s87, s66, 28672
 s_add_u32 s87, s87, 16384
 s_cmp_lt_u32 s66, 2
 s_cselect_b32 s81, s81, s87
 s_add_u32 s81, s81, 32768
 v_add_u32 v3, s81, v6
 v_lshrrev_b32 v4, 1, v73
 v_mul_u32_u24 v4, 288, v4
 v_lshl_add_u32 v4, v72, 4, v4
 v_and_b32 v76, 1, v73
 v_lshl_add_u32 v4, v76, 3, v4
 s_mul_i32 s81, s66, 576
 s_add_u32 s81, s81, 10240
 v_add_u32 v4, s81, v4
 v_and_b32 v5, 1, v74
 v_mul_u32_u24 v5, 288, v5
 v_lshrrev_b32 v77, 1, v74
 v_lshl_add_u32 v77, v73, 2, v77
 v_lshl_add_u32 v5, v77, 4, v5
 v_lshl_add_u32 v5, v75, 3, v5
 v_add_u32 v5, 10240, v5
 s_lshl_b32 s81, s66, 9
 s_add_u32 s81, s81, 0
 v_bfe_u32 v7, v0, 3, 1
 v_lshl_add_u32 v7, v7, 11, v2
 v_add_u32 v7, s81, v7
 v_lshlrev_b32 v8, 4, v75
 v_mov_b32 v77, 0x3f80
 v_lshlrev_b32 v8, v8, v77
 v_lshrrev_b32 v9, 3, v72
 v_lshrrev_b32 v77, 1, v73
 v_lshl_add_u32 v9, v9, 1, v77
 v_lshlrev_b32 v9, 12, v9
 v_lshl_add_u32 v9, v76, 6, v9
 v_and_b32 v77, 7, v0
 v_lshl_add_u32 v9, v77, 3, v9
 v_min_u32 v10, 39, v0
 v_lshlrev_b32 v10, 7, v10
 s_and_b32 s86, s66, 1
 s_lshl_b32 s86, s86, 5
 s_add_u32 s86, s86, s68
 s_mul_i32 s85, s67, 40
 s_add_u32 s85, s85, s86
 s_lshl_b32 s85, s85, 12
 s_add_u32 s85, s85, 0x40000
 s_cmp_lt_u32 s86, 40
 s_cselect_b32 s85, s85, 0x40000000
 s_mov_b32 s101, 0x40000000
 v_bfe_u32 v77, v0, 2, 1
 v_lshl_add_u32 v11, v76, 1, v77
 v_lshl_add_u32 v11, v11, 1, v75
 v_bfe_u32 v77, v0, 3, 1
 v_lshl_add_u32 v11, v11, 1, v77
 v_lshrrev_b32 v77, 5, v0
 v_lshl_add_u32 v11, v11, 1, v77
 s_lshl_b32 s81, s86, 7
 v_lshl_add_u32 v11, v11, 2, s81
 s_mov_b32 s90, 0x33333333
 s_mov_b32 s91, 0x33333333
 s_and_b32 s81, s66, 1
 s_mul_i32 s81, s81, 2560
 v_add_u32 v12, s81, v6
 s_add_u32 s81, s81, 2048
 v_lshl_add_u32 v13, v0, 3, s81
 s_lshl_b32 s81, s66, 11
 v_add_u32 v14, s81, v6
 s_add_u32 s97, s81, 16384
 s_lshl_b32 s81, s66, 9
 v_lshl_add_u32 v15, v0, 3, s81
 s_mov_b32 s98, 0x3e0293ee
 s_mov_b32 s99, 0x3e0293ee
 s_mov_b32 s72, 0
 s_mov_b32 s73, 327680
 s_mov_b32 s74, 0
 s_mul_i32 s75, s67, 327680
 s_sub_u32 s78, 2036736, s75
 s_cmp_lt_u32 s86, 40
 s_cselect_b32 s78, s78, 0x40000000
 s_add_u32 s76, s75, 0x1a0000
 s_add_u32 s75, s75, 0x100000
 s_add_u32 s77, s75, 5120
 s_lshl_b32 s79, s68, 13
 s_add_u32 s3, s79, 0x4200000
 s_add_u32 s79, s79, 0x3200000
 s_lshl_b32 s81, s68, 11
 s_add_u32 s80, s81, 0x240000
 s_add_u32 s100, s81, 0x640000
 s_cmp_eq_u32 s67, 0
 s_cselect_b32 s80, s80, 0x40000000
 s_cselect_b32 s100, 0x40000000, s100
 s_waitcnt lgkmcnt(0)
 s_cmp_ge_u32 s66, 2
 s_cbranch_scc1 rec_load1
rec_load0:
 s_lshl_b32 s81, s66, 3
 v_lshrrev_b32 v77, 4, v0
 v_add_u32 v77, s81, v77
 v_and_b32 v78, 15, v0
 v_lshlrev_b32 v72, 13, v77
 v_lshl_add_u32 v72, v78, 4, v72
 v_lshrrev_b32 v77, 2, v0
 v_and_b32 v78, 3, v0
 v_mul_u32_u24 v73, 1280, v77
 v_lshl_add_u32 v73, v78, 4, v73
 s_lshl_b32 s81, s66, 11
 s_add_u32 s81, s81, 16384
 v_add_u32 v74, s81, v6
 v_and_b32 v77, 15, v0
 v_lshl_add_u32 v77, v77, 2, s81
 v_and_b32 v75, 15, v0
 s_lshl_b32 s81, s66, 6
 s_add_u32 s81, s81, 16384
 v_lshl_add_u32 v75, v75, 2, s81
 v_bfe_u32 v78, v0, 4, 1
 v_lshl_add_u32 v75, v78, 9, v75
 v_lshrrev_b32 v78, 5, v0
 v_lshl_add_u32 v75, v78, 8, v75
 v_lshrrev_b32 v78, 4, v0
 v_lshl_add_u32 v76, v78, 8, v77
 s_lshl_b32 s81, s68, 8
 s_mul_i32 s87, s67, 2621440
 s_sub_u32 s88, 2621440, s87
 s_add_u32 s87, s87, s81
 s_add_u32 s88, s88, s81
 s_mul_i32 s82, s66, 3
 s_mul_i32 s83, s68, 163840
 s_mul_i32 s81, s67, 640
 s_add_u32 s83, s83, s81
 s_lshl_b32 s81, s82, 6
 s_add_u32 s83, s83, s81
 v_add_u32 v77, 1024, v76
 s_add_u32 s81, s87, 0x0
 buffer_load_dwordx4 v[208:211], v72, s[20:23], s81 offen
 s_add_u32 s81, s87, 0x8000
 buffer_load_dwordx4 v[212:215], v72, s[20:23], s81 offen
 s_add_u32 s81, s87, 0x40000
 buffer_load_dwordx4 a[96:99], v72, s[20:23], s81 offen
 s_add_u32 s81, s87, 0x48000
 buffer_load_dwordx4 a[100:103], v72, s[20:23], s81 offen
 s_add_u32 s81, s87, 0x80000
 buffer_load_dwordx4 a[176:179], v72, s[20:23], s81 offen
 s_add_u32 s81, s87, 0x88000
 buffer_load_dwordx4 a[180:183], v72, s[20:23], s81 offen
 s_add_u32 s81, s87, 0xc0000
 buffer_load_dwordx4 v[216:219], v72, s[20:23], s81 offen
 s_add_u32 s81, s87, 0xc8000
 buffer_load_dwordx4 v[220:223], v72, s[20:23], s81 offen
 s_add_u32 s81, s87, 0x100000
 buffer_load_dwordx4 a[104:107], v72, s[20:23], s81 offen
 s_add_u32 s81, s87, 0x108000
 buffer_load_dwordx4 a[108:111], v72, s[20:23], s81 offen
 s_add_u32 s81, s87, 0x140000
 buffer_load_dwordx4 a[184:187], v72, s[20:23], s81 offen
 s_add_u32 s81, s87, 0x148000
 buffer_load_dwordx4 a[188:191], v72, s[20:23], s81 offen
 s_add_u32 s81, s87, 0x180000
 buffer_load_dwordx4 v[224:227], v72, s[20:23], s81 offen
 s_add_u32 s81, s87, 0x188000
 buffer_load_dwordx4 v[228:231], v72, s[20:23], s81 offen
 s_add_u32 s81, s87, 0x1c0000
 buffer_load_dwordx4 a[112:115], v72, s[20:23], s81 offen
 s_add_u32 s81, s87, 0x1c8000
 buffer_load_dwordx4 a[116:119], v72, s[20:23], s81 offen
 s_add_u32 s81, s87, 0x200000
 buffer_load_dwordx4 a[192:195], v72, s[20:23], s81 offen
 s_add_u32 s81, s87, 0x208000
 buffer_load_dwordx4 a[196:199], v72, s[20:23], s81 offen
 s_add_u32 s81, s87, 0x240000
 buffer_load_dwordx4 v[232:235], v72, s[20:23], s81 offen
 s_add_u32 s81, s87, 0x248000
 buffer_load_dwordx4 v[236:239], v72, s[20:23], s81 offen
 s_add_u32 s81, s87, 0xc0000
 buffer_load_dwordx4 a[120:123], v72, s[16:19], s81 offen
 s_add_u32 s81, s87, 0xc8000
 buffer_load_dwordx4 a[124:127], v72, s[16:19], s81 offen
 s_add_u32 s81, s87, 0x1c0000
 buffer_load_dwordx4 a[200:203], v72, s[16:19], s81 offen
 s_add_u32 s81, s87, 0x1c8000
 buffer_load_dwordx4 a[204:207], v72, s[16:19], s81 offen
 s_add_u32 s81, s87, 0x0
 buffer_load_dwordx4 v[80:83], v72, s[12:15], s81 offen
 s_add_u32 s81, s87, 0x8000
 buffer_load_dwordx4 v[84:87], v72, s[12:15], s81 offen
 s_add_u32 s81, s87, 0x0
 buffer_load_dwordx4 v[240:243], v72, s[16:19], s81 offen
 s_add_u32 s81, s87, 0x8000
 buffer_load_dwordx4 v[244:247], v72, s[16:19], s81 offen
 s_add_u32 s81, s87, 0x40000
 buffer_load_dwordx4 v[88:91], v72, s[12:15], s81 offen
 s_add_u32 s81, s87, 0x48000
 buffer_load_dwordx4 v[92:95], v72, s[12:15], s81 offen
 s_add_u32 s81, s87, 0x40000
 buffer_load_dwordx4 v[248:251], v72, s[16:19], s81 offen
 s_add_u32 s81, s87, 0x48000
 buffer_load_dwordx4 v[252:255], v72, s[16:19], s81 offen
 s_add_u32 s81, s87, 0x80000
 buffer_load_dwordx4 v[96:99], v72, s[12:15], s81 offen
 s_add_u32 s81, s87, 0x88000
 buffer_load_dwordx4 v[100:103], v72, s[12:15], s81 offen
 s_add_u32 s81, s87, 0x80000
 buffer_load_dwordx4 a[0:3], v72, s[16:19], s81 offen
 s_add_u32 s81, s87, 0x88000
 buffer_load_dwordx4 a[4:7], v72, s[16:19], s81 offen
 s_add_u32 s81, s87, 0xc0000
 buffer_load_dwordx4 v[104:107], v72, s[12:15], s81 offen
 s_add_u32 s81, s87, 0xc8000
 buffer_load_dwordx4 v[108:111], v72, s[12:15], s81 offen
 s_add_u32 s81, s87, 0x100000
 buffer_load_dwordx4 v[112:115], v72, s[12:15], s81 offen
 s_add_u32 s81, s87, 0x108000
 buffer_load_dwordx4 v[116:119], v72, s[12:15], s81 offen
 s_add_u32 s81, s87, 0x100000
 buffer_load_dwordx4 a[8:11], v72, s[16:19], s81 offen
 s_add_u32 s81, s87, 0x108000
 buffer_load_dwordx4 a[12:15], v72, s[16:19], s81 offen
 s_add_u32 s81, s87, 0x140000
 buffer_load_dwordx4 v[120:123], v72, s[12:15], s81 offen
 s_add_u32 s81, s87, 0x148000
 buffer_load_dwordx4 v[124:127], v72, s[12:15], s81 offen
 s_add_u32 s81, s87, 0x140000
 buffer_load_dwordx4 a[16:19], v72, s[16:19], s81 offen
 s_add_u32 s81, s87, 0x148000
 buffer_load_dwordx4 a[20:23], v72, s[16:19], s81 offen
 s_add_u32 s81, s87, 0x180000
 buffer_load_dwordx4 v[128:131], v72, s[12:15], s81 offen
 s_add_u32 s81, s87, 0x188000
 buffer_load_dwordx4 v[132:135], v72, s[12:15], s81 offen
 s_add_u32 s81, s87, 0x180000
 buffer_load_dwordx4 a[24:27], v72, s[16:19], s81 offen
 s_add_u32 s81, s87, 0x188000
 buffer_load_dwordx4 a[28:31], v72, s[16:19], s81 offen
 s_add_u32 s81, s87, 0x1c0000
 buffer_load_dwordx4 v[136:139], v72, s[12:15], s81 offen
 s_add_u32 s81, s87, 0x1c8000
 buffer_load_dwordx4 v[140:143], v72, s[12:15], s81 offen
 s_add_u32 s81, s87, 0x200000
 buffer_load_dwordx4 v[144:147], v72, s[12:15], s81 offen
 s_add_u32 s81, s87, 0x208000
 buffer_load_dwordx4 v[148:151], v72, s[12:15], s81 offen
 s_add_u32 s81, s87, 0x200000
 buffer_load_dwordx4 a[32:35], v72, s[16:19], s81 offen
 s_add_u32 s81, s87, 0x208000
 buffer_load_dwordx4 a[36:39], v72, s[16:19], s81 offen
 s_waitcnt vmcnt(54)
 ds_write_b128 v74, v[208:211] offset:0
 ds_write_b128 v74, v[212:215] offset:1024
 s_waitcnt lgkmcnt(0)
 s_barrier
 ds_read2st64_b32 v[208:209], v75 offset0:0 offset1:4
 ds_read2st64_b32 v[210:211], v75 offset0:8 offset1:12
 ds_read2st64_b32 v[212:213], v75 offset0:16 offset1:20
 ds_read2st64_b32 v[214:215], v75 offset0:24 offset1:28
 s_waitcnt lgkmcnt(0)
 ds_write_b128 v3, v[208:211] offset:0
 ds_write_b128 v3, v[212:215] offset:1024
 s_add_u32 s81, s87, 0x240000
 buffer_load_dwordx4 v[152:155], v72, s[12:15], s81 offen
 s_add_u32 s81, s87, 0x248000
 buffer_load_dwordx4 v[156:159], v72, s[12:15], s81 offen
 s_waitcnt vmcnt(54)
 ds_write_b128 v74, a[96:99] offset:8192
 ds_write_b128 v74, a[100:103] offset:9216
 s_waitcnt lgkmcnt(0)
 s_barrier
 ds_read2st64_b32 a[96:97], v75 offset0:32 offset1:36
 ds_read2st64_b32 a[98:99], v75 offset0:40 offset1:44
 ds_read2st64_b32 a[100:101], v75 offset0:48 offset1:52
 ds_read2st64_b32 a[102:103], v75 offset0:56 offset1:60
 s_waitcnt lgkmcnt(0)
 ds_write_b128 v3, a[96:99] offset:2048
 ds_write_b128 v3, a[100:103] offset:3072
 s_add_u32 s81, s87, 0x240000
 buffer_load_dwordx4 a[40:43], v72, s[16:19], s81 offen
 s_add_u32 s81, s87, 0x248000
 buffer_load_dwordx4 a[44:47], v72, s[16:19], s81 offen
 s_waitcnt vmcnt(54)
 ds_write_b128 v74, a[176:179] offset:0
 ds_write_b128 v74, a[180:183] offset:1024
 s_waitcnt lgkmcnt(0)
 s_barrier
 ds_read2st64_b32 a[176:177], v75 offset0:0 offset1:4
 ds_read2st64_b32 a[178:179], v75 offset0:8 offset1:12
 ds_read2st64_b32 a[180:181], v75 offset0:16 offset1:20
 ds_read2st64_b32 a[182:183], v75 offset0:24 offset1:28
 s_waitcnt lgkmcnt(0)
 ds_write_b128 v3, a[176:179] offset:4096
 ds_write_b128 v3, a[180:183] offset:5120
 s_add_u32 s81, s88, 0x0
 buffer_load_dwordx4 v[160:163], v72, s[12:15], s81 offen
 s_add_u32 s81, s88, 0x8000
 buffer_load_dwordx4 v[164:167], v72, s[12:15], s81 offen
 s_waitcnt vmcnt(54)
 ds_write_b128 v74, v[216:219] offset:8192
 ds_write_b128 v74, v[220:223] offset:9216
 s_waitcnt lgkmcnt(0)
 s_barrier
 ds_read2st64_b32 v[216:217], v75 offset0:32 offset1:36
 ds_read2st64_b32 v[218:219], v75 offset0:40 offset1:44
 ds_read2st64_b32 v[220:221], v75 offset0:48 offset1:52
 ds_read2st64_b32 v[222:223], v75 offset0:56 offset1:60
 s_waitcnt lgkmcnt(0)
 ds_write_b128 v3, v[216:219] offset:8192
 ds_write_b128 v3, v[220:223] offset:9216
 s_add_u32 s81, s88, 0x0
 buffer_load_dwordx4 a[48:51], v72, s[16:19], s81 offen
 s_add_u32 s81, s88, 0x8000
 buffer_load_dwordx4 a[52:55], v72, s[16:19], s81 offen
 s_waitcnt vmcnt(54)
 ds_write_b128 v74, a[104:107] offset:0
 ds_write_b128 v74, a[108:111] offset:1024
 s_waitcnt lgkmcnt(0)
 s_barrier
 ds_read2st64_b32 a[104:105], v75 offset0:0 offset1:4
 ds_read2st64_b32 a[106:107], v75 offset0:8 offset1:12
 ds_read2st64_b32 a[108:109], v75 offset0:16 offset1:20
 ds_read2st64_b32 a[110:111], v75 offset0:24 offset1:28
 s_waitcnt lgkmcnt(0)
 ds_write_b128 v3, a[104:107] offset:10240
 ds_write_b128 v3, a[108:111] offset:11264
 s_add_u32 s81, s88, 0x0
 buffer_load_dwordx4 a[128:131], v72, s[20:23], s81 offen
 s_add_u32 s81, s88, 0x8000
 buffer_load_dwordx4 a[132:135], v72, s[20:23], s81 offen
 s_waitcnt vmcnt(54)
 ds_write_b128 v74, a[184:187] offset:8192
 ds_write_b128 v74, a[188:191] offset:9216
 s_waitcnt lgkmcnt(0)
 s_barrier
 ds_read2st64_b32 a[184:185], v75 offset0:32 offset1:36
 ds_read2st64_b32 a[186:187], v75 offset0:40 offset1:44
 ds_read2st64_b32 a[188:189], v75 offset0:48 offset1:52
 ds_read2st64_b32 a[190:191], v75 offset0:56 offset1:60
 s_waitcnt lgkmcnt(0)
 ds_write_b128 v3, a[184:187] offset:12288
 ds_write_b128 v3, a[188:191] offset:13312
 s_add_u32 s81, s88, 0x40000
 buffer_load_dwordx4 v[168:171], v72, s[12:15], s81 offen
 s_add_u32 s81, s88, 0x48000
 buffer_load_dwordx4 v[172:175], v72, s[12:15], s81 offen
 s_waitcnt vmcnt(54)
 ds_write_b128 v74, v[224:227] offset:0
 ds_write_b128 v74, v[228:231] offset:1024
 s_waitcnt lgkmcnt(0)
 s_barrier
 ds_read2st64_b32 v[224:225], v75 offset0:0 offset1:4
 ds_read2st64_b32 v[226:227], v75 offset0:8 offset1:12
 ds_read2st64_b32 v[228:229], v75 offset0:16 offset1:20
 ds_read2st64_b32 v[230:231], v75 offset0:24 offset1:28
 s_waitcnt lgkmcnt(0)
 ds_write_b128 v3, v[224:227] offset:14336
 ds_write_b128 v3, v[228:231] offset:15360
 s_add_u32 s81, s88, 0x40000
 buffer_load_dwordx4 a[56:59], v72, s[16:19], s81 offen
 s_add_u32 s81, s88, 0x48000
 buffer_load_dwordx4 a[60:63], v72, s[16:19], s81 offen
 s_waitcnt vmcnt(54)
 ds_write_b128 v74, a[112:115] offset:8192
 ds_write_b128 v74, a[116:119] offset:9216
 s_waitcnt lgkmcnt(0)
 s_barrier
 ds_read2st64_b32 a[112:113], v75 offset0:32 offset1:36
 ds_read2st64_b32 a[114:115], v75 offset0:40 offset1:44
 ds_read2st64_b32 a[116:117], v75 offset0:48 offset1:52
 ds_read2st64_b32 a[118:119], v75 offset0:56 offset1:60
 s_waitcnt lgkmcnt(0)
 ds_write_b128 v3, a[112:115] offset:18432
 ds_write_b128 v3, a[116:119] offset:19456
 s_add_u32 s81, s88, 0x40000
 buffer_load_dwordx4 a[136:139], v72, s[20:23], s81 offen
 s_add_u32 s81, s88, 0x48000
 buffer_load_dwordx4 a[140:143], v72, s[20:23], s81 offen
 s_waitcnt vmcnt(54)
 ds_write_b128 v74, a[192:195] offset:0
 ds_write_b128 v74, a[196:199] offset:1024
 s_waitcnt lgkmcnt(0)
 s_barrier
 ds_read2st64_b32 a[192:193], v75 offset0:0 offset1:4
 ds_read2st64_b32 a[194:195], v75 offset0:8 offset1:12
 ds_read2st64_b32 a[196:197], v75 offset0:16 offset1:20
 ds_read2st64_b32 a[198:199], v75 offset0:24 offset1:28
 s_waitcnt lgkmcnt(0)
 ds_write_b128 v3, a[192:195] offset:20480
 ds_write_b128 v3, a[196:199] offset:21504
 s_add_u32 s81, s88, 0x80000
 buffer_load_dwordx4 v[176:179], v72, s[12:15], s81 offen
 s_add_u32 s81, s88, 0x88000
 buffer_load_dwordx4 v[180:183], v72, s[12:15], s81 offen
 s_waitcnt vmcnt(54)
 ds_write_b128 v74, v[232:235] offset:8192
 ds_write_b128 v74, v[236:239] offset:9216
 s_waitcnt lgkmcnt(0)
 s_barrier
 ds_read2st64_b32 v[232:233], v75 offset0:32 offset1:36
 ds_read2st64_b32 v[234:235], v75 offset0:40 offset1:44
 ds_read2st64_b32 v[236:237], v75 offset0:48 offset1:52
 ds_read2st64_b32 v[238:239], v75 offset0:56 offset1:60
 s_waitcnt lgkmcnt(0)
 ds_write_b128 v3, v[232:235] offset:22528
 ds_write_b128 v3, v[236:239] offset:23552
 s_add_u32 s81, s88, 0x80000
 buffer_load_dwordx4 a[64:67], v72, s[16:19], s81 offen
 s_add_u32 s81, s88, 0x88000
 buffer_load_dwordx4 a[68:71], v72, s[16:19], s81 offen
 s_waitcnt vmcnt(54)
 ds_write_b128 v74, a[120:123] offset:0
 ds_write_b128 v74, a[124:127] offset:1024
 s_waitcnt lgkmcnt(0)
 s_barrier
 ds_read2st64_b32 a[120:121], v75 offset0:0 offset1:4
 ds_read2st64_b32 a[122:123], v75 offset0:8 offset1:12
 ds_read2st64_b32 a[124:125], v75 offset0:16 offset1:20
 ds_read2st64_b32 a[126:127], v75 offset0:24 offset1:28
 s_waitcnt lgkmcnt(0)
 ds_write_b128 v3, a[120:123] offset:6144
 ds_write_b128 v3, a[124:127] offset:7168
 s_add_u32 s81, s88, 0x80000
 buffer_load_dwordx4 a[144:147], v72, s[20:23], s81 offen
 s_add_u32 s81, s88, 0x88000
 buffer_load_dwordx4 a[148:151], v72, s[20:23], s81 offen
 s_waitcnt vmcnt(54)
 ds_write_b128 v74, a[200:203] offset:8192
 ds_write_b128 v74, a[204:207] offset:9216
 s_waitcnt lgkmcnt(0)
 s_barrier
 ds_read2st64_b32 a[200:201], v75 offset0:32 offset1:36
 ds_read2st64_b32 a[202:203], v75 offset0:40 offset1:44
 ds_read2st64_b32 a[204:205], v75 offset0:48 offset1:52
 ds_read2st64_b32 a[206:207], v75 offset0:56 offset1:60
 s_waitcnt lgkmcnt(0)
 ds_write_b128 v3, a[200:203] offset:16384
 ds_write_b128 v3, a[204:207] offset:17408
 s_add_u32 s81, s88, 0xc0000
 buffer_load_dwordx4 v[184:187], v72, s[12:15], s81 offen
 s_add_u32 s81, s88, 0xc8000
 buffer_load_dwordx4 v[188:191], v72, s[12:15], s81 offen
 s_waitcnt vmcnt(54)
 ds_write_b128 v74, v[80:83] offset:0
 ds_write_b128 v74, v[84:87] offset:1024
 s_waitcnt lgkmcnt(0)
 s_barrier
 ds_read2st64_b32 v[80:81], v75 offset0:0 offset1:4
 ds_read2st64_b32 v[82:83], v75 offset0:8 offset1:12
 ds_read2st64_b32 v[84:85], v75 offset0:16 offset1:20
 ds_read2st64_b32 v[86:87], v75 offset0:24 offset1:28
 s_add_u32 s81, s88, 0xc0000
 buffer_load_dwordx4 a[72:75], v72, s[16:19], s81 offen
 s_add_u32 s81, s88, 0xc8000
 buffer_load_dwordx4 a[76:79], v72, s[16:19], s81 offen
 s_waitcnt vmcnt(54)
 ds_write_b128 v74, v[240:243] offset:8192
 ds_write_b128 v74, v[244:247] offset:9216
 s_waitcnt lgkmcnt(0)
 s_barrier
 ds_read2st64_b32 v[240:241], v75 offset0:32 offset1:36
 ds_read2st64_b32 v[242:243], v75 offset0:40 offset1:44
 ds_read2st64_b32 v[244:245], v75 offset0:48 offset1:52
 ds_read2st64_b32 v[246:247], v75 offset0:56 offset1:60
 s_add_u32 s81, s88, 0xc0000
 buffer_load_dwordx4 a[152:155], v72, s[20:23], s81 offen
 s_add_u32 s81, s88, 0xc8000
 buffer_load_dwordx4 a[156:159], v72, s[20:23], s81 offen
 s_waitcnt vmcnt(54)
 ds_write_b128 v74, v[88:91] offset:0
 ds_write_b128 v74, v[92:95] offset:1024
 s_waitcnt lgkmcnt(0)
 s_barrier
 ds_read2st64_b32 v[88:89], v75 offset0:0 offset1:4
 ds_read2st64_b32 v[90:91], v75 offset0:8 offset1:12
 ds_read2st64_b32 v[92:93], v75 offset0:16 offset1:20
 ds_read2st64_b32 v[94:95], v75 offset0:24 offset1:28
 s_add_u32 s81, s88, 0x100000
 buffer_load_dwordx4 v[192:195], v72, s[12:15], s81 offen
 s_add_u32 s81, s88, 0x108000
 buffer_load_dwordx4 v[196:199], v72, s[12:15], s81 offen
 s_waitcnt vmcnt(54)
 ds_write_b128 v74, v[248:251] offset:8192
 ds_write_b128 v74, v[252:255] offset:9216
 s_waitcnt lgkmcnt(0)
 s_barrier
 ds_read2st64_b32 v[248:249], v75 offset0:32 offset1:36
 ds_read2st64_b32 v[250:251], v75 offset0:40 offset1:44
 ds_read2st64_b32 v[252:253], v75 offset0:48 offset1:52
 ds_read2st64_b32 v[254:255], v75 offset0:56 offset1:60
 s_add_u32 s81, s88, 0x100000
 buffer_load_dwordx4 a[80:83], v72, s[16:19], s81 offen
 s_add_u32 s81, s88, 0x108000
 buffer_load_dwordx4 a[84:87], v72, s[16:19], s81 offen
 s_waitcnt vmcnt(54)
 ds_write_b128 v74, v[96:99] offset:0
 ds_write_b128 v74, v[100:103] offset:1024
 s_waitcnt lgkmcnt(0)
 s_barrier
 ds_read2st64_b32 v[96:97], v75 offset0:0 offset1:4
 ds_read2st64_b32 v[98:99], v75 offset0:8 offset1:12
 ds_read2st64_b32 v[100:101], v75 offset0:16 offset1:20
 ds_read2st64_b32 v[102:103], v75 offset0:24 offset1:28
 s_add_u32 s81, s88, 0x100000
 buffer_load_dwordx4 a[160:163], v72, s[20:23], s81 offen
 s_add_u32 s81, s88, 0x108000
 buffer_load_dwordx4 a[164:167], v72, s[20:23], s81 offen
 s_waitcnt vmcnt(54)
 ds_write_b128 v74, a[0:3] offset:8192
 ds_write_b128 v74, a[4:7] offset:9216
 s_waitcnt lgkmcnt(0)
 s_barrier
 ds_read2st64_b32 a[0:1], v75 offset0:32 offset1:36
 ds_read2st64_b32 a[2:3], v75 offset0:40 offset1:44
 ds_read2st64_b32 a[4:5], v75 offset0:48 offset1:52
 ds_read2st64_b32 a[6:7], v75 offset0:56 offset1:60
 s_add_u32 s81, s88, 0x140000
 buffer_load_dwordx4 v[200:203], v72, s[12:15], s81 offen
 s_add_u32 s81, s88, 0x148000
 buffer_load_dwordx4 v[204:207], v72, s[12:15], s81 offen
 s_waitcnt vmcnt(54)
 ds_write_b128 v74, v[104:107] offset:0
 ds_write_b128 v74, v[108:111] offset:1024
 s_waitcnt lgkmcnt(0)
 s_barrier
 ds_read2st64_b32 v[104:105], v75 offset0:0 offset1:4
 ds_read2st64_b32 v[106:107], v75 offset0:8 offset1:12
 ds_read2st64_b32 v[108:109], v75 offset0:16 offset1:20
 ds_read2st64_b32 v[110:111], v75 offset0:24 offset1:28
 s_add_u32 s81, s88, 0x140000
 buffer_load_dwordx4 a[88:91], v72, s[16:19], s81 offen
 s_add_u32 s81, s88, 0x148000
 buffer_load_dwordx4 a[92:95], v72, s[16:19], s81 offen
 s_waitcnt vmcnt(54)
 ds_write_b128 v74, v[112:115] offset:8192
 ds_write_b128 v74, v[116:119] offset:9216
 s_waitcnt lgkmcnt(0)
 s_barrier
 ds_read2st64_b32 v[112:113], v75 offset0:32 offset1:36
 ds_read2st64_b32 v[114:115], v75 offset0:40 offset1:44
 ds_read2st64_b32 v[116:117], v75 offset0:48 offset1:52
 ds_read2st64_b32 v[118:119], v75 offset0:56 offset1:60
 s_add_u32 s81, s88, 0x140000
 buffer_load_dwordx4 a[168:171], v72, s[20:23], s81 offen
 s_add_u32 s81, s88, 0x148000
 buffer_load_dwordx4 a[172:175], v72, s[20:23], s81 offen
 s_waitcnt vmcnt(54)
 ds_write_b128 v74, a[8:11] offset:0
 ds_write_b128 v74, a[12:15] offset:1024
 s_waitcnt lgkmcnt(0)
 s_barrier
 ds_read2st64_b32 a[8:9], v75 offset0:0 offset1:4
 ds_read2st64_b32 a[10:11], v75 offset0:8 offset1:12
 ds_read2st64_b32 a[12:13], v75 offset0:16 offset1:20
 ds_read2st64_b32 a[14:15], v75 offset0:24 offset1:28
 s_add_u32 s81, s88, 0x180000
 buffer_load_dwordx4 v[208:211], v72, s[12:15], s81 offen
 s_add_u32 s81, s88, 0x188000
 buffer_load_dwordx4 v[212:215], v72, s[12:15], s81 offen
 s_waitcnt vmcnt(54)
 ds_write_b128 v74, v[120:123] offset:8192
 ds_write_b128 v74, v[124:127] offset:9216
 s_waitcnt lgkmcnt(0)
 s_barrier
 ds_read2st64_b32 v[120:121], v75 offset0:32 offset1:36
 ds_read2st64_b32 v[122:123], v75 offset0:40 offset1:44
 ds_read2st64_b32 v[124:125], v75 offset0:48 offset1:52
 ds_read2st64_b32 v[126:127], v75 offset0:56 offset1:60
 s_add_u32 s81, s88, 0x180000
 buffer_load_dwordx4 a[96:99], v72, s[16:19], s81 offen
 s_add_u32 s81, s88, 0x188000
 buffer_load_dwordx4 a[100:103], v72, s[16:19], s81 offen
 s_waitcnt vmcnt(54)
 ds_write_b128 v74, a[16:19] offset:0
 ds_write_b128 v74, a[20:23] offset:1024
 s_waitcnt lgkmcnt(0)
 s_barrier
 ds_read2st64_b32 a[16:17], v75 offset0:0 offset1:4
 ds_read2st64_b32 a[18:19], v75 offset0:8 offset1:12
 ds_read2st64_b32 a[20:21], v75 offset0:16 offset1:20
 ds_read2st64_b32 a[22:23], v75 offset0:24 offset1:28
 s_add_u32 s81, s88, 0x180000
 buffer_load_dwordx4 a[176:179], v72, s[20:23], s81 offen
 s_add_u32 s81, s88, 0x188000
 buffer_load_dwordx4 a[180:183], v72, s[20:23], s81 offen
 s_waitcnt vmcnt(54)
 ds_write_b128 v74, v[128:131] offset:8192
 ds_write_b128 v74, v[132:135] offset:9216
 s_waitcnt lgkmcnt(0)
 s_barrier
 ds_read2st64_b32 v[128:129], v75 offset0:32 offset1:36
 ds_read2st64_b32 v[130:131], v75 offset0:40 offset1:44
 ds_read2st64_b32 v[132:133], v75 offset0:48 offset1:52
 ds_read2st64_b32 v[134:135], v75 offset0:56 offset1:60
 s_add_u32 s81, s88, 0x1c0000
 buffer_load_dwordx4 v[216:219], v72, s[12:15], s81 offen
 s_add_u32 s81, s88, 0x1c8000
 buffer_load_dwordx4 v[220:223], v72, s[12:15], s81 offen
 s_waitcnt vmcnt(54)
 ds_write_b128 v74, a[24:27] offset:0
 ds_write_b128 v74, a[28:31] offset:1024
 s_waitcnt lgkmcnt(0)
 s_barrier
 ds_read2st64_b32 a[24:25], v75 offset0:0 offset1:4
 ds_read2st64_b32 a[26:27], v75 offset0:8 offset1:12
 ds_read2st64_b32 a[28:29], v75 offset0:16 offset1:20
 ds_read2st64_b32 a[30:31], v75 offset0:24 offset1:28
 s_add_u32 s81, s88, 0x1c0000
 buffer_load_dwordx4 a[104:107], v72, s[16:19], s81 offen
 s_add_u32 s81, s88, 0x1c8000
 buffer_load_dwordx4 a[108:111], v72, s[16:19], s81 offen
 s_waitcnt vmcnt(54)
 ds_write_b128 v74, v[136:139] offset:8192
 ds_write_b128 v74, v[140:143] offset:9216
 s_waitcnt lgkmcnt(0)
 s_barrier
 ds_read2st64_b32 v[136:137], v75 offset0:32 offset1:36
 ds_read2st64_b32 v[138:139], v75 offset0:40 offset1:44
 ds_read2st64_b32 v[140:141], v75 offset0:48 offset1:52
 ds_read2st64_b32 v[142:143], v75 offset0:56 offset1:60
 s_add_u32 s81, s88, 0x1c0000
 buffer_load_dwordx4 a[184:187], v72, s[20:23], s81 offen
 s_add_u32 s81, s88, 0x1c8000
 buffer_load_dwordx4 a[188:191], v72, s[20:23], s81 offen
 s_waitcnt vmcnt(54)
 ds_write_b128 v74, v[144:147] offset:0
 ds_write_b128 v74, v[148:151] offset:1024
 s_waitcnt lgkmcnt(0)
 s_barrier
 ds_read2st64_b32 v[144:145], v75 offset0:0 offset1:4
 ds_read2st64_b32 v[146:147], v75 offset0:8 offset1:12
 ds_read2st64_b32 v[148:149], v75 offset0:16 offset1:20
 ds_read2st64_b32 v[150:151], v75 offset0:24 offset1:28
 s_add_u32 s81, s88, 0x200000
 buffer_load_dwordx4 v[224:227], v72, s[12:15], s81 offen
 s_add_u32 s81, s88, 0x208000
 buffer_load_dwordx4 v[228:231], v72, s[12:15], s81 offen
 s_waitcnt vmcnt(54)
 ds_write_b128 v74, a[32:35] offset:8192
 ds_write_b128 v74, a[36:39] offset:9216
 s_waitcnt lgkmcnt(0)
 s_barrier
 ds_read2st64_b32 a[32:33], v75 offset0:32 offset1:36
 ds_read2st64_b32 a[34:35], v75 offset0:40 offset1:44
 ds_read2st64_b32 a[36:37], v75 offset0:48 offset1:52
 ds_read2st64_b32 a[38:39], v75 offset0:56 offset1:60
 s_add_u32 s81, s88, 0x200000
 buffer_load_dwordx4 a[112:115], v72, s[16:19], s81 offen
 s_add_u32 s81, s88, 0x208000
 buffer_load_dwordx4 a[116:119], v72, s[16:19], s81 offen
 s_waitcnt vmcnt(54)
 ds_write_b128 v74, v[152:155] offset:0
 ds_write_b128 v74, v[156:159] offset:1024
 s_waitcnt lgkmcnt(0)
 s_barrier
 ds_read2st64_b32 v[152:153], v75 offset0:0 offset1:4
 ds_read2st64_b32 v[154:155], v75 offset0:8 offset1:12
 ds_read2st64_b32 v[156:157], v75 offset0:16 offset1:20
 ds_read2st64_b32 v[158:159], v75 offset0:24 offset1:28
 s_add_u32 s81, s88, 0x200000
 buffer_load_dwordx4 a[192:195], v72, s[20:23], s81 offen
 s_add_u32 s81, s88, 0x208000
 buffer_load_dwordx4 a[196:199], v72, s[20:23], s81 offen
 s_waitcnt vmcnt(54)
 ds_write_b128 v74, a[40:43] offset:8192
 ds_write_b128 v74, a[44:47] offset:9216
 s_waitcnt lgkmcnt(0)
 s_barrier
 ds_read2st64_b32 a[40:41], v75 offset0:32 offset1:36
 ds_read2st64_b32 a[42:43], v75 offset0:40 offset1:44
 ds_read2st64_b32 a[44:45], v75 offset0:48 offset1:52
 ds_read2st64_b32 a[46:47], v75 offset0:56 offset1:60
 s_add_u32 s81, s88, 0x240000
 buffer_load_dwordx4 v[232:235], v72, s[12:15], s81 offen
 s_add_u32 s81, s88, 0x248000
 buffer_load_dwordx4 v[236:239], v72, s[12:15], s81 offen
 s_waitcnt vmcnt(54)
 ds_write_b128 v74, v[160:163] offset:0
 ds_write_b128 v74, v[164:167] offset:1024
 s_waitcnt lgkmcnt(0)
 s_barrier
 ds_read2st64_b32 v[160:161], v75 offset0:0 offset1:4
 ds_read2st64_b32 v[162:163], v75 offset0:8 offset1:12
 ds_read2st64_b32 v[164:165], v75 offset0:16 offset1:20
 ds_read2st64_b32 v[166:167], v75 offset0:24 offset1:28
 s_add_u32 s81, s88, 0x240000
 buffer_load_dwordx4 a[120:123], v72, s[16:19], s81 offen
 s_add_u32 s81, s88, 0x248000
 buffer_load_dwordx4 a[124:127], v72, s[16:19], s81 offen
 s_waitcnt vmcnt(54)
 ds_write_b128 v74, a[48:51] offset:8192
 ds_write_b128 v74, a[52:55] offset:9216
 s_waitcnt lgkmcnt(0)
 s_barrier
 ds_read2st64_b32 a[48:49], v75 offset0:32 offset1:36
 ds_read2st64_b32 a[50:51], v75 offset0:40 offset1:44
 ds_read2st64_b32 a[52:53], v75 offset0:48 offset1:52
 ds_read2st64_b32 a[54:55], v75 offset0:56 offset1:60
 s_add_u32 s81, s88, 0x240000
 buffer_load_dwordx4 a[200:203], v72, s[20:23], s81 offen
 s_add_u32 s81, s88, 0x248000
 buffer_load_dwordx4 a[204:207], v72, s[20:23], s81 offen
 s_waitcnt vmcnt(54)
 ds_write_b128 v74, a[128:131] offset:0
 ds_write_b128 v74, a[132:135] offset:1024
 s_waitcnt lgkmcnt(0)
 s_barrier
 ds_read2st64_b32 a[128:129], v75 offset0:0 offset1:4
 ds_read2st64_b32 a[130:131], v75 offset0:8 offset1:12
 ds_read2st64_b32 a[132:133], v75 offset0:16 offset1:20
 ds_read2st64_b32 a[134:135], v75 offset0:24 offset1:28
 s_add_u32 s81, s83, 0
 buffer_load_dwordx4 v[16:19], v73, s[24:27], s81 offen
 s_add_u32 s81, s83, 20480
 buffer_load_dwordx4 v[20:23], v73, s[24:27], s81 offen
 s_waitcnt vmcnt(54)
 ds_write_b128 v74, v[168:171] offset:8192
 ds_write_b128 v74, v[172:175] offset:9216
 s_waitcnt lgkmcnt(0)
 s_barrier
 ds_read2st64_b32 v[168:169], v75 offset0:32 offset1:36
 ds_read2st64_b32 v[170:171], v75 offset0:40 offset1:44
 ds_read2st64_b32 v[172:173], v75 offset0:48 offset1:52
 ds_read2st64_b32 v[174:175], v75 offset0:56 offset1:60
 s_add_u32 s81, s83, 40960
 buffer_load_dwordx4 v[24:27], v73, s[24:27], s81 offen
 s_add_u32 s81, s83, 61440
 buffer_load_dwordx4 v[28:31], v73, s[24:27], s81 offen
 s_waitcnt vmcnt(54)
 ds_write_b128 v74, a[56:59] offset:0
 ds_write_b128 v74, a[60:63] offset:1024
 s_waitcnt lgkmcnt(0)
 s_barrier
 ds_read2st64_b32 a[56:57], v75 offset0:0 offset1:4
 ds_read2st64_b32 a[58:59], v75 offset0:8 offset1:12
 ds_read2st64_b32 a[60:61], v75 offset0:16 offset1:20
 ds_read2st64_b32 a[62:63], v75 offset0:24 offset1:28
 s_add_u32 s81, s83, 81920
 buffer_load_dwordx4 v[32:35], v73, s[24:27], s81 offen
 s_add_u32 s81, s83, 102400
 buffer_load_dwordx4 v[36:39], v73, s[24:27], s81 offen
 s_waitcnt vmcnt(54)
 ds_write_b128 v74, a[136:139] offset:8192
 ds_write_b128 v74, a[140:143] offset:9216
 s_waitcnt lgkmcnt(0)
 s_barrier
 ds_read2st64_b32 a[136:137], v75 offset0:32 offset1:36
 ds_read2st64_b32 a[138:139], v75 offset0:40 offset1:44
 ds_read2st64_b32 a[140:141], v75 offset0:48 offset1:52
 ds_read2st64_b32 a[142:143], v75 offset0:56 offset1:60
 s_add_u32 s81, s83, 122944
 buffer_load_dwordx4 v[40:43], v73, s[24:27], s81 offen
 s_add_u32 s81, s83, 143424
 buffer_load_dwordx4 v[44:47], v73, s[24:27], s81 offen
 s_waitcnt vmcnt(54)
 ds_write_b128 v74, v[176:179] offset:0
 ds_write_b128 v74, v[180:183] offset:1024
 s_waitcnt lgkmcnt(0)
 s_barrier
 ds_read2st64_b32 v[176:177], v75 offset0:0 offset1:4
 ds_read2st64_b32 v[178:179], v75 offset0:8 offset1:12
 ds_read2st64_b32 v[180:181], v75 offset0:16 offset1:20
 ds_read2st64_b32 v[182:183], v75 offset0:24 offset1:28
 s_add_u32 s81, s83, 128
 buffer_load_dwordx4 v[48:51], v73, s[24:27], s81 offen
 s_add_u32 s81, s83, 20608
 buffer_load_dwordx4 v[52:55], v73, s[24:27], s81 offen
 s_waitcnt vmcnt(54)
 ds_write_b128 v74, a[64:67] offset:8192
 ds_write_b128 v74, a[68:71] offset:9216
 s_waitcnt lgkmcnt(0)
 s_barrier
 ds_read2st64_b32 a[64:65], v75 offset0:32 offset1:36
 ds_read2st64_b32 a[66:67], v75 offset0:40 offset1:44
 ds_read2st64_b32 a[68:69], v75 offset0:48 offset1:52
 ds_read2st64_b32 a[70:71], v75 offset0:56 offset1:60
 s_add_u32 s81, s83, 41088
 buffer_load_dwordx4 v[56:59], v73, s[24:27], s81 offen
 s_add_u32 s81, s83, 61568
 buffer_load_dwordx4 v[60:63], v73, s[24:27], s81 offen
 s_waitcnt vmcnt(54)
 ds_write_b128 v74, a[144:147] offset:0
 ds_write_b128 v74, a[148:151] offset:1024
 s_waitcnt lgkmcnt(0)
 s_barrier
 ds_read2st64_b32 a[144:145], v75 offset0:0 offset1:4
 ds_read2st64_b32 a[146:147], v75 offset0:8 offset1:12
 ds_read2st64_b32 a[148:149], v75 offset0:16 offset1:20
 ds_read2st64_b32 a[150:151], v75 offset0:24 offset1:28
 s_add_u32 s81, s83, 122880
 buffer_load_dwordx4 a[208:211], v73, s[24:27], s81 offen
 s_add_u32 s81, s83, 143360
 buffer_load_dwordx4 a[212:215], v73, s[24:27], s81 offen
 s_waitcnt vmcnt(54)
 ds_write_b128 v74, v[184:187] offset:8192
 ds_write_b128 v74, v[188:191] offset:9216
 s_waitcnt lgkmcnt(0)
 s_barrier
 ds_read2st64_b32 v[184:185], v75 offset0:32 offset1:36
 ds_read2st64_b32 v[186:187], v75 offset0:40 offset1:44
 ds_read2st64_b32 v[188:189], v75 offset0:48 offset1:52
 ds_read2st64_b32 v[190:191], v75 offset0:56 offset1:60
 s_add_u32 s81, s83, 64
 buffer_load_dwordx4 a[216:219], v73, s[24:27], s81 offen
 s_add_u32 s81, s83, 20544
 buffer_load_dwordx4 a[220:223], v73, s[24:27], s81 offen
 s_waitcnt vmcnt(54)
 ds_write_b128 v74, a[72:75] offset:0
 ds_write_b128 v74, a[76:79] offset:1024
 s_waitcnt lgkmcnt(0)
 s_barrier
 ds_read2st64_b32 a[72:73], v75 offset0:0 offset1:4
 ds_read2st64_b32 a[74:75], v75 offset0:8 offset1:12
 ds_read2st64_b32 a[76:77], v75 offset0:16 offset1:20
 ds_read2st64_b32 a[78:79], v75 offset0:24 offset1:28
 s_add_u32 s81, s83, 41024
 buffer_load_dwordx4 a[224:227], v73, s[24:27], s81 offen
 s_add_u32 s81, s83, 61504
 buffer_load_dwordx4 a[228:231], v73, s[24:27], s81 offen
 s_waitcnt vmcnt(54)
 ds_write_b128 v74, a[152:155] offset:8192
 ds_write_b128 v74, a[156:159] offset:9216
 s_waitcnt lgkmcnt(0)
 s_barrier
 ds_read2st64_b32 a[152:153], v75 offset0:32 offset1:36
 ds_read2st64_b32 a[154:155], v75 offset0:40 offset1:44
 ds_read2st64_b32 a[156:157], v75 offset0:48 offset1:52
 ds_read2st64_b32 a[158:159], v75 offset0:56 offset1:60
 s_add_u32 s81, s83, 81984
 buffer_load_dwordx4 a[232:235], v73, s[24:27], s81 offen
 s_add_u32 s81, s83, 102464
 buffer_load_dwordx4 a[236:239], v73, s[24:27], s81 offen
 s_waitcnt vmcnt(54)
 ds_write_b128 v74, v[192:195] offset:0
 ds_write_b128 v74, v[196:199] offset:1024
 s_waitcnt lgkmcnt(0)
 s_barrier
 ds_read2st64_b32 v[192:193], v75 offset0:0 offset1:4
 ds_read2st64_b32 v[194:195], v75 offset0:8 offset1:12
 ds_read2st64_b32 v[196:197], v75 offset0:16 offset1:20
 ds_read2st64_b32 v[198:199], v75 offset0:24 offset1:28
 s_add_u32 s81, s83, 82048
 buffer_load_dwordx4 a[240:243], v73, s[24:27], s81 offen
 s_add_u32 s81, s83, 102528
 buffer_load_dwordx4 a[244:247], v73, s[24:27], s81 offen
 s_waitcnt vmcnt(54)
 ds_write_b128 v74, a[80:83] offset:8192
 ds_write_b128 v74, a[84:87] offset:9216
 s_waitcnt lgkmcnt(0)
 s_barrier
 ds_read2st64_b32 a[80:81], v75 offset0:32 offset1:36
 ds_read2st64_b32 a[82:83], v75 offset0:40 offset1:44
 ds_read2st64_b32 a[84:85], v75 offset0:48 offset1:52
 ds_read2st64_b32 a[86:87], v75 offset0:56 offset1:60
 s_add_u32 s81, s83, 123008
 buffer_load_dwordx4 a[248:251], v73, s[24:27], s81 offen
 s_add_u32 s81, s83, 143488
 buffer_load_dwordx4 a[252:255], v73, s[24:27], s81 offen
 s_waitcnt vmcnt(54)
 ds_write_b128 v74, a[160:163] offset:0
 ds_write_b128 v74, a[164:167] offset:1024
 s_waitcnt lgkmcnt(0)
 s_barrier
 ds_read2st64_b32 a[160:161], v75 offset0:0 offset1:4
 ds_read2st64_b32 a[162:163], v75 offset0:8 offset1:12
 ds_read2st64_b32 a[164:165], v75 offset0:16 offset1:20
 ds_read2st64_b32 a[166:167], v75 offset0:24 offset1:28
 s_waitcnt vmcnt(52)
 ds_write_b128 v74, v[200:203] offset:8192
 ds_write_b128 v74, v[204:207] offset:9216
 s_waitcnt lgkmcnt(0)
 s_barrier
 ds_read2st64_b32 v[200:201], v75 offset0:32 offset1:36
 ds_read2st64_b32 v[202:203], v75 offset0:40 offset1:44
 ds_read2st64_b32 v[204:205], v75 offset0:48 offset1:52
 ds_read2st64_b32 v[206:207], v75 offset0:56 offset1:60
 s_waitcnt vmcnt(50)
 ds_write_b128 v74, a[88:91] offset:0
 ds_write_b128 v74, a[92:95] offset:1024
 s_waitcnt lgkmcnt(0)
 s_barrier
 ds_read2st64_b32 a[88:89], v75 offset0:0 offset1:4
 ds_read2st64_b32 a[90:91], v75 offset0:8 offset1:12
 ds_read2st64_b32 a[92:93], v75 offset0:16 offset1:20
 ds_read2st64_b32 a[94:95], v75 offset0:24 offset1:28
 s_waitcnt vmcnt(48)
 ds_write_b128 v74, a[168:171] offset:8192
 ds_write_b128 v74, a[172:175] offset:9216
 s_waitcnt lgkmcnt(0)
 s_barrier
 ds_read2st64_b32 a[168:169], v75 offset0:32 offset1:36
 ds_read2st64_b32 a[170:171], v75 offset0:40 offset1:44
 ds_read2st64_b32 a[172:173], v75 offset0:48 offset1:52
 ds_read2st64_b32 a[174:175], v75 offset0:56 offset1:60
 s_waitcnt vmcnt(46)
 ds_write_b128 v74, v[208:211] offset:0
 ds_write_b128 v74, v[212:215] offset:1024
 s_waitcnt lgkmcnt(0)
 s_barrier
 ds_read2st64_b32 v[208:209], v75 offset0:0 offset1:4
 ds_read2st64_b32 v[210:211], v75 offset0:8 offset1:12
 ds_read2st64_b32 v[212:213], v75 offset0:16 offset1:20
 ds_read2st64_b32 v[214:215], v75 offset0:24 offset1:28
 s_waitcnt vmcnt(44)
 ds_write_b128 v74, a[96:99] offset:8192
 ds_write_b128 v74, a[100:103] offset:9216
 s_waitcnt lgkmcnt(0)
 s_barrier
 ds_read2st64_b32 a[96:97], v75 offset0:32 offset1:36
 ds_read2st64_b32 a[98:99], v75 offset0:40 offset1:44
 ds_read2st64_b32 a[100:101], v75 offset0:48 offset1:52
 ds_read2st64_b32 a[102:103], v75 offset0:56 offset1:60
 s_waitcnt vmcnt(42)
 ds_write_b128 v74, a[176:179] offset:0
 ds_write_b128 v74, a[180:183] offset:1024
 s_waitcnt lgkmcnt(0)
 s_barrier
 ds_read2st64_b32 a[176:177], v75 offset0:0 offset1:4
 ds_read2st64_b32 a[178:179], v75 offset0:8 offset1:12
 ds_read2st64_b32 a[180:181], v75 offset0:16 offset1:20
 ds_read2st64_b32 a[182:183], v75 offset0:24 offset1:28
 s_waitcnt vmcnt(40)
 ds_write_b128 v74, v[216:219] offset:8192
 ds_write_b128 v74, v[220:223] offset:9216
 s_waitcnt lgkmcnt(0)
 s_barrier
 ds_read2st64_b32 v[216:217], v75 offset0:32 offset1:36
 ds_read2st64_b32 v[218:219], v75 offset0:40 offset1:44
 ds_read2st64_b32 v[220:221], v75 offset0:48 offset1:52
 ds_read2st64_b32 v[222:223], v75 offset0:56 offset1:60
 s_waitcnt vmcnt(38)
 ds_write_b128 v74, a[104:107] offset:0
 ds_write_b128 v74, a[108:111] offset:1024
 s_waitcnt lgkmcnt(0)
 s_barrier
 ds_read2st64_b32 a[104:105], v75 offset0:0 offset1:4
 ds_read2st64_b32 a[106:107], v75 offset0:8 offset1:12
 ds_read2st64_b32 a[108:109], v75 offset0:16 offset1:20
 ds_read2st64_b32 a[110:111], v75 offset0:24 offset1:28
 s_waitcnt vmcnt(36)
 ds_write_b128 v74, a[184:187] offset:8192
 ds_write_b128 v74, a[188:191] offset:9216
 s_waitcnt lgkmcnt(0)
 s_barrier
 ds_read2st64_b32 a[184:185], v75 offset0:32 offset1:36
 ds_read2st64_b32 a[186:187], v75 offset0:40 offset1:44
 ds_read2st64_b32 a[188:189], v75 offset0:48 offset1:52
 ds_read2st64_b32 a[190:191], v75 offset0:56 offset1:60
 s_waitcnt vmcnt(34)
 ds_write_b128 v74, v[224:227] offset:0
 ds_write_b128 v74, v[228:231] offset:1024
 s_waitcnt lgkmcnt(0)
 s_barrier
 ds_read2st64_b32 v[224:225], v75 offset0:0 offset1:4
 ds_read2st64_b32 v[226:227], v75 offset0:8 offset1:12
 ds_read2st64_b32 v[228:229], v75 offset0:16 offset1:20
 ds_read2st64_b32 v[230:231], v75 offset0:24 offset1:28
 s_waitcnt vmcnt(32)
 ds_write_b128 v74, a[112:115] offset:8192
 ds_write_b128 v74, a[116:119] offset:9216
 s_waitcnt lgkmcnt(0)
 s_barrier
 ds_read2st64_b32 a[112:113], v75 offset0:32 offset1:36
 ds_read2st64_b32 a[114:115], v75 offset0:40 offset1:44
 ds_read2st64_b32 a[116:117], v75 offset0:48 offset1:52
 ds_read2st64_b32 a[118:119], v75 offset0:56 offset1:60
 s_waitcnt vmcnt(30)
 ds_write_b128 v74, a[192:195] offset:0
 ds_write_b128 v74, a[196:199] offset:1024
 s_waitcnt lgkmcnt(0)
 s_barrier
 ds_read2st64_b32 a[192:193], v75 offset0:0 offset1:4
 ds_read2st64_b32 a[194:195], v75 offset0:8 offset1:12
 ds_read2st64_b32 a[196:197], v75 offset0:16 offset1:20
 ds_read2st64_b32 a[198:199], v75 offset0:24 offset1:28
 s_waitcnt vmcnt(28)
 ds_write_b128 v74, v[232:235] offset:8192
 ds_write_b128 v74, v[236:239] offset:9216
 s_waitcnt lgkmcnt(0)
 s_barrier
 ds_read2st64_b32 v[232:233], v75 offset0:32 offset1:36
 ds_read2st64_b32 v[234:235], v75 offset0:40 offset1:44
 ds_read2st64_b32 v[236:237], v75 offset0:48 offset1:52
 ds_read2st64_b32 v[238:239], v75 offset0:56 offset1:60
 s_waitcnt vmcnt(26)
 ds_write_b128 v74, a[120:123] offset:0
 ds_write_b128 v74, a[124:127] offset:1024
 s_waitcnt lgkmcnt(0)
 s_barrier
 ds_read2st64_b32 a[120:121], v75 offset0:0 offset1:4
 ds_read2st64_b32 a[122:123], v75 offset0:8 offset1:12
 ds_read2st64_b32 a[124:125], v75 offset0:16 offset1:20
 ds_read2st64_b32 a[126:127], v75 offset0:24 offset1:28
 s_waitcnt vmcnt(24)
 ds_write_b128 v74, a[200:203] offset:8192
 ds_write_b128 v74, a[204:207] offset:9216
 s_waitcnt lgkmcnt(0)
 s_barrier
 ds_read2st64_b32 a[200:201], v75 offset0:32 offset1:36
 ds_read2st64_b32 a[202:203], v75 offset0:40 offset1:44
 ds_read2st64_b32 a[204:205], v75 offset0:48 offset1:52
 ds_read2st64_b32 a[206:207], v75 offset0:56 offset1:60
 s_waitcnt vmcnt(22)
 s_waitcnt lgkmcnt(0)
 s_barrier
 ds_write_b128 v74, v[16:19] offset:0
 ds_write_b128 v74, v[20:23] offset:1024
 ds_read2_b32 v[16:17], v76 offset0:0 offset1:16
 ds_read2_b32 v[18:19], v76 offset0:32 offset1:48
 ds_read2_b32 v[20:21], v77 offset0:0 offset1:16
 ds_read2_b32 v[22:23], v77 offset0:32 offset1:48
 s_waitcnt lgkmcnt(0)
 ds_write_b128 v3, v[16:19] offset:24576
 ds_write_b128 v3, v[20:23] offset:25600
 s_waitcnt vmcnt(20)
 ds_write_b128 v74, v[24:27] offset:0
 ds_write_b128 v74, v[28:31] offset:1024
 ds_read2_b32 v[24:25], v76 offset0:0 offset1:16
 ds_read2_b32 v[26:27], v76 offset0:32 offset1:48
 ds_read2_b32 v[28:29], v77 offset0:0 offset1:16
 ds_read2_b32 v[30:31], v77 offset0:32 offset1:48
 s_waitcnt lgkmcnt(0)
 ds_write_b128 v3, v[24:27] offset:26624
 ds_write_b128 v3, v[28:31] offset:27648
 s_waitcnt vmcnt(18)
 ds_write_b128 v74, v[32:35] offset:0
 ds_write_b128 v74, v[36:39] offset:1024
 ds_read2_b32 v[32:33], v76 offset0:0 offset1:16
 ds_read2_b32 v[34:35], v76 offset0:32 offset1:48
 ds_read2_b32 v[36:37], v77 offset0:0 offset1:16
 ds_read2_b32 v[38:39], v77 offset0:32 offset1:48
 s_waitcnt lgkmcnt(0)
 ds_write_b128 v3, v[32:35] offset:28672
 ds_write_b128 v3, v[36:39] offset:29696
 s_waitcnt vmcnt(16)
 ds_write_b128 v74, v[40:43] offset:0
 ds_write_b128 v74, v[44:47] offset:1024
 ds_read2_b32 v[40:41], v76 offset0:0 offset1:16
 ds_read2_b32 v[42:43], v76 offset0:32 offset1:48
 ds_read2_b32 v[44:45], v77 offset0:0 offset1:16
 ds_read2_b32 v[46:47], v77 offset0:32 offset1:48
 s_waitcnt lgkmcnt(0)
 ds_write_b128 v3, v[40:43] offset:30720
 ds_write_b128 v3, v[44:47] offset:31744
 s_waitcnt vmcnt(14)
 ds_write_b128 v74, v[48:51] offset:0
 ds_write_b128 v74, v[52:55] offset:1024
 ds_read2_b32 v[48:49], v76 offset0:0 offset1:16
 ds_read2_b32 v[50:51], v76 offset0:32 offset1:48
 ds_read2_b32 v[52:53], v77 offset0:0 offset1:16
 ds_read2_b32 v[54:55], v77 offset0:32 offset1:48
 s_waitcnt lgkmcnt(0)
 ds_write_b128 v3, v[48:51] offset:32768
 ds_write_b128 v3, v[52:55] offset:33792
 s_waitcnt vmcnt(12)
 ds_write_b128 v74, v[56:59] offset:0
 ds_write_b128 v74, v[60:63] offset:1024
 ds_read2_b32 v[56:57], v76 offset0:0 offset1:16
 ds_read2_b32 v[58:59], v76 offset0:32 offset1:48
 ds_read2_b32 v[60:61], v77 offset0:0 offset1:16
 ds_read2_b32 v[62:63], v77 offset0:32 offset1:48
 s_waitcnt lgkmcnt(0)
 ds_write_b128 v3, v[56:59] offset:34816
 ds_write_b128 v3, v[60:63] offset:35840
 s_waitcnt vmcnt(10)
 ds_write_b128 v74, a[208:211] offset:0
 ds_write_b128 v74, a[212:215] offset:1024
 ds_read2_b32 a[208:209], v76 offset0:0 offset1:16
 ds_read2_b32 a[210:211], v76 offset0:32 offset1:48
 ds_read2_b32 a[212:213], v77 offset0:0 offset1:16
 ds_read2_b32 a[214:215], v77 offset0:32 offset1:48
 s_waitcnt lgkmcnt(6)
 s_waitcnt vmcnt(8)
 ds_write_b128 v74, a[216:219] offset:0
 ds_write_b128 v74, a[220:223] offset:1024
 ds_read2_b32 a[216:217], v76 offset0:0 offset1:16
 ds_read2_b32 a[218:219], v76 offset0:32 offset1:48
 ds_read2_b32 a[220:221], v77 offset0:0 offset1:16
 ds_read2_b32 a[222:223], v77 offset0:32 offset1:48
 s_waitcnt lgkmcnt(6)
 s_waitcnt vmcnt(6)
 ds_write_b128 v74, a[224:227] offset:0
 ds_write_b128 v74, a[228:231] offset:1024
 ds_read2_b32 a[224:225], v76 offset0:0 offset1:16
 ds_read2_b32 a[226:227], v76 offset0:32 offset1:48
 ds_read2_b32 a[228:229], v77 offset0:0 offset1:16
 ds_read2_b32 a[230:231], v77 offset0:32 offset1:48
 s_waitcnt lgkmcnt(6)
 s_waitcnt vmcnt(4)
 ds_write_b128 v74, a[232:235] offset:0
 ds_write_b128 v74, a[236:239] offset:1024
 ds_read2_b32 a[232:233], v76 offset0:0 offset1:16
 ds_read2_b32 a[234:235], v76 offset0:32 offset1:48
 ds_read2_b32 a[236:237], v77 offset0:0 offset1:16
 ds_read2_b32 a[238:239], v77 offset0:32 offset1:48
 s_waitcnt lgkmcnt(6)
 s_waitcnt vmcnt(2)
 ds_write_b128 v74, a[240:243] offset:0
 ds_write_b128 v74, a[244:247] offset:1024
 ds_read2_b32 a[240:241], v76 offset0:0 offset1:16
 ds_read2_b32 a[242:243], v76 offset0:32 offset1:48
 ds_read2_b32 a[244:245], v77 offset0:0 offset1:16
 ds_read2_b32 a[246:247], v77 offset0:32 offset1:48
 s_waitcnt lgkmcnt(6)
 s_waitcnt vmcnt(0)
 ds_write_b128 v74, a[248:251] offset:0
 ds_write_b128 v74, a[252:255] offset:1024
 ds_read2_b32 a[248:249], v76 offset0:0 offset1:16
 ds_read2_b32 a[250:251], v76 offset0:32 offset1:48
 ds_read2_b32 a[252:253], v77 offset0:0 offset1:16
 ds_read2_b32 a[254:255], v77 offset0:32 offset1:48
 s_waitcnt lgkmcnt(6)
 s_waitcnt lgkmcnt(0)
 s_barrier
 v_add_u32 v0, 16384, v6
 s_mul_i32 s81, s67, 163840
 s_lshl_b32 s82, s82, 14
 s_add_u32 s82, s82, s81
 s_lshl_b32 s81, s68, 7
 s_add_u32 s82, s82, s81
 s_add_u32 s82, s82, 0x40000
 s_add_u32 s83, s82, 0x4000
 s_add_u32 s84, s82, 0x8000
 s_cmp_lg_u32 s69, 2
 s_cbranch_scc1 confirmed_108
 s_mov_b32 s69, 1
 v_mbcnt_lo_u32_b32 v45, -1, 0
 v_and_b32 v45, 7, v45
 v_lshlrev_b32 v45, 5, v45
confirm_107:
 buffer_load_dword v44, v45, s[28:31], 0 offen sc1
 s_waitcnt vmcnt(0)
 v_readlane_b32 s87, v44, 0
 v_readlane_b32 s88, v44, 4
 s_min_u32 s87, s87, s88
 s_cmp_ge_u32 s87, 32
 s_cbranch_scc1 confirmed_108
 v_readlane_b32 s87, v44, 0
 v_readlane_b32 s88, v44, 1
 s_add_u32 s87, s87, s88
 v_readlane_b32 s88, v44, 2
 s_add_u32 s87, s87, s88
 v_readlane_b32 s88, v44, 3
 s_add_u32 s87, s87, s88
 v_readlane_b32 s88, v44, 4
 s_add_u32 s87, s87, s88
 v_readlane_b32 s88, v44, 5
 s_add_u32 s87, s87, s88
 v_readlane_b32 s88, v44, 6
 s_add_u32 s87, s87, s88
 v_readlane_b32 s88, v44, 7
 s_add_u32 s87, s87, s88
 s_cmp_ge_u32 s87, 256
 s_cbranch_scc1 reassign
 s_add_u32 s74, s74, 1
 s_cmp_lt_u32 s74, 0x40000
 s_cbranch_scc1 confirm_107
 s_branch bail2
confirmed_108:
 v_lshrrev_b32 v45, 4, v6
 v_and_b32 v45, 7, v45
 v_lshlrev_b32 v45, 5, v45
wait_109:
 buffer_load_dword v44, v45, s[28:31], 4 offen sc1
 s_waitcnt vmcnt(0)
test_111:
 v_cmp_gt_u32 vcc, 24, v44
 s_and_b32 vcc_lo, vcc_lo, 0xff
 s_and_b32 vcc_hi, vcc_hi, 0x0
 s_cmp_eq_u64 vcc, 0
 s_cbranch_scc1 ready_110
 s_sleep 6
 s_add_u32 s74, s74, 1
 s_cmp_lt_u32 s74, 0x40000
 s_cbranch_scc1 wait_109
 s_branch bail2
ready_110:
 s_lshl_b32 s89, s68, 10
 s_add_u32 s89, s89, 16384
 s_mov_b32 s96, 0
 s_mov_b32 s81, 1
 s_cmp_ge_u32 s96, s81
 s_cbranch_scc1 kvok_113
 v_and_b32 v45, 0x70, v6
 v_lshlrev_b32 v45, 3, v45
kv_112:
 buffer_load_dword v44, v45, s[8:11], s89 offen sc1
 s_waitcnt vmcnt(0)
 v_readlane_b32 s87, v44, 2
 v_readlane_b32 s88, v44, 4
 s_min_u32 s96, s87, s88
 v_readlane_b32 s87, v44, 3
 v_readlane_b32 s88, v44, 5
 s_min_u32 s87, s87, s88
 s_lshl_b32 s96, s96, 1
 s_lshl_b32 s87, s87, 1
 s_add_u32 s87, s87, 1
 s_min_u32 s96, s96, s87
 s_cmp_ge_u32 s96, s81
 s_cbranch_scc1 kvok_113
 s_add_u32 s74, s74, 1
 s_cmp_lt_u32 s74, 0x40000
 s_cbranch_scc1 kv_112
 s_branch bail2
kvok_113:
 s_lshl_b32 s5, s68, 1
 s_add_u32 s5, s5, s67
 s_lshl_b32 s5, s5, 7
 s_add_u32 s5, s5, 49152
 s_cmp_eq_u32 s66, 3
 s_cselect_b32 s7, s5, 0x40000000
 buffer_load_dwordx4 v[24:27], v14, s[8:11], s3 offen offset:0 sc1
 buffer_load_dwordx4 v[28:31], v14, s[8:11], s3 offen offset:1024 sc1
 s_mov_b32 m0, s97
 s_nop 0
 buffer_load_dwordx4 v14, s[8:11], s79 offen offset:0 sc1 lds
 buffer_load_dwordx4 v14, s[8:11], s79 offen offset:1024 sc1 lds
 s_waitcnt vmcnt(0)
 v_mov_b64 v[16:17], v[24:25]
 v_mov_b64 v[18:19], v[26:27]
 v_mov_b64 v[20:21], v[28:29]
 v_mov_b64 v[22:23], v[30:31]
 v_mov_b64 v[32:33], 0
 v_mov_b64 v[34:35], 0
 v_mov_b64 v[36:37], 0
 v_mov_b64 v[38:39], 0
 v_mov_b64 v[40:41], 0
 v_mov_b64 v[42:43], 0
 s_xor_b32 s97, s97, 0x2000
 s_add_u32 s79, s79, 0x40000
 s_add_u32 s3, s3, 0x40000
 s_add_u32 s4, s77, 5120
 s_barrier
 ds_read_b128 v[56:59], v3 offset:0
 ds_read_b128 v[60:63], v3 offset:1024
 ds_read_b128 v[64:67], v3 offset:2048
 ds_read_b128 v[68:71], v3 offset:3072
 ds_read_b128 v[72:75], v3 offset:4096
 ds_read_b128 v[76:79], v3 offset:5120
 s_cmp_lg_u32 s69, 0
 s_cbranch_scc1 rec0f_a1
 s_branch rec0s_a1
rec0f_step:
 v_mov_b64 v[16:17], v[24:25]
 v_mov_b64 v[18:19], v[26:27]
 v_mov_b64 v[20:21], v[28:29]
 v_mov_b64 v[22:23], v[30:31]
 v_mov_b64 v[32:33], 0
 v_mov_b64 v[34:35], 0
 v_mov_b64 v[36:37], 0
 v_mov_b64 v[38:39], 0
 v_mov_b64 v[40:41], 0
 v_mov_b64 v[42:43], 0
 s_xor_b32 s97, s97, 0x2000
 s_add_u32 s79, s79, 0x40000
 s_add_u32 s3, s3, 0x40000
 s_add_u32 s72, s72, 1
 s_mov_b32 s101, s85
 s_add_u32 s82, s82, s73
 s_add_u32 s83, s83, s73
 s_add_u32 s84, s84, s73
 s_add_u32 s85, s85, s73
 s_sub_u32 s73, 0, s73
 s_add_u32 s75, s75, 5120
 s_add_u32 s76, s76, 5120
 s_add_u32 s77, s77, 5120
 s_add_u32 s78, s78, 5120
 s_add_u32 s80, s80, 0x10000
 s_add_u32 s100, s100, 0x10000
 s_add_u32 s4, s77, 5120
 s_waitcnt vmcnt(2)
 ds_read_b128 v[56:59], v3 offset:0
 ds_read_b128 v[60:63], v3 offset:1024
 ds_read_b128 v[64:67], v3 offset:2048
 ds_read_b128 v[68:71], v3 offset:3072
 ds_read_b128 v[72:75], v3 offset:4096
 ds_read_b128 v[76:79], v3 offset:5120
 s_barrier
 s_cmp_lg_u32 s66, 0
 s_cbranch_scc1 notw0_114
 s_add_u32 s81, s72, 3
 s_lshr_b32 s81, s81, 1
 s_min_u32 s81, s81, 32
 s_cmp_ge_u32 s96, s81
 s_cbranch_scc1 kvok_116
 v_and_b32 v45, 0x70, v6
 v_lshlrev_b32 v45, 3, v45
kv_115:
 buffer_load_dword v44, v45, s[8:11], s89 offen sc1
 s_waitcnt vmcnt(0)
 v_readlane_b32 s87, v44, 2
 v_readlane_b32 s88, v44, 4
 s_min_u32 s96, s87, s88
 v_readlane_b32 s87, v44, 3
 v_readlane_b32 s88, v44, 5
 s_min_u32 s87, s87, s88
 s_lshl_b32 s96, s96, 1
 s_lshl_b32 s87, s87, 1
 s_add_u32 s87, s87, 1
 s_min_u32 s96, s96, s87
 s_cmp_ge_u32 s96, s81
 s_cbranch_scc1 kvok_116
 s_add_u32 s74, s74, 1
 s_cmp_lt_u32 s74, 0x40000
 s_cbranch_scc1 kv_115
 s_branch bail2
kvok_116:
notw0_114:
 s_barrier
rec0f_a1:
 ds_read_b128 v[44:47], v2 offset:0
 ds_read_b128 v[48:51], v2 offset:512
 s_waitcnt lgkmcnt(1)
 v_smfmac_f32_16x16x64_bf16 v[36:39], v[44:47], v[80:87], v1
 ds_read_b128 v[52:55], v2 offset:1024
 v_smfmac_f32_16x16x64_bf16 v[40:43], v[44:47], v[240:247], v1
 v_smfmac_f32_16x16x64_bf16 v[32:35], v[44:47], v[56:63], v1
 s_waitcnt lgkmcnt(1)
 v_smfmac_f32_16x16x64_bf16 v[36:39], v[48:51], v[88:95], v1
 ds_read_b128 v[44:47], v2 offset:1536
 ds_read_b128 v[56:59], v3 offset:6144
 v_smfmac_f32_16x16x64_bf16 v[40:43], v[48:51], v[248:255], v1
 ds_read_b128 v[60:63], v3 offset:7168
 v_smfmac_f32_16x16x64_bf16 v[32:35], v[48:51], v[64:71], v1
 s_waitcnt lgkmcnt(3)
 v_smfmac_f32_16x16x64_bf16 v[36:39], v[52:55], v[96:103], v1
 ds_read_b128 v[48:51], v2 offset:2048
 ds_read_b128 v[64:67], v3 offset:8192
 v_smfmac_f32_16x16x64_bf16 v[40:43], v[52:55], a[0:7], v1
 ds_read_b128 v[68:71], v3 offset:9216
 v_smfmac_f32_16x16x64_bf16 v[32:35], v[52:55], v[72:79], v1
 s_waitcnt lgkmcnt(5)
 v_smfmac_f32_16x16x64_bf16 v[36:39], v[44:47], v[104:111], v1
 ds_read_b128 v[52:55], v2 offset:2560
 ds_read_b128 v[72:75], v3 offset:10240
 s_waitcnt lgkmcnt(5)
 v_smfmac_f32_16x16x64_bf16 v[40:43], v[44:47], v[56:63], v1
 ds_read_b128 v[76:79], v3 offset:11264
 s_waitcnt lgkmcnt(3)
 v_smfmac_f32_16x16x64_bf16 v[32:35], v[44:47], v[64:71], v1
 ds_read_b128 v[56:59], v3 offset:12288
 ds_read_b128 v[60:63], v3 offset:13312
 v_smfmac_f32_16x16x64_bf16 v[36:39], v[48:51], v[112:119], v1
 ds_read_b128 v[44:47], v2 offset:3072
 ds_read_b128 v[64:67], v3 offset:14336
 v_smfmac_f32_16x16x64_bf16 v[40:43], v[48:51], a[8:15], v1
 ds_read_b128 v[68:71], v3 offset:15360
 s_waitcnt lgkmcnt(5)
 v_smfmac_f32_16x16x64_bf16 v[32:35], v[48:51], v[72:79], v1
 v_smfmac_f32_16x16x64_bf16 v[36:39], v[52:55], v[120:127], v1
 ds_read_b128 v[48:51], v2 offset:3584
 ds_read_b128 v[72:75], v3 offset:16384
 v_smfmac_f32_16x16x64_bf16 v[40:43], v[52:55], a[16:23], v1
 ds_read_b128 v[76:79], v3 offset:17408
 s_waitcnt lgkmcnt(6)
 v_smfmac_f32_16x16x64_bf16 v[32:35], v[52:55], v[56:63], v1
 s_waitcnt lgkmcnt(5)
 v_smfmac_f32_16x16x64_bf16 v[36:39], v[44:47], v[128:135], v1
 ds_read_b128 v[52:55], v2 offset:4096
 ds_read_b128 v[56:59], v3 offset:18432
 v_smfmac_f32_16x16x64_bf16 v[40:43], v[44:47], a[24:31], v1
 ds_read_b128 v[60:63], v3 offset:19456
 s_waitcnt lgkmcnt(6)
 v_smfmac_f32_16x16x64_bf16 v[32:35], v[44:47], v[64:71], v1
 s_waitcnt lgkmcnt(5)
 v_smfmac_f32_16x16x64_bf16 v[36:39], v[48:51], v[136:143], v1
 ds_read_b128 v[44:47], v2 offset:4608
 ds_read_b128 v[64:67], v3 offset:20480
 s_waitcnt lgkmcnt(5)
 v_smfmac_f32_16x16x64_bf16 v[40:43], v[48:51], v[72:79], v1
 ds_read_b128 v[68:71], v3 offset:21504
 s_waitcnt lgkmcnt(3)
 v_smfmac_f32_16x16x64_bf16 v[32:35], v[48:51], v[56:63], v1
 ds_read_b128 v[72:75], v3 offset:22528
 ds_read_b128 v[76:79], v3 offset:23552
 v_smfmac_f32_16x16x64_bf16 v[36:39], v[52:55], v[144:151], v1
 v_smfmac_f32_16x16x64_bf16 v[40:43], v[52:55], a[32:39], v1
 s_waitcnt lgkmcnt(2)
 v_smfmac_f32_16x16x64_bf16 v[32:35], v[52:55], v[64:71], v1
 v_smfmac_f32_16x16x64_bf16 v[36:39], v[44:47], v[152:159], v1
 v_smfmac_f32_16x16x64_bf16 v[40:43], v[44:47], a[40:47], v1
 s_waitcnt lgkmcnt(0)
 v_smfmac_f32_16x16x64_bf16 v[32:35], v[44:47], v[72:79], v1
 v_mov_b64 v[72:73], -1
 v_mov_b64 v[74:75], -1
 buffer_store_dwordx4 v[72:75], v6, s[8:11], s101 offen offset:0
 buffer_store_dwordx4 v[72:75], v6, s[8:11], s101 offen offset:1024
 buffer_store_dwordx4 v[72:75], v6, s[8:11], s101 offen offset:2048
 buffer_store_dwordx4 v[72:75], v6, s[8:11], s101 offen offset:3072
 s_waitcnt lgkmcnt(0)
 s_barrier
 ds_read_b128 v[44:47], v2 offset:5120
 ds_read_b128 v[48:51], v2 offset:5632
 ds_read_b128 v[52:55], v2 offset:6144
 s_waitcnt lgkmcnt(2)
 v_smfmac_f32_16x16x64_bf16 v[32:35], v[44:47], a[128:135], v1
 ds_read_b128 v[56:59], v2 offset:6656
 v_smfmac_f32_16x16x64_bf16 v[36:39], v[44:47], v[160:167], v1
 ds_read_b128 v[60:63], v2 offset:7168
 v_smfmac_f32_16x16x64_bf16 v[40:43], v[44:47], a[48:55], v1
 s_waitcnt lgkmcnt(2)
 v_smfmac_f32_16x16x64_bf16 v[36:39], v[48:51], v[168:175], v1
 ds_read_b128 v[64:67], v2 offset:7680
 v_smfmac_f32_16x16x64_bf16 v[40:43], v[48:51], a[56:63], v1
 s_waitcnt lgkmcnt(2)
 v_smfmac_f32_16x16x64_bf16 v[36:39], v[52:55], v[176:183], v1
 ds_read_b128 v[68:71], v2 offset:8192
 v_smfmac_f32_16x16x64_bf16 v[40:43], v[52:55], a[64:71], v1
 s_waitcnt lgkmcnt(2)
 v_smfmac_f32_16x16x64_bf16 v[36:39], v[56:59], v[184:191], v1
 ds_read_b128 v[72:75], v2 offset:8704
 v_smfmac_f32_16x16x64_bf16 v[40:43], v[56:59], a[72:79], v1
 s_waitcnt lgkmcnt(2)
 v_smfmac_f32_16x16x64_bf16 v[36:39], v[60:63], v[192:199], v1
 ds_read_b128 v[76:79], v2 offset:9216
 v_smfmac_f32_16x16x64_bf16 v[40:43], v[60:63], a[80:87], v1
 s_waitcnt lgkmcnt(1)
 v_smfmac_f32_16x16x64_bf16 v[36:39], v[64:67], v[200:207], v1
 ds_read_b128 v[44:47], v2 offset:9728
 v_smfmac_f32_16x16x64_bf16 v[40:43], v[64:67], a[88:95], v1
 buffer_load_dwordx4 v[24:27], v14, s[8:11], s3 offen offset:0 sc1
 v_smfmac_f32_16x16x64_bf16 v[36:39], v[68:71], v[208:215], v1
 buffer_load_dwordx4 v[28:31], v14, s[8:11], s3 offen offset:1024 sc1
 v_smfmac_f32_16x16x64_bf16 v[40:43], v[68:71], a[96:103], v1
 s_waitcnt lgkmcnt(0)
 v_smfmac_f32_16x16x64_bf16 v[36:39], v[72:75], v[216:223], v1
 s_mov_b32 m0, s97
 v_smfmac_f32_16x16x64_bf16 v[40:43], v[72:75], a[104:111], v1
 buffer_load_dwordx4 v14, s[8:11], s79 offen offset:0 sc1 lds
 v_smfmac_f32_16x16x64_bf16 v[36:39], v[76:79], v[224:231], v1
 buffer_load_dwordx4 v14, s[8:11], s79 offen offset:1024 sc1 lds
 v_smfmac_f32_16x16x64_bf16 v[40:43], v[76:79], a[112:119], v1
 s_mov_b32 m0, 14848
 v_smfmac_f32_16x16x64_bf16 v[36:39], v[44:47], v[232:239], v1
 buffer_load_dword v10, s[8:11], s4 offen sc1 lds
 v_smfmac_f32_16x16x64_bf16 v[40:43], v[44:47], a[120:127], v1
 v_smfmac_f32_16x16x64_bf16 v[32:35], v[56:59], a[152:159], v1
 v_smfmac_f32_16x16x64_bf16 v[32:35], v[60:63], a[160:167], v1
 v_smfmac_f32_16x16x64_bf16 v[32:35], v[64:67], a[168:175], v1
 v_cvt_pk_bf16_f32 v36, v36, v37
 v_cvt_pk_bf16_f32 v37, v38, v39
 ds_write_b64 v4, v[36:37] offset:0
 v_cvt_pk_bf16_f32 v40, v40, v41
 v_cvt_pk_bf16_f32 v41, v42, v43
 ds_write_b64 v4, v[40:41] offset:2304
 v_smfmac_f32_16x16x64_bf16 v[32:35], v[68:71], a[176:183], v1
 v_smfmac_f32_16x16x64_bf16 v[32:35], v[48:51], a[136:143], v1
 v_smfmac_f32_16x16x64_bf16 v[32:35], v[52:55], a[144:151], v1
 ds_read_b128 v[56:59], v0 offset:0
 v_smfmac_f32_16x16x64_bf16 v[32:35], v[72:75], a[184:191], v1
 ds_read_b128 v[60:63], v0 offset:4096
 v_smfmac_f32_16x16x64_bf16 v[32:35], v[76:79], a[192:199], v1
 ds_read_b128 v[64:67], v0 offset:1024
 v_smfmac_f32_16x16x64_bf16 v[32:35], v[44:47], a[200:207], v1
 ds_read_b128 v[68:71], v0 offset:5120
 s_waitcnt lgkmcnt(4)
 s_barrier
 ds_read_b64_tr_b16 v[44:45], v5 offset:0
 ds_read_b64_tr_b16 v[46:47], v5 offset:32
 ds_read_b64_tr_b16 v[48:49], v5 offset:2304
 ds_read_b64_tr_b16 v[50:51], v5 offset:2336
 ds_read_b64_tr_b16 v[52:53], v5 offset:576
 ds_read_b64_tr_b16 v[54:55], v5 offset:608
 ds_read_b64_tr_b16 v[76:77], v5 offset:2880
 ds_read_b64_tr_b16 v[78:79], v5 offset:2912
 buffer_store_dwordx2 v[40:41], v15, s[8:11], s80 offen sc1
 v_cvt_pk_bf16_f32 v32, v32, v33
 v_cvt_pk_bf16_f32 v33, v34, v35
 s_waitcnt lgkmcnt(4)
 v_mfma_f32_16x16x32_bf16 v[36:39], v[56:59], v[44:47], 0
 v_mfma_f32_16x16x32_bf16 v[40:43], v[60:63], v[44:47], 0
 v_mfma_f32_16x16x32_bf16 v[72:75], v[48:51], v[44:47], 0
 s_waitcnt lgkmcnt(0)
 v_mfma_f32_16x16x32_bf16 v[36:39], v[64:67], v[52:55], v[36:39]
 ds_read_b64_tr_b16 v[44:45], v5 offset:1152
 ds_read_b64_tr_b16 v[46:47], v5 offset:1184
 v_mfma_f32_16x16x32_bf16 v[40:43], v[68:71], v[52:55], v[40:43]
 ds_read_b64_tr_b16 v[48:49], v5 offset:3456
 ds_read_b64_tr_b16 v[50:51], v5 offset:3488
 v_mfma_f32_16x16x32_bf16 v[72:75], v[76:79], v[52:55], v[72:75]
 ds_read_b128 v[56:59], v0 offset:2048
 ds_read_b128 v[60:63], v0 offset:6144
 ds_read_b64_tr_b16 v[52:53], v5 offset:1728
 ds_read_b64_tr_b16 v[54:55], v5 offset:1760
 s_waitcnt lgkmcnt(2)
 v_mfma_f32_16x16x32_bf16 v[36:39], v[56:59], v[44:47], v[36:39]
 ds_read_b64_tr_b16 v[76:77], v5 offset:4032
 ds_read_b64_tr_b16 v[78:79], v5 offset:4064
 v_mfma_f32_16x16x32_bf16 v[40:43], v[60:63], v[44:47], v[40:43]
 ds_read_b128 v[64:67], v0 offset:3072
 ds_read_b128 v[68:71], v0 offset:7168
 v_mfma_f32_16x16x32_bf16 v[72:75], v[48:51], v[44:47], v[72:75]
 buffer_store_dwordx2 v[32:33], v15, s[8:11], s100 offen sc1
 s_waitcnt lgkmcnt(0)
 v_mfma_f32_16x16x32_bf16 v[72:75], v[76:79], v[52:55], v[72:75]
 v_xor_b32 v0, 0x2000, v0
 v_mfma_f32_16x16x32_bf16 v[36:39], v[64:67], v[52:55], v[36:39]
 v_mfma_f32_16x16x32_bf16 v[40:43], v[68:71], v[52:55], v[40:43]
 s_cmp_eq_u32 s72, 63
 s_cbranch_scc1 rec0f_last
 v_mov_b32 v44, 0x3f803f80
 v_mov_b32 v45, 0x3f803f80
 v_mov_b32 v46, 0x3f803f80
 v_mov_b32 v47, 0x3f803f80
 v_mov_b64 v[78:79], 0
 v_mov_b32_dpp v72, v74 quad_perm:[0,1,2,3] row_mask:0xf bank_mask:0xc
 v_mov_b32_dpp v73, v75 quad_perm:[0,1,2,3] row_mask:0xf bank_mask:0xc
 v_mov_b32_dpp v36, v40 quad_perm:[0,1,2,3] row_mask:0xf bank_mask:0xc
 v_mov_b32_dpp v37, v41 quad_perm:[0,1,2,3] row_mask:0xf bank_mask:0xc
 v_mov_b32_dpp v38, v42 quad_perm:[0,1,2,3] row_mask:0xf bank_mask:0xc
 v_mov_b32_dpp v39, v43 quad_perm:[0,1,2,3] row_mask:0xf bank_mask:0xc
 v_max3_f32 v76, v72, v73, v36
 v_max3_f32 v77, v37, v38, v39
 v_max_f32 v76, v76, v77
 v_mov_b64 v[74:75], 0
 s_nop 0
 v_max_f32_dpp v76, v76, v76 row_ror:8 row_mask:0xf bank_mask:0xf
 v_mov_b32 v77, v76
 s_nop 1
 v_permlane16_swap_b32 v76, v77
 v_max_f32 v76, v76, v77
 v_mov_b32 v77, v76
 s_nop 1
 v_permlane32_swap_b32 v76, v77
 v_max_f32 v76, v76, v77
 v_mul_f32 v76, 0xbe0293ee, v76
 v_pk_fma_f32 v[36:37], v[36:37], s[98:99], v[76:77] op_sel_hi:[1,0,0]
 v_pk_fma_f32 v[38:39], v[38:39], s[98:99], v[76:77] op_sel_hi:[1,0,0]
 v_pk_fma_f32 v[72:73], v[72:73], s[98:99], v[76:77] op_sel_hi:[1,0,0]
 v_exp_f32 v36, v36
 v_exp_f32 v37, v37
 v_exp_f32 v38, v38
 v_exp_f32 v39, v39
 v_exp_f32 v72, v72
 v_exp_f32 v73, v73
 v_cvt_pk_bf16_f32 v40, v36, v37
 v_cvt_pk_bf16_f32 v41, v38, v39
 v_cvt_pk_bf16_f32 v76, v72, v73
 v_mov_b32_dpp v42, v40 row_ror:8 row_mask:0xf bank_mask:0xf
 v_mov_b32_dpp v43, v41 row_ror:8 row_mask:0xf bank_mask:0xf
 v_mov_b32_dpp v74, v76 quad_perm:[0,1,2,3] row_mask:0x3 bank_mask:0xf
 v_mov_b32_dpp v75, v76 row_ror:8 row_mask:0x3 bank_mask:0xf
 v_mfma_f32_16x16x32_bf16 v[52:55], v[44:47], v[40:43], 0
 v_mov_b32_dpp v78, v76 quad_perm:[0,1,2,3] row_mask:0xc bank_mask:0xf
 v_mov_b32_dpp v79, v76 row_ror:8 row_mask:0xc bank_mask:0xf
 v_mfma_f32_16x16x32_bf16 v[48:51], v[16:19], v[40:43], 0
 v_mov_b64 v[36:37], 0
 v_mov_b64 v[38:39], 0
 v_mfma_f32_16x16x32_bf16 v[64:67], v[20:23], v[40:43], 0
 v_mfma_f32_16x16x16_bf16 v[52:55], v[44:45], v[74:75], v[52:55]
 v_mov_b64 v[40:41], 0
 v_mov_b64 v[42:43], 0
 v_mfma_f32_16x16x16_bf16 v[48:51], v[32:33], v[74:75], v[48:51]
 v_mfma_f32_16x16x16_bf16 v[64:67], v[32:33], v[78:79], v[64:67]
 v_mov_b64 v[32:33], 0
 v_mov_b64 v[34:35], 0
 v_rcp_f32 v76, v52
 s_nop 0
 v_pk_mul_f32 v[48:49], v[48:49], v[76:77] op_sel_hi:[1,0]
 v_pk_mul_f32 v[50:51], v[50:51], v[76:77] op_sel_hi:[1,0]
 s_nop 1
 v_pk_mul_f32 v[64:65], v[64:65], v[76:77] op_sel_hi:[1,0]
 v_pk_mul_f32 v[66:67], v[66:67], v[76:77] op_sel_hi:[1,0]
 v_cvt_pk_bf16_f32 v72, v48, v64
 v_cvt_pk_bf16_f32 v73, v49, v65
 v_cvt_pk_bf16_f32 v74, v50, v66
 v_cvt_pk_bf16_f32 v75, v51, v67
 ds_write_b128 v7, v[72:75]
 ds_read_b128 v[16:19], v3 offset:24576
 ds_read_b128 v[20:23], v3 offset:25600
 ds_read_b128 v[44:47], v3 offset:26624
 ds_read_b128 v[48:51], v3 offset:27648
 ds_read_b128 v[72:75], v3 offset:28672
 ds_read_b128 v[76:79], v3 offset:29696
 s_waitcnt lgkmcnt(6)
 s_barrier
 ds_read_b128 v[56:59], v2 offset:0
 ds_read_b128 v[60:63], v2 offset:512
 ds_read_b128 v[64:67], v2 offset:1024
 ds_read_b128 v[68:71], v2 offset:1536
 s_waitcnt lgkmcnt(3)
 v_smfmac_f32_16x16x64_bf16 v[32:35], v[56:59], v[16:23], v1
 s_waitcnt lgkmcnt(2)
 v_smfmac_f32_16x16x64_bf16 v[32:35], v[60:63], v[44:51], v1
 ds_read_b128 v[16:19], v3 offset:30720
 s_waitcnt lgkmcnt(2)
 v_smfmac_f32_16x16x64_bf16 v[32:35], v[64:67], v[72:79], v1
 ds_read_b128 v[20:23], v3 offset:31744
 s_waitcnt lgkmcnt(2)
 v_smfmac_f32_16x16x64_bf16 v[32:35], v[68:71], a[208:215], v1
 ds_read_b128 v[44:47], v3 offset:32768
 v_smfmac_f32_16x16x64_bf16 v[36:39], v[56:59], a[216:223], v1
 ds_read_b128 v[48:51], v3 offset:33792
 v_smfmac_f32_16x16x64_bf16 v[36:39], v[60:63], a[224:231], v1
 ds_read_b128 v[72:75], v3 offset:34816
 v_smfmac_f32_16x16x64_bf16 v[36:39], v[64:67], a[232:239], v1
 ds_read_b128 v[76:79], v3 offset:35840
 s_waitcnt lgkmcnt(4)
 v_smfmac_f32_16x16x64_bf16 v[36:39], v[68:71], v[16:23], v1
 s_waitcnt lgkmcnt(2)
 v_smfmac_f32_16x16x64_bf16 v[40:43], v[56:59], v[44:51], v1
 s_waitcnt lgkmcnt(0)
 v_smfmac_f32_16x16x64_bf16 v[40:43], v[60:63], v[72:79], v1
 v_smfmac_f32_16x16x64_bf16 v[40:43], v[64:67], a[240:247], v1
 v_smfmac_f32_16x16x64_bf16 v[40:43], v[68:71], a[248:255], v1
 v_cvt_pk_bf16_f32 v32, v32, v33
 v_cvt_pk_bf16_f32 v33, v34, v35
 buffer_store_dwordx2 v[32:33], v9, s[8:11], s82 offen
 v_cvt_pk_bf16_f32 v36, v36, v37
 v_cvt_pk_bf16_f32 v37, v38, v39
 buffer_store_dwordx2 v[36:37], v9, s[8:11], s83 offen
 s_nop 1
 v_cvt_pk_bf16_f32 v40, v40, v41
 v_cvt_pk_bf16_f32 v41, v42, v43
 buffer_store_dwordx2 v[40:41], v9, s[8:11], s84 offen
 s_cmp_ge_u32 s86, 40
 s_cbranch_scc1 idle_117
 v_mov_b64 v[44:45], 0
 v_mov_b64 v[46:47], 0
 s_nop 0
 v_mov_b32_dpp v44, v8 quad_perm:[0,1,2,3] row_mask:0xf bank_mask:0x1
 v_mov_b32_dpp v45, v8 quad_perm:[0,1,2,3] row_mask:0xf bank_mask:0x2
 v_mov_b32_dpp v46, v8 quad_perm:[0,1,2,3] row_mask:0xf bank_mask:0x4
 v_mov_b32_dpp v47, v8 quad_perm:[0,1,2,3] row_mask:0xf bank_mask:0x8
 s_waitcnt vmcnt(0)
 buffer_load_dwordx4 v[56:59], v6, s[8:11], s85 offen offset:0 sc1
 buffer_load_dwordx4 v[60:63], v6, s[8:11], s85 offen offset:1024 sc1
 buffer_load_dwordx4 v[64:67], v6, s[8:11], s85 offen offset:2048 sc1
 buffer_load_dwordx4 v[68:71], v6, s[8:11], s85 offen offset:3072 sc1
 s_waitcnt vmcnt(3)
 v_mfma_f32_16x16x32_bf16 v[48:51], v[56:59], v[44:47], 0
 v_max3_u32 v52, v56, v57, v58
 v_max_u32 v52, v52, v59
 s_waitcnt vmcnt(2)
 v_mfma_f32_16x16x32_bf16 v[48:51], v[60:63], v[44:47], v[48:51]
 v_max3_u32 v52, v52, v60, v61
 v_max3_u32 v52, v52, v62, v63
 s_waitcnt vmcnt(1)
 v_mfma_f32_16x16x32_bf16 v[48:51], v[64:67], v[44:47], v[48:51]
 v_max3_u32 v52, v52, v64, v65
 v_max3_u32 v52, v52, v66, v67
 s_waitcnt vmcnt(0)
 v_mfma_f32_16x16x32_bf16 v[48:51], v[68:71], v[44:47], v[48:51]
 v_max3_u32 v52, v52, v68, v69
 v_max3_u32 v52, v52, v70, v71
 v_cmp_eq_u32 vcc, -1, v52
 s_cbranch_vccnz red_retry_119
red_118:
 s_nop 6
 v_permlane32_swap_b32 v48, v50
 v_permlane32_swap_b32 v49, v51
 v_pk_add_f32 v[48:49], v[48:49], v[50:51]
 v_cvt_pk_bf16_f32 v52, v48, v49
 s_mov_b64 exec, s[90:91]
 buffer_store_dword v52, v11, s[8:11], s78 offen sc1
 buffer_store_dword v52, v11, s[8:11], s77 offen
 s_mov_b64 exec, -1
 s_branch rec0f_step
idle_117:
 s_waitcnt vmcnt(2)
 s_branch rec0f_step
rec0f_last:
 s_waitcnt vmcnt(0)
 s_barrier
 s_cmp_lg_u32 s66, 0
 s_cbranch_scc1 notw0_120
 v_mov_b32 v44, 64
 v_mov_b32 v45, 0
 s_mov_b64 exec, 1
 buffer_store_dword v44, v45, s[8:11], s5 offen sc1
 s_mov_b64 exec, -1
notw0_120:
 s_waitcnt vmcnt(0)
 s_branch rec_helper
 s_endpgm
red_retry_119:
 s_mov_b64 exec, vcc
 buffer_load_dwordx4 v[56:59], v6, s[8:11], s85 offen offset:0 sc1
 buffer_load_dwordx4 v[60:63], v6, s[8:11], s85 offen offset:1024 sc1
 buffer_load_dwordx4 v[64:67], v6, s[8:11], s85 offen offset:2048 sc1
 buffer_load_dwordx4 v[68:71], v6, s[8:11], s85 offen offset:3072 sc1
red_loop_121:
 s_mov_b64 exec, vcc
 buffer_load_dwordx4 v[56:59], v6, s[8:11], s85 offen offset:0 sc1
 buffer_load_dwordx4 v[60:63], v6, s[8:11], s85 offen offset:1024 sc1
 buffer_load_dwordx4 v[64:67], v6, s[8:11], s85 offen offset:2048 sc1
 buffer_load_dwordx4 v[68:71], v6, s[8:11], s85 offen offset:3072 sc1
 s_mov_b64 exec, -1
 s_waitcnt vmcnt(4)
 v_max3_u32 v52, v56, v57, v58
 v_max_u32 v52, v52, v59
 v_max3_u32 v52, v52, v60, v61
 v_max3_u32 v52, v52, v62, v63
 v_max3_u32 v52, v52, v64, v65
 v_max3_u32 v52, v52, v66, v67
 v_max3_u32 v52, v52, v68, v69
 v_max3_u32 v52, v52, v70, v71
 v_cmp_eq_u32 vcc, -1, v52
 s_cbranch_vccz red_done_122
 s_add_u32 s74, s74, 1
 s_cmp_lt_u32 s74, 0x40000
 s_cbranch_scc1 red_loop_121
 s_branch bail2
red_done_122:
 v_mfma_f32_16x16x32_bf16 v[48:51], v[56:59], v[44:47], 0
 v_mfma_f32_16x16x32_bf16 v[48:51], v[60:63], v[44:47], v[48:51]
 v_mfma_f32_16x16x32_bf16 v[48:51], v[64:67], v[44:47], v[48:51]
 v_mfma_f32_16x16x32_bf16 v[48:51], v[68:71], v[44:47], v[48:51]
 s_branch red_118
rec0s_step:
 v_mov_b64 v[16:17], v[24:25]
 v_mov_b64 v[18:19], v[26:27]
 v_mov_b64 v[20:21], v[28:29]
 v_mov_b64 v[22:23], v[30:31]
 v_mov_b64 v[32:33], 0
 v_mov_b64 v[34:35], 0
 v_mov_b64 v[36:37], 0
 v_mov_b64 v[38:39], 0
 v_mov_b64 v[40:41], 0
 v_mov_b64 v[42:43], 0
 s_xor_b32 s97, s97, 0x2000
 s_add_u32 s79, s79, 0x40000
 s_add_u32 s3, s3, 0x40000
 s_add_u32 s72, s72, 1
 s_mov_b32 s101, s85
 s_add_u32 s82, s82, s73
 s_add_u32 s83, s83, s73
 s_add_u32 s84, s84, s73
 s_add_u32 s85, s85, s73
 s_sub_u32 s73, 0, s73
 s_add_u32 s75, s75, 5120
 s_add_u32 s76, s76, 5120
 s_add_u32 s77, s77, 5120
 s_add_u32 s78, s78, 5120
 s_add_u32 s80, s80, 0x10000
 s_add_u32 s100, s100, 0x10000
 s_add_u32 s4, s77, 5120
 s_waitcnt vmcnt(2)
 ds_read_b128 v[56:59], v3 offset:0
 ds_read_b128 v[60:63], v3 offset:1024
 ds_read_b128 v[64:67], v3 offset:2048
 ds_read_b128 v[68:71], v3 offset:3072
 ds_read_b128 v[72:75], v3 offset:4096
 ds_read_b128 v[76:79], v3 offset:5120
 s_barrier
 s_cmp_lg_u32 s66, 0
 s_cbranch_scc1 notw0_123
 s_add_u32 s81, s72, 3
 s_lshr_b32 s81, s81, 1
 s_min_u32 s81, s81, 32
 s_cmp_ge_u32 s96, s81
 s_cbranch_scc1 kvok_125
 v_and_b32 v45, 0x70, v6
 v_lshlrev_b32 v45, 3, v45
kv_124:
 buffer_load_dword v44, v45, s[8:11], s89 offen sc1
 s_waitcnt vmcnt(0)
 v_readlane_b32 s87, v44, 2
 v_readlane_b32 s88, v44, 4
 s_min_u32 s96, s87, s88
 v_readlane_b32 s87, v44, 3
 v_readlane_b32 s88, v44, 5
 s_min_u32 s87, s87, s88
 s_lshl_b32 s96, s96, 1
 s_lshl_b32 s87, s87, 1
 s_add_u32 s87, s87, 1
 s_min_u32 s96, s96, s87
 s_cmp_ge_u32 s96, s81
 s_cbranch_scc1 kvok_125
 s_add_u32 s74, s74, 1
 s_cmp_lt_u32 s74, 0x40000
 s_cbranch_scc1 kv_124
 s_branch bail2
kvok_125:
notw0_123:
 s_barrier
rec0s_a1:
 ds_read_b128 v[44:47], v2 offset:0
 ds_read_b128 v[48:51], v2 offset:512
 s_waitcnt lgkmcnt(1)
 v_smfmac_f32_16x16x64_bf16 v[36:39], v[44:47], v[80:87], v1
 ds_read_b128 v[52:55], v2 offset:1024
 v_smfmac_f32_16x16x64_bf16 v[40:43], v[44:47], v[240:247], v1
 v_smfmac_f32_16x16x64_bf16 v[32:35], v[44:47], v[56:63], v1
 s_waitcnt lgkmcnt(1)
 v_smfmac_f32_16x16x64_bf16 v[36:39], v[48:51], v[88:95], v1
 ds_read_b128 v[44:47], v2 offset:1536
 ds_read_b128 v[56:59], v3 offset:6144
 v_smfmac_f32_16x16x64_bf16 v[40:43], v[48:51], v[248:255], v1
 ds_read_b128 v[60:63], v3 offset:7168
 v_smfmac_f32_16x16x64_bf16 v[32:35], v[48:51], v[64:71], v1
 s_waitcnt lgkmcnt(3)
 v_smfmac_f32_16x16x64_bf16 v[36:39], v[52:55], v[96:103], v1
 ds_read_b128 v[48:51], v2 offset:2048
 ds_read_b128 v[64:67], v3 offset:8192
 v_smfmac_f32_16x16x64_bf16 v[40:43], v[52:55], a[0:7], v1
 ds_read_b128 v[68:71], v3 offset:9216
 v_smfmac_f32_16x16x64_bf16 v[32:35], v[52:55], v[72:79], v1
 s_waitcnt lgkmcnt(5)
 v_smfmac_f32_16x16x64_bf16 v[36:39], v[44:47], v[104:111], v1
 ds_read_b128 v[52:55], v2 offset:2560
 ds_read_b128 v[72:75], v3 offset:10240
 s_waitcnt lgkmcnt(5)
 v_smfmac_f32_16x16x64_bf16 v[40:43], v[44:47], v[56:63], v1
 ds_read_b128 v[76:79], v3 offset:11264
 s_waitcnt lgkmcnt(3)
 v_smfmac_f32_16x16x64_bf16 v[32:35], v[44:47], v[64:71], v1
 ds_read_b128 v[56:59], v3 offset:12288
 ds_read_b128 v[60:63], v3 offset:13312
 v_smfmac_f32_16x16x64_bf16 v[36:39], v[48:51], v[112:119], v1
 ds_read_b128 v[44:47], v2 offset:3072
 ds_read_b128 v[64:67], v3 offset:14336
 v_smfmac_f32_16x16x64_bf16 v[40:43], v[48:51], a[8:15], v1
 ds_read_b128 v[68:71], v3 offset:15360
 s_waitcnt lgkmcnt(5)
 v_smfmac_f32_16x16x64_bf16 v[32:35], v[48:51], v[72:79], v1
 v_smfmac_f32_16x16x64_bf16 v[36:39], v[52:55], v[120:127], v1
 ds_read_b128 v[48:51], v2 offset:3584
 ds_read_b128 v[72:75], v3 offset:16384
 v_smfmac_f32_16x16x64_bf16 v[40:43], v[52:55], a[16:23], v1
 ds_read_b128 v[76:79], v3 offset:17408
 s_waitcnt lgkmcnt(6)
 v_smfmac_f32_16x16x64_bf16 v[32:35], v[52:55], v[56:63], v1
 s_waitcnt lgkmcnt(5)
 v_smfmac_f32_16x16x64_bf16 v[36:39], v[44:47], v[128:135], v1
 ds_read_b128 v[52:55], v2 offset:4096
 ds_read_b128 v[56:59], v3 offset:18432
 v_smfmac_f32_16x16x64_bf16 v[40:43], v[44:47], a[24:31], v1
 ds_read_b128 v[60:63], v3 offset:19456
 s_waitcnt lgkmcnt(6)
 v_smfmac_f32_16x16x64_bf16 v[32:35], v[44:47], v[64:71], v1
 s_waitcnt lgkmcnt(5)
 v_smfmac_f32_16x16x64_bf16 v[36:39], v[48:51], v[136:143], v1
 ds_read_b128 v[44:47], v2 offset:4608
 ds_read_b128 v[64:67], v3 offset:20480
 s_waitcnt lgkmcnt(5)
 v_smfmac_f32_16x16x64_bf16 v[40:43], v[48:51], v[72:79], v1
 ds_read_b128 v[68:71], v3 offset:21504
 s_waitcnt lgkmcnt(3)
 v_smfmac_f32_16x16x64_bf16 v[32:35], v[48:51], v[56:63], v1
 ds_read_b128 v[72:75], v3 offset:22528
 ds_read_b128 v[76:79], v3 offset:23552
 v_smfmac_f32_16x16x64_bf16 v[36:39], v[52:55], v[144:151], v1
 v_smfmac_f32_16x16x64_bf16 v[40:43], v[52:55], a[32:39], v1
 s_waitcnt lgkmcnt(2)
 v_smfmac_f32_16x16x64_bf16 v[32:35], v[52:55], v[64:71], v1
 v_smfmac_f32_16x16x64_bf16 v[36:39], v[44:47], v[152:159], v1
 v_smfmac_f32_16x16x64_bf16 v[40:43], v[44:47], a[40:47], v1
 s_waitcnt lgkmcnt(0)
 v_smfmac_f32_16x16x64_bf16 v[32:35], v[44:47], v[72:79], v1
 v_mov_b64 v[72:73], -1
 v_mov_b64 v[74:75], -1
 buffer_store_dwordx4 v[72:75], v6, s[8:11], s101 offen offset:0 sc1
 buffer_store_dwordx4 v[72:75], v6, s[8:11], s101 offen offset:1024 sc1
 buffer_store_dwordx4 v[72:75], v6, s[8:11], s101 offen offset:2048 sc1
 buffer_store_dwordx4 v[72:75], v6, s[8:11], s101 offen offset:3072 sc1
 s_waitcnt lgkmcnt(0)
 s_barrier
 ds_read_b128 v[44:47], v2 offset:5120
 ds_read_b128 v[48:51], v2 offset:5632
 ds_read_b128 v[52:55], v2 offset:6144
 s_waitcnt lgkmcnt(2)
 v_smfmac_f32_16x16x64_bf16 v[32:35], v[44:47], a[128:135], v1
 ds_read_b128 v[56:59], v2 offset:6656
 v_smfmac_f32_16x16x64_bf16 v[36:39], v[44:47], v[160:167], v1
 ds_read_b128 v[60:63], v2 offset:7168
 v_smfmac_f32_16x16x64_bf16 v[40:43], v[44:47], a[48:55], v1
 s_waitcnt lgkmcnt(2)
 v_smfmac_f32_16x16x64_bf16 v[36:39], v[48:51], v[168:175], v1
 ds_read_b128 v[64:67], v2 offset:7680
 v_smfmac_f32_16x16x64_bf16 v[40:43], v[48:51], a[56:63], v1
 s_waitcnt lgkmcnt(2)
 v_smfmac_f32_16x16x64_bf16 v[36:39], v[52:55], v[176:183], v1
 ds_read_b128 v[68:71], v2 offset:8192
 v_smfmac_f32_16x16x64_bf16 v[40:43], v[52:55], a[64:71], v1
 s_waitcnt lgkmcnt(2)
 v_smfmac_f32_16x16x64_bf16 v[36:39], v[56:59], v[184:191], v1
 ds_read_b128 v[72:75], v2 offset:8704
 v_smfmac_f32_16x16x64_bf16 v[40:43], v[56:59], a[72:79], v1
 s_waitcnt lgkmcnt(2)
 v_smfmac_f32_16x16x64_bf16 v[36:39], v[60:63], v[192:199], v1
 ds_read_b128 v[76:79], v2 offset:9216
 v_smfmac_f32_16x16x64_bf16 v[40:43], v[60:63], a[80:87], v1
 s_waitcnt lgkmcnt(1)
 v_smfmac_f32_16x16x64_bf16 v[36:39], v[64:67], v[200:207], v1
 ds_read_b128 v[44:47], v2 offset:9728
 v_smfmac_f32_16x16x64_bf16 v[40:43], v[64:67], a[88:95], v1
 buffer_load_dwordx4 v[24:27], v14, s[8:11], s3 offen offset:0 sc1
 v_smfmac_f32_16x16x64_bf16 v[36:39], v[68:71], v[208:215], v1
 buffer_load_dwordx4 v[28:31], v14, s[8:11], s3 offen offset:1024 sc1
 v_smfmac_f32_16x16x64_bf16 v[40:43], v[68:71], a[96:103], v1
 s_waitcnt lgkmcnt(0)
 v_smfmac_f32_16x16x64_bf16 v[36:39], v[72:75], v[216:223], v1
 s_mov_b32 m0, s97
 v_smfmac_f32_16x16x64_bf16 v[40:43], v[72:75], a[104:111], v1
 buffer_load_dwordx4 v14, s[8:11], s79 offen offset:0 sc1 lds
 v_smfmac_f32_16x16x64_bf16 v[36:39], v[76:79], v[224:231], v1
 buffer_load_dwordx4 v14, s[8:11], s79 offen offset:1024 sc1 lds
 v_smfmac_f32_16x16x64_bf16 v[40:43], v[76:79], a[112:119], v1
 s_mov_b32 m0, 14848
 v_smfmac_f32_16x16x64_bf16 v[36:39], v[44:47], v[232:239], v1
 buffer_load_dword v10, s[8:11], s4 offen sc1 lds
 v_smfmac_f32_16x16x64_bf16 v[40:43], v[44:47], a[120:127], v1
 v_smfmac_f32_16x16x64_bf16 v[32:35], v[56:59], a[152:159], v1
 v_smfmac_f32_16x16x64_bf16 v[32:35], v[60:63], a[160:167], v1
 v_smfmac_f32_16x16x64_bf16 v[32:35], v[64:67], a[168:175], v1
 v_cvt_pk_bf16_f32 v36, v36, v37
 v_cvt_pk_bf16_f32 v37, v38, v39
 ds_write_b64 v4, v[36:37] offset:0
 v_cvt_pk_bf16_f32 v40, v40, v41
 v_cvt_pk_bf16_f32 v41, v42, v43
 ds_write_b64 v4, v[40:41] offset:2304
 v_smfmac_f32_16x16x64_bf16 v[32:35], v[68:71], a[176:183], v1
 v_smfmac_f32_16x16x64_bf16 v[32:35], v[48:51], a[136:143], v1
 v_smfmac_f32_16x16x64_bf16 v[32:35], v[52:55], a[144:151], v1
 ds_read_b128 v[56:59], v0 offset:0
 v_smfmac_f32_16x16x64_bf16 v[32:35], v[72:75], a[184:191], v1
 ds_read_b128 v[60:63], v0 offset:4096
 v_smfmac_f32_16x16x64_bf16 v[32:35], v[76:79], a[192:199], v1
 ds_read_b128 v[64:67], v0 offset:1024
 v_smfmac_f32_16x16x64_bf16 v[32:35], v[44:47], a[200:207], v1
 ds_read_b128 v[68:71], v0 offset:5120
 s_waitcnt lgkmcnt(4)
 s_barrier
 ds_read_b64_tr_b16 v[44:45], v5 offset:0
 ds_read_b64_tr_b16 v[46:47], v5 offset:32
 ds_read_b64_tr_b16 v[48:49], v5 offset:2304
 ds_read_b64_tr_b16 v[50:51], v5 offset:2336
 ds_read_b64_tr_b16 v[52:53], v5 offset:576
 ds_read_b64_tr_b16 v[54:55], v5 offset:608
 ds_read_b64_tr_b16 v[76:77], v5 offset:2880
 ds_read_b64_tr_b16 v[78:79], v5 offset:2912
 buffer_store_dwordx2 v[40:41], v15, s[8:11], s80 offen sc1
 v_cvt_pk_bf16_f32 v32, v32, v33
 v_cvt_pk_bf16_f32 v33, v34, v35
 s_waitcnt lgkmcnt(4)
 v_mfma_f32_16x16x32_bf16 v[36:39], v[56:59], v[44:47], 0
 v_mfma_f32_16x16x32_bf16 v[40:43], v[60:63], v[44:47], 0
 v_mfma_f32_16x16x32_bf16 v[72:75], v[48:51], v[44:47], 0
 s_waitcnt lgkmcnt(0)
 v_mfma_f32_16x16x32_bf16 v[36:39], v[64:67], v[52:55], v[36:39]
 ds_read_b64_tr_b16 v[44:45], v5 offset:1152
 ds_read_b64_tr_b16 v[46:47], v5 offset:1184
 v_mfma_f32_16x16x32_bf16 v[40:43], v[68:71], v[52:55], v[40:43]
 ds_read_b64_tr_b16 v[48:49], v5 offset:3456
 ds_read_b64_tr_b16 v[50:51], v5 offset:3488
 v_mfma_f32_16x16x32_bf16 v[72:75], v[76:79], v[52:55], v[72:75]
 ds_read_b128 v[56:59], v0 offset:2048
 ds_read_b128 v[60:63], v0 offset:6144
 ds_read_b64_tr_b16 v[52:53], v5 offset:1728
 ds_read_b64_tr_b16 v[54:55], v5 offset:1760
 s_waitcnt lgkmcnt(2)
 v_mfma_f32_16x16x32_bf16 v[36:39], v[56:59], v[44:47], v[36:39]
 ds_read_b64_tr_b16 v[76:77], v5 offset:4032
 ds_read_b64_tr_b16 v[78:79], v5 offset:4064
 v_mfma_f32_16x16x32_bf16 v[40:43], v[60:63], v[44:47], v[40:43]
 ds_read_b128 v[64:67], v0 offset:3072
 ds_read_b128 v[68:71], v0 offset:7168
 v_mfma_f32_16x16x32_bf16 v[72:75], v[48:51], v[44:47], v[72:75]
 buffer_store_dwordx2 v[32:33], v15, s[8:11], s100 offen sc1
 s_waitcnt lgkmcnt(0)
 v_mfma_f32_16x16x32_bf16 v[72:75], v[76:79], v[52:55], v[72:75]
 v_xor_b32 v0, 0x2000, v0
 v_mfma_f32_16x16x32_bf16 v[36:39], v[64:67], v[52:55], v[36:39]
 v_mfma_f32_16x16x32_bf16 v[40:43], v[68:71], v[52:55], v[40:43]
 s_cmp_eq_u32 s72, 63
 s_cbranch_scc1 rec0s_last
 v_mov_b32 v44, 0x3f803f80
 v_mov_b32 v45, 0x3f803f80
 v_mov_b32 v46, 0x3f803f80
 v_mov_b32 v47, 0x3f803f80
 v_mov_b64 v[78:79], 0
 v_mov_b32_dpp v72, v74 quad_perm:[0,1,2,3] row_mask:0xf bank_mask:0xc
 v_mov_b32_dpp v73, v75 quad_perm:[0,1,2,3] row_mask:0xf bank_mask:0xc
 v_mov_b32_dpp v36, v40 quad_perm:[0,1,2,3] row_mask:0xf bank_mask:0xc
 v_mov_b32_dpp v37, v41 quad_perm:[0,1,2,3] row_mask:0xf bank_mask:0xc
 v_mov_b32_dpp v38, v42 quad_perm:[0,1,2,3] row_mask:0xf bank_mask:0xc
 v_mov_b32_dpp v39, v43 quad_perm:[0,1,2,3] row_mask:0xf bank_mask:0xc
 v_max3_f32 v76, v72, v73, v36
 v_max3_f32 v77, v37, v38, v39
 v_max_f32 v76, v76, v77
 v_mov_b64 v[74:75], 0
 s_nop 0
 v_max_f32_dpp v76, v76, v76 row_ror:8 row_mask:0xf bank_mask:0xf
 v_mov_b32 v77, v76
 s_nop 1
 v_permlane16_swap_b32 v76, v77
 v_max_f32 v76, v76, v77
 v_mov_b32 v77, v76
 s_nop 1
 v_permlane32_swap_b32 v76, v77
 v_max_f32 v76, v76, v77
 v_mul_f32 v76, 0xbe0293ee, v76
 v_pk_fma_f32 v[36:37], v[36:37], s[98:99], v[76:77] op_sel_hi:[1,0,0]
 v_pk_fma_f32 v[38:39], v[38:39], s[98:99], v[76:77] op_sel_hi:[1,0,0]
 v_pk_fma_f32 v[72:73], v[72:73], s[98:99], v[76:77] op_sel_hi:[1,0,0]
 v_exp_f32 v36, v36
 v_exp_f32 v37, v37
 v_exp_f32 v38, v38
 v_exp_f32 v39, v39
 v_exp_f32 v72, v72
 v_exp_f32 v73, v73
 v_cvt_pk_bf16_f32 v40, v36, v37
 v_cvt_pk_bf16_f32 v41, v38, v39
 v_cvt_pk_bf16_f32 v76, v72, v73
 v_mov_b32_dpp v42, v40 row_ror:8 row_mask:0xf bank_mask:0xf
 v_mov_b32_dpp v43, v41 row_ror:8 row_mask:0xf bank_mask:0xf
 v_mov_b32_dpp v74, v76 quad_perm:[0,1,2,3] row_mask:0x3 bank_mask:0xf
 v_mov_b32_dpp v75, v76 row_ror:8 row_mask:0x3 bank_mask:0xf
 v_mfma_f32_16x16x32_bf16 v[52:55], v[44:47], v[40:43], 0
 v_mov_b32_dpp v78, v76 quad_perm:[0,1,2,3] row_mask:0xc bank_mask:0xf
 v_mov_b32_dpp v79, v76 row_ror:8 row_mask:0xc bank_mask:0xf
 v_mfma_f32_16x16x32_bf16 v[48:51], v[16:19], v[40:43], 0
 v_mov_b64 v[36:37], 0
 v_mov_b64 v[38:39], 0
 v_mfma_f32_16x16x32_bf16 v[64:67], v[20:23], v[40:43], 0
 v_mfma_f32_16x16x16_bf16 v[52:55], v[44:45], v[74:75], v[52:55]
 v_mov_b64 v[40:41], 0
 v_mov_b64 v[42:43], 0
 v_mfma_f32_16x16x16_bf16 v[48:51], v[32:33], v[74:75], v[48:51]
 v_mfma_f32_16x16x16_bf16 v[64:67], v[32:33], v[78:79], v[64:67]
 v_mov_b64 v[32:33], 0
 v_mov_b64 v[34:35], 0
 v_rcp_f32 v76, v52
 s_nop 0
 v_pk_mul_f32 v[48:49], v[48:49], v[76:77] op_sel_hi:[1,0]
 v_pk_mul_f32 v[50:51], v[50:51], v[76:77] op_sel_hi:[1,0]
 s_nop 1
 v_pk_mul_f32 v[64:65], v[64:65], v[76:77] op_sel_hi:[1,0]
 v_pk_mul_f32 v[66:67], v[66:67], v[76:77] op_sel_hi:[1,0]
 v_cvt_pk_bf16_f32 v72, v48, v64
 v_cvt_pk_bf16_f32 v73, v49, v65
 v_cvt_pk_bf16_f32 v74, v50, v66
 v_cvt_pk_bf16_f32 v75, v51, v67
 ds_write_b128 v7, v[72:75]
 ds_read_b128 v[16:19], v3 offset:24576
 ds_read_b128 v[20:23], v3 offset:25600
 ds_read_b128 v[44:47], v3 offset:26624
 ds_read_b128 v[48:51], v3 offset:27648
 ds_read_b128 v[72:75], v3 offset:28672
 ds_read_b128 v[76:79], v3 offset:29696
 s_waitcnt lgkmcnt(6)
 s_barrier
 ds_read_b128 v[56:59], v2 offset:0
 ds_read_b128 v[60:63], v2 offset:512
 ds_read_b128 v[64:67], v2 offset:1024
 ds_read_b128 v[68:71], v2 offset:1536
 s_waitcnt lgkmcnt(3)
 v_smfmac_f32_16x16x64_bf16 v[32:35], v[56:59], v[16:23], v1
 s_waitcnt lgkmcnt(2)
 v_smfmac_f32_16x16x64_bf16 v[32:35], v[60:63], v[44:51], v1
 ds_read_b128 v[16:19], v3 offset:30720
 s_waitcnt lgkmcnt(2)
 v_smfmac_f32_16x16x64_bf16 v[32:35], v[64:67], v[72:79], v1
 ds_read_b128 v[20:23], v3 offset:31744
 s_waitcnt lgkmcnt(2)
 v_smfmac_f32_16x16x64_bf16 v[32:35], v[68:71], a[208:215], v1
 ds_read_b128 v[44:47], v3 offset:32768
 v_smfmac_f32_16x16x64_bf16 v[36:39], v[56:59], a[216:223], v1
 ds_read_b128 v[48:51], v3 offset:33792
 v_smfmac_f32_16x16x64_bf16 v[36:39], v[60:63], a[224:231], v1
 ds_read_b128 v[72:75], v3 offset:34816
 v_smfmac_f32_16x16x64_bf16 v[36:39], v[64:67], a[232:239], v1
 ds_read_b128 v[76:79], v3 offset:35840
 s_waitcnt lgkmcnt(4)
 v_smfmac_f32_16x16x64_bf16 v[36:39], v[68:71], v[16:23], v1
 s_waitcnt lgkmcnt(2)
 v_smfmac_f32_16x16x64_bf16 v[40:43], v[56:59], v[44:51], v1
 s_waitcnt lgkmcnt(0)
 v_smfmac_f32_16x16x64_bf16 v[40:43], v[60:63], v[72:79], v1
 v_smfmac_f32_16x16x64_bf16 v[40:43], v[64:67], a[240:247], v1
 v_smfmac_f32_16x16x64_bf16 v[40:43], v[68:71], a[248:255], v1
 v_cvt_pk_bf16_f32 v32, v32, v33
 v_cvt_pk_bf16_f32 v33, v34, v35
 buffer_store_dwordx2 v[32:33], v9, s[8:11], s82 offen sc1
 v_cvt_pk_bf16_f32 v36, v36, v37
 v_cvt_pk_bf16_f32 v37, v38, v39
 buffer_store_dwordx2 v[36:37], v9, s[8:11], s83 offen sc1
 s_nop 1
 v_cvt_pk_bf16_f32 v40, v40, v41
 v_cvt_pk_bf16_f32 v41, v42, v43
 buffer_store_dwordx2 v[40:41], v9, s[8:11], s84 offen sc1
 s_cmp_ge_u32 s86, 40
 s_cbranch_scc1 idle_126
 v_mov_b64 v[44:45], 0
 v_mov_b64 v[46:47], 0
 s_nop 0
 v_mov_b32_dpp v44, v8 quad_perm:[0,1,2,3] row_mask:0xf bank_mask:0x1
 v_mov_b32_dpp v45, v8 quad_perm:[0,1,2,3] row_mask:0xf bank_mask:0x2
 v_mov_b32_dpp v46, v8 quad_perm:[0,1,2,3] row_mask:0xf bank_mask:0x4
 v_mov_b32_dpp v47, v8 quad_perm:[0,1,2,3] row_mask:0xf bank_mask:0x8
 s_waitcnt vmcnt(0)
 buffer_load_dwordx4 v[56:59], v6, s[8:11], s85 offen offset:0 sc1
 buffer_load_dwordx4 v[60:63], v6, s[8:11], s85 offen offset:1024 sc1
 buffer_load_dwordx4 v[64:67], v6, s[8:11], s85 offen offset:2048 sc1
 buffer_load_dwordx4 v[68:71], v6, s[8:11], s85 offen offset:3072 sc1
 s_waitcnt vmcnt(3)
 v_mfma_f32_16x16x32_bf16 v[48:51], v[56:59], v[44:47], 0
 v_max3_u32 v52, v56, v57, v58
 v_max_u32 v52, v52, v59
 s_waitcnt vmcnt(2)
 v_mfma_f32_16x16x32_bf16 v[48:51], v[60:63], v[44:47], v[48:51]
 v_max3_u32 v52, v52, v60, v61
 v_max3_u32 v52, v52, v62, v63
 s_waitcnt vmcnt(1)
 v_mfma_f32_16x16x32_bf16 v[48:51], v[64:67], v[44:47], v[48:51]
 v_max3_u32 v52, v52, v64, v65
 v_max3_u32 v52, v52, v66, v67
 s_waitcnt vmcnt(0)
 v_mfma_f32_16x16x32_bf16 v[48:51], v[68:71], v[44:47], v[48:51]
 v_max3_u32 v52, v52, v68, v69
 v_max3_u32 v52, v52, v70, v71
 v_cmp_eq_u32 vcc, -1, v52
 s_cbranch_vccnz red_retry_128
red_127:
 s_nop 6
 v_permlane32_swap_b32 v48, v50
 v_permlane32_swap_b32 v49, v51
 v_pk_add_f32 v[48:49], v[48:49], v[50:51]
 v_cvt_pk_bf16_f32 v52, v48, v49
 s_mov_b64 exec, s[90:91]
 buffer_store_dword v52, v11, s[8:11], s78 offen sc1
 buffer_store_dword v52, v11, s[8:11], s77 offen sc1
 s_mov_b64 exec, -1
 s_branch rec0s_step
idle_126:
 s_waitcnt vmcnt(2)
 s_branch rec0s_step
rec0s_last:
 s_waitcnt vmcnt(0)
 s_barrier
 s_cmp_lg_u32 s66, 0
 s_cbranch_scc1 notw0_129
 v_mov_b32 v44, 64
 v_mov_b32 v45, 0
 s_mov_b64 exec, 1
 buffer_store_dword v44, v45, s[8:11], s5 offen sc1
 s_mov_b64 exec, -1
notw0_129:
 s_waitcnt vmcnt(0)
 s_branch rec_helper
 s_endpgm
red_retry_128:
 s_mov_b64 exec, vcc
 buffer_load_dwordx4 v[56:59], v6, s[8:11], s85 offen offset:0 sc1
 buffer_load_dwordx4 v[60:63], v6, s[8:11], s85 offen offset:1024 sc1
 buffer_load_dwordx4 v[64:67], v6, s[8:11], s85 offen offset:2048 sc1
 buffer_load_dwordx4 v[68:71], v6, s[8:11], s85 offen offset:3072 sc1
red_loop_130:
 s_mov_b64 exec, vcc
 buffer_load_dwordx4 v[56:59], v6, s[8:11], s85 offen offset:0 sc1
 buffer_load_dwordx4 v[60:63], v6, s[8:11], s85 offen offset:1024 sc1
 buffer_load_dwordx4 v[64:67], v6, s[8:11], s85 offen offset:2048 sc1
 buffer_load_dwordx4 v[68:71], v6, s[8:11], s85 offen offset:3072 sc1
 s_mov_b64 exec, -1
 s_waitcnt vmcnt(4)
 v_max3_u32 v52, v56, v57, v58
 v_max_u32 v52, v52, v59
 v_max3_u32 v52, v52, v60, v61
 v_max3_u32 v52, v52, v62, v63
 v_max3_u32 v52, v52, v64, v65
 v_max3_u32 v52, v52, v66, v67
 v_max3_u32 v52, v52, v68, v69
 v_max3_u32 v52, v52, v70, v71
 v_cmp_eq_u32 vcc, -1, v52
 s_cbranch_vccz red_done_131
 s_add_u32 s74, s74, 1
 s_cmp_lt_u32 s74, 0x40000
 s_cbranch_scc1 red_loop_130
 s_branch bail2
red_done_131:
 v_mfma_f32_16x16x32_bf16 v[48:51], v[56:59], v[44:47], 0
 v_mfma_f32_16x16x32_bf16 v[48:51], v[60:63], v[44:47], v[48:51]
 v_mfma_f32_16x16x32_bf16 v[48:51], v[64:67], v[44:47], v[48:51]
 v_mfma_f32_16x16x32_bf16 v[48:51], v[68:71], v[44:47], v[48:51]
 s_branch red_127
rec_load1:
 s_lshl_b32 s81, s66, 3
 v_lshrrev_b32 v77, 4, v0
 v_add_u32 v77, s81, v77
 v_and_b32 v78, 15, v0
 v_lshlrev_b32 v72, 13, v77
 v_lshl_add_u32 v72, v78, 4, v72
 v_lshrrev_b32 v77, 2, v0
 v_and_b32 v78, 3, v0
 v_mul_u32_u24 v73, 1280, v77
 v_lshl_add_u32 v73, v78, 4, v73
 s_lshl_b32 s81, s66, 11
 s_add_u32 s81, s81, 16384
 v_add_u32 v74, s81, v6
 v_and_b32 v77, 15, v0
 v_lshl_add_u32 v77, v77, 2, s81
 v_and_b32 v75, 15, v0
 s_lshl_b32 s81, s66, 6
 s_add_u32 s81, s81, 16384
 v_lshl_add_u32 v75, v75, 2, s81
 v_bfe_u32 v78, v0, 4, 1
 v_lshl_add_u32 v75, v78, 9, v75
 v_lshrrev_b32 v78, 5, v0
 v_lshl_add_u32 v75, v78, 8, v75
 v_lshrrev_b32 v78, 4, v0
 v_lshl_add_u32 v76, v78, 8, v77
 s_lshl_b32 s81, s68, 8
 s_mul_i32 s87, s67, 2621440
 s_sub_u32 s88, 2621440, s87
 s_add_u32 s87, s87, s81
 s_add_u32 s88, s88, s81
 s_lshl_b32 s82, s66, 1
 s_add_u32 s82, s82, 2
 s_mul_i32 s83, s68, 163840
 s_mul_i32 s81, s67, 640
 s_add_u32 s83, s83, s81
 s_lshl_b32 s81, s82, 6
 s_add_u32 s83, s83, s81
 v_add_u32 v77, 1024, v76
 s_add_u32 s81, s87, 0x0
 buffer_load_dwordx4 v[208:211], v72, s[20:23], s81 offen
 s_add_u32 s81, s87, 0x8000
 buffer_load_dwordx4 v[212:215], v72, s[20:23], s81 offen
 s_add_u32 s81, s87, 0x40000
 buffer_load_dwordx4 a[112:115], v72, s[20:23], s81 offen
 s_add_u32 s81, s87, 0x48000
 buffer_load_dwordx4 a[116:119], v72, s[20:23], s81 offen
 s_add_u32 s81, s87, 0x80000
 buffer_load_dwordx4 a[192:195], v72, s[20:23], s81 offen
 s_add_u32 s81, s87, 0x88000
 buffer_load_dwordx4 a[196:199], v72, s[20:23], s81 offen
 s_add_u32 s81, s87, 0xc0000
 buffer_load_dwordx4 v[216:219], v72, s[20:23], s81 offen
 s_add_u32 s81, s87, 0xc8000
 buffer_load_dwordx4 v[220:223], v72, s[20:23], s81 offen
 s_add_u32 s81, s87, 0x100000
 buffer_load_dwordx4 a[120:123], v72, s[20:23], s81 offen
 s_add_u32 s81, s87, 0x108000
 buffer_load_dwordx4 a[124:127], v72, s[20:23], s81 offen
 s_add_u32 s81, s87, 0x140000
 buffer_load_dwordx4 a[200:203], v72, s[20:23], s81 offen
 s_add_u32 s81, s87, 0x148000
 buffer_load_dwordx4 a[204:207], v72, s[20:23], s81 offen
 s_add_u32 s81, s87, 0x180000
 buffer_load_dwordx4 v[224:227], v72, s[20:23], s81 offen
 s_add_u32 s81, s87, 0x188000
 buffer_load_dwordx4 v[228:231], v72, s[20:23], s81 offen
 s_add_u32 s81, s87, 0x1c0000
 buffer_load_dwordx4 a[128:131], v72, s[20:23], s81 offen
 s_add_u32 s81, s87, 0x1c8000
 buffer_load_dwordx4 a[132:135], v72, s[20:23], s81 offen
 s_add_u32 s81, s87, 0x200000
 buffer_load_dwordx4 a[208:211], v72, s[20:23], s81 offen
 s_add_u32 s81, s87, 0x208000
 buffer_load_dwordx4 a[212:215], v72, s[20:23], s81 offen
 s_add_u32 s81, s87, 0x240000
 buffer_load_dwordx4 v[232:235], v72, s[20:23], s81 offen
 s_add_u32 s81, s87, 0x248000
 buffer_load_dwordx4 v[236:239], v72, s[20:23], s81 offen
 s_add_u32 s81, s87, 0xc0000
 buffer_load_dwordx4 a[8:11], v72, s[16:19], s81 offen
 s_add_u32 s81, s87, 0xc8000
 buffer_load_dwordx4 a[12:15], v72, s[16:19], s81 offen
 s_add_u32 s81, s87, 0x1c0000
 buffer_load_dwordx4 a[40:43], v72, s[16:19], s81 offen
 s_add_u32 s81, s87, 0x1c8000
 buffer_load_dwordx4 a[44:47], v72, s[16:19], s81 offen
 s_add_u32 s81, s87, 0x0
 buffer_load_dwordx4 v[80:83], v72, s[12:15], s81 offen
 s_add_u32 s81, s87, 0x8000
 buffer_load_dwordx4 v[84:87], v72, s[12:15], s81 offen
 s_add_u32 s81, s87, 0x0
 buffer_load_dwordx4 v[240:243], v72, s[16:19], s81 offen
 s_add_u32 s81, s87, 0x8000
 buffer_load_dwordx4 v[244:247], v72, s[16:19], s81 offen
 s_add_u32 s81, s87, 0x40000
 buffer_load_dwordx4 v[88:91], v72, s[12:15], s81 offen
 s_add_u32 s81, s87, 0x48000
 buffer_load_dwordx4 v[92:95], v72, s[12:15], s81 offen
 s_add_u32 s81, s87, 0x40000
 buffer_load_dwordx4 v[248:251], v72, s[16:19], s81 offen
 s_add_u32 s81, s87, 0x48000
 buffer_load_dwordx4 v[252:255], v72, s[16:19], s81 offen
 s_add_u32 s81, s87, 0x80000
 buffer_load_dwordx4 v[96:99], v72, s[12:15], s81 offen
 s_add_u32 s81, s87, 0x88000
 buffer_load_dwordx4 v[100:103], v72, s[12:15], s81 offen
 s_add_u32 s81, s87, 0x80000
 buffer_load_dwordx4 a[0:3], v72, s[16:19], s81 offen
 s_add_u32 s81, s87, 0x88000
 buffer_load_dwordx4 a[4:7], v72, s[16:19], s81 offen
 s_add_u32 s81, s87, 0xc0000
 buffer_load_dwordx4 v[104:107], v72, s[12:15], s81 offen
 s_add_u32 s81, s87, 0xc8000
 buffer_load_dwordx4 v[108:111], v72, s[12:15], s81 offen
 s_add_u32 s81, s87, 0x100000
 buffer_load_dwordx4 v[112:115], v72, s[12:15], s81 offen
 s_add_u32 s81, s87, 0x108000
 buffer_load_dwordx4 v[116:119], v72, s[12:15], s81 offen
 s_add_u32 s81, s87, 0x100000
 buffer_load_dwordx4 a[16:19], v72, s[16:19], s81 offen
 s_add_u32 s81, s87, 0x108000
 buffer_load_dwordx4 a[20:23], v72, s[16:19], s81 offen
 s_add_u32 s81, s87, 0x140000
 buffer_load_dwordx4 v[120:123], v72, s[12:15], s81 offen
 s_add_u32 s81, s87, 0x148000
 buffer_load_dwordx4 v[124:127], v72, s[12:15], s81 offen
 s_add_u32 s81, s87, 0x140000
 buffer_load_dwordx4 a[24:27], v72, s[16:19], s81 offen
 s_add_u32 s81, s87, 0x148000
 buffer_load_dwordx4 a[28:31], v72, s[16:19], s81 offen
 s_add_u32 s81, s87, 0x180000
 buffer_load_dwordx4 v[128:131], v72, s[12:15], s81 offen
 s_add_u32 s81, s87, 0x188000
 buffer_load_dwordx4 v[132:135], v72, s[12:15], s81 offen
 s_add_u32 s81, s87, 0x180000
 buffer_load_dwordx4 a[32:35], v72, s[16:19], s81 offen
 s_add_u32 s81, s87, 0x188000
 buffer_load_dwordx4 a[36:39], v72, s[16:19], s81 offen
 s_add_u32 s81, s87, 0x1c0000
 buffer_load_dwordx4 v[136:139], v72, s[12:15], s81 offen
 s_add_u32 s81, s87, 0x1c8000
 buffer_load_dwordx4 v[140:143], v72, s[12:15], s81 offen
 s_add_u32 s81, s87, 0x200000
 buffer_load_dwordx4 v[144:147], v72, s[12:15], s81 offen
 s_add_u32 s81, s87, 0x208000
 buffer_load_dwordx4 v[148:151], v72, s[12:15], s81 offen
 s_add_u32 s81, s87, 0x200000
 buffer_load_dwordx4 a[48:51], v72, s[16:19], s81 offen
 s_add_u32 s81, s87, 0x208000
 buffer_load_dwordx4 a[52:55], v72, s[16:19], s81 offen
 s_waitcnt vmcnt(54)
 ds_write_b128 v74, v[208:211] offset:0
 ds_write_b128 v74, v[212:215] offset:1024
 s_waitcnt lgkmcnt(0)
 s_barrier
 ds_read2st64_b32 v[208:209], v75 offset0:0 offset1:4
 ds_read2st64_b32 v[210:211], v75 offset0:8 offset1:12
 ds_read2st64_b32 v[212:213], v75 offset0:16 offset1:20
 ds_read2st64_b32 v[214:215], v75 offset0:24 offset1:28
 s_waitcnt lgkmcnt(0)
 ds_write_b128 v3, v[208:211] offset:0
 ds_write_b128 v3, v[212:215] offset:1024
 s_add_u32 s81, s87, 0x240000
 buffer_load_dwordx4 v[152:155], v72, s[12:15], s81 offen
 s_add_u32 s81, s87, 0x248000
 buffer_load_dwordx4 v[156:159], v72, s[12:15], s81 offen
 s_waitcnt vmcnt(54)
 ds_write_b128 v74, a[112:115] offset:8192
 ds_write_b128 v74, a[116:119] offset:9216
 s_waitcnt lgkmcnt(0)
 s_barrier
 ds_read2st64_b32 a[112:113], v75 offset0:32 offset1:36
 ds_read2st64_b32 a[114:115], v75 offset0:40 offset1:44
 ds_read2st64_b32 a[116:117], v75 offset0:48 offset1:52
 ds_read2st64_b32 a[118:119], v75 offset0:56 offset1:60
 s_waitcnt lgkmcnt(0)
 ds_write_b128 v3, a[112:115] offset:2048
 ds_write_b128 v3, a[116:119] offset:3072
 s_add_u32 s81, s87, 0x240000
 buffer_load_dwordx4 a[56:59], v72, s[16:19], s81 offen
 s_add_u32 s81, s87, 0x248000
 buffer_load_dwordx4 a[60:63], v72, s[16:19], s81 offen
 s_waitcnt vmcnt(54)
 ds_write_b128 v74, a[192:195] offset:0
 ds_write_b128 v74, a[196:199] offset:1024
 s_waitcnt lgkmcnt(0)
 s_barrier
 ds_read2st64_b32 a[192:193], v75 offset0:0 offset1:4
 ds_read2st64_b32 a[194:195], v75 offset0:8 offset1:12
 ds_read2st64_b32 a[196:197], v75 offset0:16 offset1:20
 ds_read2st64_b32 a[198:199], v75 offset0:24 offset1:28
 s_waitcnt lgkmcnt(0)
 ds_write_b128 v3, a[192:195] offset:4096
 ds_write_b128 v3, a[196:199] offset:5120
 s_add_u32 s81, s88, 0x0
 buffer_load_dwordx4 v[160:163], v72, s[12:15], s81 offen
 s_add_u32 s81, s88, 0x8000
 buffer_load_dwordx4 v[164:167], v72, s[12:15], s81 offen
 s_waitcnt vmcnt(54)
 ds_write_b128 v74, v[216:219] offset:8192
 ds_write_b128 v74, v[220:223] offset:9216
 s_waitcnt lgkmcnt(0)
 s_barrier
 ds_read2st64_b32 v[216:217], v75 offset0:32 offset1:36
 ds_read2st64_b32 v[218:219], v75 offset0:40 offset1:44
 ds_read2st64_b32 v[220:221], v75 offset0:48 offset1:52
 ds_read2st64_b32 v[222:223], v75 offset0:56 offset1:60
 s_waitcnt lgkmcnt(0)
 ds_write_b128 v3, v[216:219] offset:6144
 ds_write_b128 v3, v[220:223] offset:7168
 s_add_u32 s81, s88, 0x0
 buffer_load_dwordx4 a[64:67], v72, s[16:19], s81 offen
 s_add_u32 s81, s88, 0x8000
 buffer_load_dwordx4 a[68:71], v72, s[16:19], s81 offen
 s_waitcnt vmcnt(54)
 ds_write_b128 v74, a[120:123] offset:0
 ds_write_b128 v74, a[124:127] offset:1024
 s_waitcnt lgkmcnt(0)
 s_barrier
 ds_read2st64_b32 a[120:121], v75 offset0:0 offset1:4
 ds_read2st64_b32 a[122:123], v75 offset0:8 offset1:12
 ds_read2st64_b32 a[124:125], v75 offset0:16 offset1:20
 ds_read2st64_b32 a[126:127], v75 offset0:24 offset1:28
 s_waitcnt lgkmcnt(0)
 ds_write_b128 v3, a[120:123] offset:8192
 ds_write_b128 v3, a[124:127] offset:9216
 s_add_u32 s81, s88, 0x0
 buffer_load_dwordx4 a[144:147], v72, s[20:23], s81 offen
 s_add_u32 s81, s88, 0x8000
 buffer_load_dwordx4 a[148:151], v72, s[20:23], s81 offen
 s_waitcnt vmcnt(54)
 ds_write_b128 v74, a[200:203] offset:8192
 ds_write_b128 v74, a[204:207] offset:9216
 s_waitcnt lgkmcnt(0)
 s_barrier
 ds_read2st64_b32 a[200:201], v75 offset0:32 offset1:36
 ds_read2st64_b32 a[202:203], v75 offset0:40 offset1:44
 ds_read2st64_b32 a[204:205], v75 offset0:48 offset1:52
 ds_read2st64_b32 a[206:207], v75 offset0:56 offset1:60
 s_waitcnt lgkmcnt(0)
 ds_write_b128 v3, a[200:203] offset:10240
 ds_write_b128 v3, a[204:207] offset:11264
 s_add_u32 s81, s88, 0x40000
 buffer_load_dwordx4 v[168:171], v72, s[12:15], s81 offen
 s_add_u32 s81, s88, 0x48000
 buffer_load_dwordx4 v[172:175], v72, s[12:15], s81 offen
 s_waitcnt vmcnt(54)
 ds_write_b128 v74, v[224:227] offset:0
 ds_write_b128 v74, v[228:231] offset:1024
 s_waitcnt lgkmcnt(0)
 s_barrier
 ds_read2st64_b32 v[224:225], v75 offset0:0 offset1:4
 ds_read2st64_b32 v[226:227], v75 offset0:8 offset1:12
 ds_read2st64_b32 v[228:229], v75 offset0:16 offset1:20
 ds_read2st64_b32 v[230:231], v75 offset0:24 offset1:28
 s_waitcnt lgkmcnt(0)
 ds_write_b128 v3, v[224:227] offset:12288
 ds_write_b128 v3, v[228:231] offset:13312
 s_add_u32 s81, s88, 0x40000
 buffer_load_dwordx4 a[72:75], v72, s[16:19], s81 offen
 s_add_u32 s81, s88, 0x48000
 buffer_load_dwordx4 a[76:79], v72, s[16:19], s81 offen
 s_waitcnt vmcnt(54)
 ds_write_b128 v74, a[128:131] offset:8192
 ds_write_b128 v74, a[132:135] offset:9216
 s_waitcnt lgkmcnt(0)
 s_barrier
 ds_read2st64_b32 a[128:129], v75 offset0:32 offset1:36
 ds_read2st64_b32 a[130:131], v75 offset0:40 offset1:44
 ds_read2st64_b32 a[132:133], v75 offset0:48 offset1:52
 ds_read2st64_b32 a[134:135], v75 offset0:56 offset1:60
 s_waitcnt lgkmcnt(0)
 ds_write_b128 v3, a[128:131] offset:14336
 ds_write_b128 v3, a[132:135] offset:15360
 s_add_u32 s81, s88, 0x40000
 buffer_load_dwordx4 a[152:155], v72, s[20:23], s81 offen
 s_add_u32 s81, s88, 0x48000
 buffer_load_dwordx4 a[156:159], v72, s[20:23], s81 offen
 s_waitcnt vmcnt(54)
 ds_write_b128 v74, a[208:211] offset:0
 ds_write_b128 v74, a[212:215] offset:1024
 s_waitcnt lgkmcnt(0)
 s_barrier
 ds_read2st64_b32 a[208:209], v75 offset0:0 offset1:4
 ds_read2st64_b32 a[210:211], v75 offset0:8 offset1:12
 ds_read2st64_b32 a[212:213], v75 offset0:16 offset1:20
 ds_read2st64_b32 a[214:215], v75 offset0:24 offset1:28
 s_waitcnt lgkmcnt(0)
 ds_write_b128 v3, a[208:211] offset:16384
 ds_write_b128 v3, a[212:215] offset:17408
 s_add_u32 s81, s88, 0x80000
 buffer_load_dwordx4 v[176:179], v72, s[12:15], s81 offen
 s_add_u32 s81, s88, 0x88000
 buffer_load_dwordx4 v[180:183], v72, s[12:15], s81 offen
 s_waitcnt vmcnt(54)
 ds_write_b128 v74, v[232:235] offset:8192
 ds_write_b128 v74, v[236:239] offset:9216
 s_waitcnt lgkmcnt(0)
 s_barrier
 ds_read2st64_b32 v[232:233], v75 offset0:32 offset1:36
 ds_read2st64_b32 v[234:235], v75 offset0:40 offset1:44
 ds_read2st64_b32 v[236:237], v75 offset0:48 offset1:52
 ds_read2st64_b32 v[238:239], v75 offset0:56 offset1:60
 s_waitcnt lgkmcnt(0)
 ds_write_b128 v3, v[232:235] offset:18432
 ds_write_b128 v3, v[236:239] offset:19456
 s_add_u32 s81, s88, 0x80000
 buffer_load_dwordx4 a[80:83], v72, s[16:19], s81 offen
 s_add_u32 s81, s88, 0x88000
 buffer_load_dwordx4 a[84:87], v72, s[16:19], s81 offen
 s_waitcnt vmcnt(54)
 ds_write_b128 v74, a[8:11] offset:0
 ds_write_b128 v74, a[12:15] offset:1024
 s_waitcnt lgkmcnt(0)
 s_barrier
 ds_read2st64_b32 a[8:9], v75 offset0:0 offset1:4
 ds_read2st64_b32 a[10:11], v75 offset0:8 offset1:12
 ds_read2st64_b32 a[12:13], v75 offset0:16 offset1:20
 ds_read2st64_b32 a[14:15], v75 offset0:24 offset1:28
 s_add_u32 s81, s88, 0x80000
 buffer_load_dwordx4 a[160:163], v72, s[20:23], s81 offen
 s_add_u32 s81, s88, 0x88000
 buffer_load_dwordx4 a[164:167], v72, s[20:23], s81 offen
 s_waitcnt vmcnt(54)
 ds_write_b128 v74, a[40:43] offset:8192
 ds_write_b128 v74, a[44:47] offset:9216
 s_waitcnt lgkmcnt(0)
 s_barrier
 ds_read2st64_b32 a[40:41], v75 offset0:32 offset1:36
 ds_read2st64_b32 a[42:43], v75 offset0:40 offset1:44
 ds_read2st64_b32 a[44:45], v75 offset0:48 offset1:52
 ds_read2st64_b32 a[46:47], v75 offset0:56 offset1:60
 s_add_u32 s81, s88, 0xc0000
 buffer_load_dwordx4 v[184:187], v72, s[12:15], s81 offen
 s_add_u32 s81, s88, 0xc8000
 buffer_load_dwordx4 v[188:191], v72, s[12:15], s81 offen
 s_waitcnt vmcnt(54)
 ds_write_b128 v74, v[80:83] offset:0
 ds_write_b128 v74, v[84:87] offset:1024
 s_waitcnt lgkmcnt(0)
 s_barrier
 ds_read2st64_b32 v[80:81], v75 offset0:0 offset1:4
 ds_read2st64_b32 v[82:83], v75 offset0:8 offset1:12
 ds_read2st64_b32 v[84:85], v75 offset0:16 offset1:20
 ds_read2st64_b32 v[86:87], v75 offset0:24 offset1:28
 s_add_u32 s81, s88, 0xc0000
 buffer_load_dwordx4 a[88:91], v72, s[16:19], s81 offen
 s_add_u32 s81, s88, 0xc8000
 buffer_load_dwordx4 a[92:95], v72, s[16:19], s81 offen
 s_waitcnt vmcnt(54)
 ds_write_b128 v74, v[240:243] offset:8192
 ds_write_b128 v74, v[244:247] offset:9216
 s_waitcnt lgkmcnt(0)
 s_barrier
 ds_read2st64_b32 v[240:241], v75 offset0:32 offset1:36
 ds_read2st64_b32 v[242:243], v75 offset0:40 offset1:44
 ds_read2st64_b32 v[244:245], v75 offset0:48 offset1:52
 ds_read2st64_b32 v[246:247], v75 offset0:56 offset1:60
 s_add_u32 s81, s88, 0xc0000
 buffer_load_dwordx4 a[168:171], v72, s[20:23], s81 offen
 s_add_u32 s81, s88, 0xc8000
 buffer_load_dwordx4 a[172:175], v72, s[20:23], s81 offen
 s_waitcnt vmcnt(54)
 ds_write_b128 v74, v[88:91] offset:0
 ds_write_b128 v74, v[92:95] offset:1024
 s_waitcnt lgkmcnt(0)
 s_barrier
 ds_read2st64_b32 v[88:89], v75 offset0:0 offset1:4
 ds_read2st64_b32 v[90:91], v75 offset0:8 offset1:12
 ds_read2st64_b32 v[92:93], v75 offset0:16 offset1:20
 ds_read2st64_b32 v[94:95], v75 offset0:24 offset1:28
 s_add_u32 s81, s88, 0x100000
 buffer_load_dwordx4 v[192:195], v72, s[12:15], s81 offen
 s_add_u32 s81, s88, 0x108000
 buffer_load_dwordx4 v[196:199], v72, s[12:15], s81 offen
 s_waitcnt vmcnt(54)
 ds_write_b128 v74, v[248:251] offset:8192
 ds_write_b128 v74, v[252:255] offset:9216
 s_waitcnt lgkmcnt(0)
 s_barrier
 ds_read2st64_b32 v[248:249], v75 offset0:32 offset1:36
 ds_read2st64_b32 v[250:251], v75 offset0:40 offset1:44
 ds_read2st64_b32 v[252:253], v75 offset0:48 offset1:52
 ds_read2st64_b32 v[254:255], v75 offset0:56 offset1:60
 s_add_u32 s81, s88, 0x100000
 buffer_load_dwordx4 a[96:99], v72, s[16:19], s81 offen
 s_add_u32 s81, s88, 0x108000
 buffer_load_dwordx4 a[100:103], v72, s[16:19], s81 offen
 s_waitcnt vmcnt(54)
 ds_write_b128 v74, v[96:99] offset:0
 ds_write_b128 v74, v[100:103] offset:1024
 s_waitcnt lgkmcnt(0)
 s_barrier
 ds_read2st64_b32 v[96:97], v75 offset0:0 offset1:4
 ds_read2st64_b32 v[98:99], v75 offset0:8 offset1:12
 ds_read2st64_b32 v[100:101], v75 offset0:16 offset1:20
 ds_read2st64_b32 v[102:103], v75 offset0:24 offset1:28
 s_add_u32 s81, s88, 0x100000
 buffer_load_dwordx4 a[176:179], v72, s[20:23], s81 offen
 s_add_u32 s81, s88, 0x108000
 buffer_load_dwordx4 a[180:183], v72, s[20:23], s81 offen
 s_waitcnt vmcnt(54)
 ds_write_b128 v74, a[0:3] offset:8192
 ds_write_b128 v74, a[4:7] offset:9216
 s_waitcnt lgkmcnt(0)
 s_barrier
 ds_read2st64_b32 a[0:1], v75 offset0:32 offset1:36
 ds_read2st64_b32 a[2:3], v75 offset0:40 offset1:44
 ds_read2st64_b32 a[4:5], v75 offset0:48 offset1:52
 ds_read2st64_b32 a[6:7], v75 offset0:56 offset1:60
 s_add_u32 s81, s88, 0x140000
 buffer_load_dwordx4 v[200:203], v72, s[12:15], s81 offen
 s_add_u32 s81, s88, 0x148000
 buffer_load_dwordx4 v[204:207], v72, s[12:15], s81 offen
 s_waitcnt vmcnt(54)
 ds_write_b128 v74, v[104:107] offset:0
 ds_write_b128 v74, v[108:111] offset:1024
 s_waitcnt lgkmcnt(0)
 s_barrier
 ds_read2st64_b32 v[104:105], v75 offset0:0 offset1:4
 ds_read2st64_b32 v[106:107], v75 offset0:8 offset1:12
 ds_read2st64_b32 v[108:109], v75 offset0:16 offset1:20
 ds_read2st64_b32 v[110:111], v75 offset0:24 offset1:28
 s_add_u32 s81, s88, 0x140000
 buffer_load_dwordx4 a[104:107], v72, s[16:19], s81 offen
 s_add_u32 s81, s88, 0x148000
 buffer_load_dwordx4 a[108:111], v72, s[16:19], s81 offen
 s_waitcnt vmcnt(54)
 ds_write_b128 v74, v[112:115] offset:8192
 ds_write_b128 v74, v[116:119] offset:9216
 s_waitcnt lgkmcnt(0)
 s_barrier
 ds_read2st64_b32 v[112:113], v75 offset0:32 offset1:36
 ds_read2st64_b32 v[114:115], v75 offset0:40 offset1:44
 ds_read2st64_b32 v[116:117], v75 offset0:48 offset1:52
 ds_read2st64_b32 v[118:119], v75 offset0:56 offset1:60
 s_add_u32 s81, s88, 0x140000
 buffer_load_dwordx4 a[184:187], v72, s[20:23], s81 offen
 s_add_u32 s81, s88, 0x148000
 buffer_load_dwordx4 a[188:191], v72, s[20:23], s81 offen
 s_waitcnt vmcnt(54)
 ds_write_b128 v74, a[16:19] offset:0
 ds_write_b128 v74, a[20:23] offset:1024
 s_waitcnt lgkmcnt(0)
 s_barrier
 ds_read2st64_b32 a[16:17], v75 offset0:0 offset1:4
 ds_read2st64_b32 a[18:19], v75 offset0:8 offset1:12
 ds_read2st64_b32 a[20:21], v75 offset0:16 offset1:20
 ds_read2st64_b32 a[22:23], v75 offset0:24 offset1:28
 s_add_u32 s81, s88, 0x180000
 buffer_load_dwordx4 v[208:211], v72, s[12:15], s81 offen
 s_add_u32 s81, s88, 0x188000
 buffer_load_dwordx4 v[212:215], v72, s[12:15], s81 offen
 s_waitcnt vmcnt(54)
 ds_write_b128 v74, v[120:123] offset:8192
 ds_write_b128 v74, v[124:127] offset:9216
 s_waitcnt lgkmcnt(0)
 s_barrier
 ds_read2st64_b32 v[120:121], v75 offset0:32 offset1:36
 ds_read2st64_b32 v[122:123], v75 offset0:40 offset1:44
 ds_read2st64_b32 v[124:125], v75 offset0:48 offset1:52
 ds_read2st64_b32 v[126:127], v75 offset0:56 offset1:60
 s_add_u32 s81, s88, 0x180000
 buffer_load_dwordx4 a[112:115], v72, s[16:19], s81 offen
 s_add_u32 s81, s88, 0x188000
 buffer_load_dwordx4 a[116:119], v72, s[16:19], s81 offen
 s_waitcnt vmcnt(54)
 ds_write_b128 v74, a[24:27] offset:0
 ds_write_b128 v74, a[28:31] offset:1024
 s_waitcnt lgkmcnt(0)
 s_barrier
 ds_read2st64_b32 a[24:25], v75 offset0:0 offset1:4
 ds_read2st64_b32 a[26:27], v75 offset0:8 offset1:12
 ds_read2st64_b32 a[28:29], v75 offset0:16 offset1:20
 ds_read2st64_b32 a[30:31], v75 offset0:24 offset1:28
 s_add_u32 s81, s88, 0x180000
 buffer_load_dwordx4 a[192:195], v72, s[20:23], s81 offen
 s_add_u32 s81, s88, 0x188000
 buffer_load_dwordx4 a[196:199], v72, s[20:23], s81 offen
 s_waitcnt vmcnt(54)
 ds_write_b128 v74, v[128:131] offset:8192
 ds_write_b128 v74, v[132:135] offset:9216
 s_waitcnt lgkmcnt(0)
 s_barrier
 ds_read2st64_b32 v[128:129], v75 offset0:32 offset1:36
 ds_read2st64_b32 v[130:131], v75 offset0:40 offset1:44
 ds_read2st64_b32 v[132:133], v75 offset0:48 offset1:52
 ds_read2st64_b32 v[134:135], v75 offset0:56 offset1:60
 s_add_u32 s81, s88, 0x1c0000
 buffer_load_dwordx4 v[216:219], v72, s[12:15], s81 offen
 s_add_u32 s81, s88, 0x1c8000
 buffer_load_dwordx4 v[220:223], v72, s[12:15], s81 offen
 s_waitcnt vmcnt(54)
 ds_write_b128 v74, a[32:35] offset:0
 ds_write_b128 v74, a[36:39] offset:1024
 s_waitcnt lgkmcnt(0)
 s_barrier
 ds_read2st64_b32 a[32:33], v75 offset0:0 offset1:4
 ds_read2st64_b32 a[34:35], v75 offset0:8 offset1:12
 ds_read2st64_b32 a[36:37], v75 offset0:16 offset1:20
 ds_read2st64_b32 a[38:39], v75 offset0:24 offset1:28
 s_add_u32 s81, s88, 0x1c0000
 buffer_load_dwordx4 a[120:123], v72, s[16:19], s81 offen
 s_add_u32 s81, s88, 0x1c8000
 buffer_load_dwordx4 a[124:127], v72, s[16:19], s81 offen
 s_waitcnt vmcnt(54)
 ds_write_b128 v74, v[136:139] offset:8192
 ds_write_b128 v74, v[140:143] offset:9216
 s_waitcnt lgkmcnt(0)
 s_barrier
 ds_read2st64_b32 v[136:137], v75 offset0:32 offset1:36
 ds_read2st64_b32 v[138:139], v75 offset0:40 offset1:44
 ds_read2st64_b32 v[140:141], v75 offset0:48 offset1:52
 ds_read2st64_b32 v[142:143], v75 offset0:56 offset1:60
 s_add_u32 s81, s88, 0x1c0000
 buffer_load_dwordx4 a[200:203], v72, s[20:23], s81 offen
 s_add_u32 s81, s88, 0x1c8000
 buffer_load_dwordx4 a[204:207], v72, s[20:23], s81 offen
 s_waitcnt vmcnt(54)
 ds_write_b128 v74, v[144:147] offset:0
 ds_write_b128 v74, v[148:151] offset:1024
 s_waitcnt lgkmcnt(0)
 s_barrier
 ds_read2st64_b32 v[144:145], v75 offset0:0 offset1:4
 ds_read2st64_b32 v[146:147], v75 offset0:8 offset1:12
 ds_read2st64_b32 v[148:149], v75 offset0:16 offset1:20
 ds_read2st64_b32 v[150:151], v75 offset0:24 offset1:28
 s_add_u32 s81, s88, 0x200000
 buffer_load_dwordx4 v[224:227], v72, s[12:15], s81 offen
 s_add_u32 s81, s88, 0x208000
 buffer_load_dwordx4 v[228:231], v72, s[12:15], s81 offen
 s_waitcnt vmcnt(54)
 ds_write_b128 v74, a[48:51] offset:8192
 ds_write_b128 v74, a[52:55] offset:9216
 s_waitcnt lgkmcnt(0)
 s_barrier
 ds_read2st64_b32 a[48:49], v75 offset0:32 offset1:36
 ds_read2st64_b32 a[50:51], v75 offset0:40 offset1:44
 ds_read2st64_b32 a[52:53], v75 offset0:48 offset1:52
 ds_read2st64_b32 a[54:55], v75 offset0:56 offset1:60
 s_add_u32 s81, s88, 0x200000
 buffer_load_dwordx4 a[128:131], v72, s[16:19], s81 offen
 s_add_u32 s81, s88, 0x208000
 buffer_load_dwordx4 a[132:135], v72, s[16:19], s81 offen
 s_waitcnt vmcnt(54)
 ds_write_b128 v74, v[152:155] offset:0
 ds_write_b128 v74, v[156:159] offset:1024
 s_waitcnt lgkmcnt(0)
 s_barrier
 ds_read2st64_b32 v[152:153], v75 offset0:0 offset1:4
 ds_read2st64_b32 v[154:155], v75 offset0:8 offset1:12
 ds_read2st64_b32 v[156:157], v75 offset0:16 offset1:20
 ds_read2st64_b32 v[158:159], v75 offset0:24 offset1:28
 s_add_u32 s81, s88, 0x200000
 buffer_load_dwordx4 a[208:211], v72, s[20:23], s81 offen
 s_add_u32 s81, s88, 0x208000
 buffer_load_dwordx4 a[212:215], v72, s[20:23], s81 offen
 s_waitcnt vmcnt(54)
 ds_write_b128 v74, a[56:59] offset:8192
 ds_write_b128 v74, a[60:63] offset:9216
 s_waitcnt lgkmcnt(0)
 s_barrier
 ds_read2st64_b32 a[56:57], v75 offset0:32 offset1:36
 ds_read2st64_b32 a[58:59], v75 offset0:40 offset1:44
 ds_read2st64_b32 a[60:61], v75 offset0:48 offset1:52
 ds_read2st64_b32 a[62:63], v75 offset0:56 offset1:60
 s_add_u32 s81, s88, 0x240000
 buffer_load_dwordx4 v[232:235], v72, s[12:15], s81 offen
 s_add_u32 s81, s88, 0x248000
 buffer_load_dwordx4 v[236:239], v72, s[12:15], s81 offen
 s_waitcnt vmcnt(54)
 ds_write_b128 v74, v[160:163] offset:0
 ds_write_b128 v74, v[164:167] offset:1024
 s_waitcnt lgkmcnt(0)
 s_barrier
 ds_read2st64_b32 v[160:161], v75 offset0:0 offset1:4
 ds_read2st64_b32 v[162:163], v75 offset0:8 offset1:12
 ds_read2st64_b32 v[164:165], v75 offset0:16 offset1:20
 ds_read2st64_b32 v[166:167], v75 offset0:24 offset1:28
 s_add_u32 s81, s88, 0x240000
 buffer_load_dwordx4 a[136:139], v72, s[16:19], s81 offen
 s_add_u32 s81, s88, 0x248000
 buffer_load_dwordx4 a[140:143], v72, s[16:19], s81 offen
 s_waitcnt vmcnt(54)
 ds_write_b128 v74, a[64:67] offset:8192
 ds_write_b128 v74, a[68:71] offset:9216
 s_waitcnt lgkmcnt(0)
 s_barrier
 ds_read2st64_b32 a[64:65], v75 offset0:32 offset1:36
 ds_read2st64_b32 a[66:67], v75 offset0:40 offset1:44
 ds_read2st64_b32 a[68:69], v75 offset0:48 offset1:52
 ds_read2st64_b32 a[70:71], v75 offset0:56 offset1:60
 s_add_u32 s81, s88, 0x240000
 buffer_load_dwordx4 a[216:219], v72, s[20:23], s81 offen
 s_add_u32 s81, s88, 0x248000
 buffer_load_dwordx4 a[220:223], v72, s[20:23], s81 offen
 s_waitcnt vmcnt(54)
 ds_write_b128 v74, a[144:147] offset:0
 ds_write_b128 v74, a[148:151] offset:1024
 s_waitcnt lgkmcnt(0)
 s_barrier
 ds_read2st64_b32 a[144:145], v75 offset0:0 offset1:4
 ds_read2st64_b32 a[146:147], v75 offset0:8 offset1:12
 ds_read2st64_b32 a[148:149], v75 offset0:16 offset1:20
 ds_read2st64_b32 a[150:151], v75 offset0:24 offset1:28
 s_add_u32 s81, s83, 0
 buffer_load_dwordx4 v[16:19], v73, s[24:27], s81 offen
 s_add_u32 s81, s83, 20480
 buffer_load_dwordx4 v[20:23], v73, s[24:27], s81 offen
 s_waitcnt vmcnt(54)
 ds_write_b128 v74, v[168:171] offset:8192
 ds_write_b128 v74, v[172:175] offset:9216
 s_waitcnt lgkmcnt(0)
 s_barrier
 ds_read2st64_b32 v[168:169], v75 offset0:32 offset1:36
 ds_read2st64_b32 v[170:171], v75 offset0:40 offset1:44
 ds_read2st64_b32 v[172:173], v75 offset0:48 offset1:52
 ds_read2st64_b32 v[174:175], v75 offset0:56 offset1:60
 s_add_u32 s81, s83, 40960
 buffer_load_dwordx4 v[24:27], v73, s[24:27], s81 offen
 s_add_u32 s81, s83, 61440
 buffer_load_dwordx4 v[28:31], v73, s[24:27], s81 offen
 s_waitcnt vmcnt(54)
 ds_write_b128 v74, a[72:75] offset:0
 ds_write_b128 v74, a[76:79] offset:1024
 s_waitcnt lgkmcnt(0)
 s_barrier
 ds_read2st64_b32 a[72:73], v75 offset0:0 offset1:4
 ds_read2st64_b32 a[74:75], v75 offset0:8 offset1:12
 ds_read2st64_b32 a[76:77], v75 offset0:16 offset1:20
 ds_read2st64_b32 a[78:79], v75 offset0:24 offset1:28
 s_add_u32 s81, s83, 81920
 buffer_load_dwordx4 v[32:35], v73, s[24:27], s81 offen
 s_add_u32 s81, s83, 102400
 buffer_load_dwordx4 v[36:39], v73, s[24:27], s81 offen
 s_waitcnt vmcnt(54)
 ds_write_b128 v74, a[152:155] offset:8192
 ds_write_b128 v74, a[156:159] offset:9216
 s_waitcnt lgkmcnt(0)
 s_barrier
 ds_read2st64_b32 a[152:153], v75 offset0:32 offset1:36
 ds_read2st64_b32 a[154:155], v75 offset0:40 offset1:44
 ds_read2st64_b32 a[156:157], v75 offset0:48 offset1:52
 ds_read2st64_b32 a[158:159], v75 offset0:56 offset1:60
 s_add_u32 s81, s83, 122944
 buffer_load_dwordx4 v[40:43], v73, s[24:27], s81 offen
 s_add_u32 s81, s83, 143424
 buffer_load_dwordx4 v[44:47], v73, s[24:27], s81 offen
 s_waitcnt vmcnt(54)
 ds_write_b128 v74, v[176:179] offset:0
 ds_write_b128 v74, v[180:183] offset:1024
 s_waitcnt lgkmcnt(0)
 s_barrier
 ds_read2st64_b32 v[176:177], v75 offset0:0 offset1:4
 ds_read2st64_b32 v[178:179], v75 offset0:8 offset1:12
 ds_read2st64_b32 v[180:181], v75 offset0:16 offset1:20
 ds_read2st64_b32 v[182:183], v75 offset0:24 offset1:28
 s_add_u32 s81, s83, 122880
 buffer_load_dwordx4 a[224:227], v73, s[24:27], s81 offen
 s_add_u32 s81, s83, 143360
 buffer_load_dwordx4 a[228:231], v73, s[24:27], s81 offen
 s_waitcnt vmcnt(54)
 ds_write_b128 v74, a[80:83] offset:8192
 ds_write_b128 v74, a[84:87] offset:9216
 s_waitcnt lgkmcnt(0)
 s_barrier
 ds_read2st64_b32 a[80:81], v75 offset0:32 offset1:36
 ds_read2st64_b32 a[82:83], v75 offset0:40 offset1:44
 ds_read2st64_b32 a[84:85], v75 offset0:48 offset1:52
 ds_read2st64_b32 a[86:87], v75 offset0:56 offset1:60
 s_add_u32 s81, s83, 64
 buffer_load_dwordx4 a[232:235], v73, s[24:27], s81 offen
 s_add_u32 s81, s83, 20544
 buffer_load_dwordx4 a[236:239], v73, s[24:27], s81 offen
 s_waitcnt vmcnt(54)
 ds_write_b128 v74, a[160:163] offset:0
 ds_write_b128 v74, a[164:167] offset:1024
 s_waitcnt lgkmcnt(0)
 s_barrier
 ds_read2st64_b32 a[160:161], v75 offset0:0 offset1:4
 ds_read2st64_b32 a[162:163], v75 offset0:8 offset1:12
 ds_read2st64_b32 a[164:165], v75 offset0:16 offset1:20
 ds_read2st64_b32 a[166:167], v75 offset0:24 offset1:28
 s_add_u32 s81, s83, 41024
 buffer_load_dwordx4 a[240:243], v73, s[24:27], s81 offen
 s_add_u32 s81, s83, 61504
 buffer_load_dwordx4 a[244:247], v73, s[24:27], s81 offen
 s_waitcnt vmcnt(54)
 ds_write_b128 v74, v[184:187] offset:8192
 ds_write_b128 v74, v[188:191] offset:9216
 s_waitcnt lgkmcnt(0)
 s_barrier
 ds_read2st64_b32 v[184:185], v75 offset0:32 offset1:36
 ds_read2st64_b32 v[186:187], v75 offset0:40 offset1:44
 ds_read2st64_b32 v[188:189], v75 offset0:48 offset1:52
 ds_read2st64_b32 v[190:191], v75 offset0:56 offset1:60
 s_add_u32 s81, s83, 81984
 buffer_load_dwordx4 a[248:251], v73, s[24:27], s81 offen
 s_add_u32 s81, s83, 102464
 buffer_load_dwordx4 a[252:255], v73, s[24:27], s81 offen
 s_waitcnt vmcnt(54)
 ds_write_b128 v74, a[88:91] offset:0
 ds_write_b128 v74, a[92:95] offset:1024
 s_waitcnt lgkmcnt(0)
 s_barrier
 ds_read2st64_b32 a[88:89], v75 offset0:0 offset1:4
 ds_read2st64_b32 a[90:91], v75 offset0:8 offset1:12
 ds_read2st64_b32 a[92:93], v75 offset0:16 offset1:20
 ds_read2st64_b32 a[94:95], v75 offset0:24 offset1:28
 s_waitcnt vmcnt(52)
 ds_write_b128 v74, a[168:171] offset:8192
 ds_write_b128 v74, a[172:175] offset:9216
 s_waitcnt lgkmcnt(0)
 s_barrier
 ds_read2st64_b32 a[168:169], v75 offset0:32 offset1:36
 ds_read2st64_b32 a[170:171], v75 offset0:40 offset1:44
 ds_read2st64_b32 a[172:173], v75 offset0:48 offset1:52
 ds_read2st64_b32 a[174:175], v75 offset0:56 offset1:60
 s_waitcnt vmcnt(50)
 ds_write_b128 v74, v[192:195] offset:0
 ds_write_b128 v74, v[196:199] offset:1024
 s_waitcnt lgkmcnt(0)
 s_barrier
 ds_read2st64_b32 v[192:193], v75 offset0:0 offset1:4
 ds_read2st64_b32 v[194:195], v75 offset0:8 offset1:12
 ds_read2st64_b32 v[196:197], v75 offset0:16 offset1:20
 ds_read2st64_b32 v[198:199], v75 offset0:24 offset1:28
 s_waitcnt vmcnt(48)
 ds_write_b128 v74, a[96:99] offset:8192
 ds_write_b128 v74, a[100:103] offset:9216
 s_waitcnt lgkmcnt(0)
 s_barrier
 ds_read2st64_b32 a[96:97], v75 offset0:32 offset1:36
 ds_read2st64_b32 a[98:99], v75 offset0:40 offset1:44
 ds_read2st64_b32 a[100:101], v75 offset0:48 offset1:52
 ds_read2st64_b32 a[102:103], v75 offset0:56 offset1:60
 s_waitcnt vmcnt(46)
 ds_write_b128 v74, a[176:179] offset:0
 ds_write_b128 v74, a[180:183] offset:1024
 s_waitcnt lgkmcnt(0)
 s_barrier
 ds_read2st64_b32 a[176:177], v75 offset0:0 offset1:4
 ds_read2st64_b32 a[178:179], v75 offset0:8 offset1:12
 ds_read2st64_b32 a[180:181], v75 offset0:16 offset1:20
 ds_read2st64_b32 a[182:183], v75 offset0:24 offset1:28
 s_waitcnt vmcnt(44)
 ds_write_b128 v74, v[200:203] offset:8192
 ds_write_b128 v74, v[204:207] offset:9216
 s_waitcnt lgkmcnt(0)
 s_barrier
 ds_read2st64_b32 v[200:201], v75 offset0:32 offset1:36
 ds_read2st64_b32 v[202:203], v75 offset0:40 offset1:44
 ds_read2st64_b32 v[204:205], v75 offset0:48 offset1:52
 ds_read2st64_b32 v[206:207], v75 offset0:56 offset1:60
 s_waitcnt vmcnt(42)
 ds_write_b128 v74, a[104:107] offset:0
 ds_write_b128 v74, a[108:111] offset:1024
 s_waitcnt lgkmcnt(0)
 s_barrier
 ds_read2st64_b32 a[104:105], v75 offset0:0 offset1:4
 ds_read2st64_b32 a[106:107], v75 offset0:8 offset1:12
 ds_read2st64_b32 a[108:109], v75 offset0:16 offset1:20
 ds_read2st64_b32 a[110:111], v75 offset0:24 offset1:28
 s_waitcnt vmcnt(40)
 ds_write_b128 v74, a[184:187] offset:8192
 ds_write_b128 v74, a[188:191] offset:9216
 s_waitcnt lgkmcnt(0)
 s_barrier
 ds_read2st64_b32 a[184:185], v75 offset0:32 offset1:36
 ds_read2st64_b32 a[186:187], v75 offset0:40 offset1:44
 ds_read2st64_b32 a[188:189], v75 offset0:48 offset1:52
 ds_read2st64_b32 a[190:191], v75 offset0:56 offset1:60
 s_waitcnt vmcnt(38)
 ds_write_b128 v74, v[208:211] offset:0
 ds_write_b128 v74, v[212:215] offset:1024
 s_waitcnt lgkmcnt(0)
 s_barrier
 ds_read2st64_b32 v[208:209], v75 offset0:0 offset1:4
 ds_read2st64_b32 v[210:211], v75 offset0:8 offset1:12
 ds_read2st64_b32 v[212:213], v75 offset0:16 offset1:20
 ds_read2st64_b32 v[214:215], v75 offset0:24 offset1:28
 s_waitcnt vmcnt(36)
 ds_write_b128 v74, a[112:115] offset:8192
 ds_write_b128 v74, a[116:119] offset:9216
 s_waitcnt lgkmcnt(0)
 s_barrier
 ds_read2st64_b32 a[112:113], v75 offset0:32 offset1:36
 ds_read2st64_b32 a[114:115], v75 offset0:40 offset1:44
 ds_read2st64_b32 a[116:117], v75 offset0:48 offset1:52
 ds_read2st64_b32 a[118:119], v75 offset0:56 offset1:60
 s_waitcnt vmcnt(34)
 ds_write_b128 v74, a[192:195] offset:0
 ds_write_b128 v74, a[196:199] offset:1024
 s_waitcnt lgkmcnt(0)
 s_barrier
 ds_read2st64_b32 a[192:193], v75 offset0:0 offset1:4
 ds_read2st64_b32 a[194:195], v75 offset0:8 offset1:12
 ds_read2st64_b32 a[196:197], v75 offset0:16 offset1:20
 ds_read2st64_b32 a[198:199], v75 offset0:24 offset1:28
 s_waitcnt vmcnt(32)
 ds_write_b128 v74, v[216:219] offset:8192
 ds_write_b128 v74, v[220:223] offset:9216
 s_waitcnt lgkmcnt(0)
 s_barrier
 ds_read2st64_b32 v[216:217], v75 offset0:32 offset1:36
 ds_read2st64_b32 v[218:219], v75 offset0:40 offset1:44
 ds_read2st64_b32 v[220:221], v75 offset0:48 offset1:52
 ds_read2st64_b32 v[222:223], v75 offset0:56 offset1:60
 s_waitcnt vmcnt(30)
 ds_write_b128 v74, a[120:123] offset:0
 ds_write_b128 v74, a[124:127] offset:1024
 s_waitcnt lgkmcnt(0)
 s_barrier
 ds_read2st64_b32 a[120:121], v75 offset0:0 offset1:4
 ds_read2st64_b32 a[122:123], v75 offset0:8 offset1:12
 ds_read2st64_b32 a[124:125], v75 offset0:16 offset1:20
 ds_read2st64_b32 a[126:127], v75 offset0:24 offset1:28
 s_waitcnt vmcnt(28)
 ds_write_b128 v74, a[200:203] offset:8192
 ds_write_b128 v74, a[204:207] offset:9216
 s_waitcnt lgkmcnt(0)
 s_barrier
 ds_read2st64_b32 a[200:201], v75 offset0:32 offset1:36
 ds_read2st64_b32 a[202:203], v75 offset0:40 offset1:44
 ds_read2st64_b32 a[204:205], v75 offset0:48 offset1:52
 ds_read2st64_b32 a[206:207], v75 offset0:56 offset1:60
 s_waitcnt vmcnt(26)
 ds_write_b128 v74, v[224:227] offset:0
 ds_write_b128 v74, v[228:231] offset:1024
 s_waitcnt lgkmcnt(0)
 s_barrier
 ds_read2st64_b32 v[224:225], v75 offset0:0 offset1:4
 ds_read2st64_b32 v[226:227], v75 offset0:8 offset1:12
 ds_read2st64_b32 v[228:229], v75 offset0:16 offset1:20
 ds_read2st64_b32 v[230:231], v75 offset0:24 offset1:28
 s_waitcnt vmcnt(24)
 ds_write_b128 v74, a[128:131] offset:8192
 ds_write_b128 v74, a[132:135] offset:9216
 s_waitcnt lgkmcnt(0)
 s_barrier
 ds_read2st64_b32 a[128:129], v75 offset0:32 offset1:36
 ds_read2st64_b32 a[130:131], v75 offset0:40 offset1:44
 ds_read2st64_b32 a[132:133], v75 offset0:48 offset1:52
 ds_read2st64_b32 a[134:135], v75 offset0:56 offset1:60
 s_waitcnt vmcnt(22)
 ds_write_b128 v74, a[208:211] offset:0
 ds_write_b128 v74, a[212:215] offset:1024
 s_waitcnt lgkmcnt(0)
 s_barrier
 ds_read2st64_b32 a[208:209], v75 offset0:0 offset1:4
 ds_read2st64_b32 a[210:211], v75 offset0:8 offset1:12
 ds_read2st64_b32 a[212:213], v75 offset0:16 offset1:20
 ds_read2st64_b32 a[214:215], v75 offset0:24 offset1:28
 s_waitcnt vmcnt(20)
 ds_write_b128 v74, v[232:235] offset:8192
 ds_write_b128 v74, v[236:239] offset:9216
 s_waitcnt lgkmcnt(0)
 s_barrier
 ds_read2st64_b32 v[232:233], v75 offset0:32 offset1:36
 ds_read2st64_b32 v[234:235], v75 offset0:40 offset1:44
 ds_read2st64_b32 v[236:237], v75 offset0:48 offset1:52
 ds_read2st64_b32 v[238:239], v75 offset0:56 offset1:60
 s_waitcnt vmcnt(18)
 ds_write_b128 v74, a[136:139] offset:0
 ds_write_b128 v74, a[140:143] offset:1024
 s_waitcnt lgkmcnt(0)
 s_barrier
 ds_read2st64_b32 a[136:137], v75 offset0:0 offset1:4
 ds_read2st64_b32 a[138:139], v75 offset0:8 offset1:12
 ds_read2st64_b32 a[140:141], v75 offset0:16 offset1:20
 ds_read2st64_b32 a[142:143], v75 offset0:24 offset1:28
 s_waitcnt vmcnt(16)
 ds_write_b128 v74, a[216:219] offset:8192
 ds_write_b128 v74, a[220:223] offset:9216
 s_waitcnt lgkmcnt(0)
 s_barrier
 ds_read2st64_b32 a[216:217], v75 offset0:32 offset1:36
 ds_read2st64_b32 a[218:219], v75 offset0:40 offset1:44
 ds_read2st64_b32 a[220:221], v75 offset0:48 offset1:52
 ds_read2st64_b32 a[222:223], v75 offset0:56 offset1:60
 s_waitcnt vmcnt(14)
 s_waitcnt lgkmcnt(0)
 s_barrier
 ds_write_b128 v74, v[16:19] offset:0
 ds_write_b128 v74, v[20:23] offset:1024
 ds_read2_b32 v[16:17], v76 offset0:0 offset1:16
 ds_read2_b32 v[18:19], v76 offset0:32 offset1:48
 ds_read2_b32 v[20:21], v77 offset0:0 offset1:16
 ds_read2_b32 v[22:23], v77 offset0:32 offset1:48
 s_waitcnt lgkmcnt(0)
 ds_write_b128 v3, v[16:19] offset:20480
 ds_write_b128 v3, v[20:23] offset:21504
 s_waitcnt vmcnt(12)
 ds_write_b128 v74, v[24:27] offset:0
 ds_write_b128 v74, v[28:31] offset:1024
 ds_read2_b32 v[24:25], v76 offset0:0 offset1:16
 ds_read2_b32 v[26:27], v76 offset0:32 offset1:48
 ds_read2_b32 v[28:29], v77 offset0:0 offset1:16
 ds_read2_b32 v[30:31], v77 offset0:32 offset1:48
 s_waitcnt lgkmcnt(0)
 ds_write_b128 v3, v[24:27] offset:22528
 ds_write_b128 v3, v[28:31] offset:23552
 s_waitcnt vmcnt(10)
 ds_write_b128 v74, v[32:35] offset:0
 ds_write_b128 v74, v[36:39] offset:1024
 ds_read2_b32 v[32:33], v76 offset0:0 offset1:16
 ds_read2_b32 v[34:35], v76 offset0:32 offset1:48
 ds_read2_b32 v[36:37], v77 offset0:0 offset1:16
 ds_read2_b32 v[38:39], v77 offset0:32 offset1:48
 s_waitcnt lgkmcnt(0)
 ds_write_b128 v3, v[32:35] offset:24576
 ds_write_b128 v3, v[36:39] offset:25600
 s_waitcnt vmcnt(8)
 ds_write_b128 v74, v[40:43] offset:0
 ds_write_b128 v74, v[44:47] offset:1024
 ds_read2_b32 v[40:41], v76 offset0:0 offset1:16
 ds_read2_b32 v[42:43], v76 offset0:32 offset1:48
 ds_read2_b32 v[44:45], v77 offset0:0 offset1:16
 ds_read2_b32 v[46:47], v77 offset0:32 offset1:48
 s_waitcnt lgkmcnt(0)
 ds_write_b128 v3, v[40:43] offset:26624
 ds_write_b128 v3, v[44:47] offset:27648
 s_waitcnt vmcnt(6)
 ds_write_b128 v74, a[224:227] offset:0
 ds_write_b128 v74, a[228:231] offset:1024
 ds_read2_b32 a[224:225], v76 offset0:0 offset1:16
 ds_read2_b32 a[226:227], v76 offset0:32 offset1:48
 ds_read2_b32 a[228:229], v77 offset0:0 offset1:16
 ds_read2_b32 a[230:231], v77 offset0:32 offset1:48
 s_waitcnt lgkmcnt(6)
 s_waitcnt vmcnt(4)
 ds_write_b128 v74, a[232:235] offset:0
 ds_write_b128 v74, a[236:239] offset:1024
 ds_read2_b32 a[232:233], v76 offset0:0 offset1:16
 ds_read2_b32 a[234:235], v76 offset0:32 offset1:48
 ds_read2_b32 a[236:237], v77 offset0:0 offset1:16
 ds_read2_b32 a[238:239], v77 offset0:32 offset1:48
 s_waitcnt lgkmcnt(6)
 s_waitcnt vmcnt(2)
 ds_write_b128 v74, a[240:243] offset:0
 ds_write_b128 v74, a[244:247] offset:1024
 ds_read2_b32 a[240:241], v76 offset0:0 offset1:16
 ds_read2_b32 a[242:243], v76 offset0:32 offset1:48
 ds_read2_b32 a[244:245], v77 offset0:0 offset1:16
 ds_read2_b32 a[246:247], v77 offset0:32 offset1:48
 s_waitcnt lgkmcnt(6)
 s_waitcnt vmcnt(0)
 ds_write_b128 v74, a[248:251] offset:0
 ds_write_b128 v74, a[252:255] offset:1024
 ds_read2_b32 a[248:249], v76 offset0:0 offset1:16
 ds_read2_b32 a[250:251], v76 offset0:32 offset1:48
 ds_read2_b32 a[252:253], v77 offset0:0 offset1:16
 ds_read2_b32 a[254:255], v77 offset0:32 offset1:48
 s_waitcnt lgkmcnt(6)
 s_waitcnt lgkmcnt(0)
 s_barrier
 v_add_u32 v0, 16384, v6
 s_mul_i32 s81, s67, 163840
 s_lshl_b32 s82, s82, 14
 s_add_u32 s82, s82, s81
 s_lshl_b32 s81, s68, 7
 s_add_u32 s82, s82, s81
 s_add_u32 s82, s82, 0x40000
 s_add_u32 s83, s82, 0x4000
 s_add_u32 s84, s82, 0x8000
 s_cmp_lg_u32 s69, 2
 s_cbranch_scc1 confirmed_133
 s_mov_b32 s69, 1
 v_mbcnt_lo_u32_b32 v45, -1, 0
 v_and_b32 v45, 7, v45
 v_lshlrev_b32 v45, 5, v45
confirm_132:
 buffer_load_dword v44, v45, s[28:31], 0 offen sc1
 s_waitcnt vmcnt(0)
 v_readlane_b32 s87, v44, 0
 v_readlane_b32 s88, v44, 4
 s_min_u32 s87, s87, s88
 s_cmp_ge_u32 s87, 32
 s_cbranch_scc1 confirmed_133
 v_readlane_b32 s87, v44, 0
 v_readlane_b32 s88, v44, 1
 s_add_u32 s87, s87, s88
 v_readlane_b32 s88, v44, 2
 s_add_u32 s87, s87, s88
 v_readlane_b32 s88, v44, 3
 s_add_u32 s87, s87, s88
 v_readlane_b32 s88, v44, 4
 s_add_u32 s87, s87, s88
 v_readlane_b32 s88, v44, 5
 s_add_u32 s87, s87, s88
 v_readlane_b32 s88, v44, 6
 s_add_u32 s87, s87, s88
 v_readlane_b32 s88, v44, 7
 s_add_u32 s87, s87, s88
 s_cmp_ge_u32 s87, 256
 s_cbranch_scc1 reassign
 s_add_u32 s74, s74, 1
 s_cmp_lt_u32 s74, 0x40000
 s_cbranch_scc1 confirm_132
 s_branch bail2
confirmed_133:
 v_lshrrev_b32 v45, 4, v6
 v_and_b32 v45, 7, v45
 v_lshlrev_b32 v45, 5, v45
wait_134:
 buffer_load_dword v44, v45, s[28:31], 4 offen sc1
 s_waitcnt vmcnt(0)
test_136:
 v_cmp_gt_u32 vcc, 24, v44
 s_and_b32 vcc_lo, vcc_lo, 0xff
 s_and_b32 vcc_hi, vcc_hi, 0x0
 s_cmp_eq_u64 vcc, 0
 s_cbranch_scc1 ready_135
 s_sleep 6
 s_add_u32 s74, s74, 1
 s_cmp_lt_u32 s74, 0x40000
 s_cbranch_scc1 wait_134
 s_branch bail2
ready_135:
 s_lshl_b32 s89, s68, 10
 s_add_u32 s89, s89, 16384
 s_mov_b32 s96, 0
 s_mov_b32 s81, 1
 s_cmp_ge_u32 s96, s81
 s_cbranch_scc1 kvok_138
 v_and_b32 v45, 0x70, v6
 v_lshlrev_b32 v45, 3, v45
kv_137:
 buffer_load_dword v44, v45, s[8:11], s89 offen sc1
 s_waitcnt vmcnt(0)
 v_readlane_b32 s87, v44, 2
 v_readlane_b32 s88, v44, 4
 s_min_u32 s96, s87, s88
 v_readlane_b32 s87, v44, 3
 v_readlane_b32 s88, v44, 5
 s_min_u32 s87, s87, s88
 s_lshl_b32 s96, s96, 1
 s_lshl_b32 s87, s87, 1
 s_add_u32 s87, s87, 1
 s_min_u32 s96, s96, s87
 s_cmp_ge_u32 s96, s81
 s_cbranch_scc1 kvok_138
 s_add_u32 s74, s74, 1
 s_cmp_lt_u32 s74, 0x40000
 s_cbranch_scc1 kv_137
 s_branch bail2
kvok_138:
 s_lshl_b32 s5, s68, 1
 s_add_u32 s5, s5, s67
 s_lshl_b32 s5, s5, 7
 s_add_u32 s5, s5, 49152
 s_cmp_eq_u32 s66, 3
 s_cselect_b32 s7, s5, 0x40000000
 buffer_load_dwordx4 v[24:27], v14, s[8:11], s3 offen offset:0 sc1
 buffer_load_dwordx4 v[28:31], v14, s[8:11], s3 offen offset:1024 sc1
 s_mov_b32 m0, s97
 s_nop 0
 buffer_load_dwordx4 v14, s[8:11], s79 offen offset:0 sc1 lds
 buffer_load_dwordx4 v14, s[8:11], s79 offen offset:1024 sc1 lds
 s_waitcnt vmcnt(0)
 v_mov_b64 v[16:17], v[24:25]
 v_mov_b64 v[18:19], v[26:27]
 v_mov_b64 v[20:21], v[28:29]
 v_mov_b64 v[22:23], v[30:31]
 v_mov_b64 v[32:33], 0
 v_mov_b64 v[34:35], 0
 v_mov_b64 v[36:37], 0
 v_mov_b64 v[38:39], 0
 v_mov_b64 v[40:41], 0
 v_mov_b64 v[42:43], 0
 s_xor_b32 s97, s97, 0x2000
 s_add_u32 s79, s79, 0x40000
 s_add_u32 s3, s3, 0x40000
 s_add_u32 s4, s77, 5120
 s_barrier
 ds_read_b128 v[72:75], v12 offset:5120
 ds_read_b128 v[76:79], v12 offset:6144
 ds_read_b64 v[24:25], v13 offset:5120
 s_waitcnt lgkmcnt(0)
 v_min_u32 v72, -2, v72
 v_min_u32 v73, -2, v73
 v_min_u32 v74, -2, v74
 v_min_u32 v75, -2, v75
 v_min_u32 v76, -2, v76
 v_min_u32 v77, -2, v77
 v_min_u32 v78, -2, v78
 v_min_u32 v79, -2, v79
 v_min_u32 v24, -2, v24
 v_min_u32 v25, -2, v25
 buffer_store_dwordx4 v[72:75], v12, s[8:11], s76 offen sc1
 buffer_store_dwordx4 v[76:79], v12, s[8:11], s76 offen offset:1024 sc1
 buffer_store_dwordx2 v[24:25], v13, s[8:11], s76 offen sc1
 s_waitcnt vmcnt(0)
 ds_read_b128 v[56:59], v3 offset:0
 ds_read_b128 v[60:63], v3 offset:1024
 ds_read_b128 v[64:67], v3 offset:2048
 ds_read_b128 v[68:71], v3 offset:3072
 s_cmp_lg_u32 s69, 0
 s_cbranch_scc1 rec1f_a1
 s_branch rec1s_a1
rec1f_step:
 s_barrier
 v_mov_b64 v[16:17], v[24:25]
 v_mov_b64 v[18:19], v[26:27]
 v_mov_b64 v[20:21], v[28:29]
 v_mov_b64 v[22:23], v[30:31]
 v_mov_b64 v[32:33], 0
 v_mov_b64 v[34:35], 0
 v_mov_b64 v[36:37], 0
 v_mov_b64 v[38:39], 0
 v_mov_b64 v[40:41], 0
 v_mov_b64 v[42:43], 0
 s_xor_b32 s97, s97, 0x2000
 s_add_u32 s79, s79, 0x40000
 s_add_u32 s3, s3, 0x40000
 s_add_u32 s72, s72, 1
 s_mov_b32 s101, s85
 s_add_u32 s82, s82, s73
 s_add_u32 s83, s83, s73
 s_add_u32 s84, s84, s73
 s_add_u32 s85, s85, s73
 s_sub_u32 s73, 0, s73
 s_add_u32 s75, s75, 5120
 s_add_u32 s76, s76, 5120
 s_add_u32 s77, s77, 5120
 s_add_u32 s78, s78, 5120
 s_add_u32 s80, s80, 0x10000
 s_add_u32 s100, s100, 0x10000
 s_add_u32 s4, s77, 5120
 ds_read_b128 v[56:59], v3 offset:0
 ds_read_b128 v[60:63], v3 offset:1024
 ds_read_b128 v[64:67], v3 offset:2048
 ds_read_b128 v[68:71], v3 offset:3072
 s_cmp_lt_u32 s72, 60
 s_cbranch_scc1 usual_139
 v_mov_b32 v8, s72
 buffer_store_dword v8, off, s[8:11], s7 sc1
usual_139:
 buffer_load_dwordx4 v[44:47], v12, s[8:11], s75 offen sc1
 buffer_load_dwordx4 v[48:51], v12, s[8:11], s75 offen offset:1024 sc1
 buffer_load_dwordx2 v[52:53], v13, s[8:11], s75 offen sc1
 s_waitcnt vmcnt(0)
 v_max3_u32 v30, v44, v45, v46
 v_max3_u32 v31, v47, v48, v49
 v_max3_u32 v30, v30, v50, v51
 v_max3_u32 v31, v31, v52, v53
 v_max_u32 v30, v30, v31
 v_cmp_eq_u32 vcc, -1, v30
 s_cbranch_vccnz own_retry_141
 ds_write_b128 v12, v[44:47] offset:0
 ds_write_b128 v12, v[48:51] offset:1024
 ds_write_b64 v13, v[52:53] offset:0
own_140:
 s_waitcnt lgkmcnt(0)
 s_barrier
rec1f_a1:
 ds_read_b128 v[44:47], v2 offset:0
 ds_read_b128 v[48:51], v2 offset:512
 s_waitcnt lgkmcnt(1)
 v_smfmac_f32_16x16x64_bf16 v[36:39], v[44:47], v[80:87], v1
 ds_read_b128 v[52:55], v2 offset:1024
 v_smfmac_f32_16x16x64_bf16 v[40:43], v[44:47], v[240:247], v1
 v_smfmac_f32_16x16x64_bf16 v[32:35], v[44:47], v[56:63], v1
 buffer_load_dwordx4 v[72:75], v12, s[8:11], s76 offen sc1
 buffer_load_dwordx4 v[76:79], v12, s[8:11], s76 offen offset:1024 sc1
 buffer_load_dwordx2 v[24:25], v13, s[8:11], s76 offen sc1
 s_waitcnt lgkmcnt(1)
 v_smfmac_f32_16x16x64_bf16 v[36:39], v[48:51], v[88:95], v1
 ds_read_b128 v[44:47], v2 offset:1536
 ds_read_b128 v[56:59], v3 offset:4096
 v_smfmac_f32_16x16x64_bf16 v[40:43], v[48:51], v[248:255], v1
 ds_read_b128 v[60:63], v3 offset:5120
 v_smfmac_f32_16x16x64_bf16 v[32:35], v[48:51], v[64:71], v1
 s_waitcnt lgkmcnt(3)
 v_smfmac_f32_16x16x64_bf16 v[36:39], v[52:55], v[96:103], v1
 ds_read_b128 v[48:51], v2 offset:2048
 ds_read_b128 v[64:67], v3 offset:6144
 v_smfmac_f32_16x16x64_bf16 v[40:43], v[52:55], a[0:7], v1
 ds_read_b128 v[68:71], v3 offset:7168
 s_waitcnt lgkmcnt(3)
 v_smfmac_f32_16x16x64_bf16 v[32:35], v[52:55], v[56:63], v1
 v_smfmac_f32_16x16x64_bf16 v[36:39], v[44:47], v[104:111], v1
 ds_read_b128 v[52:55], v2 offset:2560
 ds_read_b128 v[56:59], v3 offset:8192
 v_smfmac_f32_16x16x64_bf16 v[40:43], v[44:47], a[8:15], v1
 ds_read_b128 v[60:63], v3 offset:9216
 s_waitcnt lgkmcnt(3)
 v_smfmac_f32_16x16x64_bf16 v[32:35], v[44:47], v[64:71], v1
 v_smfmac_f32_16x16x64_bf16 v[36:39], v[48:51], v[112:119], v1
 ds_read_b128 v[44:47], v2 offset:3072
 ds_read_b128 v[64:67], v3 offset:10240
 v_smfmac_f32_16x16x64_bf16 v[40:43], v[48:51], a[16:23], v1
 ds_read_b128 v[68:71], v3 offset:11264
 s_waitcnt lgkmcnt(3)
 v_smfmac_f32_16x16x64_bf16 v[32:35], v[48:51], v[56:63], v1
 v_smfmac_f32_16x16x64_bf16 v[36:39], v[52:55], v[120:127], v1
 ds_read_b128 v[48:51], v2 offset:3584
 ds_read_b128 v[56:59], v3 offset:12288
 v_smfmac_f32_16x16x64_bf16 v[40:43], v[52:55], a[24:31], v1
 ds_read_b128 v[60:63], v3 offset:13312
 s_waitcnt lgkmcnt(3)
 v_smfmac_f32_16x16x64_bf16 v[32:35], v[52:55], v[64:71], v1
 v_smfmac_f32_16x16x64_bf16 v[36:39], v[44:47], v[128:135], v1
 ds_read_b128 v[52:55], v2 offset:4096
 ds_read_b128 v[64:67], v3 offset:14336
 v_smfmac_f32_16x16x64_bf16 v[40:43], v[44:47], a[32:39], v1
 ds_read_b128 v[68:71], v3 offset:15360
 s_waitcnt lgkmcnt(3)
 v_smfmac_f32_16x16x64_bf16 v[32:35], v[44:47], v[56:63], v1
 v_smfmac_f32_16x16x64_bf16 v[36:39], v[48:51], v[136:143], v1
 ds_read_b128 v[44:47], v2 offset:4608
 ds_read_b128 v[56:59], v3 offset:16384
 v_smfmac_f32_16x16x64_bf16 v[40:43], v[48:51], a[40:47], v1
 ds_read_b128 v[60:63], v3 offset:17408
 s_waitcnt lgkmcnt(3)
 v_smfmac_f32_16x16x64_bf16 v[32:35], v[48:51], v[64:71], v1
 s_waitcnt vmcnt(0)
 v_max3_u32 v30, v72, v73, v74
 v_max3_u32 v31, v75, v76, v77
 v_max3_u32 v30, v30, v78, v79
 v_max3_u32 v31, v31, v24, v25
 v_max_u32 v30, v30, v31
 v_cmp_eq_u32 vcc, -1, v30
 s_cbranch_vccnz late_retry_143
 ds_write_b128 v12, v[72:75] offset:5120
 ds_write_b128 v12, v[76:79] offset:6144
 ds_write_b64 v13, v[24:25] offset:5120
late_142:
 v_smfmac_f32_16x16x64_bf16 v[36:39], v[52:55], v[144:151], v1
 ds_read_b128 v[64:67], v3 offset:18432
 ds_read_b128 v[68:71], v3 offset:19456
 v_smfmac_f32_16x16x64_bf16 v[40:43], v[52:55], a[48:55], v1
 s_waitcnt lgkmcnt(5)
 v_smfmac_f32_16x16x64_bf16 v[32:35], v[52:55], v[56:63], v1
 v_smfmac_f32_16x16x64_bf16 v[36:39], v[44:47], v[152:159], v1
 v_smfmac_f32_16x16x64_bf16 v[40:43], v[44:47], a[56:63], v1
 s_waitcnt lgkmcnt(0)
 v_smfmac_f32_16x16x64_bf16 v[32:35], v[44:47], v[64:71], v1
 s_waitcnt lgkmcnt(0)
 s_barrier
 ds_read_b128 v[44:47], v2 offset:5120
 ds_read_b128 v[48:51], v2 offset:5632
 ds_read_b128 v[52:55], v2 offset:6144
 s_waitcnt lgkmcnt(2)
 v_smfmac_f32_16x16x64_bf16 v[32:35], v[44:47], a[144:151], v1
 ds_read_b128 v[56:59], v2 offset:6656
 v_smfmac_f32_16x16x64_bf16 v[36:39], v[44:47], v[160:167], v1
 ds_read_b128 v[60:63], v2 offset:7168
 v_smfmac_f32_16x16x64_bf16 v[40:43], v[44:47], a[64:71], v1
 s_waitcnt lgkmcnt(2)
 v_smfmac_f32_16x16x64_bf16 v[36:39], v[48:51], v[168:175], v1
 ds_read_b128 v[64:67], v2 offset:7680
 v_smfmac_f32_16x16x64_bf16 v[40:43], v[48:51], a[72:79], v1
 s_waitcnt lgkmcnt(2)
 v_smfmac_f32_16x16x64_bf16 v[36:39], v[52:55], v[176:183], v1
 ds_read_b128 v[68:71], v2 offset:8192
 v_smfmac_f32_16x16x64_bf16 v[40:43], v[52:55], a[80:87], v1
 s_waitcnt lgkmcnt(2)
 v_smfmac_f32_16x16x64_bf16 v[36:39], v[56:59], v[184:191], v1
 ds_read_b128 v[72:75], v2 offset:8704
 v_smfmac_f32_16x16x64_bf16 v[40:43], v[56:59], a[88:95], v1
 s_waitcnt lgkmcnt(2)
 v_smfmac_f32_16x16x64_bf16 v[36:39], v[60:63], v[192:199], v1
 ds_read_b128 v[76:79], v2 offset:9216
 v_smfmac_f32_16x16x64_bf16 v[40:43], v[60:63], a[96:103], v1
 s_waitcnt lgkmcnt(1)
 v_smfmac_f32_16x16x64_bf16 v[36:39], v[64:67], v[200:207], v1
 ds_read_b128 v[44:47], v2 offset:9728
 v_smfmac_f32_16x16x64_bf16 v[40:43], v[64:67], a[104:111], v1
 buffer_load_dwordx4 v[24:27], v14, s[8:11], s3 offen offset:0 sc1
 v_smfmac_f32_16x16x64_bf16 v[36:39], v[68:71], v[208:215], v1
 buffer_load_dwordx4 v[28:31], v14, s[8:11], s3 offen offset:1024 sc1
 v_smfmac_f32_16x16x64_bf16 v[40:43], v[68:71], a[112:119], v1
 s_waitcnt lgkmcnt(0)
 v_smfmac_f32_16x16x64_bf16 v[36:39], v[72:75], v[216:223], v1
 s_mov_b32 m0, s97
 v_smfmac_f32_16x16x64_bf16 v[40:43], v[72:75], a[120:127], v1
 buffer_load_dwordx4 v14, s[8:11], s79 offen offset:0 sc1 lds
 v_smfmac_f32_16x16x64_bf16 v[36:39], v[76:79], v[224:231], v1
 buffer_load_dwordx4 v14, s[8:11], s79 offen offset:1024 sc1 lds
 v_smfmac_f32_16x16x64_bf16 v[40:43], v[76:79], a[128:135], v1
 v_mov_b32 v8, s72
 v_smfmac_f32_16x16x64_bf16 v[36:39], v[44:47], v[232:239], v1
 buffer_store_dword v8, off, s[8:11], s7 sc1
 v_smfmac_f32_16x16x64_bf16 v[40:43], v[44:47], a[136:143], v1
 v_smfmac_f32_16x16x64_bf16 v[32:35], v[56:59], a[168:175], v1
 v_smfmac_f32_16x16x64_bf16 v[32:35], v[60:63], a[176:183], v1
 v_smfmac_f32_16x16x64_bf16 v[32:35], v[64:67], a[184:191], v1
 v_cvt_pk_bf16_f32 v36, v36, v37
 v_cvt_pk_bf16_f32 v37, v38, v39
 ds_write_b64 v4, v[36:37] offset:0
 v_cvt_pk_bf16_f32 v40, v40, v41
 v_cvt_pk_bf16_f32 v41, v42, v43
 ds_write_b64 v4, v[40:41] offset:2304
 v_smfmac_f32_16x16x64_bf16 v[32:35], v[68:71], a[192:199], v1
 v_smfmac_f32_16x16x64_bf16 v[32:35], v[48:51], a[152:159], v1
 v_smfmac_f32_16x16x64_bf16 v[32:35], v[52:55], a[160:167], v1
 ds_read_b128 v[56:59], v0 offset:0
 v_smfmac_f32_16x16x64_bf16 v[32:35], v[72:75], a[200:207], v1
 ds_read_b128 v[60:63], v0 offset:4096
 v_smfmac_f32_16x16x64_bf16 v[32:35], v[76:79], a[208:215], v1
 ds_read_b128 v[64:67], v0 offset:1024
 v_smfmac_f32_16x16x64_bf16 v[32:35], v[44:47], a[216:223], v1
 ds_read_b128 v[68:71], v0 offset:5120
 s_waitcnt lgkmcnt(4)
 s_barrier
 ds_read_b64_tr_b16 v[44:45], v5 offset:0
 ds_read_b64_tr_b16 v[46:47], v5 offset:32
 ds_read_b64_tr_b16 v[48:49], v5 offset:2304
 ds_read_b64_tr_b16 v[50:51], v5 offset:2336
 ds_read_b64_tr_b16 v[52:53], v5 offset:576
 ds_read_b64_tr_b16 v[54:55], v5 offset:608
 ds_read_b64_tr_b16 v[76:77], v5 offset:2880
 ds_read_b64_tr_b16 v[78:79], v5 offset:2912
 buffer_store_dwordx2 v[40:41], v15, s[8:11], s80 offen sc1
 v_cvt_pk_bf16_f32 v32, v32, v33
 v_cvt_pk_bf16_f32 v33, v34, v35
 s_waitcnt lgkmcnt(4)
 v_mfma_f32_16x16x32_bf16 v[36:39], v[56:59], v[44:47], 0
 v_mfma_f32_16x16x32_bf16 v[40:43], v[60:63], v[44:47], 0
 v_mfma_f32_16x16x32_bf16 v[72:75], v[48:51], v[44:47], 0
 s_waitcnt lgkmcnt(0)
 v_mfma_f32_16x16x32_bf16 v[36:39], v[64:67], v[52:55], v[36:39]
 ds_read_b64_tr_b16 v[44:45], v5 offset:1152
 ds_read_b64_tr_b16 v[46:47], v5 offset:1184
 v_mfma_f32_16x16x32_bf16 v[40:43], v[68:71], v[52:55], v[40:43]
 ds_read_b64_tr_b16 v[48:49], v5 offset:3456
 ds_read_b64_tr_b16 v[50:51], v5 offset:3488
 v_mfma_f32_16x16x32_bf16 v[72:75], v[76:79], v[52:55], v[72:75]
 ds_read_b128 v[56:59], v0 offset:2048
 ds_read_b128 v[60:63], v0 offset:6144
 ds_read_b64_tr_b16 v[52:53], v5 offset:1728
 ds_read_b64_tr_b16 v[54:55], v5 offset:1760
 s_waitcnt lgkmcnt(2)
 v_mfma_f32_16x16x32_bf16 v[36:39], v[56:59], v[44:47], v[36:39]
 ds_read_b64_tr_b16 v[76:77], v5 offset:4032
 ds_read_b64_tr_b16 v[78:79], v5 offset:4064
 v_mfma_f32_16x16x32_bf16 v[40:43], v[60:63], v[44:47], v[40:43]
 ds_read_b128 v[64:67], v0 offset:3072
 ds_read_b128 v[68:71], v0 offset:7168
 v_mfma_f32_16x16x32_bf16 v[72:75], v[48:51], v[44:47], v[72:75]
 buffer_store_dwordx2 v[32:33], v15, s[8:11], s100 offen sc1
 s_waitcnt lgkmcnt(0)
 v_mfma_f32_16x16x32_bf16 v[72:75], v[76:79], v[52:55], v[72:75]
 v_xor_b32 v0, 0x2000, v0
 v_mfma_f32_16x16x32_bf16 v[36:39], v[64:67], v[52:55], v[36:39]
 v_mfma_f32_16x16x32_bf16 v[40:43], v[68:71], v[52:55], v[40:43]
 s_cmp_eq_u32 s72, 63
 s_cbranch_scc1 rec1f_last
 v_mov_b32 v44, 0x3f803f80
 v_mov_b32 v45, 0x3f803f80
 v_mov_b32 v46, 0x3f803f80
 v_mov_b32 v47, 0x3f803f80
 v_mov_b64 v[78:79], 0
 v_mov_b32_dpp v72, v74 quad_perm:[0,1,2,3] row_mask:0xf bank_mask:0xc
 v_mov_b32_dpp v73, v75 quad_perm:[0,1,2,3] row_mask:0xf bank_mask:0xc
 v_mov_b32_dpp v36, v40 quad_perm:[0,1,2,3] row_mask:0xf bank_mask:0xc
 v_mov_b32_dpp v37, v41 quad_perm:[0,1,2,3] row_mask:0xf bank_mask:0xc
 v_mov_b32_dpp v38, v42 quad_perm:[0,1,2,3] row_mask:0xf bank_mask:0xc
 v_mov_b32_dpp v39, v43 quad_perm:[0,1,2,3] row_mask:0xf bank_mask:0xc
 v_max3_f32 v76, v72, v73, v36
 v_max3_f32 v77, v37, v38, v39
 v_max_f32 v76, v76, v77
 v_mov_b64 v[74:75], 0
 s_nop 0
 v_max_f32_dpp v76, v76, v76 row_ror:8 row_mask:0xf bank_mask:0xf
 v_mov_b32 v77, v76
 s_nop 1
 v_permlane16_swap_b32 v76, v77
 v_max_f32 v76, v76, v77
 v_mov_b32 v77, v76
 s_nop 1
 v_permlane32_swap_b32 v76, v77
 v_max_f32 v76, v76, v77
 v_mul_f32 v76, 0xbe0293ee, v76
 v_pk_fma_f32 v[36:37], v[36:37], s[98:99], v[76:77] op_sel_hi:[1,0,0]
 v_pk_fma_f32 v[38:39], v[38:39], s[98:99], v[76:77] op_sel_hi:[1,0,0]
 v_pk_fma_f32 v[72:73], v[72:73], s[98:99], v[76:77] op_sel_hi:[1,0,0]
 v_exp_f32 v36, v36
 v_exp_f32 v37, v37
 v_exp_f32 v38, v38
 v_exp_f32 v39, v39
 v_exp_f32 v72, v72
 v_exp_f32 v73, v73
 v_cvt_pk_bf16_f32 v40, v36, v37
 v_cvt_pk_bf16_f32 v41, v38, v39
 v_cvt_pk_bf16_f32 v76, v72, v73
 v_mov_b32_dpp v42, v40 row_ror:8 row_mask:0xf bank_mask:0xf
 v_mov_b32_dpp v43, v41 row_ror:8 row_mask:0xf bank_mask:0xf
 v_mov_b32_dpp v74, v76 quad_perm:[0,1,2,3] row_mask:0x3 bank_mask:0xf
 v_mov_b32_dpp v75, v76 row_ror:8 row_mask:0x3 bank_mask:0xf
 v_mfma_f32_16x16x32_bf16 v[52:55], v[44:47], v[40:43], 0
 v_mov_b32_dpp v78, v76 quad_perm:[0,1,2,3] row_mask:0xc bank_mask:0xf
 v_mov_b32_dpp v79, v76 row_ror:8 row_mask:0xc bank_mask:0xf
 v_mfma_f32_16x16x32_bf16 v[48:51], v[16:19], v[40:43], 0
 v_mov_b64 v[36:37], 0
 v_mov_b64 v[38:39], 0
 v_mfma_f32_16x16x32_bf16 v[64:67], v[20:23], v[40:43], 0
 v_mfma_f32_16x16x16_bf16 v[52:55], v[44:45], v[74:75], v[52:55]
 v_mfma_f32_16x16x16_bf16 v[48:51], v[32:33], v[74:75], v[48:51]
 v_mfma_f32_16x16x16_bf16 v[64:67], v[32:33], v[78:79], v[64:67]
 v_mov_b64 v[32:33], 0
 v_mov_b64 v[34:35], 0
 v_rcp_f32 v76, v52
 s_nop 0
 v_pk_mul_f32 v[48:49], v[48:49], v[76:77] op_sel_hi:[1,0]
 v_pk_mul_f32 v[50:51], v[50:51], v[76:77] op_sel_hi:[1,0]
 s_nop 1
 v_pk_mul_f32 v[64:65], v[64:65], v[76:77] op_sel_hi:[1,0]
 v_pk_mul_f32 v[66:67], v[66:67], v[76:77] op_sel_hi:[1,0]
 v_cvt_pk_bf16_f32 v72, v48, v64
 v_cvt_pk_bf16_f32 v73, v49, v65
 v_cvt_pk_bf16_f32 v74, v50, v66
 v_cvt_pk_bf16_f32 v75, v51, v67
 ds_write_b128 v7, v[72:75]
 ds_read_b128 v[16:19], v3 offset:20480
 ds_read_b128 v[20:23], v3 offset:21504
 ds_read_b128 v[44:47], v3 offset:22528
 ds_read_b128 v[48:51], v3 offset:23552
 ds_read_b128 v[72:75], v3 offset:24576
 ds_read_b128 v[76:79], v3 offset:25600
 s_waitcnt lgkmcnt(6)
 s_barrier
 ds_read_b128 v[56:59], v2 offset:0
 ds_read_b128 v[60:63], v2 offset:512
 ds_read_b128 v[64:67], v2 offset:1024
 ds_read_b128 v[68:71], v2 offset:1536
 s_waitcnt lgkmcnt(3)
 v_smfmac_f32_16x16x64_bf16 v[32:35], v[56:59], v[16:23], v1
 s_waitcnt lgkmcnt(2)
 v_smfmac_f32_16x16x64_bf16 v[32:35], v[60:63], v[44:51], v1
 ds_read_b128 v[16:19], v3 offset:26624
 s_waitcnt lgkmcnt(2)
 v_smfmac_f32_16x16x64_bf16 v[32:35], v[64:67], v[72:79], v1
 ds_read_b128 v[20:23], v3 offset:27648
 s_waitcnt lgkmcnt(2)
 v_smfmac_f32_16x16x64_bf16 v[32:35], v[68:71], a[224:231], v1
 v_smfmac_f32_16x16x64_bf16 v[36:39], v[56:59], a[232:239], v1
 v_smfmac_f32_16x16x64_bf16 v[36:39], v[60:63], a[240:247], v1
 v_smfmac_f32_16x16x64_bf16 v[36:39], v[64:67], a[248:255], v1
 s_waitcnt lgkmcnt(0)
 v_smfmac_f32_16x16x64_bf16 v[36:39], v[68:71], v[16:23], v1
 v_cvt_pk_bf16_f32 v32, v32, v33
 v_cvt_pk_bf16_f32 v33, v34, v35
 buffer_store_dwordx2 v[32:33], v9, s[8:11], s82 offen
 s_nop 4
 v_cvt_pk_bf16_f32 v36, v36, v37
 v_cvt_pk_bf16_f32 v37, v38, v39
 buffer_store_dwordx2 v[36:37], v9, s[8:11], s83 offen
 s_waitcnt vmcnt(2)
 s_branch rec1f_step
rec1f_last:
 s_waitcnt vmcnt(0)
 s_barrier
 s_cmp_lg_u32 s66, 0
 s_cbranch_scc1 notw0_144
 v_mov_b32 v44, 64
 v_mov_b32 v45, 0
 s_mov_b64 exec, 1
 buffer_store_dword v44, v45, s[8:11], s5 offen sc1
 s_mov_b64 exec, -1
notw0_144:
 s_waitcnt vmcnt(0)
 s_branch rec_helper
 s_endpgm
own_retry_141:
 s_mov_b64 exec, vcc
 buffer_load_dwordx4 v[44:47], v12, s[8:11], s75 offen sc1
 buffer_load_dwordx4 v[48:51], v12, s[8:11], s75 offen offset:1024 sc1
 buffer_load_dwordx2 v[52:53], v13, s[8:11], s75 offen sc1
own_loop_145:
 s_mov_b64 exec, vcc
 buffer_load_dwordx4 v[44:47], v12, s[8:11], s75 offen sc1
 buffer_load_dwordx4 v[48:51], v12, s[8:11], s75 offen offset:1024 sc1
 buffer_load_dwordx2 v[52:53], v13, s[8:11], s75 offen sc1
 s_mov_b64 exec, -1
 s_waitcnt vmcnt(3)
 v_max3_u32 v30, v44, v45, v46
 v_max3_u32 v31, v47, v48, v49
 v_max3_u32 v30, v30, v50, v51
 v_max3_u32 v31, v31, v52, v53
 v_max_u32 v30, v30, v31
 v_cmp_eq_u32 vcc, -1, v30
 s_cbranch_vccz own_done_146
 s_add_u32 s74, s74, 1
 s_cmp_lt_u32 s74, 0x40000
 s_cbranch_scc1 own_loop_145
 s_branch bail2
own_done_146:
 ds_write_b128 v12, v[44:47] offset:0
 ds_write_b128 v12, v[48:51] offset:1024
 ds_write_b64 v13, v[52:53] offset:0
 s_waitcnt vmcnt(0)
 s_branch own_140
late_retry_143:
 s_mov_b64 exec, vcc
 buffer_load_dwordx4 v[72:75], v12, s[8:11], s76 offen sc1
 buffer_load_dwordx4 v[76:79], v12, s[8:11], s76 offen offset:1024 sc1
 buffer_load_dwordx2 v[24:25], v13, s[8:11], s76 offen sc1
late_loop_147:
 s_mov_b64 exec, vcc
 buffer_load_dwordx4 v[72:75], v12, s[8:11], s76 offen sc1
 buffer_load_dwordx4 v[76:79], v12, s[8:11], s76 offen offset:1024 sc1
 buffer_load_dwordx2 v[24:25], v13, s[8:11], s76 offen sc1
 s_mov_b64 exec, -1
 s_waitcnt vmcnt(3)
 v_max3_u32 v30, v72, v73, v74
 v_max3_u32 v31, v75, v76, v77
 v_max3_u32 v30, v30, v78, v79
 v_max3_u32 v31, v31, v24, v25
 v_max_u32 v30, v30, v31
 v_cmp_eq_u32 vcc, -1, v30
 s_cbranch_vccz late_done_148
 s_add_u32 s74, s74, 1
 s_cmp_lt_u32 s74, 0x40000
 s_cbranch_scc1 late_loop_147
 s_branch bail2
late_done_148:
 ds_write_b128 v12, v[72:75] offset:5120
 ds_write_b128 v12, v[76:79] offset:6144
 ds_write_b64 v13, v[24:25] offset:5120
 s_waitcnt vmcnt(0)
 s_branch late_142
rec1s_step:
 s_barrier
 v_mov_b64 v[16:17], v[24:25]
 v_mov_b64 v[18:19], v[26:27]
 v_mov_b64 v[20:21], v[28:29]
 v_mov_b64 v[22:23], v[30:31]
 v_mov_b64 v[32:33], 0
 v_mov_b64 v[34:35], 0
 v_mov_b64 v[36:37], 0
 v_mov_b64 v[38:39], 0
 v_mov_b64 v[40:41], 0
 v_mov_b64 v[42:43], 0
 s_xor_b32 s97, s97, 0x2000
 s_add_u32 s79, s79, 0x40000
 s_add_u32 s3, s3, 0x40000
 s_add_u32 s72, s72, 1
 s_mov_b32 s101, s85
 s_add_u32 s82, s82, s73
 s_add_u32 s83, s83, s73
 s_add_u32 s84, s84, s73
 s_add_u32 s85, s85, s73
 s_sub_u32 s73, 0, s73
 s_add_u32 s75, s75, 5120
 s_add_u32 s76, s76, 5120
 s_add_u32 s77, s77, 5120
 s_add_u32 s78, s78, 5120
 s_add_u32 s80, s80, 0x10000
 s_add_u32 s100, s100, 0x10000
 s_add_u32 s4, s77, 5120
 ds_read_b128 v[56:59], v3 offset:0
 ds_read_b128 v[60:63], v3 offset:1024
 ds_read_b128 v[64:67], v3 offset:2048
 ds_read_b128 v[68:71], v3 offset:3072
 s_cmp_lt_u32 s72, 60
 s_cbranch_scc1 usual_149
 v_mov_b32 v8, s72
 buffer_store_dword v8, off, s[8:11], s7 sc1
usual_149:
 buffer_load_dwordx4 v[44:47], v12, s[8:11], s75 offen sc1
 buffer_load_dwordx4 v[48:51], v12, s[8:11], s75 offen offset:1024 sc1
 buffer_load_dwordx2 v[52:53], v13, s[8:11], s75 offen sc1
 s_waitcnt vmcnt(0)
 v_max3_u32 v30, v44, v45, v46
 v_max3_u32 v31, v47, v48, v49
 v_max3_u32 v30, v30, v50, v51
 v_max3_u32 v31, v31, v52, v53
 v_max_u32 v30, v30, v31
 v_cmp_eq_u32 vcc, -1, v30
 s_cbranch_vccnz own_retry_151
 ds_write_b128 v12, v[44:47] offset:0
 ds_write_b128 v12, v[48:51] offset:1024
 ds_write_b64 v13, v[52:53] offset:0
own_150:
 s_waitcnt lgkmcnt(0)
 s_barrier
rec1s_a1:
 ds_read_b128 v[44:47], v2 offset:0
 ds_read_b128 v[48:51], v2 offset:512
 s_waitcnt lgkmcnt(1)
 v_smfmac_f32_16x16x64_bf16 v[36:39], v[44:47], v[80:87], v1
 ds_read_b128 v[52:55], v2 offset:1024
 v_smfmac_f32_16x16x64_bf16 v[40:43], v[44:47], v[240:247], v1
 v_smfmac_f32_16x16x64_bf16 v[32:35], v[44:47], v[56:63], v1
 buffer_load_dwordx4 v[72:75], v12, s[8:11], s76 offen sc1
 buffer_load_dwordx4 v[76:79], v12, s[8:11], s76 offen offset:1024 sc1
 buffer_load_dwordx2 v[24:25], v13, s[8:11], s76 offen sc1
 s_waitcnt lgkmcnt(1)
 v_smfmac_f32_16x16x64_bf16 v[36:39], v[48:51], v[88:95], v1
 ds_read_b128 v[44:47], v2 offset:1536
 ds_read_b128 v[56:59], v3 offset:4096
 v_smfmac_f32_16x16x64_bf16 v[40:43], v[48:51], v[248:255], v1
 ds_read_b128 v[60:63], v3 offset:5120
 v_smfmac_f32_16x16x64_bf16 v[32:35], v[48:51], v[64:71], v1
 s_waitcnt lgkmcnt(3)
 v_smfmac_f32_16x16x64_bf16 v[36:39], v[52:55], v[96:103], v1
 ds_read_b128 v[48:51], v2 offset:2048
 ds_read_b128 v[64:67], v3 offset:6144
 v_smfmac_f32_16x16x64_bf16 v[40:43], v[52:55], a[0:7], v1
 ds_read_b128 v[68:71], v3 offset:7168
 s_waitcnt lgkmcnt(3)
 v_smfmac_f32_16x16x64_bf16 v[32:35], v[52:55], v[56:63], v1
 v_smfmac_f32_16x16x64_bf16 v[36:39], v[44:47], v[104:111], v1
 ds_read_b128 v[52:55], v2 offset:2560
 ds_read_b128 v[56:59], v3 offset:8192
 v_smfmac_f32_16x16x64_bf16 v[40:43], v[44:47], a[8:15], v1
 ds_read_b128 v[60:63], v3 offset:9216
 s_waitcnt lgkmcnt(3)
 v_smfmac_f32_16x16x64_bf16 v[32:35], v[44:47], v[64:71], v1
 v_smfmac_f32_16x16x64_bf16 v[36:39], v[48:51], v[112:119], v1
 ds_read_b128 v[44:47], v2 offset:3072
 ds_read_b128 v[64:67], v3 offset:10240
 v_smfmac_f32_16x16x64_bf16 v[40:43], v[48:51], a[16:23], v1
 ds_read_b128 v[68:71], v3 offset:11264
 s_waitcnt lgkmcnt(3)
 v_smfmac_f32_16x16x64_bf16 v[32:35], v[48:51], v[56:63], v1
 v_smfmac_f32_16x16x64_bf16 v[36:39], v[52:55], v[120:127], v1
 ds_read_b128 v[48:51], v2 offset:3584
 ds_read_b128 v[56:59], v3 offset:12288
 v_smfmac_f32_16x16x64_bf16 v[40:43], v[52:55], a[24:31], v1
 ds_read_b128 v[60:63], v3 offset:13312
 s_waitcnt lgkmcnt(3)
 v_smfmac_f32_16x16x64_bf16 v[32:35], v[52:55], v[64:71], v1
 v_smfmac_f32_16x16x64_bf16 v[36:39], v[44:47], v[128:135], v1
 ds_read_b128 v[52:55], v2 offset:4096
 ds_read_b128 v[64:67], v3 offset:14336
 v_smfmac_f32_16x16x64_bf16 v[40:43], v[44:47], a[32:39], v1
 ds_read_b128 v[68:71], v3 offset:15360
 s_waitcnt lgkmcnt(3)
 v_smfmac_f32_16x16x64_bf16 v[32:35], v[44:47], v[56:63], v1
 v_smfmac_f32_16x16x64_bf16 v[36:39], v[48:51], v[136:143], v1
 ds_read_b128 v[44:47], v2 offset:4608
 ds_read_b128 v[56:59], v3 offset:16384
 v_smfmac_f32_16x16x64_bf16 v[40:43], v[48:51], a[40:47], v1
 ds_read_b128 v[60:63], v3 offset:17408
 s_waitcnt lgkmcnt(3)
 v_smfmac_f32_16x16x64_bf16 v[32:35], v[48:51], v[64:71], v1
 s_waitcnt vmcnt(0)
 v_max3_u32 v30, v72, v73, v74
 v_max3_u32 v31, v75, v76, v77
 v_max3_u32 v30, v30, v78, v79
 v_max3_u32 v31, v31, v24, v25
 v_max_u32 v30, v30, v31
 v_cmp_eq_u32 vcc, -1, v30
 s_cbranch_vccnz late_retry_153
 ds_write_b128 v12, v[72:75] offset:5120
 ds_write_b128 v12, v[76:79] offset:6144
 ds_write_b64 v13, v[24:25] offset:5120
late_152:
 v_smfmac_f32_16x16x64_bf16 v[36:39], v[52:55], v[144:151], v1
 ds_read_b128 v[64:67], v3 offset:18432
 ds_read_b128 v[68:71], v3 offset:19456
 v_smfmac_f32_16x16x64_bf16 v[40:43], v[52:55], a[48:55], v1
 s_waitcnt lgkmcnt(5)
 v_smfmac_f32_16x16x64_bf16 v[32:35], v[52:55], v[56:63], v1
 v_smfmac_f32_16x16x64_bf16 v[36:39], v[44:47], v[152:159], v1
 v_smfmac_f32_16x16x64_bf16 v[40:43], v[44:47], a[56:63], v1
 s_waitcnt lgkmcnt(0)
 v_smfmac_f32_16x16x64_bf16 v[32:35], v[44:47], v[64:71], v1
 s_waitcnt lgkmcnt(0)
 s_barrier
 ds_read_b128 v[44:47], v2 offset:5120
 ds_read_b128 v[48:51], v2 offset:5632
 ds_read_b128 v[52:55], v2 offset:6144
 s_waitcnt lgkmcnt(2)
 v_smfmac_f32_16x16x64_bf16 v[32:35], v[44:47], a[144:151], v1
 ds_read_b128 v[56:59], v2 offset:6656
 v_smfmac_f32_16x16x64_bf16 v[36:39], v[44:47], v[160:167], v1
 ds_read_b128 v[60:63], v2 offset:7168
 v_smfmac_f32_16x16x64_bf16 v[40:43], v[44:47], a[64:71], v1
 s_waitcnt lgkmcnt(2)
 v_smfmac_f32_16x16x64_bf16 v[36:39], v[48:51], v[168:175], v1
 ds_read_b128 v[64:67], v2 offset:7680
 v_smfmac_f32_16x16x64_bf16 v[40:43], v[48:51], a[72:79], v1
 s_waitcnt lgkmcnt(2)
 v_smfmac_f32_16x16x64_bf16 v[36:39], v[52:55], v[176:183], v1
 ds_read_b128 v[68:71], v2 offset:8192
 v_smfmac_f32_16x16x64_bf16 v[40:43], v[52:55], a[80:87], v1
 s_waitcnt lgkmcnt(2)
 v_smfmac_f32_16x16x64_bf16 v[36:39], v[56:59], v[184:191], v1
 ds_read_b128 v[72:75], v2 offset:8704
 v_smfmac_f32_16x16x64_bf16 v[40:43], v[56:59], a[88:95], v1
 s_waitcnt lgkmcnt(2)
 v_smfmac_f32_16x16x64_bf16 v[36:39], v[60:63], v[192:199], v1
 ds_read_b128 v[76:79], v2 offset:9216
 v_smfmac_f32_16x16x64_bf16 v[40:43], v[60:63], a[96:103], v1
 s_waitcnt lgkmcnt(1)
 v_smfmac_f32_16x16x64_bf16 v[36:39], v[64:67], v[200:207], v1
 ds_read_b128 v[44:47], v2 offset:9728
 v_smfmac_f32_16x16x64_bf16 v[40:43], v[64:67], a[104:111], v1
 buffer_load_dwordx4 v[24:27], v14, s[8:11], s3 offen offset:0 sc1
 v_smfmac_f32_16x16x64_bf16 v[36:39], v[68:71], v[208:215], v1
 buffer_load_dwordx4 v[28:31], v14, s[8:11], s3 offen offset:1024 sc1
 v_smfmac_f32_16x16x64_bf16 v[40:43], v[68:71], a[112:119], v1
 s_waitcnt lgkmcnt(0)
 v_smfmac_f32_16x16x64_bf16 v[36:39], v[72:75], v[216:223], v1
 s_mov_b32 m0, s97
 v_smfmac_f32_16x16x64_bf16 v[40:43], v[72:75], a[120:127], v1
 buffer_load_dwordx4 v14, s[8:11], s79 offen offset:0 sc1 lds
 v_smfmac_f32_16x16x64_bf16 v[36:39], v[76:79], v[224:231], v1
 buffer_load_dwordx4 v14, s[8:11], s79 offen offset:1024 sc1 lds
 v_smfmac_f32_16x16x64_bf16 v[40:43], v[76:79], a[128:135], v1
 v_mov_b32 v8, s72
 v_smfmac_f32_16x16x64_bf16 v[36:39], v[44:47], v[232:239], v1
 buffer_store_dword v8, off, s[8:11], s7 sc1
 v_smfmac_f32_16x16x64_bf16 v[40:43], v[44:47], a[136:143], v1
 v_smfmac_f32_16x16x64_bf16 v[32:35], v[56:59], a[168:175], v1
 v_smfmac_f32_16x16x64_bf16 v[32:35], v[60:63], a[176:183], v1
 v_smfmac_f32_16x16x64_bf16 v[32:35], v[64:67], a[184:191], v1
 v_cvt_pk_bf16_f32 v36, v36, v37
 v_cvt_pk_bf16_f32 v37, v38, v39
 ds_write_b64 v4, v[36:37] offset:0
 v_cvt_pk_bf16_f32 v40, v40, v41
 v_cvt_pk_bf16_f32 v41, v42, v43
 ds_write_b64 v4, v[40:41] offset:2304
 v_smfmac_f32_16x16x64_bf16 v[32:35], v[68:71], a[192:199], v1
 v_smfmac_f32_16x16x64_bf16 v[32:35], v[48:51], a[152:159], v1
 v_smfmac_f32_16x16x64_bf16 v[32:35], v[52:55], a[160:167], v1
 ds_read_b128 v[56:59], v0 offset:0
 v_smfmac_f32_16x16x64_bf16 v[32:35], v[72:75], a[200:207], v1
 ds_read_b128 v[60:63], v0 offset:4096
 v_smfmac_f32_16x16x64_bf16 v[32:35], v[76:79], a[208:215], v1
 ds_read_b128 v[64:67], v0 offset:1024
 v_smfmac_f32_16x16x64_bf16 v[32:35], v[44:47], a[216:223], v1
 ds_read_b128 v[68:71], v0 offset:5120
 s_waitcnt lgkmcnt(4)
 s_barrier
 ds_read_b64_tr_b16 v[44:45], v5 offset:0
 ds_read_b64_tr_b16 v[46:47], v5 offset:32
 ds_read_b64_tr_b16 v[48:49], v5 offset:2304
 ds_read_b64_tr_b16 v[50:51], v5 offset:2336
 ds_read_b64_tr_b16 v[52:53], v5 offset:576
 ds_read_b64_tr_b16 v[54:55], v5 offset:608
 ds_read_b64_tr_b16 v[76:77], v5 offset:2880
 ds_read_b64_tr_b16 v[78:79], v5 offset:2912
 buffer_store_dwordx2 v[40:41], v15, s[8:11], s80 offen sc1
 v_cvt_pk_bf16_f32 v32, v32, v33
 v_cvt_pk_bf16_f32 v33, v34, v35
 s_waitcnt lgkmcnt(4)
 v_mfma_f32_16x16x32_bf16 v[36:39], v[56:59], v[44:47], 0
 v_mfma_f32_16x16x32_bf16 v[40:43], v[60:63], v[44:47], 0
 v_mfma_f32_16x16x32_bf16 v[72:75], v[48:51], v[44:47], 0
 s_waitcnt lgkmcnt(0)
 v_mfma_f32_16x16x32_bf16 v[36:39], v[64:67], v[52:55], v[36:39]
 ds_read_b64_tr_b16 v[44:45], v5 offset:1152
 ds_read_b64_tr_b16 v[46:47], v5 offset:1184
 v_mfma_f32_16x16x32_bf16 v[40:43], v[68:71], v[52:55], v[40:43]
 ds_read_b64_tr_b16 v[48:49], v5 offset:3456
 ds_read_b64_tr_b16 v[50:51], v5 offset:3488
 v_mfma_f32_16x16x32_bf16 v[72:75], v[76:79], v[52:55], v[72:75]
 ds_read_b128 v[56:59], v0 offset:2048
 ds_read_b128 v[60:63], v0 offset:6144
 ds_read_b64_tr_b16 v[52:53], v5 offset:1728
 ds_read_b64_tr_b16 v[54:55], v5 offset:1760
 s_waitcnt lgkmcnt(2)
 v_mfma_f32_16x16x32_bf16 v[36:39], v[56:59], v[44:47], v[36:39]
 ds_read_b64_tr_b16 v[76:77], v5 offset:4032
 ds_read_b64_tr_b16 v[78:79], v5 offset:4064
 v_mfma_f32_16x16x32_bf16 v[40:43], v[60:63], v[44:47], v[40:43]
 ds_read_b128 v[64:67], v0 offset:3072
 ds_read_b128 v[68:71], v0 offset:7168
 v_mfma_f32_16x16x32_bf16 v[72:75], v[48:51], v[44:47], v[72:75]
 buffer_store_dwordx2 v[32:33], v15, s[8:11], s100 offen sc1
 s_waitcnt lgkmcnt(0)
 v_mfma_f32_16x16x32_bf16 v[72:75], v[76:79], v[52:55], v[72:75]
 v_xor_b32 v0, 0x2000, v0
 v_mfma_f32_16x16x32_bf16 v[36:39], v[64:67], v[52:55], v[36:39]
 v_mfma_f32_16x16x32_bf16 v[40:43], v[68:71], v[52:55], v[40:43]
 s_cmp_eq_u32 s72, 63
 s_cbranch_scc1 rec1s_last
 v_mov_b32 v44, 0x3f803f80
 v_mov_b32 v45, 0x3f803f80
 v_mov_b32 v46, 0x3f803f80
 v_mov_b32 v47, 0x3f803f80
 v_mov_b64 v[78:79], 0
 v_mov_b32_dpp v72, v74 quad_perm:[0,1,2,3] row_mask:0xf bank_mask:0xc
 v_mov_b32_dpp v73, v75 quad_perm:[0,1,2,3] row_mask:0xf bank_mask:0xc
 v_mov_b32_dpp v36, v40 quad_perm:[0,1,2,3] row_mask:0xf bank_mask:0xc
 v_mov_b32_dpp v37, v41 quad_perm:[0,1,2,3] row_mask:0xf bank_mask:0xc
 v_mov_b32_dpp v38, v42 quad_perm:[0,1,2,3] row_mask:0xf bank_mask:0xc
 v_mov_b32_dpp v39, v43 quad_perm:[0,1,2,3] row_mask:0xf bank_mask:0xc
 v_max3_f32 v76, v72, v73, v36
 v_max3_f32 v77, v37, v38, v39
 v_max_f32 v76, v76, v77
 v_mov_b64 v[74:75], 0
 s_nop 0
 v_max_f32_dpp v76, v76, v76 row_ror:8 row_mask:0xf bank_mask:0xf
 v_mov_b32 v77, v76
 s_nop 1
 v_permlane16_swap_b32 v76, v77
 v_max_f32 v76, v76, v77
 v_mov_b32 v77, v76
 s_nop 1
 v_permlane32_swap_b32 v76, v77
 v_max_f32 v76, v76, v77
 v_mul_f32 v76, 0xbe0293ee, v76
 v_pk_fma_f32 v[36:37], v[36:37], s[98:99], v[76:77] op_sel_hi:[1,0,0]
 v_pk_fma_f32 v[38:39], v[38:39], s[98:99], v[76:77] op_sel_hi:[1,0,0]
 v_pk_fma_f32 v[72:73], v[72:73], s[98:99], v[76:77] op_sel_hi:[1,0,0]
 v_exp_f32 v36, v36
 v_exp_f32 v37, v37
 v_exp_f32 v38, v38
 v_exp_f32 v39, v39
 v_exp_f32 v72, v72
 v_exp_f32 v73, v73
 v_cvt_pk_bf16_f32 v40, v36, v37
 v_cvt_pk_bf16_f32 v41, v38, v39
 v_cvt_pk_bf16_f32 v76, v72, v73
 v_mov_b32_dpp v42, v40 row_ror:8 row_mask:0xf bank_mask:0xf
 v_mov_b32_dpp v43, v41 row_ror:8 row_mask:0xf bank_mask:0xf
 v_mov_b32_dpp v74, v76 quad_perm:[0,1,2,3] row_mask:0x3 bank_mask:0xf
 v_mov_b32_dpp v75, v76 row_ror:8 row_mask:0x3 bank_mask:0xf
 v_mfma_f32_16x16x32_bf16 v[52:55], v[44:47], v[40:43], 0
 v_mov_b32_dpp v78, v76 quad_perm:[0,1,2,3] row_mask:0xc bank_mask:0xf
 v_mov_b32_dpp v79, v76 row_ror:8 row_mask:0xc bank_mask:0xf
 v_mfma_f32_16x16x32_bf16 v[48:51], v[16:19], v[40:43], 0
 v_mov_b64 v[36:37], 0
 v_mov_b64 v[38:39], 0
 v_mfma_f32_16x16x32_bf16 v[64:67], v[20:23], v[40:43], 0
 v_mfma_f32_16x16x16_bf16 v[52:55], v[44:45], v[74:75], v[52:55]
 v_mfma_f32_16x16x16_bf16 v[48:51], v[32:33], v[74:75], v[48:51]
 v_mfma_f32_16x16x16_bf16 v[64:67], v[32:33], v[78:79], v[64:67]
 v_mov_b64 v[32:33], 0
 v_mov_b64 v[34:35], 0
 v_rcp_f32 v76, v52
 s_nop 0
 v_pk_mul_f32 v[48:49], v[48:49], v[76:77] op_sel_hi:[1,0]
 v_pk_mul_f32 v[50:51], v[50:51], v[76:77] op_sel_hi:[1,0]
 s_nop 1
 v_pk_mul_f32 v[64:65], v[64:65], v[76:77] op_sel_hi:[1,0]
 v_pk_mul_f32 v[66:67], v[66:67], v[76:77] op_sel_hi:[1,0]
 v_cvt_pk_bf16_f32 v72, v48, v64
 v_cvt_pk_bf16_f32 v73, v49, v65
 v_cvt_pk_bf16_f32 v74, v50, v66
 v_cvt_pk_bf16_f32 v75, v51, v67
 ds_write_b128 v7, v[72:75]
 ds_read_b128 v[16:19], v3 offset:20480
 ds_read_b128 v[20:23], v3 offset:21504
 ds_read_b128 v[44:47], v3 offset:22528
 ds_read_b128 v[48:51], v3 offset:23552
 ds_read_b128 v[72:75], v3 offset:24576
 ds_read_b128 v[76:79], v3 offset:25600
 s_waitcnt lgkmcnt(6)
 s_barrier
 ds_read_b128 v[56:59], v2 offset:0
 ds_read_b128 v[60:63], v2 offset:512
 ds_read_b128 v[64:67], v2 offset:1024
 ds_read_b128 v[68:71], v2 offset:1536
 s_waitcnt lgkmcnt(3)
 v_smfmac_f32_16x16x64_bf16 v[32:35], v[56:59], v[16:23], v1
 s_waitcnt lgkmcnt(2)
 v_smfmac_f32_16x16x64_bf16 v[32:35], v[60:63], v[44:51], v1
 ds_read_b128 v[16:19], v3 offset:26624
 s_waitcnt lgkmcnt(2)
 v_smfmac_f32_16x16x64_bf16 v[32:35], v[64:67], v[72:79], v1
 ds_read_b128 v[20:23], v3 offset:27648
 s_waitcnt lgkmcnt(2)
 v_smfmac_f32_16x16x64_bf16 v[32:35], v[68:71], a[224:231], v1
 v_smfmac_f32_16x16x64_bf16 v[36:39], v[56:59], a[232:239], v1
 v_smfmac_f32_16x16x64_bf16 v[36:39], v[60:63], a[240:247], v1
 v_smfmac_f32_16x16x64_bf16 v[36:39], v[64:67], a[248:255], v1
 s_waitcnt lgkmcnt(0)
 v_smfmac_f32_16x16x64_bf16 v[36:39], v[68:71], v[16:23], v1
 v_cvt_pk_bf16_f32 v32, v32, v33
 v_cvt_pk_bf16_f32 v33, v34, v35
 buffer_store_dwordx2 v[32:33], v9, s[8:11], s82 offen sc1
 s_nop 4
 v_cvt_pk_bf16_f32 v36, v36, v37
 v_cvt_pk_bf16_f32 v37, v38, v39
 buffer_store_dwordx2 v[36:37], v9, s[8:11], s83 offen sc1
 s_waitcnt vmcnt(2)
 s_branch rec1s_step
rec1s_last:
 s_waitcnt vmcnt(0)
 s_barrier
 s_cmp_lg_u32 s66, 0
 s_cbranch_scc1 notw0_154
 v_mov_b32 v44, 64
 v_mov_b32 v45, 0
 s_mov_b64 exec, 1
 buffer_store_dword v44, v45, s[8:11], s5 offen sc1
 s_mov_b64 exec, -1
notw0_154:
 s_waitcnt vmcnt(0)
 s_branch rec_helper
 s_endpgm
own_retry_151:
 s_mov_b64 exec, vcc
 buffer_load_dwordx4 v[44:47], v12, s[8:11], s75 offen sc1
 buffer_load_dwordx4 v[48:51], v12, s[8:11], s75 offen offset:1024 sc1
 buffer_load_dwordx2 v[52:53], v13, s[8:11], s75 offen sc1
own_loop_155:
 s_mov_b64 exec, vcc
 buffer_load_dwordx4 v[44:47], v12, s[8:11], s75 offen sc1
 buffer_load_dwordx4 v[48:51], v12, s[8:11], s75 offen offset:1024 sc1
 buffer_load_dwordx2 v[52:53], v13, s[8:11], s75 offen sc1
 s_mov_b64 exec, -1
 s_waitcnt vmcnt(3)
 v_max3_u32 v30, v44, v45, v46
 v_max3_u32 v31, v47, v48, v49
 v_max3_u32 v30, v30, v50, v51
 v_max3_u32 v31, v31, v52, v53
 v_max_u32 v30, v30, v31
 v_cmp_eq_u32 vcc, -1, v30
 s_cbranch_vccz own_done_156
 s_add_u32 s74, s74, 1
 s_cmp_lt_u32 s74, 0x40000
 s_cbranch_scc1 own_loop_155
 s_branch bail2
own_done_156:
 ds_write_b128 v12, v[44:47] offset:0
 ds_write_b128 v12, v[48:51] offset:1024
 ds_write_b64 v13, v[52:53] offset:0
 s_waitcnt vmcnt(0)
 s_branch own_150
late_retry_153:
 s_mov_b64 exec, vcc
 buffer_load_dwordx4 v[72:75], v12, s[8:11], s76 offen sc1
 buffer_load_dwordx4 v[76:79], v12, s[8:11], s76 offen offset:1024 sc1
 buffer_load_dwordx2 v[24:25], v13, s[8:11], s76 offen sc1
late_loop_157:
 s_mov_b64 exec, vcc
 buffer_load_dwordx4 v[72:75], v12, s[8:11], s76 offen sc1
 buffer_load_dwordx4 v[76:79], v12, s[8:11], s76 offen offset:1024 sc1
 buffer_load_dwordx2 v[24:25], v13, s[8:11], s76 offen sc1
 s_mov_b64 exec, -1
 s_waitcnt vmcnt(3)
 v_max3_u32 v30, v72, v73, v74
 v_max3_u32 v31, v75, v76, v77
 v_max3_u32 v30, v30, v78, v79
 v_max3_u32 v31, v31, v24, v25
 v_max_u32 v30, v30, v31
 v_cmp_eq_u32 vcc, -1, v30
 s_cbranch_vccz late_done_158
 s_add_u32 s74, s74, 1
 s_cmp_lt_u32 s74, 0x40000
 s_cbranch_scc1 late_loop_157
 s_branch bail2
late_done_158:
 ds_write_b128 v12, v[72:75] offset:5120
 ds_write_b128 v12, v[76:79] offset:6144
 ds_write_b64 v13, v[24:25] offset:5120
 s_waitcnt vmcnt(0)
 s_branch late_152
.section .rodata,"a"
.p2align 6
.amdhsa_kernel adaLN_cond__memory_aug_recurrent_mem_tr__mixer_s_mlp__prompt_kernel
  .amdhsa_next_free_vgpr 512
  .amdhsa_next_free_sgpr 102
  .amdhsa_accum_offset 256
  .amdhsa_group_segment_fixed_size 0
  .amdhsa_kernarg_size 136
  .amdhsa_user_sgpr_count 2
  .amdhsa_user_sgpr_kernarg_segment_ptr 1
  .amdhsa_system_sgpr_workgroup_id_x 1
  .amdhsa_float_denorm_mode_32 3
.end_amdhsa_kernel
```
